```python
import torch

def _softmax(x, axis=-1):
    return torch.softmax(x, dim=axis)
def _gelu(x):
    return torch.nn.functional.gelu(x, approximate="tanh")
def _silu(x):
    return torch.nn.functional.silu(x)
def _sigmoid(x):
    return torch.sigmoid(x)
def _layernorm(x, axis=-1, eps=1e-5):
    m = x.mean(dim=axis, keepdim=True)
    v = x.var(dim=axis, keepdim=True, unbiased=False)
    return (x - m) / torch.sqrt(v + eps)
def _scatter_add(tgt, idx, src, axis=0):
    return tgt.clone().index_add_(axis, idx, src)
def _segment_sum(src, seg, n):
    out = torch.zeros((n,) + src.shape[1:], dtype=src.dtype)
    return out.index_add_(0, seg, src)
def _pad(x, pw):
    flat = tuple(v for pair in reversed(pw) for v in pair)
    return torch.nn.functional.pad(x, flat)

kernel_name = 'concat_heads__mha_block_cached__gqa_block_cached__near_ridge'

def setup_inputs():

    _w = (lambda a: (lambda t: t.to(torch.bfloat16) if t.is_floating_point() else t)(torch.as_tensor(a)))
    def _A_setup():
        B, Sq, D = 8, 288, 512
        H, Sk, Dh = 32, 1024, 128
        return {
            "x": _w((lambda *s: torch.randn(*s, dtype=torch.bfloat16) * 0.8)(B, Sq, D)),
            "k_cache": _w((lambda *s: torch.randn(*s, dtype=torch.bfloat16) * 0.8)(B, H, Sk, Dh)),
            "v_cache": _w((lambda *s: torch.randn(*s, dtype=torch.bfloat16) * 0.05)(B, H, Sk, Dh)),
            "wq": _w((lambda *s: torch.randn(*s, dtype=torch.bfloat16) * 0.8)(D, H * Dh) * (D ** -0.5)),
            "wo": _w((lambda *s: torch.randn(*s, dtype=torch.bfloat16) * 0.05)(H * Dh, D) * ((H * Dh) ** -0.5)),
        }
    _A_in = _A_setup()

    def _B_setup():
        B, Sq, D = 8, 288, 512
        Hq, Hkv, Sk, Dh = 32, 32, 1024, 128
        assert Hq % Hkv == 0, (Hq, Hkv)
        return {
            "x": _w((lambda *s: torch.randn(*s, dtype=torch.bfloat16) * 0.8)(B, Sq, D)),
            "k_cache": _w((lambda *s: torch.randn(*s, dtype=torch.bfloat16) * 0.8)(B, Hkv, Sk, Dh)),
            "v_cache": _w((lambda *s: torch.randn(*s, dtype=torch.bfloat16) * 0.05)(B, Hkv, Sk, Dh)),
            "wq": _w((lambda *s: torch.randn(*s, dtype=torch.bfloat16) * 0.8)(D, Hq * Dh) * (D ** -0.5)),
            "wo": _w((lambda *s: torch.randn(*s, dtype=torch.bfloat16) * 0.05)(Hq * Dh, D) * ((Hq * Dh) ** -0.5)),
        }
    _B_in = _B_setup()

    return {
        "A_x": _A_in["x"],
        "A_k_cache": _A_in["k_cache"],
        "A_v_cache": _A_in["v_cache"],
        "A_wq": _A_in["wq"],
        "A_wo": _A_in["wo"],
        "B_x": _B_in["x"],
        "B_k_cache": _B_in["k_cache"],
        "B_v_cache": _B_in["v_cache"],
        "B_wq": _B_in["wq"],
        "B_wo": _B_in["wo"],
    }

def reference(A_x, A_k_cache, A_v_cache, A_wq, A_wo, B_x, B_k_cache, B_v_cache, B_wq, B_wo):
    def _A_ref(x, k_cache, v_cache, wq, wo):
        B, Sq, D = x.shape
        H, Dh = 32, 128
        q = (lambda x, *d: x.permute(*d))((x @ wq).reshape(B, Sq, H, Dh), 0, 2, 1, 3)
        scores = torch.einsum("bhqd,bhkd->bhqk", q, k_cache) * (Dh ** -0.5)
        p = _softmax(scores, axis=-1)
        o = torch.einsum("bhqk,bhkd->bhqd", p, v_cache)
        return (lambda x, *d: x.permute(*d))(o, 0, 2, 1, 3).reshape(B, Sq, H * Dh) @ wo

    def _B_ref(x, k_cache, v_cache, wq, wo):
        B, Sq, D = x.shape
        Hq, Dh = 32, 128
        Hkv = k_cache.shape[1]
        rep = Hq // Hkv
        q = (lambda x, *d: x.permute(*d))((x @ wq).reshape(B, Sq, Hq, Dh), 0, 2, 1, 3)
        k = (lambda x, n, axis: torch.repeat_interleave(x, n, dim=axis))(k_cache, rep, axis=1)
        v = (lambda x, n, axis: torch.repeat_interleave(x, n, dim=axis))(v_cache, rep, axis=1)
        scores = torch.einsum("bhqd,bhkd->bhqk", q, k) * (Dh ** -0.5)
        p = _softmax(scores, axis=-1)
        o = torch.einsum("bhqk,bhkd->bhqd", p, v)
        return (lambda x, *d: x.permute(*d))(o, 0, 2, 1, 3).reshape(B, Sq, Hq * Dh) @ wo

    a = _A_ref(A_x, A_k_cache, A_v_cache, A_wq, A_wo)
    b = _B_ref(B_x, B_k_cache, B_v_cache, B_wq, B_wo)
    return torch.concatenate([a, b], axis=-1)
```

```asm
; @launch grid=(256,1,1) block=(256,1,1) lds=163840
.amdgcn_target "amdgcn-amd-amdhsa--gfx950"
.text
.globl concat_heads__mha_block_cached__gqa_block_cached__near_ridge_kernel
.p2align 8
.type concat_heads__mha_block_cached__gqa_block_cached__near_ridge_kernel,@function
concat_heads__mha_block_cached__gqa_block_cached__near_ridge_kernel:
    s_cmp_ge_u32 s2, 256
    s_cbranch_scc1 concat_heads__mha_block_cached__gqa_block_cached__near_ridge_kernel_end
    s_load_dwordx16 s[40:55], s[0:1], 0
    s_load_dwordx4 s[56:59], s[0:1], 64
    s_getpc_b64 s[92:93]
L_pc:
    s_mov_b32 s94, L_last-L_pc
    s_mov_b32 s95, 0x20000
    v_lshlrev_b32 v6, 7, v0
    s_and_b32 s35, s2, 24
    s_lshl_b32 s35, s35, 12
    buffer_load_dword v247, v6, s[92:95], s35 offen
    s_load_dwordx2 s[60:61], s[0:1], 80
    s_load_dwordx2 s[70:71], s[0:1], 88
    s_load_dwordx2 s[64:65], s[0:1], 96
    s_and_b32 s3, s2, 4
    s_lshl_b32 s3, s3, 1
    s_lshr_b32 s35, s2, 3
    s_and_b32 s35, s35, 7
    s_add_u32 s3, s3, s35
    s_and_b32 s62, s2, 3
    s_lshl_b32 s62, s62, 2
    s_lshr_b32 s36, s2, 6
    s_add_u32 s62, s62, s36
    s_lshl_b32 s36, s36, 1
    s_add_u32 s73, s35, s36
    s_and_b32 s73, s73, 7
    s_and_b32 s63, s3, 7
    v_lshrrev_b32 v1, 6, v0
    v_and_b32 v0, 63, v0
    v_readfirstlane_b32 s28, v1
    v_and_b32 v2, 15, v0
    v_lshrrev_b32 v3, 4, v0
    v_lshrrev_b32 v4, 2, v2
    v_and_b32 v5, 3, v2
    s_waitcnt lgkmcnt(0)
    s_cmp_ge_u32 s3, 8
    s_cselect_b64 s[40:41], s[50:51], s[40:41]
    s_cselect_b64 s[42:43], s[52:53], s[42:43]
    s_cselect_b64 s[44:45], s[54:55], s[44:45]
    s_cselect_b64 s[46:47], s[56:57], s[46:47]
    s_mul_i32 s35, s63, 294912
    s_add_u32 s12, s40, s35
    s_addc_u32 s13, s41, 0
    s_mov_b32 s14, 294912
    s_mov_b32 s15, 0x20000
    s_lshl_b32 s35, s62, 9
    s_sub_u32 s36, 4194304, s35
    s_add_u32 s16, s46, s35
    s_addc_u32 s17, s47, 0
    s_mov_b32 s18, s36
    s_mov_b32 s19, 0x20000
    s_lshl_b32 s37, s28, 10
    s_lshl_b32 s29, s28, 12
    v_lshrrev_b32 v6, 3, v0
    v_lshlrev_b32 v6, 10, v6
    v_and_b32 v7, 1, v1
    v_lshlrev_b32 v7, 2, v7
    v_add_u32 v7, v7, v3
    v_and_b32 v8, 7, v0
    v_xor_b32 v7, v7, v8
    v_lshl_add_u32 v6, v7, 4, v6
    v_lshl_add_u32 v240, v1, 13, v6
    v_lshlrev_b32 v6, 2, v3
    v_xor_b32 v6, v6, v2
    v_lshlrev_b32 v6, 4, v6
    v_lshl_add_u32 v6, v3, 13, v6
    v_lshl_add_u32 v241, v1, 15, v6
    s_and_b32 s73, s73, 0
    s_lshl_b32 s38, s73, 7
    s_lshl_b32 s39, s73, 19
    s_add_u32 m0, s37, 61440
    s_add_u32 s35, s39, 0
    buffer_load_dwordx4 v241, s[16:19], s35 offen lds
    s_add_u32 m0, s37, 24576
    s_add_u32 s35, s38, 0
    buffer_load_dwordx4 v240, s[12:15], s35 offen lds
    s_add_u32 m0, s37, 65536
    s_add_u32 s35, s39, 131072
    buffer_load_dwordx4 v241, s[16:19], s35 offen lds
    s_add_u32 m0, s37, 28672
    s_add_u32 s35, s38, 32768
    buffer_load_dwordx4 v240, s[12:15], s35 offen lds
    s_add_u32 m0, s37, 69632
    s_add_u32 s35, s39, 262144
    buffer_load_dwordx4 v241, s[16:19], s35 offen lds
    s_add_u32 m0, s37, 32768
    s_add_u32 s35, s38, 65536
    buffer_load_dwordx4 v240, s[12:15], s35 offen lds
    s_add_u32 m0, s37, 73728
    s_add_u32 s35, s39, 393216
    buffer_load_dwordx4 v241, s[16:19], s35 offen lds
    s_add_u32 m0, s37, 36864
    s_add_u32 s35, s38, 98304
    buffer_load_dwordx4 v240, s[12:15], s35 offen lds
    s_add_u32 m0, s37, 40960
    s_add_u32 s35, s38, 131072
    buffer_load_dwordx4 v240, s[12:15], s35 offen lds
    v_lshrrev_b32 v242, 1, v1
    v_lshlrev_b32 v38, 4, v0
    v_xor_b32 v6, 0, v242
    v_lshl_add_u32 v6, v6, 5, v2
    v_lshlrev_b32 v6, 8, v6
    v_lshlrev_b32 v7, 1, v242
    v_xor_b32 v7, 0, v7
    v_lshl_add_u32 v7, v7, 2, v3
    v_xor_b32 v7, v7, v2
    v_lshl_add_u32 v8, v7, 4, v6
    v_lshlrev_b32 v7, 1, v242
    v_xor_b32 v7, 1, v7
    v_lshl_add_u32 v7, v7, 2, v3
    v_xor_b32 v7, v7, v2
    v_lshl_add_u32 v10, v7, 4, v6
    v_lshlrev_b32 v7, 1, v242
    v_xor_b32 v7, 2, v7
    v_lshl_add_u32 v7, v7, 2, v3
    v_xor_b32 v7, v7, v2
    v_lshl_add_u32 v12, v7, 4, v6
    s_add_u32 m0, s37, 45056
    s_add_u32 s35, s38, 163840
    buffer_load_dwordx4 v240, s[12:15], s35 offen lds
    v_lshlrev_b32 v7, 1, v242
    v_xor_b32 v7, 3, v7
    v_lshl_add_u32 v7, v7, 2, v3
    v_xor_b32 v7, v7, v2
    v_lshl_add_u32 v14, v7, 4, v6
    v_xor_b32 v6, 1, v242
    v_lshl_add_u32 v6, v6, 5, v2
    v_lshlrev_b32 v6, 8, v6
    v_lshlrev_b32 v7, 1, v242
    v_xor_b32 v7, 0, v7
    v_lshl_add_u32 v7, v7, 2, v3
    v_xor_b32 v7, v7, v2
    v_lshl_add_u32 v9, v7, 4, v6
    v_lshlrev_b32 v7, 1, v242
    v_xor_b32 v7, 1, v7
    v_lshl_add_u32 v7, v7, 2, v3
    v_xor_b32 v7, v7, v2
    v_lshl_add_u32 v11, v7, 4, v6
    v_lshlrev_b32 v7, 1, v242
    v_xor_b32 v7, 2, v7
    s_add_u32 m0, s37, 49152
    s_add_u32 s35, s38, 196608
    buffer_load_dwordx4 v240, s[12:15], s35 offen lds
    v_lshl_add_u32 v7, v7, 2, v3
    v_xor_b32 v7, v7, v2
    v_lshl_add_u32 v13, v7, 4, v6
    v_lshlrev_b32 v7, 1, v242
    v_xor_b32 v7, 3, v7
    v_lshl_add_u32 v7, v7, 2, v3
    v_xor_b32 v7, v7, v2
    v_lshl_add_u32 v15, v7, 4, v6
    v_and_b32 v243, 1, v3
    v_lshl_add_u32 v243, v243, 2, v4
    v_lshlrev_b32 v7, 2, v242
    v_xor_b32 v243, v243, v7
    v_xor_b32 v6, 0, v242
    v_lshlrev_b32 v6, 5, v6
    v_lshl_add_u32 v6, v3, 2, v6
    v_add_u32 v6, v6, v4
    v_lshlrev_b32 v6, 8, v6
    v_lshl_add_u32 v6, v5, 3, v6
    v_add_u32 v6, 0x10000, v6
    s_add_u32 m0, s37, 53248
    s_add_u32 s35, s38, 229376
    buffer_load_dwordx4 v240, s[12:15], s35 offen lds
    v_xor_b32 v7, 0, v243
    v_lshl_add_u32 v16, v7, 5, v6
    v_xor_b32 v7, 1, v243
    v_lshl_add_u32 v18, v7, 5, v6
    v_xor_b32 v7, 2, v243
    v_lshl_add_u32 v20, v7, 5, v6
    v_xor_b32 v7, 3, v243
    v_lshl_add_u32 v22, v7, 5, v6
    v_xor_b32 v7, 4, v243
    v_lshl_add_u32 v24, v7, 5, v6
    v_xor_b32 v7, 5, v243
    v_lshl_add_u32 v26, v7, 5, v6
    v_xor_b32 v7, 6, v243
    v_lshl_add_u32 v28, v7, 5, v6
    v_xor_b32 v7, 7, v243
    v_lshl_add_u32 v30, v7, 5, v6
    v_xor_b32 v6, 1, v242
    v_lshlrev_b32 v6, 5, v6
    v_lshl_add_u32 v6, v3, 2, v6
    v_add_u32 v6, v6, v4
    s_add_u32 m0, s37, 57344
    s_add_u32 s35, s38, 262144
    buffer_load_dwordx4 v240, s[12:15], s35 offen lds
    v_lshlrev_b32 v6, 8, v6
    v_lshl_add_u32 v6, v5, 3, v6
    v_add_u32 v6, 0x10000, v6
    v_xor_b32 v7, 0, v243
    v_lshl_add_u32 v17, v7, 5, v6
    v_xor_b32 v7, 1, v243
    v_lshl_add_u32 v19, v7, 5, v6
    v_xor_b32 v7, 2, v243
    v_lshl_add_u32 v21, v7, 5, v6
    v_xor_b32 v7, 3, v243
    v_lshl_add_u32 v23, v7, 5, v6
    v_xor_b32 v7, 4, v243
    v_lshl_add_u32 v25, v7, 5, v6
    v_xor_b32 v7, 5, v243
    v_lshl_add_u32 v27, v7, 5, v6
    v_xor_b32 v7, 6, v243
    v_lshl_add_u32 v29, v7, 5, v6
    v_xor_b32 v7, 7, v243
    v_lshl_add_u32 v31, v7, 5, v6
    s_add_u32 m0, s37, 77824
    s_add_u32 s35, s39, 256
    buffer_load_dwordx4 v241, s[16:19], s35 offen lds
    v_add_u32 v7, 0, v3
    v_xor_b32 v7, v7, v2
    v_lshlrev_b32 v7, 4, v7
    v_lshl_add_u32 v32, v3, 8, v7
    v_add_u32 v7, 4, v3
    v_xor_b32 v7, v7, v2
    v_lshlrev_b32 v7, 4, v7
    v_lshl_add_u32 v33, v3, 8, v7
    v_add_u32 v7, 8, v3
    v_xor_b32 v7, v7, v2
    v_lshlrev_b32 v7, 4, v7
    v_lshl_add_u32 v34, v3, 8, v7
    v_add_u32 v7, 12, v3
    v_xor_b32 v7, v7, v2
    v_lshlrev_b32 v7, 4, v7
    v_lshl_add_u32 v35, v3, 8, v7
    v_add_u32 v7, 0, v3
    v_lshlrev_b32 v7, 1, v7
    v_xor_b32 v7, v7, v2
    v_lshlrev_b32 v7, 4, v7
    s_add_u32 m0, s37, 81920
    s_add_u32 s35, s39, 131328
    buffer_load_dwordx4 v241, s[16:19], s35 offen lds
    v_lshl_add_u32 v36, v3, 8, v7
    v_add_u32 v7, 4, v3
    v_lshlrev_b32 v7, 1, v7
    v_xor_b32 v7, v7, v2
    v_lshlrev_b32 v7, 4, v7
    v_lshl_add_u32 v37, v3, 8, v7
    v_lshl_add_u32 v6, v1, 13, v38
    v_add_u32 v39, 131072, v6
    v_lshrrev_b32 v244, 1, v2
    v_add_u32 v7, 0, v3
    v_xor_b32 v7, v7, v244
    v_lshlrev_b32 v7, 4, v7
    v_lshl_add_u32 v7, v2, 7, v7
    v_lshl_add_u32 v6, v1, 13, v7
    v_add_u32 v224, 24576, v6
    v_add_u32 v225, 94208, v6
    v_and_b32 v6, 1, v1
    v_lshl_add_u32 v6, v6, 11, v7
    v_add_u32 v228, 57344, v6
    s_add_u32 m0, s37, 86016
    s_add_u32 s35, s39, 262400
    buffer_load_dwordx4 v241, s[16:19], s35 offen lds
    v_add_u32 v229, 126976, v6
    v_add_u32 v7, 4, v3
    v_xor_b32 v7, v7, v244
    v_lshlrev_b32 v7, 4, v7
    v_lshl_add_u32 v7, v2, 7, v7
    v_lshl_add_u32 v6, v1, 13, v7
    v_add_u32 v226, 24576, v6
    v_add_u32 v227, 94208, v6
    v_and_b32 v6, 1, v1
    v_lshl_add_u32 v6, v6, 11, v7
    v_add_u32 v230, 57344, v6
    v_add_u32 v231, 126976, v6
    v_lshl_add_u32 v6, v3, 3, v4
    v_lshlrev_b32 v6, 8, v6
    v_lshl_add_u32 v6, v5, 4, v6
    v_lshlrev_b32 v7, 1, v242
    v_xor_b32 v7, 0, v7
    v_xor_b32 v7, v7, v4
    v_lshl_add_u32 v7, v7, 6, v6
    v_add_u32 v232, 61440, v7
    s_add_u32 m0, s37, 90112
    s_add_u32 s35, s39, 393472
    buffer_load_dwordx4 v241, s[16:19], s35 offen lds
    s_add_u32 s38, s38, 128
    s_add_u32 s39, s39, 524288
    s_and_b32 s38, s38, 1023
    s_and_b32 s39, s39, 4194303
    v_add_u32 v233, 131072, v7
    v_lshlrev_b32 v7, 1, v242
    v_xor_b32 v7, 1, v7
    v_xor_b32 v7, v7, v4
    v_lshl_add_u32 v7, v7, 6, v6
    v_add_u32 v234, 61440, v7
    v_add_u32 v235, 131072, v7
    v_lshlrev_b32 v7, 1, v242
    v_xor_b32 v7, 2, v7
    v_xor_b32 v7, v7, v4
    v_lshl_add_u32 v7, v7, 6, v6
    v_add_u32 v236, 61440, v7
    v_add_u32 v237, 131072, v7
    v_lshlrev_b32 v7, 1, v242
    v_xor_b32 v7, 3, v7
    v_xor_b32 v7, v7, v4
    v_lshl_add_u32 v7, v7, 6, v6
    v_add_u32 v238, 61440, v7
    v_add_u32 v239, 131072, v7
    v_mov_b32 v7, 0x1000000
    s_and_b32 s35, s62, 3
    s_lshl_b32 s35, s35, 2
    s_add_u32 s35, s35, s28
    s_mul_i32 s35, s35, 18432
    v_lshlrev_b32 v6, 10, v0
    v_add_u32 v6, s35, v6
    v_cmp_le_u32 vcc, 18, v0
    s_nop 1
    v_cndmask_b32 v244, v6, v7, vcc
    s_lshl_b32 s35, s63, 16
    s_lshl_b32 s36, s28, 14
    s_add_u32 s35, s35, s36
    v_lshlrev_b32 v6, 13, v4
    v_lshl_add_u32 v6, v5, 7, v6
    v_add_u32 v6, s35, v6
    v_cmp_le_u32 vcc, 8, v0
    s_nop 1
    v_cndmask_b32 v245, v6, v7, vcc
    buffer_load_dword v247, v244, s[12:15], s38 offen offset:0
    s_add_u32 s35, s39, 0
    buffer_load_dword v247, v245, s[16:19], s35 offen
    buffer_load_dword v247, v244, s[12:15], s38 offen offset:128
    s_add_u32 s35, s39, 524288
    buffer_load_dword v247, v245, s[16:19], s35 offen
    s_lshl_b32 s35, s63, 4
    s_add_u32 s35, s35, s62
    s_lshl_b32 s35, s35, 19
    s_add_u32 s4, s42, s35
    s_addc_u32 s5, s43, 0
    s_mov_b32 s6, 524288
    s_mov_b32 s7, 0x20000
    s_add_u32 s8, s44, s35
    s_addc_u32 s9, s45, 0
    s_mov_b32 s10, 524288
    s_mov_b32 s11, 0x20000
    s_mul_i32 s35, s3, 2359296
    s_add_u32 s20, s64, s35
    s_addc_u32 s21, s65, 0
    s_mov_b32 s22, 2359296
    s_mov_b32 s23, 0x20000
    s_cmp_ge_u32 s3, 8
    s_cselect_b64 s[48:49], s[58:59], s[48:49]
    s_mov_b32 s30, s29
    s_mov_b32 s31, s29
    s_lshl_b32 s35, s3, 2
    s_add_u32 s35, s35, 128
    s_add_u32 s92, s70, s35
    s_addc_u32 s93, s71, 0
    s_mov_b32 s94, 4
    s_mov_b32 s95, 0x20000
    s_mov_b32 s66, 0x3e0293ee
    s_mov_b32 s72, 0x53800000
    s_mov_b32 s33, 0
    s_mov_b32 s34, 0
    s_mul_i32 s36, s62, 73728
    s_lshr_b32 s50, s62, 2
    s_xor_b32 s89, s50, 3
    s_lshl_b32 s89, s89, 1
    s_and_b32 s35, s62, 7
    s_cmp_eq_u32 s35, 7
    s_cselect_b32 s91, 2, 0
    s_xor_b32 s91, s91, s89
    s_lshl_b32 s35, s28, 2
    s_add_u32 s35, s35, 0
    s_cmp_ge_u32 s35, 9
    s_cselect_b32 s53, 9, 0
    s_sub_u32 s35, s35, s53
    s_xor_b32 s32, s35, s91
    s_cmp_ge_u32 s32, 6
    s_addc_u32 s32, s32, 0
    s_cmp_eq_u32 s35, 8
    s_cselect_b32 s32, 6, s32
    s_add_u32 s32, s32, s53
    s_lshl_b32 s32, s32, 10
    s_add_u32 s74, s32, s36
    s_xor_b32 s32, s35, s89
    s_cmp_ge_u32 s32, 6
    s_addc_u32 s32, s32, 0
    s_cmp_eq_u32 s35, 8
    s_cselect_b32 s32, 6, s32
    s_add_u32 s32, s32, s53
    s_lshl_b32 s32, s32, 10
    s_add_u32 s100, s32, s36
    s_lshl_b32 s35, s28, 2
    s_add_u32 s35, s35, 1
    s_cmp_ge_u32 s35, 9
    s_cselect_b32 s53, 9, 0
    s_sub_u32 s35, s35, s53
    s_xor_b32 s32, s35, s91
    s_cmp_ge_u32 s32, 6
    s_addc_u32 s32, s32, 0
    s_cmp_eq_u32 s35, 8
    s_cselect_b32 s32, 6, s32
    s_add_u32 s32, s32, s53
    s_lshl_b32 s32, s32, 10
    s_add_u32 s75, s32, s36
    s_xor_b32 s32, s35, s89
    s_cmp_ge_u32 s32, 6
    s_addc_u32 s32, s32, 0
    s_cmp_eq_u32 s35, 8
    s_cselect_b32 s32, 6, s32
    s_add_u32 s32, s32, s53
    s_lshl_b32 s32, s32, 10
    s_add_u32 s101, s32, s36
    s_lshl_b32 s35, s28, 2
    s_add_u32 s35, s35, 2
    s_cmp_ge_u32 s35, 9
    s_cselect_b32 s53, 9, 0
    s_sub_u32 s35, s35, s53
    s_xor_b32 s32, s35, s91
    s_cmp_ge_u32 s32, 6
    s_addc_u32 s32, s32, 0
    s_cmp_eq_u32 s35, 8
    s_cselect_b32 s32, 6, s32
    s_add_u32 s32, s32, s53
    s_lshl_b32 s32, s32, 10
    s_add_u32 s0, s32, s36
    s_xor_b32 s32, s35, s89
    s_cmp_ge_u32 s32, 6
    s_addc_u32 s32, s32, 0
    s_cmp_eq_u32 s35, 8
    s_cselect_b32 s32, 6, s32
    s_add_u32 s32, s32, s53
    s_lshl_b32 s32, s32, 10
    s_add_u32 s67, s32, s36
    s_lshl_b32 s35, s28, 2
    s_add_u32 s35, s35, 3
    s_cmp_ge_u32 s35, 9
    s_cselect_b32 s53, 9, 0
    s_sub_u32 s35, s35, s53
    s_xor_b32 s32, s35, s91
    s_cmp_ge_u32 s32, 6
    s_addc_u32 s32, s32, 0
    s_cmp_eq_u32 s35, 8
    s_cselect_b32 s32, 6, s32
    s_add_u32 s32, s32, s53
    s_lshl_b32 s32, s32, 10
    s_add_u32 s1, s32, s36
    s_xor_b32 s32, s35, s89
    s_cmp_ge_u32 s32, 6
    s_addc_u32 s32, s32, 0
    s_cmp_eq_u32 s35, 8
    s_cselect_b32 s32, 6, s32
    s_add_u32 s32, s32, s53
    s_lshl_b32 s32, s32, 10
    s_add_u32 s70, s32, s36
    s_and_b32 s35, s28, 1
    s_add_u32 s35, s35, 16
    s_cmp_ge_u32 s35, 9
    s_cselect_b32 s53, 9, 0
    s_sub_u32 s35, s35, s53
    s_xor_b32 s32, s35, s91
    s_cmp_ge_u32 s32, 6
    s_addc_u32 s32, s32, 0
    s_cmp_eq_u32 s35, 8
    s_cselect_b32 s32, 6, s32
    s_add_u32 s32, s32, s53
    s_lshl_b32 s32, s32, 10
    s_add_u32 s73, s32, s36
    s_xor_b32 s32, s35, s89
    s_cmp_ge_u32 s32, 6
    s_addc_u32 s32, s32, 0
    s_cmp_eq_u32 s35, 8
    s_cselect_b32 s32, 6, s32
    s_add_u32 s32, s32, s53
    s_lshl_b32 s32, s32, 10
    s_add_u32 s71, s32, s36
    s_lshr_b32 s35, s28, 1
    s_mul_i32 s68, s35, 36864
    s_sub_u32 s69, 36864, s68
    s_lshl_b32 s35, s3, 13
    s_add_u32 s35, s35, 83886080
    s_add_u32 s96, s64, s35
    s_addc_u32 s97, s65, 0
    s_mov_b32 s98, 8192
    s_mov_b32 s99, 0x20000
    v_lshl_add_u32 v6, v1, 6, v0
    v_lshlrev_b32 v6, 7, v6
    v_add_u32 v7, 0x7fe80, v6
    v_and_b32 v7, 0x80000, v7
    v_add_u32 v6, v6, v7
    s_lshl_b32 s35, s62, 9
    v_mov_b32 v7, 0
    buffer_store_dword v7, v6, s[96:99], s35 offen sc1
    s_add_u32 s24, s48, 0
    s_addc_u32 s25, s49, 0
    s_mov_b32 s26, 4194304
    s_mov_b32 s27, 0x20000
    s_lshl_b32 s35, s63, 4
    s_add_u32 s35, s35, s62
    s_lshl_b32 s35, s35, 2
    s_add_u32 s35, s35, s28
    s_lshl_b32 s90, s35, 13
    s_add_u32 s56, s48, s90
    s_addc_u32 s57, s49, 0
    s_mov_b32 s58, 8192
    s_mov_b32 s59, 0x20000
    s_mov_b32 s55, 0
    v_lshlrev_b32 v246, 7, v0
    v_cmp_le_u32 vcc, 10, v0
    v_mov_b32 v6, 0x100000
    s_nop 0
    v_cndmask_b32 v246, v246, v6, vcc
    s_lshr_b32 s50, s62, 2
    s_and_b32 s51, s62, 3
    s_mul_i32 s44, s28, 9216
    s_lshl_b32 s49, s51, 8
    s_lshl_b32 s35, s28, 14
    s_add_u32 s49, s49, s35
    s_and_b32 s48, s62, 12
    s_add_u32 s35, s51, 0
    s_and_b32 s35, s35, 3
    s_add_u32 s35, s35, s48
    s_mul_i32 s36, s35, 73728
    s_add_u32 s84, s36, s44
    s_lshl_b32 s36, s35, 18
    s_add_u32 s40, s36, s49
    s_add_u32 s35, s51, 1
    s_and_b32 s35, s35, 3
    s_add_u32 s35, s35, s48
    s_mul_i32 s36, s35, 73728
    s_add_u32 s85, s36, s44
    s_lshl_b32 s36, s35, 18
    s_add_u32 s41, s36, s49
    s_add_u32 s35, s51, 2
    s_and_b32 s35, s35, 3
    s_add_u32 s35, s35, s48
    s_mul_i32 s36, s35, 73728
    s_add_u32 s86, s36, s44
    s_lshl_b32 s36, s35, 18
    s_add_u32 s42, s36, s49
    s_add_u32 s35, s51, 3
    s_and_b32 s35, s35, 3
    s_add_u32 s35, s35, s48
    s_mul_i32 s36, s35, 73728
    s_add_u32 s87, s36, s44
    s_lshl_b32 s36, s35, 18
    s_add_u32 s43, s36, s49
    s_lshr_b32 s49, s3, 3
    s_lshl_b32 s49, s49, 10
    s_lshl_b32 s35, s51, 8
    s_add_u32 s49, s49, s35
    s_xor_b32 s35, s50, 3
    s_mul_i32 s35, s35, 61440
    s_add_u32 s35, s35, 0
    s_add_u32 s45, s35, s29
    s_xor_b32 s35, s50, 2
    s_mul_i32 s35, s35, 61440
    s_add_u32 s35, s35, 20480
    s_add_u32 s46, s35, s29
    s_xor_b32 s35, s50, 1
    s_mul_i32 s35, s35, 61440
    s_add_u32 s35, s35, 40960
    s_add_u32 s47, s35, s29
    s_mul_i32 s48, s50, 61440
    s_waitcnt lgkmcnt(15)
    s_waitcnt vmcnt(9)
    s_barrier
    ds_read_b64_tr_b16 a[208:209], v232 offset:0
    ds_read_b64_tr_b16 a[210:211], v232 offset:1024
    ds_read_b128 a[128:131], v224 offset:0
    ds_read_b64_tr_b16 a[212:213], v232 offset:8192
    ds_read_b64_tr_b16 a[214:215], v232 offset:9216
    ds_read_b128 a[132:135], v226 offset:0
    ds_read_b128 a[136:139], v224 offset:2048
    ds_read_b128 a[140:143], v226 offset:2048
    ds_read_b128 a[144:147], v224 offset:4096
    ds_read_b128 a[148:151], v226 offset:4096
    ds_read_b128 a[152:155], v224 offset:6144
    ds_read_b128 a[156:159], v226 offset:6144
    ds_read_b128 a[160:163], v228 offset:0
    ds_read_b128 a[164:167], v230 offset:0
    ds_read_b64_tr_b16 a[216:217], v232 offset:8
    s_waitcnt lgkmcnt(7)
    ds_read_b64_tr_b16 a[218:219], v232 offset:1032
    s_waitcnt lgkmcnt(15)
    v_mfma_f32_16x16x32_bf16 v[64:67], a[208:211], a[128:131], 0
    ds_read_b64_tr_b16 a[220:221], v232 offset:8200
    s_add_u32 m0, s37, 131072
    v_mfma_f32_16x16x32_bf16 v[64:67], a[212:215], a[132:135], v[64:67]
    ds_read_b64_tr_b16 a[222:223], v232 offset:9224
    s_add_u32 s35, s39, 0
    v_mfma_f32_16x16x32_bf16 v[72:75], a[212:215], a[140:143], 0
    v_mfma_f32_16x16x32_bf16 v[72:75], a[208:211], a[136:139], v[72:75]
    s_waitcnt lgkmcnt(8)
    v_mfma_f32_16x16x32_bf16 v[80:83], a[208:211], a[144:147], 0
    ds_read_b64_tr_b16 a[224:225], v234 offset:0
    v_mfma_f32_16x16x32_bf16 v[80:83], a[212:215], a[148:151], v[80:83]
    ds_read_b64_tr_b16 a[226:227], v234 offset:1024
    s_waitcnt lgkmcnt(8)
    v_mfma_f32_16x16x32_bf16 v[88:91], a[212:215], a[156:159], 0
    ds_read_b64_tr_b16 a[228:229], v234 offset:8192
    v_mfma_f32_16x16x32_bf16 v[88:91], a[208:211], a[152:155], v[88:91]
    ds_read_b64_tr_b16 a[230:231], v234 offset:9216
    s_waitcnt lgkmcnt(8)
    v_mfma_f32_16x16x32_bf16 v[192:195], a[208:211], a[160:163], 0
    buffer_load_dwordx4 v241, s[16:19], s35 offen lds
    v_mfma_f32_16x16x32_bf16 v[192:195], a[212:215], a[164:167], v[192:195]
    s_add_u32 m0, s37, 94208
    s_waitcnt lgkmcnt(4)
    v_mfma_f32_16x16x32_bf16 v[68:71], a[216:219], a[128:131], 0
    s_add_u32 s35, s38, 0
    v_mfma_f32_16x16x32_bf16 v[68:71], a[220:223], a[132:135], v[68:71]
    v_mfma_f32_16x16x32_bf16 v[76:79], a[220:223], a[140:143], 0
    buffer_load_dwordx4 v240, s[12:15], s35 offen lds
    v_mfma_f32_16x16x32_bf16 v[76:79], a[216:219], a[136:139], v[76:79]
    s_add_u32 m0, s37, 135168
    v_mfma_f32_16x16x32_bf16 v[84:87], a[216:219], a[144:147], 0
    ds_read_b64_tr_b16 a[232:233], v234 offset:8
    s_add_u32 s35, s39, 131072
    v_mfma_f32_16x16x32_bf16 v[84:87], a[220:223], a[148:151], v[84:87]
    ds_read_b64_tr_b16 a[234:235], v234 offset:1032
    v_mfma_f32_16x16x32_bf16 v[92:95], a[220:223], a[156:159], 0
    buffer_load_dwordx4 v241, s[16:19], s35 offen lds
    v_mfma_f32_16x16x32_bf16 v[92:95], a[216:219], a[152:155], v[92:95]
    ds_read_b64_tr_b16 a[236:237], v234 offset:8200
    s_add_u32 m0, s37, 98304
    v_mfma_f32_16x16x32_bf16 v[196:199], a[216:219], a[160:163], 0
    ds_read_b64_tr_b16 a[238:239], v234 offset:9224
    s_add_u32 s35, s38, 32768
    v_mfma_f32_16x16x32_bf16 v[196:199], a[220:223], a[164:167], v[196:199]
    s_waitcnt lgkmcnt(4)
    v_mfma_f32_16x16x32_bf16 v[96:99], a[224:227], a[128:131], 0
    buffer_load_dwordx4 v240, s[12:15], s35 offen lds
    v_mfma_f32_16x16x32_bf16 v[96:99], a[228:231], a[132:135], v[96:99]
    s_add_u32 m0, s37, 139264
    v_mfma_f32_16x16x32_bf16 v[104:107], a[228:231], a[140:143], 0
    s_add_u32 s35, s39, 262144
    v_mfma_f32_16x16x32_bf16 v[104:107], a[224:227], a[136:139], v[104:107]
    v_mfma_f32_16x16x32_bf16 v[112:115], a[224:227], a[144:147], 0
    buffer_load_dwordx4 v241, s[16:19], s35 offen lds
    v_mfma_f32_16x16x32_bf16 v[112:115], a[228:231], a[148:151], v[112:115]
    ds_read_b64_tr_b16 a[208:209], v236 offset:0
    s_add_u32 m0, s37, 102400
    v_mfma_f32_16x16x32_bf16 v[120:123], a[228:231], a[156:159], 0
    ds_read_b64_tr_b16 a[210:211], v236 offset:1024
    s_add_u32 s35, s38, 65536
    v_mfma_f32_16x16x32_bf16 v[120:123], a[224:227], a[152:155], v[120:123]
    ds_read_b64_tr_b16 a[212:213], v236 offset:8192
    s_waitcnt lgkmcnt(3)
    v_mfma_f32_16x16x32_bf16 v[200:203], a[224:227], a[160:163], 0
    buffer_load_dwordx4 v240, s[12:15], s35 offen lds
    v_mfma_f32_16x16x32_bf16 v[200:203], a[228:231], a[164:167], v[200:203]
    ds_read_b64_tr_b16 a[214:215], v236 offset:9216
    s_add_u32 m0, s37, 143360
    v_mfma_f32_16x16x32_bf16 v[100:103], a[232:235], a[128:131], 0
    s_add_u32 s35, s39, 393216
    v_mfma_f32_16x16x32_bf16 v[100:103], a[236:239], a[132:135], v[100:103]
    v_mfma_f32_16x16x32_bf16 v[108:111], a[236:239], a[140:143], 0
    buffer_load_dwordx4 v241, s[16:19], s35 offen lds
    v_mfma_f32_16x16x32_bf16 v[108:111], a[232:235], a[136:139], v[108:111]
    ds_read_b64_tr_b16 a[216:217], v236 offset:8
    s_add_u32 m0, s37, 106496
    v_mfma_f32_16x16x32_bf16 v[116:119], a[232:235], a[144:147], 0
    ds_read_b64_tr_b16 a[218:219], v236 offset:1032
    s_add_u32 s35, s38, 98304
    v_mfma_f32_16x16x32_bf16 v[116:119], a[236:239], a[148:151], v[116:119]
    ds_read_b64_tr_b16 a[220:221], v236 offset:8200
    v_mfma_f32_16x16x32_bf16 v[124:127], a[236:239], a[156:159], 0
    buffer_load_dwordx4 v240, s[12:15], s35 offen lds
    v_mfma_f32_16x16x32_bf16 v[124:127], a[232:235], a[152:155], v[124:127]
    ds_read_b64_tr_b16 a[222:223], v236 offset:9224
    s_add_u32 m0, s37, 147456
    v_mfma_f32_16x16x32_bf16 v[204:207], a[232:235], a[160:163], 0
    s_add_u32 s35, s39, 256
    v_mfma_f32_16x16x32_bf16 v[204:207], a[236:239], a[164:167], v[204:207]
    s_waitcnt lgkmcnt(4)
    v_mfma_f32_16x16x32_bf16 v[128:131], a[208:211], a[128:131], 0
    buffer_load_dwordx4 v241, s[16:19], s35 offen lds
    v_mfma_f32_16x16x32_bf16 v[128:131], a[212:215], a[132:135], v[128:131]
    ds_read_b64_tr_b16 a[224:225], v238 offset:0
    s_add_u32 m0, s37, 110592
    v_mfma_f32_16x16x32_bf16 v[136:139], a[212:215], a[140:143], 0
    ds_read_b64_tr_b16 a[226:227], v238 offset:1024
    s_add_u32 s35, s38, 131072
    v_mfma_f32_16x16x32_bf16 v[136:139], a[208:211], a[136:139], v[136:139]
    ds_read_b64_tr_b16 a[228:229], v238 offset:8192
    v_mfma_f32_16x16x32_bf16 v[144:147], a[208:211], a[144:147], 0
    buffer_load_dwordx4 v240, s[12:15], s35 offen lds
    v_mfma_f32_16x16x32_bf16 v[144:147], a[212:215], a[148:151], v[144:147]
    ds_read_b64_tr_b16 a[230:231], v238 offset:9216
    s_add_u32 m0, s37, 151552
    v_mfma_f32_16x16x32_bf16 v[152:155], a[212:215], a[156:159], 0
    s_add_u32 s35, s39, 131328
    v_mfma_f32_16x16x32_bf16 v[152:155], a[208:211], a[152:155], v[152:155]
    s_waitcnt lgkmcnt(4)
    v_mfma_f32_16x16x32_bf16 v[132:135], a[216:219], a[128:131], 0
    buffer_load_dwordx4 v241, s[16:19], s35 offen lds
    v_mfma_f32_16x16x32_bf16 v[132:135], a[220:223], a[132:135], v[132:135]
    ds_read_b64_tr_b16 a[232:233], v238 offset:8
    s_add_u32 m0, s37, 114688
    v_mfma_f32_16x16x32_bf16 v[140:143], a[220:223], a[140:143], 0
    ds_read_b64_tr_b16 a[234:235], v238 offset:1032
    s_add_u32 s35, s38, 163840
    v_mfma_f32_16x16x32_bf16 v[140:143], a[216:219], a[136:139], v[140:143]
    ds_read_b64_tr_b16 a[236:237], v238 offset:8200
    v_mfma_f32_16x16x32_bf16 v[148:151], a[216:219], a[144:147], 0
    buffer_load_dwordx4 v240, s[12:15], s35 offen lds
    v_mfma_f32_16x16x32_bf16 v[148:151], a[220:223], a[148:151], v[148:151]
    ds_read_b64_tr_b16 a[238:239], v238 offset:9224
    s_add_u32 m0, s37, 155648
    v_mfma_f32_16x16x32_bf16 v[156:159], a[220:223], a[156:159], 0
    s_add_u32 s35, s39, 262400
    v_mfma_f32_16x16x32_bf16 v[156:159], a[216:219], a[152:155], v[156:159]
    s_waitcnt lgkmcnt(4)
    v_mfma_f32_16x16x32_bf16 v[160:163], a[224:227], a[128:131], 0
    buffer_load_dwordx4 v241, s[16:19], s35 offen lds
    v_mfma_f32_16x16x32_bf16 v[160:163], a[228:231], a[132:135], v[160:163]
    s_waitcnt vmcnt(18)
    s_barrier
    ds_read_b64_tr_b16 a[208:209], v232 offset:16384
    s_add_u32 m0, s37, 118784
    v_mfma_f32_16x16x32_bf16 v[168:171], a[228:231], a[140:143], 0
    ds_read_b64_tr_b16 a[210:211], v232 offset:17408
    s_add_u32 s35, s38, 196608
    v_mfma_f32_16x16x32_bf16 v[168:171], a[224:227], a[136:139], v[168:171]
    ds_read_b64_tr_b16 a[212:213], v232 offset:24576
    v_mfma_f32_16x16x32_bf16 v[176:179], a[224:227], a[144:147], 0
    buffer_load_dwordx4 v240, s[12:15], s35 offen lds
    v_mfma_f32_16x16x32_bf16 v[176:179], a[228:231], a[148:151], v[176:179]
    ds_read_b64_tr_b16 a[214:215], v232 offset:25600
    s_add_u32 m0, s37, 159744
    v_mfma_f32_16x16x32_bf16 v[184:187], a[228:231], a[156:159], 0
    s_add_u32 s35, s39, 393472
    v_mfma_f32_16x16x32_bf16 v[184:187], a[224:227], a[152:155], v[184:187]
    s_waitcnt lgkmcnt(4)
    v_mfma_f32_16x16x32_bf16 v[164:167], a[232:235], a[128:131], 0
    buffer_load_dwordx4 v241, s[16:19], s35 offen lds
    v_mfma_f32_16x16x32_bf16 v[164:167], a[236:239], a[132:135], v[164:167]
    s_add_u32 m0, s37, 122880
    v_mfma_f32_16x16x32_bf16 v[172:175], a[236:239], a[140:143], 0
    ds_read_b64_tr_b16 a[216:217], v232 offset:16392
    s_add_u32 s35, s38, 229376
    v_mfma_f32_16x16x32_bf16 v[172:175], a[232:235], a[136:139], v[172:175]
    ds_read_b64_tr_b16 a[218:219], v232 offset:17416
    v_mfma_f32_16x16x32_bf16 v[180:183], a[232:235], a[144:147], 0
    buffer_load_dwordx4 v240, s[12:15], s35 offen lds
    v_mfma_f32_16x16x32_bf16 v[180:183], a[236:239], a[148:151], v[180:183]
    ds_read_b64_tr_b16 a[220:221], v232 offset:24584
    s_add_u32 m0, s37, 126976
    v_mfma_f32_16x16x32_bf16 v[188:191], a[236:239], a[156:159], 0
    ds_read_b64_tr_b16 a[222:223], v232 offset:25608
    s_add_u32 s35, s38, 262144
    v_mfma_f32_16x16x32_bf16 v[188:191], a[232:235], a[152:155], v[188:191]
    s_waitcnt lgkmcnt(4)
    v_mfma_f32_16x16x32_bf16 a[0:3], a[208:211], a[128:131], 0
    buffer_load_dwordx4 v240, s[12:15], s35 offen lds
    v_mfma_f32_16x16x32_bf16 a[0:3], a[212:215], a[132:135], a[0:3]
    s_add_u32 s38, s38, 128
    s_add_u32 s39, s39, 524288
    v_mfma_f32_16x16x32_bf16 a[8:11], a[212:215], a[140:143], 0
    s_and_b32 s38, s38, 1023
    s_and_b32 s39, s39, 4194303
    v_mfma_f32_16x16x32_bf16 a[8:11], a[208:211], a[136:139], a[8:11]
    s_add_u32 s35, s39, 524288
    v_mfma_f32_16x16x32_bf16 a[16:19], a[208:211], a[144:147], 0
    buffer_load_dword v247, v244, s[12:15], s38 offen offset:128
    v_mfma_f32_16x16x32_bf16 a[16:19], a[212:215], a[148:151], a[16:19]
    ds_read_b64_tr_b16 a[224:225], v234 offset:16384
    v_mfma_f32_16x16x32_bf16 a[24:27], a[212:215], a[156:159], 0
    ds_read_b64_tr_b16 a[226:227], v234 offset:17408
    v_mfma_f32_16x16x32_bf16 a[24:27], a[208:211], a[152:155], a[24:27]
    ds_read_b64_tr_b16 a[228:229], v234 offset:24576
    v_mfma_f32_16x16x32_bf16 v[208:211], a[208:211], a[160:163], 0
    buffer_load_dword v247, v245, s[16:19], s35 offen
    v_mfma_f32_16x16x32_bf16 v[208:211], a[212:215], a[164:167], v[208:211]
    ds_read_b64_tr_b16 a[230:231], v234 offset:25600
    s_waitcnt lgkmcnt(4)
    v_mfma_f32_16x16x32_bf16 a[4:7], a[216:219], a[128:131], 0
    v_mfma_f32_16x16x32_bf16 a[4:7], a[220:223], a[132:135], a[4:7]
    v_mfma_f32_16x16x32_bf16 a[12:15], a[220:223], a[140:143], 0
    v_mfma_f32_16x16x32_bf16 a[12:15], a[216:219], a[136:139], a[12:15]
    v_mfma_f32_16x16x32_bf16 a[20:23], a[216:219], a[144:147], 0
    buffer_load_dword v247, v246, s[56:59], s55 offen
    v_mfma_f32_16x16x32_bf16 a[20:23], a[220:223], a[148:151], a[20:23]
    ds_read_b64_tr_b16 a[232:233], v234 offset:16392
    s_add_u32 s55, s55, 1280
    v_mfma_f32_16x16x32_bf16 a[28:31], a[220:223], a[156:159], 0
    ds_read_b64_tr_b16 a[234:235], v234 offset:17416
    v_mfma_f32_16x16x32_bf16 a[28:31], a[216:219], a[152:155], a[28:31]
    ds_read_b64_tr_b16 a[236:237], v234 offset:24584
    v_mfma_f32_16x16x32_bf16 v[212:215], a[216:219], a[160:163], 0
    ds_read_b64_tr_b16 a[238:239], v234 offset:25608
    v_mfma_f32_16x16x32_bf16 v[212:215], a[220:223], a[164:167], v[212:215]
    s_waitcnt lgkmcnt(4)
    v_mfma_f32_16x16x32_bf16 a[32:35], a[224:227], a[128:131], 0
    v_mfma_f32_16x16x32_bf16 a[32:35], a[228:231], a[132:135], a[32:35]
    v_mfma_f32_16x16x32_bf16 a[40:43], a[228:231], a[140:143], 0
    v_mfma_f32_16x16x32_bf16 a[40:43], a[224:227], a[136:139], a[40:43]
    v_mfma_f32_16x16x32_bf16 a[48:51], a[224:227], a[144:147], 0
    ds_read_b64_tr_b16 a[208:209], v236 offset:16384
    v_mfma_f32_16x16x32_bf16 a[48:51], a[228:231], a[148:151], a[48:51]
    ds_read_b64_tr_b16 a[210:211], v236 offset:17408
    v_mfma_f32_16x16x32_bf16 a[56:59], a[228:231], a[156:159], 0
    ds_read_b64_tr_b16 a[212:213], v236 offset:24576
    v_mfma_f32_16x16x32_bf16 a[56:59], a[224:227], a[152:155], a[56:59]
    ds_read_b64_tr_b16 a[214:215], v236 offset:25600
    v_mfma_f32_16x16x32_bf16 v[216:219], a[224:227], a[160:163], 0
    v_mfma_f32_16x16x32_bf16 v[216:219], a[228:231], a[164:167], v[216:219]
    s_waitcnt lgkmcnt(4)
    v_mfma_f32_16x16x32_bf16 a[36:39], a[232:235], a[128:131], 0
    v_mfma_f32_16x16x32_bf16 a[36:39], a[236:239], a[132:135], a[36:39]
    v_mfma_f32_16x16x32_bf16 a[44:47], a[236:239], a[140:143], 0
    ds_read_b64_tr_b16 a[216:217], v236 offset:16392
    v_mfma_f32_16x16x32_bf16 a[44:47], a[232:235], a[136:139], a[44:47]
    ds_read_b64_tr_b16 a[218:219], v236 offset:17416
    v_mfma_f32_16x16x32_bf16 a[52:55], a[232:235], a[144:147], 0
    ds_read_b64_tr_b16 a[220:221], v236 offset:24584
    v_mfma_f32_16x16x32_bf16 a[52:55], a[236:239], a[148:151], a[52:55]
    ds_read_b64_tr_b16 a[222:223], v236 offset:25608
    v_mfma_f32_16x16x32_bf16 a[60:63], a[236:239], a[156:159], 0
    v_mfma_f32_16x16x32_bf16 a[60:63], a[232:235], a[152:155], a[60:63]
    ds_read_b64_tr_b16 a[224:225], v238 offset:16384
    v_mfma_f32_16x16x32_bf16 v[220:223], a[232:235], a[160:163], 0
    ds_read_b64_tr_b16 a[226:227], v238 offset:17408
    v_mfma_f32_16x16x32_bf16 v[220:223], a[236:239], a[164:167], v[220:223]
    ds_read_b64_tr_b16 a[228:229], v238 offset:24576
    s_waitcnt lgkmcnt(7)
    v_mfma_f32_16x16x32_bf16 a[64:67], a[208:211], a[128:131], 0
    ds_read_b64_tr_b16 a[230:231], v238 offset:25600
    v_mfma_f32_16x16x32_bf16 a[64:67], a[212:215], a[132:135], a[64:67]
    ds_read_b64_tr_b16 a[232:233], v238 offset:16392
    v_mfma_f32_16x16x32_bf16 a[72:75], a[212:215], a[140:143], 0
    ds_read_b64_tr_b16 a[234:235], v238 offset:17416
    v_mfma_f32_16x16x32_bf16 a[72:75], a[208:211], a[136:139], a[72:75]
    ds_read_b64_tr_b16 a[236:237], v238 offset:24584
    v_mfma_f32_16x16x32_bf16 a[80:83], a[208:211], a[144:147], 0
    ds_read_b64_tr_b16 a[238:239], v238 offset:25608
    v_mfma_f32_16x16x32_bf16 a[80:83], a[212:215], a[148:151], a[80:83]
    v_mfma_f32_16x16x32_bf16 a[88:91], a[212:215], a[156:159], 0
    v_mfma_f32_16x16x32_bf16 a[88:91], a[208:211], a[152:155], a[88:91]
    s_waitcnt lgkmcnt(8)
    v_mfma_f32_16x16x32_bf16 a[68:71], a[216:219], a[128:131], 0
    v_mfma_f32_16x16x32_bf16 a[68:71], a[220:223], a[132:135], a[68:71]
    v_mfma_f32_16x16x32_bf16 a[76:79], a[220:223], a[140:143], 0
    v_mfma_f32_16x16x32_bf16 a[76:79], a[216:219], a[136:139], a[76:79]
    v_mfma_f32_16x16x32_bf16 a[84:87], a[216:219], a[144:147], 0
    v_mfma_f32_16x16x32_bf16 a[84:87], a[220:223], a[148:151], a[84:87]
    s_waitcnt lgkmcnt(0)
    s_waitcnt vmcnt(3)
    v_mfma_f32_16x16x32_bf16 a[92:95], a[220:223], a[156:159], 0
    s_barrier
    v_mfma_f32_16x16x32_bf16 a[92:95], a[216:219], a[152:155], a[92:95]
    s_waitcnt lgkmcnt(15)
    v_mfma_f32_16x16x32_bf16 a[96:99], a[224:227], a[128:131], 0
    ds_read_b64_tr_b16 a[208:209], v233 offset:0
    v_mfma_f32_16x16x32_bf16 a[96:99], a[228:231], a[132:135], a[96:99]
    ds_read_b64_tr_b16 a[210:211], v233 offset:1024
    v_mfma_f32_16x16x32_bf16 a[104:107], a[228:231], a[140:143], 0
    ds_read_b128 a[168:171], v225 offset:0
    v_mfma_f32_16x16x32_bf16 a[104:107], a[224:227], a[136:139], a[104:107]
    ds_read_b64_tr_b16 a[212:213], v233 offset:8192
    v_mfma_f32_16x16x32_bf16 a[112:115], a[224:227], a[144:147], 0
    ds_read_b64_tr_b16 a[214:215], v233 offset:9216
    v_mfma_f32_16x16x32_bf16 a[112:115], a[228:231], a[148:151], a[112:115]
    ds_read_b128 a[172:175], v227 offset:0
    v_mfma_f32_16x16x32_bf16 a[120:123], a[228:231], a[156:159], 0
    ds_read_b128 a[176:179], v225 offset:2048
    v_mfma_f32_16x16x32_bf16 a[120:123], a[224:227], a[152:155], a[120:123]
    ds_read_b128 a[180:183], v227 offset:2048
    s_waitcnt lgkmcnt(15)
    v_mfma_f32_16x16x32_bf16 a[100:103], a[232:235], a[128:131], 0
    ds_read_b128 a[184:187], v225 offset:4096
    v_mfma_f32_16x16x32_bf16 a[100:103], a[236:239], a[132:135], a[100:103]
    ds_read_b128 a[188:191], v227 offset:4096
    v_mfma_f32_16x16x32_bf16 a[108:111], a[236:239], a[140:143], 0
    ds_read_b128 a[192:195], v225 offset:6144
    v_mfma_f32_16x16x32_bf16 a[108:111], a[232:235], a[136:139], a[108:111]
    ds_read_b128 a[196:199], v227 offset:6144
    v_mfma_f32_16x16x32_bf16 a[116:119], a[232:235], a[144:147], 0
    ds_read_b128 a[200:203], v229 offset:0
    v_mfma_f32_16x16x32_bf16 a[116:119], a[236:239], a[148:151], a[116:119]
    ds_read_b128 a[204:207], v231 offset:0
    v_mfma_f32_16x16x32_bf16 a[124:127], a[236:239], a[156:159], 0
    ds_read_b64_tr_b16 a[216:217], v233 offset:8
    s_waitcnt lgkmcnt(7)
    v_mfma_f32_16x16x32_bf16 a[124:127], a[232:235], a[152:155], a[124:127]
    ds_read_b64_tr_b16 a[218:219], v233 offset:1032
    s_waitcnt lgkmcnt(15)
    s_mov_b32 s32, 3
.p2align 3
L_qp:
    v_mfma_f32_16x16x32_bf16 v[64:67], a[208:211], a[168:171], v[64:67]
    ds_read_b64_tr_b16 a[220:221], v233 offset:8200
    s_add_u32 m0, s37, 61440
    v_mfma_f32_16x16x32_bf16 v[64:67], a[212:215], a[172:175], v[64:67]
    ds_read_b64_tr_b16 a[222:223], v233 offset:9224
    s_add_u32 s35, s39, 0
    v_mfma_f32_16x16x32_bf16 v[72:75], a[212:215], a[180:183], v[72:75]
    v_mfma_f32_16x16x32_bf16 v[72:75], a[208:211], a[176:179], v[72:75]
    s_waitcnt lgkmcnt(8)
    v_mfma_f32_16x16x32_bf16 v[80:83], a[208:211], a[184:187], v[80:83]
    ds_read_b64_tr_b16 a[224:225], v235 offset:0
    v_mfma_f32_16x16x32_bf16 v[80:83], a[212:215], a[188:191], v[80:83]
    ds_read_b64_tr_b16 a[226:227], v235 offset:1024
    s_waitcnt lgkmcnt(8)
    v_mfma_f32_16x16x32_bf16 v[88:91], a[212:215], a[196:199], v[88:91]
    ds_read_b64_tr_b16 a[228:229], v235 offset:8192
    v_mfma_f32_16x16x32_bf16 v[88:91], a[208:211], a[192:195], v[88:91]
    ds_read_b64_tr_b16 a[230:231], v235 offset:9216
    s_waitcnt lgkmcnt(8)
    v_mfma_f32_16x16x32_bf16 v[192:195], a[208:211], a[200:203], v[192:195]
    buffer_load_dwordx4 v241, s[16:19], s35 offen lds
    v_mfma_f32_16x16x32_bf16 v[192:195], a[212:215], a[204:207], v[192:195]
    s_add_u32 m0, s37, 24576
    s_waitcnt lgkmcnt(4)
    v_mfma_f32_16x16x32_bf16 v[68:71], a[216:219], a[168:171], v[68:71]
    s_add_u32 s35, s38, 0
    v_mfma_f32_16x16x32_bf16 v[68:71], a[220:223], a[172:175], v[68:71]
    v_mfma_f32_16x16x32_bf16 v[76:79], a[220:223], a[180:183], v[76:79]
    buffer_load_dwordx4 v240, s[12:15], s35 offen lds
    v_mfma_f32_16x16x32_bf16 v[76:79], a[216:219], a[176:179], v[76:79]
    s_add_u32 m0, s37, 65536
    v_mfma_f32_16x16x32_bf16 v[84:87], a[216:219], a[184:187], v[84:87]
    ds_read_b64_tr_b16 a[232:233], v235 offset:8
    s_add_u32 s35, s39, 131072
    v_mfma_f32_16x16x32_bf16 v[84:87], a[220:223], a[188:191], v[84:87]
    ds_read_b64_tr_b16 a[234:235], v235 offset:1032
    v_mfma_f32_16x16x32_bf16 v[92:95], a[220:223], a[196:199], v[92:95]
    buffer_load_dwordx4 v241, s[16:19], s35 offen lds
    v_mfma_f32_16x16x32_bf16 v[92:95], a[216:219], a[192:195], v[92:95]
    ds_read_b64_tr_b16 a[236:237], v235 offset:8200
    s_add_u32 m0, s37, 28672
    v_mfma_f32_16x16x32_bf16 v[196:199], a[216:219], a[200:203], v[196:199]
    ds_read_b64_tr_b16 a[238:239], v235 offset:9224
    s_add_u32 s35, s38, 32768
    v_mfma_f32_16x16x32_bf16 v[196:199], a[220:223], a[204:207], v[196:199]
    s_waitcnt lgkmcnt(4)
    v_mfma_f32_16x16x32_bf16 v[96:99], a[224:227], a[168:171], v[96:99]
    buffer_load_dwordx4 v240, s[12:15], s35 offen lds
    v_mfma_f32_16x16x32_bf16 v[96:99], a[228:231], a[172:175], v[96:99]
    s_add_u32 m0, s37, 69632
    v_mfma_f32_16x16x32_bf16 v[104:107], a[228:231], a[180:183], v[104:107]
    s_add_u32 s35, s39, 262144
    v_mfma_f32_16x16x32_bf16 v[104:107], a[224:227], a[176:179], v[104:107]
    v_mfma_f32_16x16x32_bf16 v[112:115], a[224:227], a[184:187], v[112:115]
    buffer_load_dwordx4 v241, s[16:19], s35 offen lds
    v_mfma_f32_16x16x32_bf16 v[112:115], a[228:231], a[188:191], v[112:115]
    ds_read_b64_tr_b16 a[208:209], v237 offset:0
    s_add_u32 m0, s37, 32768
    v_mfma_f32_16x16x32_bf16 v[120:123], a[228:231], a[196:199], v[120:123]
    ds_read_b64_tr_b16 a[210:211], v237 offset:1024
    s_add_u32 s35, s38, 65536
    v_mfma_f32_16x16x32_bf16 v[120:123], a[224:227], a[192:195], v[120:123]
    ds_read_b64_tr_b16 a[212:213], v237 offset:8192
    s_waitcnt lgkmcnt(3)
    v_mfma_f32_16x16x32_bf16 v[200:203], a[224:227], a[200:203], v[200:203]
    buffer_load_dwordx4 v240, s[12:15], s35 offen lds
    v_mfma_f32_16x16x32_bf16 v[200:203], a[228:231], a[204:207], v[200:203]
    ds_read_b64_tr_b16 a[214:215], v237 offset:9216
    s_add_u32 m0, s37, 73728
    v_mfma_f32_16x16x32_bf16 v[100:103], a[232:235], a[168:171], v[100:103]
    s_add_u32 s35, s39, 393216
    v_mfma_f32_16x16x32_bf16 v[100:103], a[236:239], a[172:175], v[100:103]
    v_mfma_f32_16x16x32_bf16 v[108:111], a[236:239], a[180:183], v[108:111]
    buffer_load_dwordx4 v241, s[16:19], s35 offen lds
    v_mfma_f32_16x16x32_bf16 v[108:111], a[232:235], a[176:179], v[108:111]
    ds_read_b64_tr_b16 a[216:217], v237 offset:8
    s_add_u32 m0, s37, 36864
    v_mfma_f32_16x16x32_bf16 v[116:119], a[232:235], a[184:187], v[116:119]
    ds_read_b64_tr_b16 a[218:219], v237 offset:1032
    s_add_u32 s35, s38, 98304
    v_mfma_f32_16x16x32_bf16 v[116:119], a[236:239], a[188:191], v[116:119]
    ds_read_b64_tr_b16 a[220:221], v237 offset:8200
    v_mfma_f32_16x16x32_bf16 v[124:127], a[236:239], a[196:199], v[124:127]
    buffer_load_dwordx4 v240, s[12:15], s35 offen lds
    v_mfma_f32_16x16x32_bf16 v[124:127], a[232:235], a[192:195], v[124:127]
    ds_read_b64_tr_b16 a[222:223], v237 offset:9224
    s_add_u32 m0, s37, 77824
    v_mfma_f32_16x16x32_bf16 v[204:207], a[232:235], a[200:203], v[204:207]
    s_add_u32 s35, s39, 256
    v_mfma_f32_16x16x32_bf16 v[204:207], a[236:239], a[204:207], v[204:207]
    s_waitcnt lgkmcnt(4)
    v_mfma_f32_16x16x32_bf16 v[128:131], a[208:211], a[168:171], v[128:131]
    buffer_load_dwordx4 v241, s[16:19], s35 offen lds
    v_mfma_f32_16x16x32_bf16 v[128:131], a[212:215], a[172:175], v[128:131]
    ds_read_b64_tr_b16 a[224:225], v239 offset:0
    s_add_u32 m0, s37, 40960
    v_mfma_f32_16x16x32_bf16 v[136:139], a[212:215], a[180:183], v[136:139]
    ds_read_b64_tr_b16 a[226:227], v239 offset:1024
    s_add_u32 s35, s38, 131072
    v_mfma_f32_16x16x32_bf16 v[136:139], a[208:211], a[176:179], v[136:139]
    ds_read_b64_tr_b16 a[228:229], v239 offset:8192
    v_mfma_f32_16x16x32_bf16 v[144:147], a[208:211], a[184:187], v[144:147]
    buffer_load_dwordx4 v240, s[12:15], s35 offen lds
    v_mfma_f32_16x16x32_bf16 v[144:147], a[212:215], a[188:191], v[144:147]
    ds_read_b64_tr_b16 a[230:231], v239 offset:9216
    s_add_u32 m0, s37, 81920
    v_mfma_f32_16x16x32_bf16 v[152:155], a[212:215], a[196:199], v[152:155]
    s_add_u32 s35, s39, 131328
    v_mfma_f32_16x16x32_bf16 v[152:155], a[208:211], a[192:195], v[152:155]
    s_waitcnt lgkmcnt(4)
    v_mfma_f32_16x16x32_bf16 v[132:135], a[216:219], a[168:171], v[132:135]
    buffer_load_dwordx4 v241, s[16:19], s35 offen lds
    v_mfma_f32_16x16x32_bf16 v[132:135], a[220:223], a[172:175], v[132:135]
    ds_read_b64_tr_b16 a[232:233], v239 offset:8
    s_add_u32 m0, s37, 45056
    v_mfma_f32_16x16x32_bf16 v[140:143], a[220:223], a[180:183], v[140:143]
    ds_read_b64_tr_b16 a[234:235], v239 offset:1032
    s_add_u32 s35, s38, 163840
    v_mfma_f32_16x16x32_bf16 v[140:143], a[216:219], a[176:179], v[140:143]
    ds_read_b64_tr_b16 a[236:237], v239 offset:8200
    v_mfma_f32_16x16x32_bf16 v[148:151], a[216:219], a[184:187], v[148:151]
    buffer_load_dwordx4 v240, s[12:15], s35 offen lds
    v_mfma_f32_16x16x32_bf16 v[148:151], a[220:223], a[188:191], v[148:151]
    ds_read_b64_tr_b16 a[238:239], v239 offset:9224
    s_add_u32 m0, s37, 86016
    v_mfma_f32_16x16x32_bf16 v[156:159], a[220:223], a[196:199], v[156:159]
    s_add_u32 s35, s39, 262400
    v_mfma_f32_16x16x32_bf16 v[156:159], a[216:219], a[192:195], v[156:159]
    s_waitcnt lgkmcnt(4)
    v_mfma_f32_16x16x32_bf16 v[160:163], a[224:227], a[168:171], v[160:163]
    buffer_load_dwordx4 v241, s[16:19], s35 offen lds
    v_mfma_f32_16x16x32_bf16 v[160:163], a[228:231], a[172:175], v[160:163]
    ds_read_b64_tr_b16 a[208:209], v233 offset:16384
    s_add_u32 m0, s37, 49152
    v_mfma_f32_16x16x32_bf16 v[168:171], a[228:231], a[180:183], v[168:171]
    ds_read_b64_tr_b16 a[210:211], v233 offset:17408
    s_add_u32 s35, s38, 196608
    v_mfma_f32_16x16x32_bf16 v[168:171], a[224:227], a[176:179], v[168:171]
    ds_read_b64_tr_b16 a[212:213], v233 offset:24576
    v_mfma_f32_16x16x32_bf16 v[176:179], a[224:227], a[184:187], v[176:179]
    buffer_load_dwordx4 v240, s[12:15], s35 offen lds
    v_mfma_f32_16x16x32_bf16 v[176:179], a[228:231], a[188:191], v[176:179]
    ds_read_b64_tr_b16 a[214:215], v233 offset:25600
    s_add_u32 m0, s37, 90112
    v_mfma_f32_16x16x32_bf16 v[184:187], a[228:231], a[196:199], v[184:187]
    s_add_u32 s35, s39, 393472
    v_mfma_f32_16x16x32_bf16 v[184:187], a[224:227], a[192:195], v[184:187]
    s_waitcnt lgkmcnt(4)
    v_mfma_f32_16x16x32_bf16 v[164:167], a[232:235], a[168:171], v[164:167]
    buffer_load_dwordx4 v241, s[16:19], s35 offen lds
    v_mfma_f32_16x16x32_bf16 v[164:167], a[236:239], a[172:175], v[164:167]
    s_add_u32 m0, s37, 53248
    v_mfma_f32_16x16x32_bf16 v[172:175], a[236:239], a[180:183], v[172:175]
    ds_read_b64_tr_b16 a[216:217], v233 offset:16392
    s_add_u32 s35, s38, 229376
    v_mfma_f32_16x16x32_bf16 v[172:175], a[232:235], a[176:179], v[172:175]
    ds_read_b64_tr_b16 a[218:219], v233 offset:17416
    v_mfma_f32_16x16x32_bf16 v[180:183], a[232:235], a[184:187], v[180:183]
    buffer_load_dwordx4 v240, s[12:15], s35 offen lds
    v_mfma_f32_16x16x32_bf16 v[180:183], a[236:239], a[188:191], v[180:183]
    ds_read_b64_tr_b16 a[220:221], v233 offset:24584
    s_add_u32 m0, s37, 57344
    v_mfma_f32_16x16x32_bf16 v[188:191], a[236:239], a[196:199], v[188:191]
    ds_read_b64_tr_b16 a[222:223], v233 offset:25608
    s_add_u32 s35, s38, 262144
    v_mfma_f32_16x16x32_bf16 v[188:191], a[232:235], a[192:195], v[188:191]
    s_waitcnt lgkmcnt(4)
    v_mfma_f32_16x16x32_bf16 a[0:3], a[208:211], a[168:171], a[0:3]
    buffer_load_dwordx4 v240, s[12:15], s35 offen lds
    v_mfma_f32_16x16x32_bf16 a[0:3], a[212:215], a[172:175], a[0:3]
    s_add_u32 s38, s38, 128
    s_add_u32 s39, s39, 524288
    v_mfma_f32_16x16x32_bf16 a[8:11], a[212:215], a[180:183], a[8:11]
    s_and_b32 s38, s38, 1023
    s_and_b32 s39, s39, 4194303
    v_mfma_f32_16x16x32_bf16 a[8:11], a[208:211], a[176:179], a[8:11]
    s_add_u32 s35, s39, 524288
    v_mfma_f32_16x16x32_bf16 a[16:19], a[208:211], a[184:187], a[16:19]
    buffer_load_dword v247, v244, s[12:15], s38 offen offset:128
    v_mfma_f32_16x16x32_bf16 a[16:19], a[212:215], a[188:191], a[16:19]
    ds_read_b64_tr_b16 a[224:225], v235 offset:16384
    v_mfma_f32_16x16x32_bf16 a[24:27], a[212:215], a[196:199], a[24:27]
    ds_read_b64_tr_b16 a[226:227], v235 offset:17408
    v_mfma_f32_16x16x32_bf16 a[24:27], a[208:211], a[192:195], a[24:27]
    ds_read_b64_tr_b16 a[228:229], v235 offset:24576
    v_mfma_f32_16x16x32_bf16 v[208:211], a[208:211], a[200:203], v[208:211]
    buffer_load_dword v247, v245, s[16:19], s35 offen
    v_mfma_f32_16x16x32_bf16 v[208:211], a[212:215], a[204:207], v[208:211]
    ds_read_b64_tr_b16 a[230:231], v235 offset:25600
    s_waitcnt lgkmcnt(4)
    v_mfma_f32_16x16x32_bf16 a[4:7], a[216:219], a[168:171], a[4:7]
    v_mfma_f32_16x16x32_bf16 a[4:7], a[220:223], a[172:175], a[4:7]
    v_mfma_f32_16x16x32_bf16 a[12:15], a[220:223], a[180:183], a[12:15]
    v_mfma_f32_16x16x32_bf16 a[12:15], a[216:219], a[176:179], a[12:15]
    v_mfma_f32_16x16x32_bf16 a[20:23], a[216:219], a[184:187], a[20:23]
    buffer_load_dword v247, v246, s[56:59], s55 offen
    v_mfma_f32_16x16x32_bf16 a[20:23], a[220:223], a[188:191], a[20:23]
    ds_read_b64_tr_b16 a[232:233], v235 offset:16392
    s_add_u32 s55, s55, 1280
    v_mfma_f32_16x16x32_bf16 a[28:31], a[220:223], a[196:199], a[28:31]
    ds_read_b64_tr_b16 a[234:235], v235 offset:17416
    v_mfma_f32_16x16x32_bf16 a[28:31], a[216:219], a[192:195], a[28:31]
    ds_read_b64_tr_b16 a[236:237], v235 offset:24584
    v_mfma_f32_16x16x32_bf16 v[212:215], a[216:219], a[200:203], v[212:215]
    ds_read_b64_tr_b16 a[238:239], v235 offset:25608
    v_mfma_f32_16x16x32_bf16 v[212:215], a[220:223], a[204:207], v[212:215]
    s_waitcnt lgkmcnt(4)
    v_mfma_f32_16x16x32_bf16 a[32:35], a[224:227], a[168:171], a[32:35]
    v_mfma_f32_16x16x32_bf16 a[32:35], a[228:231], a[172:175], a[32:35]
    v_mfma_f32_16x16x32_bf16 a[40:43], a[228:231], a[180:183], a[40:43]
    v_mfma_f32_16x16x32_bf16 a[40:43], a[224:227], a[176:179], a[40:43]
    v_mfma_f32_16x16x32_bf16 a[48:51], a[224:227], a[184:187], a[48:51]
    ds_read_b64_tr_b16 a[208:209], v237 offset:16384
    v_mfma_f32_16x16x32_bf16 a[48:51], a[228:231], a[188:191], a[48:51]
    ds_read_b64_tr_b16 a[210:211], v237 offset:17408
    v_mfma_f32_16x16x32_bf16 a[56:59], a[228:231], a[196:199], a[56:59]
    ds_read_b64_tr_b16 a[212:213], v237 offset:24576
    v_mfma_f32_16x16x32_bf16 a[56:59], a[224:227], a[192:195], a[56:59]
    ds_read_b64_tr_b16 a[214:215], v237 offset:25600
    v_mfma_f32_16x16x32_bf16 v[216:219], a[224:227], a[200:203], v[216:219]
    v_mfma_f32_16x16x32_bf16 v[216:219], a[228:231], a[204:207], v[216:219]
    s_waitcnt lgkmcnt(4)
    v_mfma_f32_16x16x32_bf16 a[36:39], a[232:235], a[168:171], a[36:39]
    v_mfma_f32_16x16x32_bf16 a[36:39], a[236:239], a[172:175], a[36:39]
    v_mfma_f32_16x16x32_bf16 a[44:47], a[236:239], a[180:183], a[44:47]
    ds_read_b64_tr_b16 a[216:217], v237 offset:16392
    v_mfma_f32_16x16x32_bf16 a[44:47], a[232:235], a[176:179], a[44:47]
    ds_read_b64_tr_b16 a[218:219], v237 offset:17416
    v_mfma_f32_16x16x32_bf16 a[52:55], a[232:235], a[184:187], a[52:55]
    ds_read_b64_tr_b16 a[220:221], v237 offset:24584
    v_mfma_f32_16x16x32_bf16 a[52:55], a[236:239], a[188:191], a[52:55]
    ds_read_b64_tr_b16 a[222:223], v237 offset:25608
    v_mfma_f32_16x16x32_bf16 a[60:63], a[236:239], a[196:199], a[60:63]
    v_mfma_f32_16x16x32_bf16 a[60:63], a[232:235], a[192:195], a[60:63]
    ds_read_b64_tr_b16 a[224:225], v239 offset:16384
    v_mfma_f32_16x16x32_bf16 v[220:223], a[232:235], a[200:203], v[220:223]
    ds_read_b64_tr_b16 a[226:227], v239 offset:17408
    v_mfma_f32_16x16x32_bf16 v[220:223], a[236:239], a[204:207], v[220:223]
    ds_read_b64_tr_b16 a[228:229], v239 offset:24576
    s_waitcnt lgkmcnt(7)
    v_mfma_f32_16x16x32_bf16 a[64:67], a[208:211], a[168:171], a[64:67]
    ds_read_b64_tr_b16 a[230:231], v239 offset:25600
    v_mfma_f32_16x16x32_bf16 a[64:67], a[212:215], a[172:175], a[64:67]
    ds_read_b64_tr_b16 a[232:233], v239 offset:16392
    v_mfma_f32_16x16x32_bf16 a[72:75], a[212:215], a[180:183], a[72:75]
    ds_read_b64_tr_b16 a[234:235], v239 offset:17416
    v_mfma_f32_16x16x32_bf16 a[72:75], a[208:211], a[176:179], a[72:75]
    ds_read_b64_tr_b16 a[236:237], v239 offset:24584
    v_mfma_f32_16x16x32_bf16 a[80:83], a[208:211], a[184:187], a[80:83]
    ds_read_b64_tr_b16 a[238:239], v239 offset:25608
    v_mfma_f32_16x16x32_bf16 a[80:83], a[212:215], a[188:191], a[80:83]
    v_mfma_f32_16x16x32_bf16 a[88:91], a[212:215], a[196:199], a[88:91]
    v_mfma_f32_16x16x32_bf16 a[88:91], a[208:211], a[192:195], a[88:91]
    s_waitcnt lgkmcnt(8)
    v_mfma_f32_16x16x32_bf16 a[68:71], a[216:219], a[168:171], a[68:71]
    v_mfma_f32_16x16x32_bf16 a[68:71], a[220:223], a[172:175], a[68:71]
    v_mfma_f32_16x16x32_bf16 a[76:79], a[220:223], a[180:183], a[76:79]
    v_mfma_f32_16x16x32_bf16 a[76:79], a[216:219], a[176:179], a[76:79]
    v_mfma_f32_16x16x32_bf16 a[84:87], a[216:219], a[184:187], a[84:87]
    v_mfma_f32_16x16x32_bf16 a[84:87], a[220:223], a[188:191], a[84:87]
    s_waitcnt lgkmcnt(0)
    s_waitcnt vmcnt(3)
    v_mfma_f32_16x16x32_bf16 a[92:95], a[220:223], a[196:199], a[92:95]
    s_barrier
    v_mfma_f32_16x16x32_bf16 a[92:95], a[216:219], a[192:195], a[92:95]
    s_waitcnt lgkmcnt(15)
    v_mfma_f32_16x16x32_bf16 a[96:99], a[224:227], a[168:171], a[96:99]
    ds_read_b64_tr_b16 a[208:209], v232 offset:0
    v_mfma_f32_16x16x32_bf16 a[96:99], a[228:231], a[172:175], a[96:99]
    ds_read_b64_tr_b16 a[210:211], v232 offset:1024
    v_mfma_f32_16x16x32_bf16 a[104:107], a[228:231], a[180:183], a[104:107]
    ds_read_b128 a[128:131], v224 offset:0
    v_mfma_f32_16x16x32_bf16 a[104:107], a[224:227], a[176:179], a[104:107]
    ds_read_b64_tr_b16 a[212:213], v232 offset:8192
    v_mfma_f32_16x16x32_bf16 a[112:115], a[224:227], a[184:187], a[112:115]
    ds_read_b64_tr_b16 a[214:215], v232 offset:9216
    v_mfma_f32_16x16x32_bf16 a[112:115], a[228:231], a[188:191], a[112:115]
    ds_read_b128 a[132:135], v226 offset:0
    v_mfma_f32_16x16x32_bf16 a[120:123], a[228:231], a[196:199], a[120:123]
    ds_read_b128 a[136:139], v224 offset:2048
    v_mfma_f32_16x16x32_bf16 a[120:123], a[224:227], a[192:195], a[120:123]
    ds_read_b128 a[140:143], v226 offset:2048
    s_waitcnt lgkmcnt(15)
    v_mfma_f32_16x16x32_bf16 a[100:103], a[232:235], a[168:171], a[100:103]
    ds_read_b128 a[144:147], v224 offset:4096
    v_mfma_f32_16x16x32_bf16 a[100:103], a[236:239], a[172:175], a[100:103]
    ds_read_b128 a[148:151], v226 offset:4096
    v_mfma_f32_16x16x32_bf16 a[108:111], a[236:239], a[180:183], a[108:111]
    ds_read_b128 a[152:155], v224 offset:6144
    v_mfma_f32_16x16x32_bf16 a[108:111], a[232:235], a[176:179], a[108:111]
    ds_read_b128 a[156:159], v226 offset:6144
    v_mfma_f32_16x16x32_bf16 a[116:119], a[232:235], a[184:187], a[116:119]
    ds_read_b128 a[160:163], v228 offset:0
    v_mfma_f32_16x16x32_bf16 a[116:119], a[236:239], a[188:191], a[116:119]
    ds_read_b128 a[164:167], v230 offset:0
    v_mfma_f32_16x16x32_bf16 a[124:127], a[236:239], a[196:199], a[124:127]
    ds_read_b64_tr_b16 a[216:217], v232 offset:8
    s_waitcnt lgkmcnt(7)
    v_mfma_f32_16x16x32_bf16 a[124:127], a[232:235], a[192:195], a[124:127]
    ds_read_b64_tr_b16 a[218:219], v232 offset:1032
    s_waitcnt lgkmcnt(15)
    v_mfma_f32_16x16x32_bf16 v[64:67], a[208:211], a[128:131], v[64:67]
    ds_read_b64_tr_b16 a[220:221], v232 offset:8200
    s_add_u32 m0, s37, 131072
    v_mfma_f32_16x16x32_bf16 v[64:67], a[212:215], a[132:135], v[64:67]
    ds_read_b64_tr_b16 a[222:223], v232 offset:9224
    s_add_u32 s35, s39, 0
    v_mfma_f32_16x16x32_bf16 v[72:75], a[212:215], a[140:143], v[72:75]
    v_mfma_f32_16x16x32_bf16 v[72:75], a[208:211], a[136:139], v[72:75]
    s_waitcnt lgkmcnt(8)
    v_mfma_f32_16x16x32_bf16 v[80:83], a[208:211], a[144:147], v[80:83]
    ds_read_b64_tr_b16 a[224:225], v234 offset:0
    v_mfma_f32_16x16x32_bf16 v[80:83], a[212:215], a[148:151], v[80:83]
    ds_read_b64_tr_b16 a[226:227], v234 offset:1024
    s_waitcnt lgkmcnt(8)
    v_mfma_f32_16x16x32_bf16 v[88:91], a[212:215], a[156:159], v[88:91]
    ds_read_b64_tr_b16 a[228:229], v234 offset:8192
    v_mfma_f32_16x16x32_bf16 v[88:91], a[208:211], a[152:155], v[88:91]
    ds_read_b64_tr_b16 a[230:231], v234 offset:9216
    s_waitcnt lgkmcnt(8)
    v_mfma_f32_16x16x32_bf16 v[192:195], a[208:211], a[160:163], v[192:195]
    buffer_load_dwordx4 v241, s[16:19], s35 offen lds
    v_mfma_f32_16x16x32_bf16 v[192:195], a[212:215], a[164:167], v[192:195]
    s_add_u32 m0, s37, 94208
    s_waitcnt lgkmcnt(4)
    v_mfma_f32_16x16x32_bf16 v[68:71], a[216:219], a[128:131], v[68:71]
    s_add_u32 s35, s38, 0
    v_mfma_f32_16x16x32_bf16 v[68:71], a[220:223], a[132:135], v[68:71]
    v_mfma_f32_16x16x32_bf16 v[76:79], a[220:223], a[140:143], v[76:79]
    buffer_load_dwordx4 v240, s[12:15], s35 offen lds
    v_mfma_f32_16x16x32_bf16 v[76:79], a[216:219], a[136:139], v[76:79]
    s_add_u32 m0, s37, 135168
    v_mfma_f32_16x16x32_bf16 v[84:87], a[216:219], a[144:147], v[84:87]
    ds_read_b64_tr_b16 a[232:233], v234 offset:8
    s_add_u32 s35, s39, 131072
    v_mfma_f32_16x16x32_bf16 v[84:87], a[220:223], a[148:151], v[84:87]
    ds_read_b64_tr_b16 a[234:235], v234 offset:1032
    v_mfma_f32_16x16x32_bf16 v[92:95], a[220:223], a[156:159], v[92:95]
    buffer_load_dwordx4 v241, s[16:19], s35 offen lds
    v_mfma_f32_16x16x32_bf16 v[92:95], a[216:219], a[152:155], v[92:95]
    ds_read_b64_tr_b16 a[236:237], v234 offset:8200
    s_add_u32 m0, s37, 98304
    v_mfma_f32_16x16x32_bf16 v[196:199], a[216:219], a[160:163], v[196:199]
    ds_read_b64_tr_b16 a[238:239], v234 offset:9224
    s_add_u32 s35, s38, 32768
    v_mfma_f32_16x16x32_bf16 v[196:199], a[220:223], a[164:167], v[196:199]
    s_waitcnt lgkmcnt(4)
    v_mfma_f32_16x16x32_bf16 v[96:99], a[224:227], a[128:131], v[96:99]
    buffer_load_dwordx4 v240, s[12:15], s35 offen lds
    v_mfma_f32_16x16x32_bf16 v[96:99], a[228:231], a[132:135], v[96:99]
    s_add_u32 m0, s37, 139264
    v_mfma_f32_16x16x32_bf16 v[104:107], a[228:231], a[140:143], v[104:107]
    s_add_u32 s35, s39, 262144
    v_mfma_f32_16x16x32_bf16 v[104:107], a[224:227], a[136:139], v[104:107]
    v_mfma_f32_16x16x32_bf16 v[112:115], a[224:227], a[144:147], v[112:115]
    buffer_load_dwordx4 v241, s[16:19], s35 offen lds
    v_mfma_f32_16x16x32_bf16 v[112:115], a[228:231], a[148:151], v[112:115]
    ds_read_b64_tr_b16 a[208:209], v236 offset:0
    s_add_u32 m0, s37, 102400
    v_mfma_f32_16x16x32_bf16 v[120:123], a[228:231], a[156:159], v[120:123]
    ds_read_b64_tr_b16 a[210:211], v236 offset:1024
    s_add_u32 s35, s38, 65536
    v_mfma_f32_16x16x32_bf16 v[120:123], a[224:227], a[152:155], v[120:123]
    ds_read_b64_tr_b16 a[212:213], v236 offset:8192
    s_waitcnt lgkmcnt(3)
    v_mfma_f32_16x16x32_bf16 v[200:203], a[224:227], a[160:163], v[200:203]
    buffer_load_dwordx4 v240, s[12:15], s35 offen lds
    v_mfma_f32_16x16x32_bf16 v[200:203], a[228:231], a[164:167], v[200:203]
    ds_read_b64_tr_b16 a[214:215], v236 offset:9216
    s_add_u32 m0, s37, 143360
    v_mfma_f32_16x16x32_bf16 v[100:103], a[232:235], a[128:131], v[100:103]
    s_add_u32 s35, s39, 393216
    v_mfma_f32_16x16x32_bf16 v[100:103], a[236:239], a[132:135], v[100:103]
    v_mfma_f32_16x16x32_bf16 v[108:111], a[236:239], a[140:143], v[108:111]
    buffer_load_dwordx4 v241, s[16:19], s35 offen lds
    v_mfma_f32_16x16x32_bf16 v[108:111], a[232:235], a[136:139], v[108:111]
    ds_read_b64_tr_b16 a[216:217], v236 offset:8
    s_add_u32 m0, s37, 106496
    v_mfma_f32_16x16x32_bf16 v[116:119], a[232:235], a[144:147], v[116:119]
    ds_read_b64_tr_b16 a[218:219], v236 offset:1032
    s_add_u32 s35, s38, 98304
    v_mfma_f32_16x16x32_bf16 v[116:119], a[236:239], a[148:151], v[116:119]
    ds_read_b64_tr_b16 a[220:221], v236 offset:8200
    v_mfma_f32_16x16x32_bf16 v[124:127], a[236:239], a[156:159], v[124:127]
    buffer_load_dwordx4 v240, s[12:15], s35 offen lds
    v_mfma_f32_16x16x32_bf16 v[124:127], a[232:235], a[152:155], v[124:127]
    ds_read_b64_tr_b16 a[222:223], v236 offset:9224
    s_add_u32 m0, s37, 147456
    v_mfma_f32_16x16x32_bf16 v[204:207], a[232:235], a[160:163], v[204:207]
    s_add_u32 s35, s39, 256
    v_mfma_f32_16x16x32_bf16 v[204:207], a[236:239], a[164:167], v[204:207]
    s_waitcnt lgkmcnt(4)
    v_mfma_f32_16x16x32_bf16 v[128:131], a[208:211], a[128:131], v[128:131]
    buffer_load_dwordx4 v241, s[16:19], s35 offen lds
    v_mfma_f32_16x16x32_bf16 v[128:131], a[212:215], a[132:135], v[128:131]
    ds_read_b64_tr_b16 a[224:225], v238 offset:0
    s_add_u32 m0, s37, 110592
    v_mfma_f32_16x16x32_bf16 v[136:139], a[212:215], a[140:143], v[136:139]
    ds_read_b64_tr_b16 a[226:227], v238 offset:1024
    s_add_u32 s35, s38, 131072
    v_mfma_f32_16x16x32_bf16 v[136:139], a[208:211], a[136:139], v[136:139]
    ds_read_b64_tr_b16 a[228:229], v238 offset:8192
    v_mfma_f32_16x16x32_bf16 v[144:147], a[208:211], a[144:147], v[144:147]
    buffer_load_dwordx4 v240, s[12:15], s35 offen lds
    v_mfma_f32_16x16x32_bf16 v[144:147], a[212:215], a[148:151], v[144:147]
    ds_read_b64_tr_b16 a[230:231], v238 offset:9216
    s_add_u32 m0, s37, 151552
    v_mfma_f32_16x16x32_bf16 v[152:155], a[212:215], a[156:159], v[152:155]
    s_add_u32 s35, s39, 131328
    v_mfma_f32_16x16x32_bf16 v[152:155], a[208:211], a[152:155], v[152:155]
    s_waitcnt lgkmcnt(4)
    v_mfma_f32_16x16x32_bf16 v[132:135], a[216:219], a[128:131], v[132:135]
    buffer_load_dwordx4 v241, s[16:19], s35 offen lds
    v_mfma_f32_16x16x32_bf16 v[132:135], a[220:223], a[132:135], v[132:135]
    ds_read_b64_tr_b16 a[232:233], v238 offset:8
    s_add_u32 m0, s37, 114688
    v_mfma_f32_16x16x32_bf16 v[140:143], a[220:223], a[140:143], v[140:143]
    ds_read_b64_tr_b16 a[234:235], v238 offset:1032
    s_add_u32 s35, s38, 163840
    v_mfma_f32_16x16x32_bf16 v[140:143], a[216:219], a[136:139], v[140:143]
    ds_read_b64_tr_b16 a[236:237], v238 offset:8200
    v_mfma_f32_16x16x32_bf16 v[148:151], a[216:219], a[144:147], v[148:151]
    buffer_load_dwordx4 v240, s[12:15], s35 offen lds
    v_mfma_f32_16x16x32_bf16 v[148:151], a[220:223], a[148:151], v[148:151]
    ds_read_b64_tr_b16 a[238:239], v238 offset:9224
    s_add_u32 m0, s37, 155648
    v_mfma_f32_16x16x32_bf16 v[156:159], a[220:223], a[156:159], v[156:159]
    s_add_u32 s35, s39, 262400
    v_mfma_f32_16x16x32_bf16 v[156:159], a[216:219], a[152:155], v[156:159]
    s_waitcnt lgkmcnt(4)
    v_mfma_f32_16x16x32_bf16 v[160:163], a[224:227], a[128:131], v[160:163]
    buffer_load_dwordx4 v241, s[16:19], s35 offen lds
    v_mfma_f32_16x16x32_bf16 v[160:163], a[228:231], a[132:135], v[160:163]
    ds_read_b64_tr_b16 a[208:209], v232 offset:16384
    s_add_u32 m0, s37, 118784
    v_mfma_f32_16x16x32_bf16 v[168:171], a[228:231], a[140:143], v[168:171]
    ds_read_b64_tr_b16 a[210:211], v232 offset:17408
    s_add_u32 s35, s38, 196608
    v_mfma_f32_16x16x32_bf16 v[168:171], a[224:227], a[136:139], v[168:171]
    ds_read_b64_tr_b16 a[212:213], v232 offset:24576
    v_mfma_f32_16x16x32_bf16 v[176:179], a[224:227], a[144:147], v[176:179]
    buffer_load_dwordx4 v240, s[12:15], s35 offen lds
    v_mfma_f32_16x16x32_bf16 v[176:179], a[228:231], a[148:151], v[176:179]
    ds_read_b64_tr_b16 a[214:215], v232 offset:25600
    s_add_u32 m0, s37, 159744
    v_mfma_f32_16x16x32_bf16 v[184:187], a[228:231], a[156:159], v[184:187]
    s_add_u32 s35, s39, 393472
    v_mfma_f32_16x16x32_bf16 v[184:187], a[224:227], a[152:155], v[184:187]
    s_waitcnt lgkmcnt(4)
    v_mfma_f32_16x16x32_bf16 v[164:167], a[232:235], a[128:131], v[164:167]
    buffer_load_dwordx4 v241, s[16:19], s35 offen lds
    v_mfma_f32_16x16x32_bf16 v[164:167], a[236:239], a[132:135], v[164:167]
    s_add_u32 m0, s37, 122880
    v_mfma_f32_16x16x32_bf16 v[172:175], a[236:239], a[140:143], v[172:175]
    ds_read_b64_tr_b16 a[216:217], v232 offset:16392
    s_add_u32 s35, s38, 229376
    v_mfma_f32_16x16x32_bf16 v[172:175], a[232:235], a[136:139], v[172:175]
    ds_read_b64_tr_b16 a[218:219], v232 offset:17416
    v_mfma_f32_16x16x32_bf16 v[180:183], a[232:235], a[144:147], v[180:183]
    buffer_load_dwordx4 v240, s[12:15], s35 offen lds
    v_mfma_f32_16x16x32_bf16 v[180:183], a[236:239], a[148:151], v[180:183]
    ds_read_b64_tr_b16 a[220:221], v232 offset:24584
    s_add_u32 m0, s37, 126976
    v_mfma_f32_16x16x32_bf16 v[188:191], a[236:239], a[156:159], v[188:191]
    ds_read_b64_tr_b16 a[222:223], v232 offset:25608
    s_add_u32 s35, s38, 262144
    v_mfma_f32_16x16x32_bf16 v[188:191], a[232:235], a[152:155], v[188:191]
    s_waitcnt lgkmcnt(4)
    v_mfma_f32_16x16x32_bf16 a[0:3], a[208:211], a[128:131], a[0:3]
    buffer_load_dwordx4 v240, s[12:15], s35 offen lds
    v_mfma_f32_16x16x32_bf16 a[0:3], a[212:215], a[132:135], a[0:3]
    s_add_u32 s38, s38, 128
    s_add_u32 s39, s39, 524288
    v_mfma_f32_16x16x32_bf16 a[8:11], a[212:215], a[140:143], a[8:11]
    s_and_b32 s38, s38, 1023
    s_and_b32 s39, s39, 4194303
    v_mfma_f32_16x16x32_bf16 a[8:11], a[208:211], a[136:139], a[8:11]
    s_add_u32 s35, s39, 524288
    v_mfma_f32_16x16x32_bf16 a[16:19], a[208:211], a[144:147], a[16:19]
    buffer_load_dword v247, v244, s[12:15], s38 offen offset:128
    v_mfma_f32_16x16x32_bf16 a[16:19], a[212:215], a[148:151], a[16:19]
    ds_read_b64_tr_b16 a[224:225], v234 offset:16384
    v_mfma_f32_16x16x32_bf16 a[24:27], a[212:215], a[156:159], a[24:27]
    ds_read_b64_tr_b16 a[226:227], v234 offset:17408
    v_mfma_f32_16x16x32_bf16 a[24:27], a[208:211], a[152:155], a[24:27]
    ds_read_b64_tr_b16 a[228:229], v234 offset:24576
    v_mfma_f32_16x16x32_bf16 v[208:211], a[208:211], a[160:163], v[208:211]
    buffer_load_dword v247, v245, s[16:19], s35 offen
    v_mfma_f32_16x16x32_bf16 v[208:211], a[212:215], a[164:167], v[208:211]
    ds_read_b64_tr_b16 a[230:231], v234 offset:25600
    s_waitcnt lgkmcnt(4)
    v_mfma_f32_16x16x32_bf16 a[4:7], a[216:219], a[128:131], a[4:7]
    v_mfma_f32_16x16x32_bf16 a[4:7], a[220:223], a[132:135], a[4:7]
    v_mfma_f32_16x16x32_bf16 a[12:15], a[220:223], a[140:143], a[12:15]
    v_mfma_f32_16x16x32_bf16 a[12:15], a[216:219], a[136:139], a[12:15]
    v_mfma_f32_16x16x32_bf16 a[20:23], a[216:219], a[144:147], a[20:23]
    buffer_load_dword v247, v246, s[56:59], s55 offen
    v_mfma_f32_16x16x32_bf16 a[20:23], a[220:223], a[148:151], a[20:23]
    ds_read_b64_tr_b16 a[232:233], v234 offset:16392
    s_add_u32 s55, s55, 1280
    v_mfma_f32_16x16x32_bf16 a[28:31], a[220:223], a[156:159], a[28:31]
    ds_read_b64_tr_b16 a[234:235], v234 offset:17416
    v_mfma_f32_16x16x32_bf16 a[28:31], a[216:219], a[152:155], a[28:31]
    ds_read_b64_tr_b16 a[236:237], v234 offset:24584
    v_mfma_f32_16x16x32_bf16 v[212:215], a[216:219], a[160:163], v[212:215]
    ds_read_b64_tr_b16 a[238:239], v234 offset:25608
    v_mfma_f32_16x16x32_bf16 v[212:215], a[220:223], a[164:167], v[212:215]
    s_waitcnt lgkmcnt(4)
    v_mfma_f32_16x16x32_bf16 a[32:35], a[224:227], a[128:131], a[32:35]
    v_mfma_f32_16x16x32_bf16 a[32:35], a[228:231], a[132:135], a[32:35]
    v_mfma_f32_16x16x32_bf16 a[40:43], a[228:231], a[140:143], a[40:43]
    v_mfma_f32_16x16x32_bf16 a[40:43], a[224:227], a[136:139], a[40:43]
    v_mfma_f32_16x16x32_bf16 a[48:51], a[224:227], a[144:147], a[48:51]
    ds_read_b64_tr_b16 a[208:209], v236 offset:16384
    v_mfma_f32_16x16x32_bf16 a[48:51], a[228:231], a[148:151], a[48:51]
    ds_read_b64_tr_b16 a[210:211], v236 offset:17408
    v_mfma_f32_16x16x32_bf16 a[56:59], a[228:231], a[156:159], a[56:59]
    ds_read_b64_tr_b16 a[212:213], v236 offset:24576
    v_mfma_f32_16x16x32_bf16 a[56:59], a[224:227], a[152:155], a[56:59]
    ds_read_b64_tr_b16 a[214:215], v236 offset:25600
    v_mfma_f32_16x16x32_bf16 v[216:219], a[224:227], a[160:163], v[216:219]
    v_mfma_f32_16x16x32_bf16 v[216:219], a[228:231], a[164:167], v[216:219]
    s_waitcnt lgkmcnt(4)
    v_mfma_f32_16x16x32_bf16 a[36:39], a[232:235], a[128:131], a[36:39]
    v_mfma_f32_16x16x32_bf16 a[36:39], a[236:239], a[132:135], a[36:39]
    v_mfma_f32_16x16x32_bf16 a[44:47], a[236:239], a[140:143], a[44:47]
    ds_read_b64_tr_b16 a[216:217], v236 offset:16392
    v_mfma_f32_16x16x32_bf16 a[44:47], a[232:235], a[136:139], a[44:47]
    ds_read_b64_tr_b16 a[218:219], v236 offset:17416
    v_mfma_f32_16x16x32_bf16 a[52:55], a[232:235], a[144:147], a[52:55]
    ds_read_b64_tr_b16 a[220:221], v236 offset:24584
    v_mfma_f32_16x16x32_bf16 a[52:55], a[236:239], a[148:151], a[52:55]
    ds_read_b64_tr_b16 a[222:223], v236 offset:25608
    v_mfma_f32_16x16x32_bf16 a[60:63], a[236:239], a[156:159], a[60:63]
    v_mfma_f32_16x16x32_bf16 a[60:63], a[232:235], a[152:155], a[60:63]
    ds_read_b64_tr_b16 a[224:225], v238 offset:16384
    v_mfma_f32_16x16x32_bf16 v[220:223], a[232:235], a[160:163], v[220:223]
    ds_read_b64_tr_b16 a[226:227], v238 offset:17408
    v_mfma_f32_16x16x32_bf16 v[220:223], a[236:239], a[164:167], v[220:223]
    ds_read_b64_tr_b16 a[228:229], v238 offset:24576
    s_waitcnt lgkmcnt(7)
    v_mfma_f32_16x16x32_bf16 a[64:67], a[208:211], a[128:131], a[64:67]
    ds_read_b64_tr_b16 a[230:231], v238 offset:25600
    v_mfma_f32_16x16x32_bf16 a[64:67], a[212:215], a[132:135], a[64:67]
    ds_read_b64_tr_b16 a[232:233], v238 offset:16392
    v_mfma_f32_16x16x32_bf16 a[72:75], a[212:215], a[140:143], a[72:75]
    ds_read_b64_tr_b16 a[234:235], v238 offset:17416
    v_mfma_f32_16x16x32_bf16 a[72:75], a[208:211], a[136:139], a[72:75]
    ds_read_b64_tr_b16 a[236:237], v238 offset:24584
    v_mfma_f32_16x16x32_bf16 a[80:83], a[208:211], a[144:147], a[80:83]
    ds_read_b64_tr_b16 a[238:239], v238 offset:25608
    v_mfma_f32_16x16x32_bf16 a[80:83], a[212:215], a[148:151], a[80:83]
    v_mfma_f32_16x16x32_bf16 a[88:91], a[212:215], a[156:159], a[88:91]
    v_mfma_f32_16x16x32_bf16 a[88:91], a[208:211], a[152:155], a[88:91]
    s_waitcnt lgkmcnt(8)
    v_mfma_f32_16x16x32_bf16 a[68:71], a[216:219], a[128:131], a[68:71]
    v_mfma_f32_16x16x32_bf16 a[68:71], a[220:223], a[132:135], a[68:71]
    v_mfma_f32_16x16x32_bf16 a[76:79], a[220:223], a[140:143], a[76:79]
    v_mfma_f32_16x16x32_bf16 a[76:79], a[216:219], a[136:139], a[76:79]
    v_mfma_f32_16x16x32_bf16 a[84:87], a[216:219], a[144:147], a[84:87]
    v_mfma_f32_16x16x32_bf16 a[84:87], a[220:223], a[148:151], a[84:87]
    s_waitcnt lgkmcnt(0)
    s_waitcnt vmcnt(3)
    v_mfma_f32_16x16x32_bf16 a[92:95], a[220:223], a[156:159], a[92:95]
    s_barrier
    v_mfma_f32_16x16x32_bf16 a[92:95], a[216:219], a[152:155], a[92:95]
    s_waitcnt lgkmcnt(15)
    v_mfma_f32_16x16x32_bf16 a[96:99], a[224:227], a[128:131], a[96:99]
    ds_read_b64_tr_b16 a[208:209], v233 offset:0
    v_mfma_f32_16x16x32_bf16 a[96:99], a[228:231], a[132:135], a[96:99]
    ds_read_b64_tr_b16 a[210:211], v233 offset:1024
    v_mfma_f32_16x16x32_bf16 a[104:107], a[228:231], a[140:143], a[104:107]
    ds_read_b128 a[168:171], v225 offset:0
    v_mfma_f32_16x16x32_bf16 a[104:107], a[224:227], a[136:139], a[104:107]
    ds_read_b64_tr_b16 a[212:213], v233 offset:8192
    v_mfma_f32_16x16x32_bf16 a[112:115], a[224:227], a[144:147], a[112:115]
    ds_read_b64_tr_b16 a[214:215], v233 offset:9216
    v_mfma_f32_16x16x32_bf16 a[112:115], a[228:231], a[148:151], a[112:115]
    ds_read_b128 a[172:175], v227 offset:0
    v_mfma_f32_16x16x32_bf16 a[120:123], a[228:231], a[156:159], a[120:123]
    ds_read_b128 a[176:179], v225 offset:2048
    v_mfma_f32_16x16x32_bf16 a[120:123], a[224:227], a[152:155], a[120:123]
    ds_read_b128 a[180:183], v227 offset:2048
    s_waitcnt lgkmcnt(15)
    v_mfma_f32_16x16x32_bf16 a[100:103], a[232:235], a[128:131], a[100:103]
    ds_read_b128 a[184:187], v225 offset:4096
    v_mfma_f32_16x16x32_bf16 a[100:103], a[236:239], a[132:135], a[100:103]
    ds_read_b128 a[188:191], v227 offset:4096
    v_mfma_f32_16x16x32_bf16 a[108:111], a[236:239], a[140:143], a[108:111]
    ds_read_b128 a[192:195], v225 offset:6144
    v_mfma_f32_16x16x32_bf16 a[108:111], a[232:235], a[136:139], a[108:111]
    ds_read_b128 a[196:199], v227 offset:6144
    v_mfma_f32_16x16x32_bf16 a[116:119], a[232:235], a[144:147], a[116:119]
    ds_read_b128 a[200:203], v229 offset:0
    v_mfma_f32_16x16x32_bf16 a[116:119], a[236:239], a[148:151], a[116:119]
    ds_read_b128 a[204:207], v231 offset:0
    v_mfma_f32_16x16x32_bf16 a[124:127], a[236:239], a[156:159], a[124:127]
    ds_read_b64_tr_b16 a[216:217], v233 offset:8
    s_waitcnt lgkmcnt(7)
    v_mfma_f32_16x16x32_bf16 a[124:127], a[232:235], a[152:155], a[124:127]
    ds_read_b64_tr_b16 a[218:219], v233 offset:1032
    s_waitcnt lgkmcnt(15)
    s_sub_u32 s32, s32, 1
    s_cmp_lg_u32 s32, 0
    s_cbranch_scc1 L_qp
    v_mfma_f32_16x16x32_bf16 v[64:67], a[208:211], a[168:171], v[64:67]
    ds_read_b64_tr_b16 a[220:221], v233 offset:8200
    v_lshl_add_u32 v242, v1, 11, v38
    v_mfma_f32_16x16x32_bf16 v[64:67], a[212:215], a[172:175], v[64:67]
    ds_read_b64_tr_b16 a[222:223], v233 offset:9224
    v_add_u32 v242, 81920, v242
    v_mfma_f32_16x16x32_bf16 v[72:75], a[212:215], a[180:183], v[72:75]
    s_add_u32 m0, s29, 0
    v_xor_b32 v243, 0x1000, v242
    v_mfma_f32_16x16x32_bf16 v[72:75], a[208:211], a[176:179], v[72:75]
    s_waitcnt lgkmcnt(8)
    v_mfma_f32_16x16x32_bf16 v[80:83], a[208:211], a[184:187], v[80:83]
    ds_read_b64_tr_b16 a[224:225], v235 offset:0
    v_mfma_f32_16x16x32_bf16 v[80:83], a[212:215], a[188:191], v[80:83]
    ds_read_b64_tr_b16 a[226:227], v235 offset:1024
    s_waitcnt lgkmcnt(8)
    v_mfma_f32_16x16x32_bf16 v[88:91], a[212:215], a[196:199], v[88:91]
    ds_read_b64_tr_b16 a[228:229], v235 offset:8192
    v_mfma_f32_16x16x32_bf16 v[88:91], a[208:211], a[192:195], v[88:91]
    ds_read_b64_tr_b16 a[230:231], v235 offset:9216
    s_waitcnt lgkmcnt(8)
    v_mfma_f32_16x16x32_bf16 v[192:195], a[208:211], a[200:203], v[192:195]
    buffer_load_dwordx4 v32, s[4:7], s30 offen offset:0 nt lds
    v_mfma_f32_16x16x32_bf16 v[192:195], a[212:215], a[204:207], v[192:195]
    s_waitcnt lgkmcnt(4)
    v_mfma_f32_16x16x32_bf16 v[68:71], a[216:219], a[168:171], v[68:71]
    v_mfma_f32_16x16x32_bf16 v[68:71], a[220:223], a[172:175], v[68:71]
    v_mfma_f32_16x16x32_bf16 v[76:79], a[220:223], a[180:183], v[76:79]
    v_mfma_f32_16x16x32_bf16 v[76:79], a[216:219], a[176:179], v[76:79]
    buffer_load_dwordx4 v33, s[4:7], s30 offen offset:1024 nt lds
    v_mfma_f32_16x16x32_bf16 v[84:87], a[216:219], a[184:187], v[84:87]
    ds_read_b64_tr_b16 a[232:233], v235 offset:8
    v_mfma_f32_16x16x32_bf16 v[84:87], a[220:223], a[188:191], v[84:87]
    ds_read_b64_tr_b16 a[234:235], v235 offset:1032
    v_mfma_f32_16x16x32_bf16 v[92:95], a[220:223], a[196:199], v[92:95]
    v_mul_f32 v64, s66, v64
    v_mul_f32 v65, s66, v65
    v_mfma_f32_16x16x32_bf16 v[92:95], a[216:219], a[192:195], v[92:95]
    ds_read_b64_tr_b16 a[236:237], v235 offset:8200
    v_mul_f32 v66, s66, v66
    v_mfma_f32_16x16x32_bf16 v[196:199], a[216:219], a[200:203], v[196:199]
    ds_read_b64_tr_b16 a[238:239], v235 offset:9224
    v_mul_f32 v67, s66, v67
    v_mfma_f32_16x16x32_bf16 v[196:199], a[220:223], a[204:207], v[196:199]
    v_mul_f32 v68, s66, v68
    s_waitcnt lgkmcnt(4)
    v_mfma_f32_16x16x32_bf16 v[96:99], a[224:227], a[168:171], v[96:99]
    v_mul_f32 v69, s66, v69
    v_mul_f32 v70, s66, v70
    v_mfma_f32_16x16x32_bf16 v[96:99], a[228:231], a[172:175], v[96:99]
    v_mul_f32 v71, s66, v71
    v_cvt_pk_bf16_f32 v64, v64, v65
    v_mfma_f32_16x16x32_bf16 v[104:107], a[228:231], a[180:183], v[104:107]
    v_cvt_pk_bf16_f32 v65, v66, v67
    v_cvt_pk_bf16_f32 v66, v68, v69
    v_mfma_f32_16x16x32_bf16 v[104:107], a[224:227], a[176:179], v[104:107]
    v_cvt_pk_bf16_f32 v67, v70, v71
    v_mul_f32 v72, s66, v72
    v_mfma_f32_16x16x32_bf16 v[112:115], a[224:227], a[184:187], v[112:115]
    buffer_load_dwordx4 v34, s[4:7], s30 offen offset:2048 nt lds
    v_mfma_f32_16x16x32_bf16 v[112:115], a[228:231], a[188:191], v[112:115]
    ds_read_b64_tr_b16 a[208:209], v237 offset:0
    v_mul_f32 v73, s66, v73
    v_mfma_f32_16x16x32_bf16 v[120:123], a[228:231], a[196:199], v[120:123]
    ds_read_b64_tr_b16 a[210:211], v237 offset:1024
    v_mul_f32 v74, s66, v74
    v_mfma_f32_16x16x32_bf16 v[120:123], a[224:227], a[192:195], v[120:123]
    ds_read_b64_tr_b16 a[212:213], v237 offset:8192
    s_waitcnt lgkmcnt(3)
    v_mfma_f32_16x16x32_bf16 v[200:203], a[224:227], a[200:203], v[200:203]
    v_mul_f32 v75, s66, v75
    v_mul_f32 v76, s66, v76
    v_mfma_f32_16x16x32_bf16 v[200:203], a[228:231], a[204:207], v[200:203]
    ds_read_b64_tr_b16 a[214:215], v237 offset:9216
    v_mul_f32 v77, s66, v77
    v_mfma_f32_16x16x32_bf16 v[100:103], a[232:235], a[168:171], v[100:103]
    v_mul_f32 v78, s66, v78
    v_mul_f32 v79, s66, v79
    v_mfma_f32_16x16x32_bf16 v[100:103], a[236:239], a[172:175], v[100:103]
    v_cvt_pk_bf16_f32 v68, v72, v73
    v_cvt_pk_bf16_f32 v69, v74, v75
    v_mfma_f32_16x16x32_bf16 v[108:111], a[236:239], a[180:183], v[108:111]
    v_cvt_pk_bf16_f32 v70, v76, v77
    v_cvt_pk_bf16_f32 v71, v78, v79
    v_mfma_f32_16x16x32_bf16 v[108:111], a[232:235], a[176:179], v[108:111]
    ds_read_b64_tr_b16 a[216:217], v237 offset:8
    v_mul_f32 v80, s66, v80
    v_mfma_f32_16x16x32_bf16 v[116:119], a[232:235], a[184:187], v[116:119]
    ds_read_b64_tr_b16 a[218:219], v237 offset:1032
    v_mul_f32 v81, s66, v81
    v_mfma_f32_16x16x32_bf16 v[116:119], a[236:239], a[188:191], v[116:119]
    ds_read_b64_tr_b16 a[220:221], v237 offset:8200
    v_mul_f32 v82, s66, v82
    v_mfma_f32_16x16x32_bf16 v[124:127], a[236:239], a[196:199], v[124:127]
    buffer_load_dwordx4 v35, s[4:7], s30 offen offset:3072 nt lds
    v_mfma_f32_16x16x32_bf16 v[124:127], a[232:235], a[192:195], v[124:127]
    ds_read_b64_tr_b16 a[222:223], v237 offset:9224
    v_mul_f32 v83, s66, v83
    v_mfma_f32_16x16x32_bf16 v[204:207], a[232:235], a[200:203], v[204:207]
    v_mul_f32 v84, s66, v84
    v_mul_f32 v85, s66, v85
    v_mfma_f32_16x16x32_bf16 v[204:207], a[236:239], a[204:207], v[204:207]
    v_mul_f32 v86, s66, v86
    s_waitcnt lgkmcnt(4)
    v_mfma_f32_16x16x32_bf16 v[128:131], a[208:211], a[168:171], v[128:131]
    v_mul_f32 v87, s66, v87
    v_cvt_pk_bf16_f32 v72, v80, v81
    v_mfma_f32_16x16x32_bf16 v[128:131], a[212:215], a[172:175], v[128:131]
    ds_read_b64_tr_b16 a[224:225], v239 offset:0
    v_cvt_pk_bf16_f32 v73, v82, v83
    v_mfma_f32_16x16x32_bf16 v[136:139], a[212:215], a[180:183], v[136:139]
    ds_read_b64_tr_b16 a[226:227], v239 offset:1024
    v_cvt_pk_bf16_f32 v74, v84, v85
    v_mfma_f32_16x16x32_bf16 v[136:139], a[208:211], a[176:179], v[136:139]
    ds_read_b64_tr_b16 a[228:229], v239 offset:8192
    v_cvt_pk_bf16_f32 v75, v86, v87
    v_mfma_f32_16x16x32_bf16 v[144:147], a[208:211], a[184:187], v[144:147]
    v_mul_f32 v88, s66, v88
    v_mul_f32 v89, s66, v89
    v_mfma_f32_16x16x32_bf16 v[144:147], a[212:215], a[188:191], v[144:147]
    ds_read_b64_tr_b16 a[230:231], v239 offset:9216
    v_mul_f32 v90, s66, v90
    v_mfma_f32_16x16x32_bf16 v[152:155], a[212:215], a[196:199], v[152:155]
    s_add_u32 s30, s30, 16384
    s_add_u32 m0, s29, 65536
    v_mfma_f32_16x16x32_bf16 v[152:155], a[208:211], a[192:195], v[152:155]
    v_mul_f32 v91, s66, v91
    s_waitcnt lgkmcnt(4)
    v_mfma_f32_16x16x32_bf16 v[132:135], a[216:219], a[168:171], v[132:135]
    buffer_load_dwordx4 v36, s[8:11], s31 offen offset:0 nt lds
    v_mfma_f32_16x16x32_bf16 v[132:135], a[220:223], a[172:175], v[132:135]
    ds_read_b64_tr_b16 a[232:233], v239 offset:8
    v_mul_f32 v92, s66, v92
    v_mfma_f32_16x16x32_bf16 v[140:143], a[220:223], a[180:183], v[140:143]
    ds_read_b64_tr_b16 a[234:235], v239 offset:1032
    v_mul_f32 v93, s66, v93
    v_mfma_f32_16x16x32_bf16 v[140:143], a[216:219], a[176:179], v[140:143]
    ds_read_b64_tr_b16 a[236:237], v239 offset:8200
    v_mul_f32 v94, s66, v94
    v_mfma_f32_16x16x32_bf16 v[148:151], a[216:219], a[184:187], v[148:151]
    v_mul_f32 v95, s66, v95
    v_cvt_pk_bf16_f32 v76, v88, v89
    v_mfma_f32_16x16x32_bf16 v[148:151], a[220:223], a[188:191], v[148:151]
    ds_read_b64_tr_b16 a[238:239], v239 offset:9224
    v_cvt_pk_bf16_f32 v77, v90, v91
    v_mfma_f32_16x16x32_bf16 v[156:159], a[220:223], a[196:199], v[156:159]
    v_cvt_pk_bf16_f32 v78, v92, v93
    v_cvt_pk_bf16_f32 v79, v94, v95
    v_mfma_f32_16x16x32_bf16 v[156:159], a[216:219], a[192:195], v[156:159]
    v_mul_f32 v192, s66, v192
    s_waitcnt lgkmcnt(4)
    v_mfma_f32_16x16x32_bf16 v[160:163], a[224:227], a[168:171], v[160:163]
    v_mul_f32 v193, s66, v193
    v_mul_f32 v194, s66, v194
    v_mfma_f32_16x16x32_bf16 v[160:163], a[228:231], a[172:175], v[160:163]
    ds_read_b64_tr_b16 a[208:209], v233 offset:16384
    v_mul_f32 v195, s66, v195
    v_mfma_f32_16x16x32_bf16 v[168:171], a[228:231], a[180:183], v[168:171]
    ds_read_b64_tr_b16 a[210:211], v233 offset:17408
    v_mul_f32 v196, s66, v196
    v_mfma_f32_16x16x32_bf16 v[168:171], a[224:227], a[176:179], v[168:171]
    ds_read_b64_tr_b16 a[212:213], v233 offset:24576
    v_mul_f32 v197, s66, v197
    v_mfma_f32_16x16x32_bf16 v[176:179], a[224:227], a[184:187], v[176:179]
    buffer_load_dwordx4 v37, s[8:11], s31 offen offset:1024 nt lds
    v_mfma_f32_16x16x32_bf16 v[176:179], a[228:231], a[188:191], v[176:179]
    ds_read_b64_tr_b16 a[214:215], v233 offset:25600
    v_mul_f32 v198, s66, v198
    v_mfma_f32_16x16x32_bf16 v[184:187], a[228:231], a[196:199], v[184:187]
    v_mul_f32 v199, s66, v199
    v_cvt_pk_bf16_f32 v224, v192, v193
    v_mfma_f32_16x16x32_bf16 v[184:187], a[224:227], a[192:195], v[184:187]
    v_cvt_pk_bf16_f32 v225, v194, v195
    s_waitcnt lgkmcnt(4)
    v_mfma_f32_16x16x32_bf16 v[164:167], a[232:235], a[168:171], v[164:167]
    v_cvt_pk_bf16_f32 v226, v196, v197
    v_cvt_pk_bf16_f32 v227, v198, v199
    v_mfma_f32_16x16x32_bf16 v[164:167], a[236:239], a[172:175], v[164:167]
    ds_write_b128 v242, v[224:227] offset:0
    v_mul_f32 v96, s66, v96
    v_mfma_f32_16x16x32_bf16 v[172:175], a[236:239], a[180:183], v[172:175]
    ds_read_b64_tr_b16 a[216:217], v233 offset:16392
    v_mul_f32 v97, s66, v97
    v_mfma_f32_16x16x32_bf16 v[172:175], a[232:235], a[176:179], v[172:175]
    ds_read_b64_tr_b16 a[218:219], v233 offset:17416
    v_mul_f32 v98, s66, v98
    v_mfma_f32_16x16x32_bf16 v[180:183], a[232:235], a[184:187], v[180:183]
    buffer_load_dwordx4 v36, s[8:11], s31 offen offset:2048 nt lds
    v_mfma_f32_16x16x32_bf16 v[180:183], a[236:239], a[188:191], v[180:183]
    ds_read_b64_tr_b16 a[220:221], v233 offset:24584
    v_mul_f32 v99, s66, v99
    v_mfma_f32_16x16x32_bf16 v[188:191], a[236:239], a[196:199], v[188:191]
    ds_read_b64_tr_b16 a[222:223], v233 offset:25608
    v_mul_f32 v100, s66, v100
    v_mfma_f32_16x16x32_bf16 v[188:191], a[232:235], a[192:195], v[188:191]
    v_mul_f32 v101, s66, v101
    s_waitcnt lgkmcnt(5)
    v_mfma_f32_16x16x32_bf16 a[0:3], a[208:211], a[168:171], a[0:3]
    v_mul_f32 v102, s66, v102
    v_mul_f32 v103, s66, v103
    v_mfma_f32_16x16x32_bf16 a[0:3], a[212:215], a[172:175], a[0:3]
    v_cvt_pk_bf16_f32 v80, v96, v97
    v_cvt_pk_bf16_f32 v81, v98, v99
    v_mfma_f32_16x16x32_bf16 a[8:11], a[212:215], a[180:183], a[8:11]
    v_cvt_pk_bf16_f32 v82, v100, v101
    v_cvt_pk_bf16_f32 v83, v102, v103
    v_mfma_f32_16x16x32_bf16 a[8:11], a[208:211], a[176:179], a[8:11]
    v_mul_f32 v104, s66, v104
    v_mul_f32 v105, s66, v105
    v_mfma_f32_16x16x32_bf16 a[16:19], a[208:211], a[184:187], a[16:19]
    v_mul_f32 v106, s66, v106
    v_mul_f32 v107, s66, v107
    v_mfma_f32_16x16x32_bf16 a[16:19], a[212:215], a[188:191], a[16:19]
    ds_read_b64_tr_b16 a[224:225], v235 offset:16384
    v_mul_f32 v108, s66, v108
    v_mfma_f32_16x16x32_bf16 a[24:27], a[212:215], a[196:199], a[24:27]
    ds_read_b64_tr_b16 a[226:227], v235 offset:17408
    v_mul_f32 v109, s66, v109
    v_mfma_f32_16x16x32_bf16 a[24:27], a[208:211], a[192:195], a[24:27]
    ds_read_b64_tr_b16 a[228:229], v235 offset:24576
    v_mul_f32 v110, s66, v110
    v_mfma_f32_16x16x32_bf16 v[208:211], a[208:211], a[200:203], v[208:211]
    buffer_load_dwordx4 v37, s[8:11], s31 offen offset:3072 nt lds
    v_mfma_f32_16x16x32_bf16 v[208:211], a[212:215], a[204:207], v[208:211]
    ds_read_b64_tr_b16 a[230:231], v235 offset:25600
    s_waitcnt lgkmcnt(4)
    v_mfma_f32_16x16x32_bf16 a[4:7], a[216:219], a[168:171], a[4:7]
    v_mul_f32 v111, s66, v111
    v_cvt_pk_bf16_f32 v84, v104, v105
    v_mfma_f32_16x16x32_bf16 a[4:7], a[220:223], a[172:175], a[4:7]
    v_cvt_pk_bf16_f32 v85, v106, v107
    v_cvt_pk_bf16_f32 v86, v108, v109
    v_mfma_f32_16x16x32_bf16 a[12:15], a[220:223], a[180:183], a[12:15]
    v_cvt_pk_bf16_f32 v87, v110, v111
    v_mul_f32 v112, s66, v112
    v_mfma_f32_16x16x32_bf16 a[12:15], a[216:219], a[176:179], a[12:15]
    v_mul_f32 v113, s66, v113
    v_mul_f32 v114, s66, v114
    v_mfma_f32_16x16x32_bf16 a[20:23], a[216:219], a[184:187], a[20:23]
    v_mul_f32 v115, s66, v115
    v_mul_f32 v116, s66, v116
    v_mfma_f32_16x16x32_bf16 a[20:23], a[220:223], a[188:191], a[20:23]
    ds_read_b64_tr_b16 a[232:233], v235 offset:16392
    v_mul_f32 v117, s66, v117
    v_mfma_f32_16x16x32_bf16 a[28:31], a[220:223], a[196:199], a[28:31]
    ds_read_b64_tr_b16 a[234:235], v235 offset:17416
    v_mul_f32 v118, s66, v118
    v_mfma_f32_16x16x32_bf16 a[28:31], a[216:219], a[192:195], a[28:31]
    ds_read_b64_tr_b16 a[236:237], v235 offset:24584
    v_mul_f32 v119, s66, v119
    v_mfma_f32_16x16x32_bf16 v[212:215], a[216:219], a[200:203], v[212:215]
    ds_read_b64_tr_b16 a[238:239], v235 offset:25608
    s_add_u32 s31, s31, 16384
    v_mfma_f32_16x16x32_bf16 v[212:215], a[220:223], a[204:207], v[212:215]
    s_add_u32 m0, s29, 16384
    s_waitcnt lgkmcnt(4)
    v_mfma_f32_16x16x32_bf16 a[32:35], a[224:227], a[168:171], a[32:35]
    buffer_load_dwordx4 v32, s[4:7], s30 offen offset:0 nt lds
    v_mfma_f32_16x16x32_bf16 a[32:35], a[228:231], a[172:175], a[32:35]
    v_cvt_pk_bf16_f32 v88, v112, v113
    v_cvt_pk_bf16_f32 v89, v114, v115
    v_mfma_f32_16x16x32_bf16 a[40:43], a[228:231], a[180:183], a[40:43]
    v_cvt_pk_bf16_f32 v90, v116, v117
    v_cvt_pk_bf16_f32 v91, v118, v119
    v_mfma_f32_16x16x32_bf16 a[40:43], a[224:227], a[176:179], a[40:43]
    v_mul_f32 v120, s66, v120
    v_mul_f32 v121, s66, v121
    v_mfma_f32_16x16x32_bf16 a[48:51], a[224:227], a[184:187], a[48:51]
    ds_read_b64_tr_b16 a[208:209], v237 offset:16384
    v_mul_f32 v122, s66, v122
    v_mfma_f32_16x16x32_bf16 a[48:51], a[228:231], a[188:191], a[48:51]
    ds_read_b64_tr_b16 a[210:211], v237 offset:17408
    v_mul_f32 v123, s66, v123
    v_mfma_f32_16x16x32_bf16 a[56:59], a[228:231], a[196:199], a[56:59]
    ds_read_b64_tr_b16 a[212:213], v237 offset:24576
    v_mul_f32 v124, s66, v124
    v_mfma_f32_16x16x32_bf16 a[56:59], a[224:227], a[192:195], a[56:59]
    ds_read_b64_tr_b16 a[214:215], v237 offset:25600
    v_mul_f32 v125, s66, v125
    v_mfma_f32_16x16x32_bf16 v[216:219], a[224:227], a[200:203], v[216:219]
    v_mul_f32 v126, s66, v126
    v_mul_f32 v127, s66, v127
    v_mfma_f32_16x16x32_bf16 v[216:219], a[228:231], a[204:207], v[216:219]
    v_cvt_pk_bf16_f32 v92, v120, v121
    s_waitcnt lgkmcnt(4)
    v_mfma_f32_16x16x32_bf16 a[36:39], a[232:235], a[168:171], a[36:39]
    buffer_load_dwordx4 v33, s[4:7], s30 offen offset:1024 nt lds
    v_mfma_f32_16x16x32_bf16 a[36:39], a[236:239], a[172:175], a[36:39]
    v_cvt_pk_bf16_f32 v93, v122, v123
    v_cvt_pk_bf16_f32 v94, v124, v125
    v_mfma_f32_16x16x32_bf16 a[44:47], a[236:239], a[180:183], a[44:47]
    ds_read_b64_tr_b16 a[216:217], v237 offset:16392
    v_cvt_pk_bf16_f32 v95, v126, v127
    v_mfma_f32_16x16x32_bf16 a[44:47], a[232:235], a[176:179], a[44:47]
    ds_read_b64_tr_b16 a[218:219], v237 offset:17416
    v_mul_f32 v200, s66, v200
    v_mfma_f32_16x16x32_bf16 a[52:55], a[232:235], a[184:187], a[52:55]
    ds_read_b64_tr_b16 a[220:221], v237 offset:24584
    v_mul_f32 v201, s66, v201
    v_mfma_f32_16x16x32_bf16 a[52:55], a[236:239], a[188:191], a[52:55]
    ds_read_b64_tr_b16 a[222:223], v237 offset:25608
    v_mul_f32 v202, s66, v202
    v_mfma_f32_16x16x32_bf16 a[60:63], a[236:239], a[196:199], a[60:63]
    v_mul_f32 v203, s66, v203
    v_mul_f32 v204, s66, v204
    v_mfma_f32_16x16x32_bf16 a[60:63], a[232:235], a[192:195], a[60:63]
    ds_read_b64_tr_b16 a[224:225], v239 offset:16384
    v_mul_f32 v205, s66, v205
    v_mfma_f32_16x16x32_bf16 v[220:223], a[232:235], a[200:203], v[220:223]
    ds_read_b64_tr_b16 a[226:227], v239 offset:17408
    v_mul_f32 v206, s66, v206
    v_mfma_f32_16x16x32_bf16 v[220:223], a[236:239], a[204:207], v[220:223]
    ds_read_b64_tr_b16 a[228:229], v239 offset:24576
    s_waitcnt lgkmcnt(7)
    v_mfma_f32_16x16x32_bf16 a[64:67], a[208:211], a[168:171], a[64:67]
    ds_read_b64_tr_b16 a[230:231], v239 offset:25600
    v_mul_f32 v207, s66, v207
    v_mfma_f32_16x16x32_bf16 a[64:67], a[212:215], a[172:175], a[64:67]
    ds_read_b64_tr_b16 a[232:233], v239 offset:16392
    v_cvt_pk_bf16_f32 v228, v200, v201
    v_mfma_f32_16x16x32_bf16 a[72:75], a[212:215], a[180:183], a[72:75]
    ds_read_b64_tr_b16 a[234:235], v239 offset:17416
    v_cvt_pk_bf16_f32 v229, v202, v203
    v_mfma_f32_16x16x32_bf16 a[72:75], a[208:211], a[176:179], a[72:75]
    ds_read_b64_tr_b16 a[236:237], v239 offset:24584
    v_cvt_pk_bf16_f32 v230, v204, v205
    v_mfma_f32_16x16x32_bf16 a[80:83], a[208:211], a[184:187], a[80:83]
    ds_read_b64_tr_b16 a[238:239], v239 offset:25608
    v_cvt_pk_bf16_f32 v231, v206, v207
    v_mfma_f32_16x16x32_bf16 a[80:83], a[212:215], a[188:191], a[80:83]
    buffer_load_dwordx4 v34, s[4:7], s30 offen offset:2048 nt lds
    v_mfma_f32_16x16x32_bf16 a[88:91], a[212:215], a[196:199], a[88:91]
    ds_write_b128 v242, v[228:231] offset:1024
    v_mul_f32 v128, s66, v128
    v_mfma_f32_16x16x32_bf16 a[88:91], a[208:211], a[192:195], a[88:91]
    v_mul_f32 v129, s66, v129
    s_waitcnt lgkmcnt(9)
    v_mfma_f32_16x16x32_bf16 a[68:71], a[216:219], a[168:171], a[68:71]
    v_mul_f32 v130, s66, v130
    v_mul_f32 v131, s66, v131
    v_mfma_f32_16x16x32_bf16 a[68:71], a[220:223], a[172:175], a[68:71]
    v_mul_f32 v132, s66, v132
    v_mul_f32 v133, s66, v133
    v_mfma_f32_16x16x32_bf16 a[76:79], a[220:223], a[180:183], a[76:79]
    v_mul_f32 v134, s66, v134
    v_mul_f32 v135, s66, v135
    v_mfma_f32_16x16x32_bf16 a[76:79], a[216:219], a[176:179], a[76:79]
    buffer_load_dwordx4 v35, s[4:7], s30 offen offset:3072 nt lds
    v_mfma_f32_16x16x32_bf16 a[84:87], a[216:219], a[184:187], a[84:87]
    v_cvt_pk_bf16_f32 v96, v128, v129
    v_cvt_pk_bf16_f32 v97, v130, v131
    v_mfma_f32_16x16x32_bf16 a[84:87], a[220:223], a[188:191], a[84:87]
    v_cvt_pk_bf16_f32 v98, v132, v133
    v_cvt_pk_bf16_f32 v99, v134, v135
    v_mfma_f32_16x16x32_bf16 a[92:95], a[220:223], a[196:199], a[92:95]
    v_mul_f32 v136, s66, v136
    v_mul_f32 v137, s66, v137
    v_mfma_f32_16x16x32_bf16 a[92:95], a[216:219], a[192:195], a[92:95]
    v_mul_f32 v138, s66, v138
    s_waitcnt lgkmcnt(5)
    v_mfma_f32_16x16x32_bf16 a[96:99], a[224:227], a[168:171], a[96:99]
    v_mul_f32 v139, s66, v139
    v_mul_f32 v140, s66, v140
    v_mfma_f32_16x16x32_bf16 a[96:99], a[228:231], a[172:175], a[96:99]
    v_mul_f32 v141, s66, v141
    v_mul_f32 v142, s66, v142
    v_mfma_f32_16x16x32_bf16 a[104:107], a[228:231], a[180:183], a[104:107]
    v_mul_f32 v143, s66, v143
    v_cvt_pk_bf16_f32 v100, v136, v137
    v_mfma_f32_16x16x32_bf16 a[104:107], a[224:227], a[176:179], a[104:107]
    v_cvt_pk_bf16_f32 v101, v138, v139
    v_cvt_pk_bf16_f32 v102, v140, v141
    v_mfma_f32_16x16x32_bf16 a[112:115], a[224:227], a[184:187], a[112:115]
    v_cvt_pk_bf16_f32 v103, v142, v143
    v_mul_f32 v144, s66, v144
    v_mfma_f32_16x16x32_bf16 a[112:115], a[228:231], a[188:191], a[112:115]
    v_mul_f32 v145, s66, v145
    v_mul_f32 v146, s66, v146
    v_mfma_f32_16x16x32_bf16 a[120:123], a[228:231], a[196:199], a[120:123]
    s_add_u32 s30, s30, 16384
    v_mul_f32 v147, s66, v147
    v_mfma_f32_16x16x32_bf16 a[120:123], a[224:227], a[192:195], a[120:123]
    v_mul_f32 v148, s66, v148
    s_waitcnt lgkmcnt(1)
    v_mfma_f32_16x16x32_bf16 a[100:103], a[232:235], a[168:171], a[100:103]
    v_mul_f32 v149, s66, v149
    v_mul_f32 v150, s66, v150
    v_mfma_f32_16x16x32_bf16 a[100:103], a[236:239], a[172:175], a[100:103]
    v_mul_f32 v151, s66, v151
    v_cvt_pk_bf16_f32 v104, v144, v145
    v_mfma_f32_16x16x32_bf16 a[108:111], a[236:239], a[180:183], a[108:111]
    v_cvt_pk_bf16_f32 v105, v146, v147
    v_cvt_pk_bf16_f32 v106, v148, v149
    v_mfma_f32_16x16x32_bf16 a[108:111], a[232:235], a[176:179], a[108:111]
    v_cvt_pk_bf16_f32 v107, v150, v151
    v_mul_f32 v152, s66, v152
    v_mfma_f32_16x16x32_bf16 a[116:119], a[232:235], a[184:187], a[116:119]
    v_mul_f32 v153, s66, v153
    v_mul_f32 v154, s66, v154
    v_mfma_f32_16x16x32_bf16 a[116:119], a[236:239], a[188:191], a[116:119]
    v_mul_f32 v155, s66, v155
    v_mul_f32 v156, s66, v156
    v_mfma_f32_16x16x32_bf16 a[124:127], a[236:239], a[196:199], a[124:127]
    v_mul_f32 v157, s66, v157
    v_mul_f32 v158, s66, v158
    v_mfma_f32_16x16x32_bf16 a[124:127], a[232:235], a[192:195], a[124:127]
    v_mul_f32 v159, s66, v159
    v_cvt_pk_bf16_f32 v108, v152, v153
    s_waitcnt lgkmcnt(0)
    s_barrier
    s_add_u32 m0, s29, 32768
    s_nop 0
    buffer_load_dwordx4 v32, s[4:7], s30 offen offset:0 nt lds
    v_cvt_pk_bf16_f32 v109, v154, v155
    v_cvt_pk_bf16_f32 v110, v156, v157
    v_cvt_pk_bf16_f32 v111, v158, v159
    v_pk_mul_f32 v[160:161], v[160:161], s[66:67] op_sel_hi:[1,0]
    v_pk_mul_f32 v[162:163], v[162:163], s[66:67] op_sel_hi:[1,0]
    v_pk_mul_f32 v[164:165], v[164:165], s[66:67] op_sel_hi:[1,0]
    v_pk_mul_f32 v[166:167], v[166:167], s[66:67] op_sel_hi:[1,0]
    v_cvt_pk_bf16_f32 v112, v160, v161
    v_cvt_pk_bf16_f32 v113, v162, v163
    v_cvt_pk_bf16_f32 v114, v164, v165
    v_cvt_pk_bf16_f32 v115, v166, v167
    v_pk_mul_f32 v[168:169], v[168:169], s[66:67] op_sel_hi:[1,0]
    v_pk_mul_f32 v[170:171], v[170:171], s[66:67] op_sel_hi:[1,0]
    v_pk_mul_f32 v[172:173], v[172:173], s[66:67] op_sel_hi:[1,0]
    v_pk_mul_f32 v[174:175], v[174:175], s[66:67] op_sel_hi:[1,0]
    v_cvt_pk_bf16_f32 v116, v168, v169
    v_cvt_pk_bf16_f32 v117, v170, v171
    v_cvt_pk_bf16_f32 v118, v172, v173
    v_cvt_pk_bf16_f32 v119, v174, v175
    v_pk_mul_f32 v[176:177], v[176:177], s[66:67] op_sel_hi:[1,0]
    v_pk_mul_f32 v[178:179], v[178:179], s[66:67] op_sel_hi:[1,0]
    v_pk_mul_f32 v[180:181], v[180:181], s[66:67] op_sel_hi:[1,0]
    v_pk_mul_f32 v[182:183], v[182:183], s[66:67] op_sel_hi:[1,0]
    v_cvt_pk_bf16_f32 v120, v176, v177
    v_cvt_pk_bf16_f32 v121, v178, v179
    v_cvt_pk_bf16_f32 v122, v180, v181
    v_cvt_pk_bf16_f32 v123, v182, v183
    v_pk_mul_f32 v[184:185], v[184:185], s[66:67] op_sel_hi:[1,0]
    v_pk_mul_f32 v[186:187], v[186:187], s[66:67] op_sel_hi:[1,0]
    v_pk_mul_f32 v[188:189], v[188:189], s[66:67] op_sel_hi:[1,0]
    v_pk_mul_f32 v[190:191], v[190:191], s[66:67] op_sel_hi:[1,0]
    v_cvt_pk_bf16_f32 v124, v184, v185
    v_cvt_pk_bf16_f32 v125, v186, v187
    v_cvt_pk_bf16_f32 v126, v188, v189
    v_cvt_pk_bf16_f32 v127, v190, v191
    v_mov_b64 v[128:129], v[224:225]
    v_mov_b64 v[130:131], v[226:227]
    v_mov_b64 v[132:133], v[228:229]
    v_mov_b64 v[134:135], v[230:231]
    v_accvgpr_read_b32 v176, a0
    v_accvgpr_read_b32 v177, a1
    v_accvgpr_read_b32 v178, a2
    buffer_load_dwordx4 v33, s[4:7], s30 offen offset:1024 nt lds
    v_accvgpr_read_b32 v179, a3
    v_accvgpr_read_b32 v180, a4
    v_accvgpr_read_b32 v181, a5
    v_accvgpr_read_b32 v182, a6
    v_accvgpr_read_b32 v183, a7
    v_pk_mul_f32 v[176:177], v[176:177], s[66:67] op_sel_hi:[1,0]
    v_pk_mul_f32 v[178:179], v[178:179], s[66:67] op_sel_hi:[1,0]
    v_pk_mul_f32 v[180:181], v[180:181], s[66:67] op_sel_hi:[1,0]
    v_pk_mul_f32 v[182:183], v[182:183], s[66:67] op_sel_hi:[1,0]
    v_cvt_pk_bf16_f32 v144, v176, v177
    v_cvt_pk_bf16_f32 v145, v178, v179
    v_cvt_pk_bf16_f32 v146, v180, v181
    v_cvt_pk_bf16_f32 v147, v182, v183
    v_accvgpr_read_b32 v184, a8
    v_accvgpr_read_b32 v185, a9
    v_accvgpr_read_b32 v186, a10
    v_accvgpr_read_b32 v187, a11
    v_accvgpr_read_b32 v188, a12
    v_accvgpr_read_b32 v189, a13
    v_accvgpr_read_b32 v190, a14
    v_accvgpr_read_b32 v191, a15
    v_pk_mul_f32 v[184:185], v[184:185], s[66:67] op_sel_hi:[1,0]
    v_pk_mul_f32 v[186:187], v[186:187], s[66:67] op_sel_hi:[1,0]
    v_pk_mul_f32 v[188:189], v[188:189], s[66:67] op_sel_hi:[1,0]
    v_pk_mul_f32 v[190:191], v[190:191], s[66:67] op_sel_hi:[1,0]
    v_cvt_pk_bf16_f32 v148, v184, v185
    v_cvt_pk_bf16_f32 v149, v186, v187
    v_cvt_pk_bf16_f32 v150, v188, v189
    v_cvt_pk_bf16_f32 v151, v190, v191
    v_accvgpr_read_b32 v176, a16
    v_accvgpr_read_b32 v177, a17
    v_accvgpr_read_b32 v178, a18
    v_accvgpr_read_b32 v179, a19
    v_accvgpr_read_b32 v180, a20
    v_accvgpr_read_b32 v181, a21
    v_accvgpr_read_b32 v182, a22
    v_accvgpr_read_b32 v183, a23
    v_pk_mul_f32 v[176:177], v[176:177], s[66:67] op_sel_hi:[1,0]
    v_pk_mul_f32 v[178:179], v[178:179], s[66:67] op_sel_hi:[1,0]
    v_pk_mul_f32 v[180:181], v[180:181], s[66:67] op_sel_hi:[1,0]
    v_pk_mul_f32 v[182:183], v[182:183], s[66:67] op_sel_hi:[1,0]
    v_cvt_pk_bf16_f32 v152, v176, v177
    buffer_load_dwordx4 v34, s[4:7], s30 offen offset:2048 nt lds
    v_cvt_pk_bf16_f32 v153, v178, v179
    v_cvt_pk_bf16_f32 v154, v180, v181
    v_cvt_pk_bf16_f32 v155, v182, v183
    v_accvgpr_read_b32 v184, a24
    v_accvgpr_read_b32 v185, a25
    v_accvgpr_read_b32 v186, a26
    v_accvgpr_read_b32 v187, a27
    v_accvgpr_read_b32 v188, a28
    v_accvgpr_read_b32 v189, a29
    v_accvgpr_read_b32 v190, a30
    v_accvgpr_read_b32 v191, a31
    v_pk_mul_f32 v[184:185], v[184:185], s[66:67] op_sel_hi:[1,0]
    v_pk_mul_f32 v[186:187], v[186:187], s[66:67] op_sel_hi:[1,0]
    v_pk_mul_f32 v[188:189], v[188:189], s[66:67] op_sel_hi:[1,0]
    v_pk_mul_f32 v[190:191], v[190:191], s[66:67] op_sel_hi:[1,0]
    v_cvt_pk_bf16_f32 v156, v184, v185
    v_cvt_pk_bf16_f32 v157, v186, v187
    v_cvt_pk_bf16_f32 v158, v188, v189
    v_cvt_pk_bf16_f32 v159, v190, v191
    v_accvgpr_read_b32 v176, a32
    v_accvgpr_read_b32 v177, a33
    v_accvgpr_read_b32 v178, a34
    v_accvgpr_read_b32 v179, a35
    v_accvgpr_read_b32 v180, a36
    v_accvgpr_read_b32 v181, a37
    v_accvgpr_read_b32 v182, a38
    v_accvgpr_read_b32 v183, a39
    v_pk_mul_f32 v[176:177], v[176:177], s[66:67] op_sel_hi:[1,0]
    v_pk_mul_f32 v[178:179], v[178:179], s[66:67] op_sel_hi:[1,0]
    v_pk_mul_f32 v[180:181], v[180:181], s[66:67] op_sel_hi:[1,0]
    v_pk_mul_f32 v[182:183], v[182:183], s[66:67] op_sel_hi:[1,0]
    v_cvt_pk_bf16_f32 v160, v176, v177
    v_cvt_pk_bf16_f32 v161, v178, v179
    v_cvt_pk_bf16_f32 v162, v180, v181
    v_cvt_pk_bf16_f32 v163, v182, v183
    v_accvgpr_read_b32 v184, a40
    v_accvgpr_read_b32 v185, a41
    v_accvgpr_read_b32 v186, a42
    v_accvgpr_read_b32 v187, a43
    v_accvgpr_read_b32 v188, a44
    v_accvgpr_read_b32 v189, a45
    v_accvgpr_read_b32 v190, a46
    buffer_load_dwordx4 v35, s[4:7], s30 offen offset:3072 nt lds
    v_accvgpr_read_b32 v191, a47
    v_pk_mul_f32 v[184:185], v[184:185], s[66:67] op_sel_hi:[1,0]
    v_pk_mul_f32 v[186:187], v[186:187], s[66:67] op_sel_hi:[1,0]
    v_pk_mul_f32 v[188:189], v[188:189], s[66:67] op_sel_hi:[1,0]
    v_pk_mul_f32 v[190:191], v[190:191], s[66:67] op_sel_hi:[1,0]
    v_cvt_pk_bf16_f32 v164, v184, v185
    v_cvt_pk_bf16_f32 v165, v186, v187
    v_cvt_pk_bf16_f32 v166, v188, v189
    v_cvt_pk_bf16_f32 v167, v190, v191
    v_accvgpr_read_b32 v176, a48
    v_accvgpr_read_b32 v177, a49
    v_accvgpr_read_b32 v178, a50
    v_accvgpr_read_b32 v179, a51
    v_accvgpr_read_b32 v180, a52
    v_accvgpr_read_b32 v181, a53
    v_accvgpr_read_b32 v182, a54
    v_accvgpr_read_b32 v183, a55
    v_pk_mul_f32 v[176:177], v[176:177], s[66:67] op_sel_hi:[1,0]
    v_pk_mul_f32 v[178:179], v[178:179], s[66:67] op_sel_hi:[1,0]
    v_pk_mul_f32 v[180:181], v[180:181], s[66:67] op_sel_hi:[1,0]
    v_pk_mul_f32 v[182:183], v[182:183], s[66:67] op_sel_hi:[1,0]
    v_cvt_pk_bf16_f32 v168, v176, v177
    v_cvt_pk_bf16_f32 v169, v178, v179
    v_cvt_pk_bf16_f32 v170, v180, v181
    v_cvt_pk_bf16_f32 v171, v182, v183
    v_accvgpr_read_b32 v184, a56
    v_accvgpr_read_b32 v185, a57
    v_accvgpr_read_b32 v186, a58
    v_accvgpr_read_b32 v187, a59
    v_accvgpr_read_b32 v188, a60
    v_accvgpr_read_b32 v189, a61
    v_accvgpr_read_b32 v190, a62
    v_accvgpr_read_b32 v191, a63
    v_pk_mul_f32 v[184:185], v[184:185], s[66:67] op_sel_hi:[1,0]
    v_pk_mul_f32 v[186:187], v[186:187], s[66:67] op_sel_hi:[1,0]
    v_pk_mul_f32 v[188:189], v[188:189], s[66:67] op_sel_hi:[1,0]
    v_pk_mul_f32 v[190:191], v[190:191], s[66:67] op_sel_hi:[1,0]
    v_cvt_pk_bf16_f32 v172, v184, v185
    v_cvt_pk_bf16_f32 v173, v186, v187
    v_cvt_pk_bf16_f32 v174, v188, v189
    v_cvt_pk_bf16_f32 v175, v190, v191
    ds_read_b128 v[136:139], v243 offset:0
    s_add_u32 s30, s30, 16384
    s_add_u32 m0, s29, 49152
    s_nop 0
    buffer_load_dwordx4 v32, s[4:7], s30 offen offset:0 nt lds
    ds_read_b128 v[140:143], v243 offset:1024
    ds_write_b128 v39, v[144:147] offset:0
    v_accvgpr_read_b32 v176, a64
    v_accvgpr_read_b32 v177, a65
    v_accvgpr_read_b32 v178, a66
    v_accvgpr_read_b32 v179, a67
    v_accvgpr_read_b32 v180, a68
    v_accvgpr_read_b32 v181, a69
    v_accvgpr_read_b32 v182, a70
    v_accvgpr_read_b32 v183, a71
    v_pk_mul_f32 v[176:177], v[176:177], s[66:67] op_sel_hi:[1,0]
    v_pk_mul_f32 v[178:179], v[178:179], s[66:67] op_sel_hi:[1,0]
    v_pk_mul_f32 v[180:181], v[180:181], s[66:67] op_sel_hi:[1,0]
    v_pk_mul_f32 v[182:183], v[182:183], s[66:67] op_sel_hi:[1,0]
    v_cvt_pk_bf16_f32 v232, v176, v177
    v_cvt_pk_bf16_f32 v233, v178, v179
    v_cvt_pk_bf16_f32 v234, v180, v181
    v_cvt_pk_bf16_f32 v235, v182, v183
    v_accvgpr_read_b32 v184, a72
    v_accvgpr_read_b32 v185, a73
    v_accvgpr_read_b32 v186, a74
    v_accvgpr_read_b32 v187, a75
    ds_write_b128 v39, v[148:151] offset:1024
    v_accvgpr_read_b32 v188, a76
    v_accvgpr_read_b32 v189, a77
    v_accvgpr_read_b32 v190, a78
    v_accvgpr_read_b32 v191, a79
    v_pk_mul_f32 v[184:185], v[184:185], s[66:67] op_sel_hi:[1,0]
    v_pk_mul_f32 v[186:187], v[186:187], s[66:67] op_sel_hi:[1,0]
    v_pk_mul_f32 v[188:189], v[188:189], s[66:67] op_sel_hi:[1,0]
    v_pk_mul_f32 v[190:191], v[190:191], s[66:67] op_sel_hi:[1,0]
    v_cvt_pk_bf16_f32 v236, v184, v185
    v_cvt_pk_bf16_f32 v237, v186, v187
    v_cvt_pk_bf16_f32 v238, v188, v189
    v_cvt_pk_bf16_f32 v239, v190, v191
    v_accvgpr_read_b32 v176, a80
    v_accvgpr_read_b32 v177, a81
    v_accvgpr_read_b32 v178, a82
    v_accvgpr_read_b32 v179, a83
    v_accvgpr_read_b32 v180, a84
    v_accvgpr_read_b32 v181, a85
    v_accvgpr_read_b32 v182, a86
    buffer_load_dwordx4 v33, s[4:7], s30 offen offset:1024 nt lds
    v_accvgpr_read_b32 v183, a87
    ds_write_b128 v39, v[152:155] offset:2048
    v_pk_mul_f32 v[176:177], v[176:177], s[66:67] op_sel_hi:[1,0]
    v_pk_mul_f32 v[178:179], v[178:179], s[66:67] op_sel_hi:[1,0]
    v_pk_mul_f32 v[180:181], v[180:181], s[66:67] op_sel_hi:[1,0]
    v_pk_mul_f32 v[182:183], v[182:183], s[66:67] op_sel_hi:[1,0]
    v_cvt_pk_bf16_f32 v240, v176, v177
    v_cvt_pk_bf16_f32 v241, v178, v179
    v_cvt_pk_bf16_f32 v242, v180, v181
    v_cvt_pk_bf16_f32 v243, v182, v183
    v_accvgpr_read_b32 v184, a88
    v_accvgpr_read_b32 v185, a89
    v_accvgpr_read_b32 v186, a90
    v_accvgpr_read_b32 v187, a91
    v_accvgpr_read_b32 v188, a92
    v_accvgpr_read_b32 v189, a93
    v_accvgpr_read_b32 v190, a94
    v_accvgpr_read_b32 v191, a95
    v_pk_mul_f32 v[184:185], v[184:185], s[66:67] op_sel_hi:[1,0]
    v_pk_mul_f32 v[186:187], v[186:187], s[66:67] op_sel_hi:[1,0]
    v_pk_mul_f32 v[188:189], v[188:189], s[66:67] op_sel_hi:[1,0]
    v_pk_mul_f32 v[190:191], v[190:191], s[66:67] op_sel_hi:[1,0]
    ds_write_b128 v39, v[156:159] offset:3072
    v_cvt_pk_bf16_f32 v244, v184, v185
    v_cvt_pk_bf16_f32 v245, v186, v187
    v_cvt_pk_bf16_f32 v246, v188, v189
    s_waitcnt vmcnt(18)
    v_cvt_pk_bf16_f32 v247, v190, v191
    v_accvgpr_read_b32 v176, a96
    v_accvgpr_read_b32 v177, a97
    v_accvgpr_read_b32 v178, a98
    v_accvgpr_read_b32 v179, a99
    v_accvgpr_read_b32 v180, a100
    v_accvgpr_read_b32 v181, a101
    v_accvgpr_read_b32 v182, a102
    v_accvgpr_read_b32 v183, a103
    v_pk_mul_f32 v[176:177], v[176:177], s[66:67] op_sel_hi:[1,0]
    v_pk_mul_f32 v[178:179], v[178:179], s[66:67] op_sel_hi:[1,0]
    v_pk_mul_f32 v[180:181], v[180:181], s[66:67] op_sel_hi:[1,0]
    v_pk_mul_f32 v[182:183], v[182:183], s[66:67] op_sel_hi:[1,0]
    v_cvt_pk_bf16_f32 v248, v176, v177
    v_cvt_pk_bf16_f32 v249, v178, v179
    v_cvt_pk_bf16_f32 v250, v180, v181
    buffer_load_dwordx4 v34, s[4:7], s30 offen offset:2048 nt lds
    ds_write_b128 v39, v[160:163] offset:4096
    v_cvt_pk_bf16_f32 v251, v182, v183
    v_accvgpr_read_b32 v184, a104
    v_accvgpr_read_b32 v185, a105
    v_accvgpr_read_b32 v186, a106
    v_accvgpr_read_b32 v187, a107
    v_accvgpr_read_b32 v188, a108
    v_accvgpr_read_b32 v189, a109
    v_accvgpr_read_b32 v190, a110
    v_accvgpr_read_b32 v191, a111
    v_pk_mul_f32 v[184:185], v[184:185], s[66:67] op_sel_hi:[1,0]
    v_pk_mul_f32 v[186:187], v[186:187], s[66:67] op_sel_hi:[1,0]
    v_pk_mul_f32 v[188:189], v[188:189], s[66:67] op_sel_hi:[1,0]
    v_pk_mul_f32 v[190:191], v[190:191], s[66:67] op_sel_hi:[1,0]
    v_cvt_pk_bf16_f32 v252, v184, v185
    v_cvt_pk_bf16_f32 v253, v186, v187
    v_cvt_pk_bf16_f32 v254, v188, v189
    v_cvt_pk_bf16_f32 v255, v190, v191
    v_accvgpr_read_b32 v176, a112
    v_accvgpr_read_b32 v177, a113
    v_accvgpr_read_b32 v178, a114
    ds_write_b128 v39, v[164:167] offset:5120
    v_accvgpr_read_b32 v179, a115
    v_accvgpr_read_b32 v180, a116
    v_accvgpr_read_b32 v181, a117
    v_accvgpr_read_b32 v182, a118
    v_accvgpr_read_b32 v183, a119
    v_pk_mul_f32 v[176:177], v[176:177], s[66:67] op_sel_hi:[1,0]
    v_pk_mul_f32 v[178:179], v[178:179], s[66:67] op_sel_hi:[1,0]
    v_pk_mul_f32 v[180:181], v[180:181], s[66:67] op_sel_hi:[1,0]
    v_pk_mul_f32 v[182:183], v[182:183], s[66:67] op_sel_hi:[1,0]
    v_cvt_pk_bf16_f32 v176, v176, v177
    v_cvt_pk_bf16_f32 v177, v178, v179
    v_cvt_pk_bf16_f32 v178, v180, v181
    v_cvt_pk_bf16_f32 v179, v182, v183
    v_accvgpr_write_b32 a248, v176
    v_accvgpr_write_b32 a249, v177
    v_accvgpr_write_b32 a250, v178
    v_accvgpr_write_b32 a251, v179
    v_accvgpr_read_b32 v184, a120
    v_accvgpr_read_b32 v185, a121
    v_accvgpr_read_b32 v186, a122
    buffer_load_dwordx4 v35, s[4:7], s30 offen offset:3072 nt lds
    s_add_u32 s30, s30, 16384
    ds_write_b128 v39, v[168:171] offset:6144
    v_accvgpr_read_b32 v187, a123
    v_accvgpr_read_b32 v188, a124
    v_accvgpr_read_b32 v189, a125
    v_accvgpr_read_b32 v190, a126
    v_accvgpr_read_b32 v191, a127
    v_pk_mul_f32 v[184:185], v[184:185], s[66:67] op_sel_hi:[1,0]
    v_pk_mul_f32 v[186:187], v[186:187], s[66:67] op_sel_hi:[1,0]
    v_pk_mul_f32 v[188:189], v[188:189], s[66:67] op_sel_hi:[1,0]
    v_pk_mul_f32 v[190:191], v[190:191], s[66:67] op_sel_hi:[1,0]
    v_cvt_pk_bf16_f32 v184, v184, v185
    v_cvt_pk_bf16_f32 v185, v186, v187
    v_cvt_pk_bf16_f32 v186, v188, v189
    v_cvt_pk_bf16_f32 v187, v190, v191
    v_accvgpr_write_b32 a252, v184
    v_accvgpr_write_b32 a253, v185
    v_accvgpr_write_b32 a254, v186
    v_accvgpr_write_b32 a255, v187
    v_pk_mul_f32 v[208:209], v[208:209], s[66:67] op_sel_hi:[1,0]
    v_pk_mul_f32 v[210:211], v[210:211], s[66:67] op_sel_hi:[1,0]
    v_pk_mul_f32 v[212:213], v[212:213], s[66:67] op_sel_hi:[1,0]
    ds_write_b128 v39, v[172:175] offset:7168
    v_pk_mul_f32 v[214:215], v[214:215], s[66:67] op_sel_hi:[1,0]
    v_cvt_pk_bf16_f32 v208, v208, v209
    v_cvt_pk_bf16_f32 v209, v210, v211
    v_cvt_pk_bf16_f32 v210, v212, v213
    v_cvt_pk_bf16_f32 v211, v214, v215
    v_accvgpr_write_b32 a168, v208
    v_accvgpr_write_b32 a169, v209
    v_accvgpr_write_b32 a170, v210
    v_accvgpr_write_b32 a171, v211
    v_pk_mul_f32 v[216:217], v[216:217], s[66:67] op_sel_hi:[1,0]
    v_pk_mul_f32 v[218:219], v[218:219], s[66:67] op_sel_hi:[1,0]
    v_pk_mul_f32 v[220:221], v[220:221], s[66:67] op_sel_hi:[1,0]
    v_pk_mul_f32 v[222:223], v[222:223], s[66:67] op_sel_hi:[1,0]
    v_cvt_pk_bf16_f32 v216, v216, v217
    v_cvt_pk_bf16_f32 v217, v218, v219
    v_cvt_pk_bf16_f32 v218, v220, v221
    v_cvt_pk_bf16_f32 v219, v222, v223
    v_mov_b64 v[40:41], v[216:217]
    v_mov_b64 v[42:43], v[218:219]
    s_mov_b32 s52, 0x40000000
    s_mov_b32 s54, 99
    s_mov_b32 s38, 0
    s_mov_b32 s39, 0
    s_mov_b32 s91, 0
    s_add_u32 s90, s29, 0x28000
    v_mov_b32 v6, 0x3f803f80
    v_and_b32 v7, 1, v0
    v_mul_u32_u24 v7, 0x3f80, v7
    v_lshl_or_b32 v7, v7, 16, v7
    v_xor_b32 v6, v6, v7
    v_accvgpr_write_b32 a172, v7
    v_accvgpr_write_b32 a173, v7
    v_accvgpr_write_b32 a174, v7
    v_accvgpr_write_b32 a175, v7
    v_accvgpr_write_b32 a180, v6
    v_accvgpr_write_b32 a181, v6
    v_accvgpr_write_b32 a182, v6
    v_accvgpr_write_b32 a183, v6
    s_waitcnt lgkmcnt(0)
    s_waitcnt vmcnt(16)
    s_barrier
    s_add_u32 m0, s29, 81920
    s_nop 0
    buffer_load_dwordx4 v36, s[8:11], s31 offen offset:0 nt lds
    buffer_load_dwordx4 v37, s[8:11], s31 offen offset:1024 nt lds
    buffer_load_dwordx4 v36, s[8:11], s31 offen offset:2048 nt lds
    buffer_load_dwordx4 v37, s[8:11], s31 offen offset:3072 nt lds
    s_add_u32 s31, s31, 16384
    s_add_u32 m0, s29, 98304
    s_nop 0
    buffer_load_dwordx4 v36, s[8:11], s31 offen offset:0 nt lds
    buffer_load_dwordx4 v37, s[8:11], s31 offen offset:1024 nt lds
    buffer_load_dwordx4 v36, s[8:11], s31 offen offset:2048 nt lds
    buffer_load_dwordx4 v37, s[8:11], s31 offen offset:3072 nt lds
    s_add_u32 s31, s31, 16384
L_head:
    ds_read_b128 a[200:203], v9 offset:0
    ds_read_b128 a[204:207], v11 offset:0
    ds_read_b128 a[208:211], v13 offset:0
    ds_read_b128 a[212:215], v15 offset:0
    ds_read_b128 a[184:187], v8 offset:0
    ds_read_b128 a[188:191], v10 offset:0
    ds_read_b128 a[192:195], v12 offset:0
    ds_read_b128 a[196:199], v14 offset:0
    v_mov_b32 v196, 0
    v_mov_b32 v197, 0
    v_mov_b32 v198, 0
    v_mov_b32 v199, 0
    s_nop 1
    v_mfma_f32_32x32x16_bf16 a[0:15], v[196:199], v[196:199], 0
    v_mfma_f32_32x32x16_bf16 a[16:31], v[196:199], v[196:199], 0
    v_mfma_f32_32x32x16_bf16 a[32:47], v[196:199], v[196:199], 0
    s_waitcnt lgkmcnt(7)
    v_mfma_f32_16x16x32_bf16 v[180:183], a[200:203], v[128:131], 0
    s_waitcnt lgkmcnt(6)
    v_mfma_f32_16x16x32_bf16 v[180:183], a[204:207], v[132:135], v[180:183]
    s_waitcnt lgkmcnt(5)
    v_mfma_f32_16x16x32_bf16 v[180:183], a[208:211], v[136:139], v[180:183]
    s_waitcnt lgkmcnt(4)
    v_mfma_f32_16x16x32_bf16 v[180:183], a[212:215], v[140:143], v[180:183]
    s_waitcnt lgkmcnt(3)
    v_mfma_f32_16x16x32_bf16 v[176:179], a[184:187], v[128:131], 0
    s_waitcnt lgkmcnt(2)
    v_mfma_f32_16x16x32_bf16 v[176:179], a[188:191], v[132:135], v[176:179]
    s_waitcnt lgkmcnt(1)
    v_mfma_f32_16x16x32_bf16 v[176:179], a[192:195], v[136:139], v[176:179]
    s_waitcnt lgkmcnt(0)
    v_mfma_f32_16x16x32_bf16 v[176:179], a[196:199], v[140:143], v[176:179]
    v_mfma_f32_16x16x32_bf16 v[160:163], a[184:187], v[64:67], 0
    v_mfma_f32_16x16x32_bf16 v[160:163], a[188:191], v[80:83], v[160:163]
    v_mfma_f32_16x16x32_bf16 v[160:163], a[192:195], v[96:99], v[160:163]
    v_mfma_f32_16x16x32_bf16 v[160:163], a[196:199], v[112:115], v[160:163]
    v_mfma_f32_16x16x32_bf16 v[164:167], a[184:187], v[68:71], 0
    s_nop 2
    v_max3_f32 v176, v176, v177, v178
    v_mfma_f32_16x16x32_bf16 v[164:167], a[188:191], v[84:87], v[164:167]
    v_max_f32 v176, v176, v179
    v_max3_f32 v176, v176, v180, v181
    v_mfma_f32_16x16x32_bf16 v[164:167], a[192:195], v[100:103], v[164:167]
    v_max3_f32 v176, v176, v182, v183
    v_mov_b32 v177, v176
    v_mfma_f32_16x16x32_bf16 v[164:167], a[196:199], v[116:119], v[164:167]
    s_nop 0
    v_permlane32_swap_b32 v176, v177
    v_mfma_f32_16x16x32_bf16 v[168:171], a[184:187], v[72:75], 0
    v_max_f32 v176, v176, v177
    v_mov_b32 v177, v176
    v_mfma_f32_16x16x32_bf16 v[168:171], a[188:191], v[88:91], v[168:171]
    s_nop 0
    v_permlane16_swap_b32 v176, v177
    v_mfma_f32_16x16x32_bf16 v[168:171], a[192:195], v[104:107], v[168:171]
    v_max_f32 v176, v176, v177
    v_sub_f32 v60, 0, v176
    v_mfma_f32_16x16x32_bf16 v[168:171], a[196:199], v[120:123], v[168:171]
    v_sub_f32 v61, 0, v176
    v_sub_f32 v62, 0, v176
    v_mfma_f32_16x16x32_bf16 v[172:175], a[184:187], v[76:79], 0
    v_sub_f32 v63, 0, v176
    v_max3_f32 v160, v160, v161, v162
    v_mfma_f32_16x16x32_bf16 v[172:175], a[188:191], v[92:95], v[172:175]
    v_max_f32 v160, v160, v163
    v_mov_b32 v161, v160
    v_mfma_f32_16x16x32_bf16 v[172:175], a[192:195], v[108:111], v[172:175]
    s_nop 0
    v_permlane32_swap_b32 v160, v161
    v_mfma_f32_16x16x32_bf16 v[172:175], a[196:199], v[124:127], v[172:175]
    v_max_f32 v160, v160, v161
    v_mov_b32 v161, v160
    v_mfma_f32_32x32x16_bf16 a[48:63], v[196:199], v[196:199], 0
    s_nop 0
    v_permlane16_swap_b32 v160, v161
    v_max3_f32 v164, v164, v165, v166
    v_max3_f32 v168, v168, v169, v170
    s_nop 0
    v_max3_f32 v172, v172, v173, v174
    v_max_f32 v160, v160, v161
    v_mfma_f32_32x32x16_bf16 a[64:79], v[196:199], v[196:199], 0
    v_max_f32 v164, v164, v167
    v_max_f32 v168, v168, v171
    v_max_f32 v172, v172, v175
    v_sub_f32 v44, 0, v160
    v_mfma_f32_32x32x16_bf16 a[80:95], v[196:199], v[196:199], 0
    v_mov_b32 v165, v164
    v_mov_b32 v169, v168
    v_mov_b32 v173, v172
    v_sub_f32 v45, 0, v160
    v_mfma_f32_32x32x16_bf16 a[96:111], v[196:199], v[196:199], 0
    v_permlane32_swap_b32 v164, v165
    v_permlane32_swap_b32 v168, v169
    v_permlane32_swap_b32 v172, v173
    v_sub_f32 v46, 0, v160
    v_mfma_f32_32x32x16_bf16 a[112:127], v[196:199], v[196:199], 0
    v_max_f32 v164, v164, v165
    v_max_f32 v168, v168, v169
    v_max_f32 v172, v172, v173
    v_sub_f32 v47, 0, v160
    v_mfma_f32_32x32x16_bf16 a[128:143], v[196:199], v[196:199], 0
    v_mov_b32 v165, v164
    v_mov_b32 v169, v168
    v_mov_b32 v173, v172
    v_permlane16_swap_b32 v164, v165
    v_permlane16_swap_b32 v168, v169
    v_mfma_f32_32x32x16_bf16 a[144:159], v[196:199], v[196:199], 0
    v_permlane16_swap_b32 v172, v173
    v_max_f32 v164, v164, v165
    v_max_f32 v168, v168, v169
    v_max_f32 v172, v172, v173
    v_mfma_f32_16x16x32_bf16 a[160:163], v[196:199], v[196:199], 0
    v_sub_f32 v48, 0, v164
    v_sub_f32 v52, 0, v168
    v_sub_f32 v56, 0, v172
    v_sub_f32 v49, 0, v164
    v_mfma_f32_16x16x32_bf16 a[164:167], v[196:199], v[196:199], 0
    v_sub_f32 v53, 0, v168
    v_sub_f32 v57, 0, v172
    v_sub_f32 v50, 0, v164
    v_sub_f32 v54, 0, v168
    v_mfma_f32_16x16x32_bf16 a[176:179], v[196:199], v[196:199], 0
    v_sub_f32 v58, 0, v172
    v_sub_f32 v51, 0, v164
    v_sub_f32 v55, 0, v168
    v_sub_f32 v59, 0, v172
L_enter:
    v_mfma_f32_16x16x32_bf16 v[144:147], a[184:187], v[64:67], v[44:47]
    ds_read_b128 a[200:203], v8 offset:4096
    v_mfma_f32_16x16x32_bf16 v[144:147], a[188:191], v[80:83], v[144:147]
    ds_read_b128 a[204:207], v10 offset:4096
    v_mfma_f32_16x16x32_bf16 v[144:147], a[192:195], v[96:99], v[144:147]
    ds_read_b128 a[208:211], v12 offset:4096
    v_mfma_f32_16x16x32_bf16 v[144:147], a[196:199], v[112:115], v[144:147]
    ds_read_b128 a[212:215], v14 offset:4096
    v_mfma_f32_16x16x32_bf16 v[148:151], a[184:187], v[68:71], v[48:51]
    v_mfma_f32_16x16x32_bf16 v[148:151], a[188:191], v[84:87], v[148:151]
    v_mfma_f32_16x16x32_bf16 v[148:151], a[192:195], v[100:103], v[148:151]
    v_mfma_f32_16x16x32_bf16 v[148:151], a[196:199], v[116:119], v[148:151]
    v_mfma_f32_16x16x32_bf16 v[152:155], a[184:187], v[72:75], v[52:55]
    v_mfma_f32_16x16x32_bf16 v[152:155], a[188:191], v[88:91], v[152:155]
    v_mfma_f32_16x16x32_bf16 v[152:155], a[192:195], v[104:107], v[152:155]
    v_exp_f32 v144, v144
    v_mfma_f32_16x16x32_bf16 v[152:155], a[196:199], v[120:123], v[152:155]
    v_exp_f32 v145, v145
    v_mfma_f32_16x16x32_bf16 v[156:159], a[184:187], v[76:79], v[56:59]
    v_exp_f32 v146, v146
    v_mfma_f32_16x16x32_bf16 v[156:159], a[188:191], v[92:95], v[156:159]
    v_exp_f32 v147, v147
    v_mfma_f32_16x16x32_bf16 v[156:159], a[192:195], v[108:111], v[156:159]
    v_cvt_pk_bf16_f32 v161, v146, v147
    v_cvt_pk_bf16_f32 v160, v144, v145
    v_mfma_f32_16x16x32_bf16 v[156:159], a[196:199], v[124:127], v[156:159]
    v_exp_f32 v148, v148
    v_mfma_f32_16x16x32_bf16 v[144:147], a[184:187], v[128:131], v[60:63]
    v_exp_f32 v149, v149
    v_mfma_f32_16x16x32_bf16 v[144:147], a[188:191], v[132:135], v[144:147]
    v_cvt_pk_bf16_f32 v168, v148, v149
    v_exp_f32 v150, v150
    v_mfma_f32_16x16x32_bf16 v[144:147], a[192:195], v[136:139], v[144:147]
    v_exp_f32 v151, v151
    v_mfma_f32_16x16x32_bf16 v[144:147], a[196:199], v[140:143], v[144:147]
    v_cvt_pk_bf16_f32 v169, v150, v151
    v_exp_f32 v152, v152
    v_exp_f32 v153, v153
    s_waitcnt lgkmcnt(3)
    v_mfma_f32_16x16x32_bf16 v[148:151], a[200:203], v[64:67], v[44:47]
    v_cvt_pk_bf16_f32 v176, v152, v153
    v_exp_f32 v154, v154
    s_waitcnt lgkmcnt(2)
    v_mfma_f32_16x16x32_bf16 v[148:151], a[204:207], v[80:83], v[148:151]
    v_exp_f32 v155, v155
    s_waitcnt lgkmcnt(1)
    v_mfma_f32_16x16x32_bf16 v[148:151], a[208:211], v[96:99], v[148:151]
    v_cvt_pk_bf16_f32 v177, v154, v155
    v_exp_f32 v156, v156
    s_waitcnt lgkmcnt(0)
    v_mfma_f32_16x16x32_bf16 v[148:151], a[212:215], v[112:115], v[148:151]
    v_exp_f32 v157, v157
    v_mfma_f32_16x16x32_bf16 v[152:155], a[200:203], v[68:71], v[48:51]
    v_exp_f32 v158, v158
    v_mfma_f32_16x16x32_bf16 v[152:155], a[204:207], v[84:87], v[152:155]
    v_cvt_pk_bf16_f32 v184, v156, v157
    v_exp_f32 v159, v159
    v_mfma_f32_16x16x32_bf16 v[152:155], a[208:211], v[100:103], v[152:155]
    v_cvt_pk_bf16_f32 v185, v158, v159
    v_mfma_f32_16x16x32_bf16 v[152:155], a[212:215], v[116:119], v[152:155]
    ds_read_b128 a[184:187], v9 offset:0
    v_mfma_f32_16x16x32_bf16 v[156:159], a[200:203], v[72:75], v[52:55]
    ds_read_b128 a[188:191], v11 offset:0
    v_mfma_f32_16x16x32_bf16 v[156:159], a[204:207], v[88:91], v[156:159]
    ds_read_b128 a[192:195], v13 offset:0
    v_mfma_f32_16x16x32_bf16 v[156:159], a[208:211], v[104:107], v[156:159]
    ds_read_b128 a[196:199], v15 offset:0
    v_exp_f32 v144, v144
    v_mfma_f32_16x16x32_bf16 v[156:159], a[212:215], v[120:123], v[156:159]
    v_exp_f32 v145, v145
    s_nop 0
    v_cvt_pk_bf16_f32 v192, v144, v145
    v_exp_f32 v146, v146
    v_exp_f32 v147, v147
    s_nop 0
    v_cvt_pk_bf16_f32 v193, v146, v147
    v_exp_f32 v148, v148
    v_exp_f32 v149, v149
    v_mfma_f32_16x16x32_bf16 v[144:147], a[200:203], v[76:79], v[56:59]
    v_exp_f32 v150, v150
    v_mfma_f32_16x16x32_bf16 v[144:147], a[204:207], v[92:95], v[144:147]
    v_cvt_pk_bf16_f32 v162, v148, v149
    v_exp_f32 v151, v151
    v_mfma_f32_16x16x32_bf16 v[144:147], a[208:211], v[108:111], v[144:147]
    v_cvt_pk_bf16_f32 v163, v150, v151
    v_exp_f32 v152, v152
    v_mfma_f32_16x16x32_bf16 v[144:147], a[212:215], v[124:127], v[144:147]
    v_exp_f32 v153, v153
    v_mfma_f32_16x16x32_bf16 v[148:151], a[200:203], v[128:131], v[60:63]
    v_cvt_pk_bf16_f32 v170, v152, v153
    v_exp_f32 v154, v154
    v_mfma_f32_16x16x32_bf16 v[148:151], a[204:207], v[132:135], v[148:151]
    v_exp_f32 v155, v155
    v_mfma_f32_16x16x32_bf16 v[148:151], a[208:211], v[136:139], v[148:151]
    v_cvt_pk_bf16_f32 v171, v154, v155
    v_exp_f32 v156, v156
    v_mfma_f32_16x16x32_bf16 v[148:151], a[212:215], v[140:143], v[148:151]
    v_exp_f32 v157, v157
    s_waitcnt lgkmcnt(3)
    v_mfma_f32_16x16x32_bf16 v[152:155], a[184:187], v[64:67], v[44:47]
    v_cvt_pk_bf16_f32 v178, v156, v157
    v_exp_f32 v158, v158
    s_waitcnt lgkmcnt(2)
    v_mfma_f32_16x16x32_bf16 v[152:155], a[188:191], v[80:83], v[152:155]
    v_exp_f32 v159, v159
    s_waitcnt lgkmcnt(1)
    v_mfma_f32_16x16x32_bf16 v[152:155], a[192:195], v[96:99], v[152:155]
    v_cvt_pk_bf16_f32 v179, v158, v159
    v_exp_f32 v144, v144
    s_waitcnt lgkmcnt(0)
    v_mfma_f32_16x16x32_bf16 v[152:155], a[196:199], v[112:115], v[152:155]
    v_exp_f32 v145, v145
    v_mfma_f32_16x16x32_bf16 v[156:159], a[184:187], v[68:71], v[48:51]
    v_cvt_pk_bf16_f32 v186, v144, v145
    v_exp_f32 v146, v146
    v_mfma_f32_16x16x32_bf16 v[156:159], a[188:191], v[84:87], v[156:159]
    v_exp_f32 v147, v147
    v_mfma_f32_16x16x32_bf16 v[156:159], a[192:195], v[100:103], v[156:159]
    v_cvt_pk_bf16_f32 v187, v146, v147
    v_mfma_f32_16x16x32_bf16 v[156:159], a[196:199], v[116:119], v[156:159]
    ds_read_b128 a[200:203], v9 offset:4096
    v_mfma_f32_16x16x32_bf16 v[144:147], a[184:187], v[72:75], v[52:55]
    ds_read_b128 a[204:207], v11 offset:4096
    v_mfma_f32_16x16x32_bf16 v[144:147], a[188:191], v[88:91], v[144:147]
    ds_read_b128 a[208:211], v13 offset:4096
    v_mfma_f32_16x16x32_bf16 v[144:147], a[192:195], v[104:107], v[144:147]
    ds_read_b128 a[212:215], v15 offset:4096
    v_exp_f32 v148, v148
    v_mfma_f32_16x16x32_bf16 v[144:147], a[196:199], v[120:123], v[144:147]
    v_exp_f32 v149, v149
    s_nop 0
    v_cvt_pk_bf16_f32 v194, v148, v149
    v_exp_f32 v150, v150
    v_exp_f32 v151, v151
    s_nop 0
    v_cvt_pk_bf16_f32 v195, v150, v151
    v_exp_f32 v152, v152
    v_exp_f32 v153, v153
    v_mfma_f32_16x16x32_bf16 v[148:151], a[184:187], v[76:79], v[56:59]
    v_cvt_pk_bf16_f32 v164, v152, v153
    v_exp_f32 v154, v154
    v_mfma_f32_16x16x32_bf16 v[148:151], a[188:191], v[92:95], v[148:151]
    v_exp_f32 v155, v155
    v_mfma_f32_16x16x32_bf16 v[148:151], a[192:195], v[108:111], v[148:151]
    v_cvt_pk_bf16_f32 v165, v154, v155
    v_exp_f32 v156, v156
    v_mfma_f32_16x16x32_bf16 v[148:151], a[196:199], v[124:127], v[148:151]
    v_exp_f32 v157, v157
    s_waitcnt lgkmcnt(3)
    v_mfma_f32_16x16x32_bf16 v[152:155], a[200:203], v[64:67], v[44:47]
    v_cvt_pk_bf16_f32 v172, v156, v157
    v_exp_f32 v158, v158
    s_waitcnt lgkmcnt(2)
    v_mfma_f32_16x16x32_bf16 v[152:155], a[204:207], v[80:83], v[152:155]
    v_exp_f32 v159, v159
    s_waitcnt lgkmcnt(1)
    v_mfma_f32_16x16x32_bf16 v[152:155], a[208:211], v[96:99], v[152:155]
    v_cvt_pk_bf16_f32 v173, v158, v159
    v_exp_f32 v144, v144
    s_waitcnt lgkmcnt(0)
    v_mfma_f32_16x16x32_bf16 v[152:155], a[212:215], v[112:115], v[152:155]
    v_exp_f32 v145, v145
    v_mfma_f32_16x16x32_bf16 v[156:159], a[200:203], v[68:71], v[48:51]
    v_cvt_pk_bf16_f32 v180, v144, v145
    v_exp_f32 v146, v146
    v_mfma_f32_16x16x32_bf16 v[156:159], a[204:207], v[84:87], v[156:159]
    v_exp_f32 v147, v147
    v_mfma_f32_16x16x32_bf16 v[156:159], a[208:211], v[100:103], v[156:159]
    v_cvt_pk_bf16_f32 v181, v146, v147
    s_waitcnt lgkmcnt(15)
    v_mfma_f32_16x16x32_bf16 v[156:159], a[212:215], v[116:119], v[156:159]
    s_waitcnt vmcnt(16)
    v_mfma_f32_16x16x32_bf16 v[144:147], a[200:203], v[72:75], v[52:55]
    s_barrier
    v_exp_f32 v148, v148
    v_mfma_f32_16x16x32_bf16 v[144:147], a[204:207], v[88:91], v[144:147]
    v_exp_f32 v149, v149
    v_mfma_f32_16x16x32_bf16 v[144:147], a[208:211], v[104:107], v[144:147]
    v_cvt_pk_bf16_f32 v188, v148, v149
    v_exp_f32 v150, v150
    v_mfma_f32_16x16x32_bf16 v[144:147], a[212:215], v[120:123], v[144:147]
    v_exp_f32 v151, v151
    s_nop 0
    v_cvt_pk_bf16_f32 v189, v150, v151
    ds_read_b128 a[184:187], v8 offset:16384
    ds_read_b128 a[188:191], v10 offset:16384
    v_mfma_f32_16x16x32_bf16 v[148:151], a[200:203], v[76:79], v[56:59]
    ds_read_b128 a[192:195], v12 offset:16384
    v_mfma_f32_16x16x32_bf16 v[148:151], a[204:207], v[92:95], v[148:151]
    ds_read_b128 a[196:199], v14 offset:16384
    v_exp_f32 v152, v152
    v_mfma_f32_16x16x32_bf16 v[148:151], a[208:211], v[108:111], v[148:151]
    v_exp_f32 v153, v153
    v_mfma_f32_16x16x32_bf16 v[148:151], a[212:215], v[124:127], v[148:151]
    v_cvt_pk_bf16_f32 v166, v152, v153
    v_exp_f32 v154, v154
    v_exp_f32 v155, v155
    s_nop 0
    v_cvt_pk_bf16_f32 v167, v154, v155
    ds_read_b64_tr_b16 a[216:217], v16 offset:0
    ds_read_b64_tr_b16 a[218:219], v16 offset:4096
    ds_read_b64_tr_b16 a[220:221], v17 offset:0
    ds_read_b64_tr_b16 a[222:223], v17 offset:4096
    v_exp_f32 v156, v156
    v_exp_f32 v157, v157
    s_nop 0
    v_cvt_pk_bf16_f32 v174, v156, v157
    v_exp_f32 v158, v158
    v_exp_f32 v159, v159
    s_nop 0
    v_cvt_pk_bf16_f32 v175, v158, v159
    ds_read_b64_tr_b16 a[224:225], v18 offset:0
    ds_read_b64_tr_b16 a[226:227], v18 offset:4096
    ds_read_b64_tr_b16 a[228:229], v19 offset:0
    v_exp_f32 v144, v144
    v_exp_f32 v145, v145
    s_nop 0
    v_cvt_pk_bf16_f32 v182, v144, v145
    v_exp_f32 v146, v146
    v_exp_f32 v147, v147
    s_waitcnt lgkmcnt(3)
    s_waitcnt lgkmcnt(15)
    s_mov_b32 s53, s29
    s_mov_b32 s32, 4
.p2align 3
L_loop:
    v_mfma_f32_16x16x32_bf16 v[152:155], a[184:187], v[64:67], v[44:47]
    v_exp_f32 v148, v148
    v_mfma_f32_16x16x32_bf16 v[152:155], a[188:191], v[80:83], v[152:155]
    ds_read_b64_tr_b16 a[230:231], v19 offset:4096
    s_add_u32 m0, s29, 114688
    v_mfma_f32_16x16x32_bf16 v[152:155], a[192:195], v[96:99], v[152:155]
    v_exp_f32 v149, v149
    v_mfma_f32_16x16x32_bf16 v[152:155], a[196:199], v[112:115], v[152:155]
    buffer_load_dwordx4 v36, s[8:11], s31 offen offset:0 nt lds
    v_mfma_f32_16x16x32_bf16 a[0:3], a[216:219], v[160:163], a[0:3]
    v_exp_f32 v150, v150
    v_mfma_f32_16x16x32_bf16 a[0:3], a[220:223], v[164:167], a[0:3]
    v_cvt_pk_bf16_f32 v190, v148, v149
    v_cvt_pk_bf16_f32 v183, v146, v147
    v_mfma_f32_16x16x32_bf16 a[32:35], a[220:223], v[172:175], a[32:35]
    v_exp_f32 v151, v151
    v_mfma_f32_16x16x32_bf16 a[32:35], a[216:219], v[168:171], a[32:35]
    buffer_load_dwordx4 v37, s[8:11], s31 offen offset:1024 nt lds
    v_mfma_f32_16x16x32_bf16 a[64:67], a[216:219], v[176:179], a[64:67]
    v_exp_f32 v152, v152
    v_cvt_pk_bf16_f32 v191, v150, v151
    v_mfma_f32_16x16x32_bf16 a[64:67], a[220:223], v[180:183], a[64:67]
    ds_read_b64_tr_b16 a[232:233], v20 offset:0
    v_mfma_f32_16x16x32_bf16 a[96:99], a[220:223], v[188:191], a[96:99]
    v_exp_f32 v153, v153
    v_mfma_f32_16x16x32_bf16 a[96:99], a[216:219], v[184:187], a[96:99]
    buffer_load_dwordx4 v36, s[8:11], s31 offen offset:2048 nt lds
    v_mfma_f32_16x16x32_bf16 v[156:159], a[184:187], v[68:71], v[48:51]
    v_exp_f32 v154, v154
    v_mfma_f32_16x16x32_bf16 v[156:159], a[188:191], v[84:87], v[156:159]
    ds_read_b64_tr_b16 a[234:235], v20 offset:4096
    s_waitcnt lgkmcnt(2)
    v_mfma_f32_16x16x32_bf16 v[156:159], a[192:195], v[100:103], v[156:159]
    v_exp_f32 v155, v155
    v_mfma_f32_16x16x32_bf16 v[156:159], a[196:199], v[116:119], v[156:159]
    buffer_load_dwordx4 v37, s[8:11], s31 offen offset:3072 nt lds
    v_mfma_f32_16x16x32_bf16 a[128:131], a[216:219], v[192:195], a[128:131]
    ds_read_b64_tr_b16 a[236:237], v21 offset:0
    s_add_u32 s31, s31, 16384
    v_mfma_f32_16x16x32_bf16 a[132:135], a[224:227], v[192:195], a[132:135]
    ds_read_b64_tr_b16 a[238:239], v21 offset:4096
    v_cvt_pk_bf16_f32 v197, v154, v155
    v_mfma_f32_16x16x32_bf16 a[160:163], a[180:183], v[160:163], a[160:163]
    ds_read_b128 a[200:203], v8 offset:20480
    v_cvt_pk_bf16_f32 v196, v152, v153
    v_mfma_f32_16x16x32_bf16 a[160:163], a[180:183], v[164:167], a[160:163]
    ds_read_b128 a[204:207], v10 offset:20480
    s_add_u32 m0, s53, 0
    v_mfma_f32_16x16x32_bf16 v[144:147], a[184:187], v[72:75], v[52:55]
    v_exp_f32 v156, v156
    v_mfma_f32_16x16x32_bf16 v[144:147], a[188:191], v[88:91], v[144:147]
    buffer_load_dwordx4 v32, s[4:7], s30 offen offset:0 nt lds
    v_mfma_f32_16x16x32_bf16 v[144:147], a[192:195], v[104:107], v[144:147]
    v_exp_f32 v157, v157
    v_mfma_f32_16x16x32_bf16 v[144:147], a[196:199], v[120:123], v[144:147]
    ds_read_b128 a[208:211], v12 offset:20480
    v_cvt_pk_bf16_f32 v204, v156, v157
    v_mfma_f32_16x16x32_bf16 a[4:7], a[224:227], v[160:163], a[4:7]
    v_exp_f32 v158, v158
    v_mfma_f32_16x16x32_bf16 a[4:7], a[228:231], v[164:167], a[4:7]
    buffer_load_dwordx4 v33, s[4:7], s30 offen offset:1024 nt lds
    v_mfma_f32_16x16x32_bf16 a[36:39], a[228:231], v[172:175], a[36:39]
    v_exp_f32 v159, v159
    v_mfma_f32_16x16x32_bf16 a[36:39], a[224:227], v[168:171], a[36:39]
    ds_read_b128 a[212:215], v14 offset:20480
    v_cvt_pk_bf16_f32 v205, v158, v159
    v_mfma_f32_16x16x32_bf16 v[148:151], a[184:187], v[76:79], v[56:59]
    v_exp_f32 v144, v144
    v_mfma_f32_16x16x32_bf16 v[148:151], a[188:191], v[92:95], v[148:151]
    buffer_load_dwordx4 v34, s[4:7], s30 offen offset:2048 nt lds
    v_mfma_f32_16x16x32_bf16 v[148:151], a[192:195], v[108:111], v[148:151]
    v_exp_f32 v145, v145
    v_mfma_f32_16x16x32_bf16 v[148:151], a[196:199], v[124:127], v[148:151]
    ds_read_b64_tr_b16 a[240:241], v22 offset:0
    v_cvt_pk_bf16_f32 v212, v144, v145
    v_mfma_f32_16x16x32_bf16 a[68:71], a[224:227], v[176:179], a[68:71]
    v_exp_f32 v146, v146
    v_mfma_f32_16x16x32_bf16 a[68:71], a[228:231], v[180:183], a[68:71]
    buffer_load_dwordx4 v35, s[4:7], s30 offen offset:3072 nt lds
    v_mfma_f32_16x16x32_bf16 a[100:103], a[228:231], v[188:191], a[100:103]
    v_exp_f32 v147, v147
    v_mfma_f32_16x16x32_bf16 a[100:103], a[224:227], v[184:187], a[100:103]
    ds_read_b64_tr_b16 a[242:243], v22 offset:4096
    s_add_u32 s30, s30, 16384
    v_mfma_f32_16x16x32_bf16 v[152:155], a[184:187], v[128:131], v[60:63]
    v_exp_f32 v148, v148
    v_mfma_f32_16x16x32_bf16 v[152:155], a[188:191], v[132:135], v[152:155]
    ds_read_b64_tr_b16 a[244:245], v23 offset:0
    v_cvt_pk_bf16_f32 v213, v146, v147
    v_mfma_f32_16x16x32_bf16 v[152:155], a[192:195], v[136:139], v[152:155]
    v_exp_f32 v149, v149
    v_mfma_f32_16x16x32_bf16 v[152:155], a[196:199], v[140:143], v[152:155]
    ds_read_b64_tr_b16 a[246:247], v23 offset:4096
    s_waitcnt lgkmcnt(4)
    v_mfma_f32_16x16x32_bf16 a[8:11], a[232:235], v[160:163], a[8:11]
    v_exp_f32 v150, v150
    v_mfma_f32_16x16x32_bf16 a[8:11], a[236:239], v[164:167], a[8:11]
    v_cvt_pk_bf16_f32 v220, v148, v149
    v_mfma_f32_16x16x32_bf16 a[40:43], a[236:239], v[172:175], a[40:43]
    v_exp_f32 v151, v151
    v_mfma_f32_16x16x32_bf16 a[40:43], a[232:235], v[168:171], a[40:43]
    v_cvt_pk_bf16_f32 v221, v150, v151
    v_mfma_f32_16x16x32_bf16 v[156:159], a[200:203], v[64:67], v[44:47]
    v_exp_f32 v152, v152
    v_mfma_f32_16x16x32_bf16 v[156:159], a[204:207], v[80:83], v[156:159]
    v_mfma_f32_16x16x32_bf16 v[156:159], a[208:211], v[96:99], v[156:159]
    v_exp_f32 v153, v153
    v_mfma_f32_16x16x32_bf16 v[156:159], a[212:215], v[112:115], v[156:159]
    ds_read_b64_tr_b16 a[216:217], v24 offset:0
    v_cvt_pk_bf16_f32 v228, v152, v153
    v_mfma_f32_16x16x32_bf16 a[72:75], a[232:235], v[176:179], a[72:75]
    v_exp_f32 v154, v154
    v_mfma_f32_16x16x32_bf16 a[72:75], a[236:239], v[180:183], a[72:75]
    ds_read_b64_tr_b16 a[218:219], v24 offset:4096
    v_mfma_f32_16x16x32_bf16 a[104:107], a[236:239], v[188:191], a[104:107]
    v_exp_f32 v155, v155
    v_mfma_f32_16x16x32_bf16 a[104:107], a[232:235], v[184:187], a[104:107]
    ds_read_b64_tr_b16 a[220:221], v25 offset:0
    v_cvt_pk_bf16_f32 v229, v154, v155
    v_mfma_f32_16x16x32_bf16 v[144:147], a[200:203], v[68:71], v[48:51]
    v_exp_f32 v156, v156
    v_mfma_f32_16x16x32_bf16 v[144:147], a[204:207], v[84:87], v[144:147]
    ds_read_b64_tr_b16 a[222:223], v25 offset:4096
    v_mfma_f32_16x16x32_bf16 v[144:147], a[208:211], v[100:103], v[144:147]
    v_exp_f32 v157, v157
    v_mfma_f32_16x16x32_bf16 v[144:147], a[212:215], v[116:119], v[144:147]
    ds_read_b128 a[184:187], v9 offset:16384
    s_waitcnt lgkmcnt(5)
    v_mfma_f32_16x16x32_bf16 a[136:139], a[232:235], v[192:195], a[136:139]
    v_exp_f32 v158, v158
    v_mfma_f32_16x16x32_bf16 a[140:143], a[240:243], v[192:195], a[140:143]
    ds_read_b128 a[188:191], v11 offset:16384
    v_cvt_pk_bf16_f32 v198, v156, v157
    v_mfma_f32_16x16x32_bf16 a[176:179], a[180:183], v[192:195], a[176:179]
    v_exp_f32 v159, v159
    v_mfma_f32_16x16x32_bf16 a[160:163], a[172:175], v[176:179], a[160:163]
    ds_read_b128 a[192:195], v13 offset:16384
    v_cvt_pk_bf16_f32 v199, v158, v159
    v_mfma_f32_16x16x32_bf16 a[160:163], a[172:175], v[180:183], a[160:163]
    v_exp_f32 v144, v144
    v_mfma_f32_16x16x32_bf16 v[148:151], a[200:203], v[72:75], v[52:55]
    ds_read_b128 a[196:199], v15 offset:16384
    v_mfma_f32_16x16x32_bf16 v[148:151], a[204:207], v[88:91], v[148:151]
    v_exp_f32 v145, v145
    v_mfma_f32_16x16x32_bf16 v[148:151], a[208:211], v[104:107], v[148:151]
    ds_read_b64_tr_b16 a[224:225], v26 offset:0
    v_cvt_pk_bf16_f32 v206, v144, v145
    v_mfma_f32_16x16x32_bf16 v[148:151], a[212:215], v[120:123], v[148:151]
    v_exp_f32 v146, v146
    v_mfma_f32_16x16x32_bf16 a[12:15], a[240:243], v[160:163], a[12:15]
    ds_read_b64_tr_b16 a[226:227], v26 offset:4096
    v_mfma_f32_16x16x32_bf16 a[12:15], a[244:247], v[164:167], a[12:15]
    v_exp_f32 v147, v147
    v_mfma_f32_16x16x32_bf16 a[44:47], a[244:247], v[172:175], a[44:47]
    ds_read_b64_tr_b16 a[228:229], v27 offset:0
    v_cvt_pk_bf16_f32 v207, v146, v147
    v_mfma_f32_16x16x32_bf16 a[44:47], a[240:243], v[168:171], a[44:47]
    ds_read_b64_tr_b16 a[230:231], v27 offset:4096
    v_mfma_f32_16x16x32_bf16 v[152:155], a[200:203], v[76:79], v[56:59]
    v_exp_f32 v148, v148
    v_mfma_f32_16x16x32_bf16 v[152:155], a[204:207], v[92:95], v[152:155]
    v_mfma_f32_16x16x32_bf16 v[152:155], a[208:211], v[108:111], v[152:155]
    v_exp_f32 v149, v149
    v_mfma_f32_16x16x32_bf16 v[152:155], a[212:215], v[124:127], v[152:155]
    v_cvt_pk_bf16_f32 v214, v148, v149
    v_mfma_f32_16x16x32_bf16 a[76:79], a[240:243], v[176:179], a[76:79]
    v_exp_f32 v150, v150
    v_mfma_f32_16x16x32_bf16 a[76:79], a[244:247], v[180:183], a[76:79]
    v_mfma_f32_16x16x32_bf16 a[108:111], a[244:247], v[188:191], a[108:111]
    v_exp_f32 v151, v151
    v_mfma_f32_16x16x32_bf16 a[108:111], a[240:243], v[184:187], a[108:111]
    v_cvt_pk_bf16_f32 v215, v150, v151
    v_mfma_f32_16x16x32_bf16 v[156:159], a[200:203], v[128:131], v[60:63]
    v_exp_f32 v152, v152
    v_mfma_f32_16x16x32_bf16 v[156:159], a[204:207], v[132:135], v[156:159]
    v_mfma_f32_16x16x32_bf16 v[156:159], a[208:211], v[136:139], v[156:159]
    v_exp_f32 v153, v153
    v_mfma_f32_16x16x32_bf16 v[156:159], a[212:215], v[140:143], v[156:159]
    v_cvt_pk_bf16_f32 v222, v152, v153
    s_waitcnt lgkmcnt(0)
    v_mfma_f32_16x16x32_bf16 a[16:19], a[216:219], v[160:163], a[16:19]
    v_exp_f32 v154, v154
    v_mfma_f32_16x16x32_bf16 a[16:19], a[220:223], v[164:167], a[16:19]
    v_mfma_f32_16x16x32_bf16 a[48:51], a[220:223], v[172:175], a[48:51]
    v_exp_f32 v155, v155
    v_mfma_f32_16x16x32_bf16 a[48:51], a[216:219], v[168:171], a[48:51]
    ds_read_b64_tr_b16 a[232:233], v28 offset:0
    v_cvt_pk_bf16_f32 v223, v154, v155
    v_mfma_f32_16x16x32_bf16 v[144:147], a[184:187], v[64:67], v[44:47]
    v_exp_f32 v156, v156
    v_mfma_f32_16x16x32_bf16 v[144:147], a[188:191], v[80:83], v[144:147]
    ds_read_b64_tr_b16 a[234:235], v28 offset:4096
    v_mfma_f32_16x16x32_bf16 v[144:147], a[192:195], v[96:99], v[144:147]
    v_exp_f32 v157, v157
    v_mfma_f32_16x16x32_bf16 v[144:147], a[196:199], v[112:115], v[144:147]
    ds_read_b64_tr_b16 a[236:237], v29 offset:0
    v_cvt_pk_bf16_f32 v230, v156, v157
    v_mfma_f32_16x16x32_bf16 a[80:83], a[216:219], v[176:179], a[80:83]
    v_exp_f32 v158, v158
    v_mfma_f32_16x16x32_bf16 a[80:83], a[220:223], v[180:183], a[80:83]
    ds_read_b64_tr_b16 a[238:239], v29 offset:4096
    v_mfma_f32_16x16x32_bf16 a[112:115], a[220:223], v[188:191], a[112:115]
    v_exp_f32 v159, v159
    v_mfma_f32_16x16x32_bf16 a[112:115], a[216:219], v[184:187], a[112:115]
    ds_read_b128 a[200:203], v9 offset:20480
    v_cvt_pk_bf16_f32 v231, v158, v159
    v_mfma_f32_16x16x32_bf16 a[144:147], a[216:219], v[192:195], a[144:147]
    v_exp_f32 v144, v144
    v_mfma_f32_16x16x32_bf16 a[148:151], a[224:227], v[192:195], a[148:151]
    ds_read_b128 a[204:207], v11 offset:20480
    v_mfma_f32_16x16x32_bf16 a[164:167], a[180:183], v[168:171], a[164:167]
    v_exp_f32 v145, v145
    v_mfma_f32_16x16x32_bf16 a[164:167], a[180:183], v[172:175], a[164:167]
    ds_read_b128 a[208:211], v13 offset:20480
    v_cvt_pk_bf16_f32 v200, v144, v145
    v_mfma_f32_16x16x32_bf16 v[148:151], a[184:187], v[68:71], v[48:51]
    v_exp_f32 v146, v146
    v_mfma_f32_16x16x32_bf16 v[148:151], a[188:191], v[84:87], v[148:151]
    ds_read_b128 a[212:215], v15 offset:20480
    v_mfma_f32_16x16x32_bf16 v[148:151], a[192:195], v[100:103], v[148:151]
    v_exp_f32 v147, v147
    v_mfma_f32_16x16x32_bf16 v[148:151], a[196:199], v[116:119], v[148:151]
    ds_read_b64_tr_b16 a[240:241], v30 offset:0
    v_cvt_pk_bf16_f32 v201, v146, v147
    v_mfma_f32_16x16x32_bf16 a[20:23], a[224:227], v[160:163], a[20:23]
    ds_read_b64_tr_b16 a[242:243], v30 offset:4096
    v_mfma_f32_16x16x32_bf16 a[20:23], a[228:231], v[164:167], a[20:23]
    ds_read_b64_tr_b16 a[244:245], v31 offset:0
    v_mfma_f32_16x16x32_bf16 a[52:55], a[228:231], v[172:175], a[52:55]
    ds_read_b64_tr_b16 a[246:247], v31 offset:4096
    v_mfma_f32_16x16x32_bf16 a[52:55], a[224:227], v[168:171], a[52:55]
    v_mfma_f32_16x16x32_bf16 v[152:155], a[184:187], v[72:75], v[52:55]
    v_exp_f32 v148, v148
    v_mfma_f32_16x16x32_bf16 v[152:155], a[188:191], v[88:91], v[152:155]
    v_mfma_f32_16x16x32_bf16 v[152:155], a[192:195], v[104:107], v[152:155]
    v_exp_f32 v149, v149
    v_mfma_f32_16x16x32_bf16 v[152:155], a[196:199], v[120:123], v[152:155]
    v_cvt_pk_bf16_f32 v208, v148, v149
    v_mfma_f32_16x16x32_bf16 a[84:87], a[224:227], v[176:179], a[84:87]
    v_exp_f32 v150, v150
    v_mfma_f32_16x16x32_bf16 a[84:87], a[228:231], v[180:183], a[84:87]
    v_mfma_f32_16x16x32_bf16 a[116:119], a[228:231], v[188:191], a[116:119]
    v_exp_f32 v151, v151
    v_mfma_f32_16x16x32_bf16 a[116:119], a[224:227], v[184:187], a[116:119]
    v_cvt_pk_bf16_f32 v209, v150, v151
    v_mfma_f32_16x16x32_bf16 v[156:159], a[184:187], v[76:79], v[56:59]
    v_exp_f32 v152, v152
    v_mfma_f32_16x16x32_bf16 v[156:159], a[188:191], v[92:95], v[156:159]
    v_mfma_f32_16x16x32_bf16 v[156:159], a[192:195], v[108:111], v[156:159]
    v_exp_f32 v153, v153
    v_mfma_f32_16x16x32_bf16 v[156:159], a[196:199], v[124:127], v[156:159]
    v_cvt_pk_bf16_f32 v216, v152, v153
    s_waitcnt lgkmcnt(0)
    v_mfma_f32_16x16x32_bf16 a[24:27], a[232:235], v[160:163], a[24:27]
    v_exp_f32 v154, v154
    v_mfma_f32_16x16x32_bf16 a[24:27], a[236:239], v[164:167], a[24:27]
    v_mfma_f32_16x16x32_bf16 a[56:59], a[236:239], v[172:175], a[56:59]
    v_exp_f32 v155, v155
    v_mfma_f32_16x16x32_bf16 a[56:59], a[232:235], v[168:171], a[56:59]
    v_cvt_pk_bf16_f32 v217, v154, v155
    v_mfma_f32_16x16x32_bf16 v[144:147], a[200:203], v[64:67], v[44:47]
    v_exp_f32 v156, v156
    v_mfma_f32_16x16x32_bf16 v[144:147], a[204:207], v[80:83], v[144:147]
    v_mfma_f32_16x16x32_bf16 v[144:147], a[208:211], v[96:99], v[144:147]
    v_exp_f32 v157, v157
    v_mfma_f32_16x16x32_bf16 v[144:147], a[212:215], v[112:115], v[144:147]
    v_cvt_pk_bf16_f32 v224, v156, v157
    v_mfma_f32_16x16x32_bf16 a[88:91], a[232:235], v[176:179], a[88:91]
    v_exp_f32 v158, v158
    v_mfma_f32_16x16x32_bf16 a[88:91], a[236:239], v[180:183], a[88:91]
    v_mfma_f32_16x16x32_bf16 a[120:123], a[236:239], v[188:191], a[120:123]
    v_exp_f32 v159, v159
    v_mfma_f32_16x16x32_bf16 a[120:123], a[232:235], v[184:187], a[120:123]
    s_waitcnt lgkmcnt(15)
    s_waitcnt vmcnt(12)
    v_mfma_f32_16x16x32_bf16 v[148:151], a[200:203], v[68:71], v[48:51]
    s_barrier
    v_cvt_pk_bf16_f32 v225, v158, v159
    v_mfma_f32_16x16x32_bf16 v[148:151], a[204:207], v[84:87], v[148:151]
    v_exp_f32 v144, v144
    v_mfma_f32_16x16x32_bf16 v[148:151], a[208:211], v[100:103], v[148:151]
    v_exp_f32 v145, v145
    v_mfma_f32_16x16x32_bf16 v[148:151], a[212:215], v[116:119], v[148:151]
    ds_read_b128 a[184:187], v8 offset:32768
    v_cvt_pk_bf16_f32 v202, v144, v145
    v_mfma_f32_16x16x32_bf16 a[152:155], a[232:235], v[192:195], a[152:155]
    v_exp_f32 v146, v146
    v_mfma_f32_16x16x32_bf16 a[156:159], a[240:243], v[192:195], a[156:159]
    ds_read_b128 a[188:191], v10 offset:32768
    v_mfma_f32_16x16x32_bf16 a[164:167], a[172:175], v[184:187], a[164:167]
    v_exp_f32 v147, v147
    v_mfma_f32_16x16x32_bf16 a[164:167], a[172:175], v[188:191], a[164:167]
    ds_read_b128 a[192:195], v12 offset:32768
    v_cvt_pk_bf16_f32 v203, v146, v147
    v_mfma_f32_16x16x32_bf16 v[152:155], a[200:203], v[72:75], v[52:55]
    v_exp_f32 v148, v148
    v_mfma_f32_16x16x32_bf16 v[152:155], a[204:207], v[88:91], v[152:155]
    ds_read_b128 a[196:199], v14 offset:32768
    v_mfma_f32_16x16x32_bf16 v[152:155], a[208:211], v[104:107], v[152:155]
    v_exp_f32 v149, v149
    v_mfma_f32_16x16x32_bf16 v[152:155], a[212:215], v[120:123], v[152:155]
    ds_read_b64_tr_b16 a[216:217], v16 offset:16384
    v_cvt_pk_bf16_f32 v210, v148, v149
    v_mfma_f32_16x16x32_bf16 a[28:31], a[240:243], v[160:163], a[28:31]
    v_exp_f32 v150, v150
    v_mfma_f32_16x16x32_bf16 a[28:31], a[244:247], v[164:167], a[28:31]
    ds_read_b64_tr_b16 a[218:219], v16 offset:20480
    v_mfma_f32_16x16x32_bf16 a[60:63], a[244:247], v[172:175], a[60:63]
    v_exp_f32 v151, v151
    v_mfma_f32_16x16x32_bf16 a[60:63], a[240:243], v[168:171], a[60:63]
    ds_read_b64_tr_b16 a[220:221], v17 offset:16384
    v_cvt_pk_bf16_f32 v211, v150, v151
    v_mfma_f32_16x16x32_bf16 v[156:159], a[200:203], v[76:79], v[56:59]
    v_exp_f32 v152, v152
    v_mfma_f32_16x16x32_bf16 v[156:159], a[204:207], v[92:95], v[156:159]
    ds_read_b64_tr_b16 a[222:223], v17 offset:20480
    v_mfma_f32_16x16x32_bf16 v[156:159], a[208:211], v[108:111], v[156:159]
    v_exp_f32 v153, v153
    v_mfma_f32_16x16x32_bf16 v[156:159], a[212:215], v[124:127], v[156:159]
    ds_read_b64_tr_b16 a[224:225], v18 offset:16384
    v_cvt_pk_bf16_f32 v218, v152, v153
    v_mfma_f32_16x16x32_bf16 a[92:95], a[240:243], v[176:179], a[92:95]
    v_exp_f32 v154, v154
    v_mfma_f32_16x16x32_bf16 a[92:95], a[244:247], v[180:183], a[92:95]
    ds_read_b64_tr_b16 a[226:227], v18 offset:20480
    s_waitcnt lgkmcnt(2)
    v_mfma_f32_16x16x32_bf16 a[124:127], a[244:247], v[188:191], a[124:127]
    v_exp_f32 v155, v155
    v_mfma_f32_16x16x32_bf16 a[124:127], a[240:243], v[184:187], a[124:127]
    ds_read_b64_tr_b16 a[228:229], v19 offset:16384
    s_waitcnt lgkmcnt(15)
    v_mfma_f32_16x16x32_bf16 v[144:147], a[184:187], v[64:67], v[44:47]
    v_exp_f32 v156, v156
    v_mfma_f32_16x16x32_bf16 v[144:147], a[188:191], v[80:83], v[144:147]
    ds_read_b64_tr_b16 a[230:231], v19 offset:20480
    s_add_u32 m0, s29, 65536
    v_mfma_f32_16x16x32_bf16 v[144:147], a[192:195], v[96:99], v[144:147]
    v_exp_f32 v157, v157
    v_mfma_f32_16x16x32_bf16 v[144:147], a[196:199], v[112:115], v[144:147]
    buffer_load_dwordx4 v36, s[8:11], s31 offen offset:0 nt lds
    v_mfma_f32_16x16x32_bf16 a[0:3], a[216:219], v[196:199], a[0:3]
    v_exp_f32 v158, v158
    v_mfma_f32_16x16x32_bf16 a[0:3], a[220:223], v[200:203], a[0:3]
    v_cvt_pk_bf16_f32 v226, v156, v157
    v_cvt_pk_bf16_f32 v219, v154, v155
    v_mfma_f32_16x16x32_bf16 a[32:35], a[220:223], v[208:211], a[32:35]
    v_exp_f32 v159, v159
    v_mfma_f32_16x16x32_bf16 a[32:35], a[216:219], v[204:207], a[32:35]
    buffer_load_dwordx4 v37, s[8:11], s31 offen offset:1024 nt lds
    v_mfma_f32_16x16x32_bf16 a[64:67], a[216:219], v[212:215], a[64:67]
    v_exp_f32 v144, v144
    v_cvt_pk_bf16_f32 v227, v158, v159
    v_mfma_f32_16x16x32_bf16 a[64:67], a[220:223], v[216:219], a[64:67]
    ds_read_b64_tr_b16 a[232:233], v20 offset:16384
    v_mfma_f32_16x16x32_bf16 a[96:99], a[220:223], v[224:227], a[96:99]
    v_exp_f32 v145, v145
    v_mfma_f32_16x16x32_bf16 a[96:99], a[216:219], v[220:223], a[96:99]
    buffer_load_dwordx4 v36, s[8:11], s31 offen offset:2048 nt lds
    v_mfma_f32_16x16x32_bf16 v[148:151], a[184:187], v[68:71], v[48:51]
    v_exp_f32 v146, v146
    v_mfma_f32_16x16x32_bf16 v[148:151], a[188:191], v[84:87], v[148:151]
    ds_read_b64_tr_b16 a[234:235], v20 offset:20480
    s_waitcnt lgkmcnt(2)
    v_mfma_f32_16x16x32_bf16 v[148:151], a[192:195], v[100:103], v[148:151]
    v_exp_f32 v147, v147
    v_mfma_f32_16x16x32_bf16 v[148:151], a[196:199], v[116:119], v[148:151]
    buffer_load_dwordx4 v37, s[8:11], s31 offen offset:3072 nt lds
    v_mfma_f32_16x16x32_bf16 a[128:131], a[216:219], v[228:231], a[128:131]
    ds_read_b64_tr_b16 a[236:237], v21 offset:16384
    s_add_u32 s31, s31, 16384
    v_mfma_f32_16x16x32_bf16 a[132:135], a[224:227], v[228:231], a[132:135]
    ds_read_b64_tr_b16 a[238:239], v21 offset:20480
    v_cvt_pk_bf16_f32 v161, v146, v147
    v_mfma_f32_16x16x32_bf16 a[160:163], a[180:183], v[196:199], a[160:163]
    ds_read_b128 a[200:203], v8 offset:36864
    v_cvt_pk_bf16_f32 v160, v144, v145
    v_mfma_f32_16x16x32_bf16 a[160:163], a[180:183], v[200:203], a[160:163]
    ds_read_b128 a[204:207], v10 offset:36864
    s_add_u32 m0, s53, 16384
    v_mfma_f32_16x16x32_bf16 v[152:155], a[184:187], v[72:75], v[52:55]
    v_exp_f32 v148, v148
    v_mfma_f32_16x16x32_bf16 v[152:155], a[188:191], v[88:91], v[152:155]
    buffer_load_dwordx4 v32, s[4:7], s30 offen offset:0 nt lds
    v_mfma_f32_16x16x32_bf16 v[152:155], a[192:195], v[104:107], v[152:155]
    v_exp_f32 v149, v149
    v_mfma_f32_16x16x32_bf16 v[152:155], a[196:199], v[120:123], v[152:155]
    ds_read_b128 a[208:211], v12 offset:36864
    v_cvt_pk_bf16_f32 v168, v148, v149
    v_mfma_f32_16x16x32_bf16 a[4:7], a[224:227], v[196:199], a[4:7]
    v_exp_f32 v150, v150
    v_mfma_f32_16x16x32_bf16 a[4:7], a[228:231], v[200:203], a[4:7]
    buffer_load_dwordx4 v33, s[4:7], s30 offen offset:1024 nt lds
    v_mfma_f32_16x16x32_bf16 a[36:39], a[228:231], v[208:211], a[36:39]
    v_exp_f32 v151, v151
    v_mfma_f32_16x16x32_bf16 a[36:39], a[224:227], v[204:207], a[36:39]
    ds_read_b128 a[212:215], v14 offset:36864
    v_cvt_pk_bf16_f32 v169, v150, v151
    v_mfma_f32_16x16x32_bf16 v[156:159], a[184:187], v[76:79], v[56:59]
    v_exp_f32 v152, v152
    v_mfma_f32_16x16x32_bf16 v[156:159], a[188:191], v[92:95], v[156:159]
    buffer_load_dwordx4 v34, s[4:7], s30 offen offset:2048 nt lds
    v_mfma_f32_16x16x32_bf16 v[156:159], a[192:195], v[108:111], v[156:159]
    v_exp_f32 v153, v153
    v_mfma_f32_16x16x32_bf16 v[156:159], a[196:199], v[124:127], v[156:159]
    ds_read_b64_tr_b16 a[240:241], v22 offset:16384
    v_cvt_pk_bf16_f32 v176, v152, v153
    v_mfma_f32_16x16x32_bf16 a[68:71], a[224:227], v[212:215], a[68:71]
    v_exp_f32 v154, v154
    v_mfma_f32_16x16x32_bf16 a[68:71], a[228:231], v[216:219], a[68:71]
    buffer_load_dwordx4 v35, s[4:7], s30 offen offset:3072 nt lds
    v_mfma_f32_16x16x32_bf16 a[100:103], a[228:231], v[224:227], a[100:103]
    v_exp_f32 v155, v155
    v_mfma_f32_16x16x32_bf16 a[100:103], a[224:227], v[220:223], a[100:103]
    ds_read_b64_tr_b16 a[242:243], v22 offset:20480
    s_add_u32 s30, s30, 16384
    v_mfma_f32_16x16x32_bf16 v[144:147], a[184:187], v[128:131], v[60:63]
    v_exp_f32 v156, v156
    v_mfma_f32_16x16x32_bf16 v[144:147], a[188:191], v[132:135], v[144:147]
    ds_read_b64_tr_b16 a[244:245], v23 offset:16384
    v_cvt_pk_bf16_f32 v177, v154, v155
    v_mfma_f32_16x16x32_bf16 v[144:147], a[192:195], v[136:139], v[144:147]
    v_exp_f32 v157, v157
    v_mfma_f32_16x16x32_bf16 v[144:147], a[196:199], v[140:143], v[144:147]
    ds_read_b64_tr_b16 a[246:247], v23 offset:20480
    s_waitcnt lgkmcnt(4)
    v_mfma_f32_16x16x32_bf16 a[8:11], a[232:235], v[196:199], a[8:11]
    v_exp_f32 v158, v158
    v_mfma_f32_16x16x32_bf16 a[8:11], a[236:239], v[200:203], a[8:11]
    v_cvt_pk_bf16_f32 v184, v156, v157
    v_mfma_f32_16x16x32_bf16 a[40:43], a[236:239], v[208:211], a[40:43]
    v_exp_f32 v159, v159
    v_mfma_f32_16x16x32_bf16 a[40:43], a[232:235], v[204:207], a[40:43]
    v_cvt_pk_bf16_f32 v185, v158, v159
    v_mfma_f32_16x16x32_bf16 v[148:151], a[200:203], v[64:67], v[44:47]
    v_exp_f32 v144, v144
    v_mfma_f32_16x16x32_bf16 v[148:151], a[204:207], v[80:83], v[148:151]
    v_mfma_f32_16x16x32_bf16 v[148:151], a[208:211], v[96:99], v[148:151]
    v_exp_f32 v145, v145
    v_mfma_f32_16x16x32_bf16 v[148:151], a[212:215], v[112:115], v[148:151]
    ds_read_b64_tr_b16 a[216:217], v24 offset:16384
    v_cvt_pk_bf16_f32 v192, v144, v145
    v_mfma_f32_16x16x32_bf16 a[72:75], a[232:235], v[212:215], a[72:75]
    v_exp_f32 v146, v146
    v_mfma_f32_16x16x32_bf16 a[72:75], a[236:239], v[216:219], a[72:75]
    ds_read_b64_tr_b16 a[218:219], v24 offset:20480
    v_mfma_f32_16x16x32_bf16 a[104:107], a[236:239], v[224:227], a[104:107]
    v_exp_f32 v147, v147
    v_mfma_f32_16x16x32_bf16 a[104:107], a[232:235], v[220:223], a[104:107]
    ds_read_b64_tr_b16 a[220:221], v25 offset:16384
    v_cvt_pk_bf16_f32 v193, v146, v147
    v_mfma_f32_16x16x32_bf16 v[152:155], a[200:203], v[68:71], v[48:51]
    v_exp_f32 v148, v148
    v_mfma_f32_16x16x32_bf16 v[152:155], a[204:207], v[84:87], v[152:155]
    ds_read_b64_tr_b16 a[222:223], v25 offset:20480
    v_mfma_f32_16x16x32_bf16 v[152:155], a[208:211], v[100:103], v[152:155]
    v_exp_f32 v149, v149
    v_mfma_f32_16x16x32_bf16 v[152:155], a[212:215], v[116:119], v[152:155]
    ds_read_b128 a[184:187], v9 offset:32768
    s_waitcnt lgkmcnt(5)
    v_mfma_f32_16x16x32_bf16 a[136:139], a[232:235], v[228:231], a[136:139]
    v_exp_f32 v150, v150
    v_mfma_f32_16x16x32_bf16 a[140:143], a[240:243], v[228:231], a[140:143]
    ds_read_b128 a[188:191], v11 offset:32768
    v_cvt_pk_bf16_f32 v162, v148, v149
    v_mfma_f32_16x16x32_bf16 a[176:179], a[180:183], v[228:231], a[176:179]
    v_exp_f32 v151, v151
    v_mfma_f32_16x16x32_bf16 a[160:163], a[172:175], v[212:215], a[160:163]
    ds_read_b128 a[192:195], v13 offset:32768
    v_cvt_pk_bf16_f32 v163, v150, v151
    v_mfma_f32_16x16x32_bf16 a[160:163], a[172:175], v[216:219], a[160:163]
    v_exp_f32 v152, v152
    v_mfma_f32_16x16x32_bf16 v[156:159], a[200:203], v[72:75], v[52:55]
    ds_read_b128 a[196:199], v15 offset:32768
    v_mfma_f32_16x16x32_bf16 v[156:159], a[204:207], v[88:91], v[156:159]
    v_exp_f32 v153, v153
    v_mfma_f32_16x16x32_bf16 v[156:159], a[208:211], v[104:107], v[156:159]
    ds_read_b64_tr_b16 a[224:225], v26 offset:16384
    v_cvt_pk_bf16_f32 v170, v152, v153
    v_mfma_f32_16x16x32_bf16 v[156:159], a[212:215], v[120:123], v[156:159]
    v_exp_f32 v154, v154
    v_mfma_f32_16x16x32_bf16 a[12:15], a[240:243], v[196:199], a[12:15]
    ds_read_b64_tr_b16 a[226:227], v26 offset:20480
    v_mfma_f32_16x16x32_bf16 a[12:15], a[244:247], v[200:203], a[12:15]
    v_exp_f32 v155, v155
    v_mfma_f32_16x16x32_bf16 a[44:47], a[244:247], v[208:211], a[44:47]
    ds_read_b64_tr_b16 a[228:229], v27 offset:16384
    v_cvt_pk_bf16_f32 v171, v154, v155
    v_mfma_f32_16x16x32_bf16 a[44:47], a[240:243], v[204:207], a[44:47]
    ds_read_b64_tr_b16 a[230:231], v27 offset:20480
    v_mfma_f32_16x16x32_bf16 v[144:147], a[200:203], v[76:79], v[56:59]
    v_exp_f32 v156, v156
    v_mfma_f32_16x16x32_bf16 v[144:147], a[204:207], v[92:95], v[144:147]
    v_mfma_f32_16x16x32_bf16 v[144:147], a[208:211], v[108:111], v[144:147]
    v_exp_f32 v157, v157
    v_mfma_f32_16x16x32_bf16 v[144:147], a[212:215], v[124:127], v[144:147]
    v_cvt_pk_bf16_f32 v178, v156, v157
    v_mfma_f32_16x16x32_bf16 a[76:79], a[240:243], v[212:215], a[76:79]
    v_exp_f32 v158, v158
    v_mfma_f32_16x16x32_bf16 a[76:79], a[244:247], v[216:219], a[76:79]
    v_mfma_f32_16x16x32_bf16 a[108:111], a[244:247], v[224:227], a[108:111]
    v_exp_f32 v159, v159
    v_mfma_f32_16x16x32_bf16 a[108:111], a[240:243], v[220:223], a[108:111]
    v_cvt_pk_bf16_f32 v179, v158, v159
    v_mfma_f32_16x16x32_bf16 v[148:151], a[200:203], v[128:131], v[60:63]
    v_exp_f32 v144, v144
    v_mfma_f32_16x16x32_bf16 v[148:151], a[204:207], v[132:135], v[148:151]
    v_mfma_f32_16x16x32_bf16 v[148:151], a[208:211], v[136:139], v[148:151]
    v_exp_f32 v145, v145
    v_mfma_f32_16x16x32_bf16 v[148:151], a[212:215], v[140:143], v[148:151]
    v_cvt_pk_bf16_f32 v186, v144, v145
    s_waitcnt lgkmcnt(0)
    v_mfma_f32_16x16x32_bf16 a[16:19], a[216:219], v[196:199], a[16:19]
    v_exp_f32 v146, v146
    v_mfma_f32_16x16x32_bf16 a[16:19], a[220:223], v[200:203], a[16:19]
    v_mfma_f32_16x16x32_bf16 a[48:51], a[220:223], v[208:211], a[48:51]
    v_exp_f32 v147, v147
    v_mfma_f32_16x16x32_bf16 a[48:51], a[216:219], v[204:207], a[48:51]
    ds_read_b64_tr_b16 a[232:233], v28 offset:16384
    v_cvt_pk_bf16_f32 v187, v146, v147
    v_mfma_f32_16x16x32_bf16 v[152:155], a[184:187], v[64:67], v[44:47]
    v_exp_f32 v148, v148
    v_mfma_f32_16x16x32_bf16 v[152:155], a[188:191], v[80:83], v[152:155]
    ds_read_b64_tr_b16 a[234:235], v28 offset:20480
    v_mfma_f32_16x16x32_bf16 v[152:155], a[192:195], v[96:99], v[152:155]
    v_exp_f32 v149, v149
    v_mfma_f32_16x16x32_bf16 v[152:155], a[196:199], v[112:115], v[152:155]
    ds_read_b64_tr_b16 a[236:237], v29 offset:16384
    v_cvt_pk_bf16_f32 v194, v148, v149
    v_mfma_f32_16x16x32_bf16 a[80:83], a[216:219], v[212:215], a[80:83]
    v_exp_f32 v150, v150
    v_mfma_f32_16x16x32_bf16 a[80:83], a[220:223], v[216:219], a[80:83]
    ds_read_b64_tr_b16 a[238:239], v29 offset:20480
    v_mfma_f32_16x16x32_bf16 a[112:115], a[220:223], v[224:227], a[112:115]
    v_exp_f32 v151, v151
    v_mfma_f32_16x16x32_bf16 a[112:115], a[216:219], v[220:223], a[112:115]
    ds_read_b128 a[200:203], v9 offset:36864
    v_cvt_pk_bf16_f32 v195, v150, v151
    v_mfma_f32_16x16x32_bf16 a[144:147], a[216:219], v[228:231], a[144:147]
    v_exp_f32 v152, v152
    v_mfma_f32_16x16x32_bf16 a[148:151], a[224:227], v[228:231], a[148:151]
    ds_read_b128 a[204:207], v11 offset:36864
    v_mfma_f32_16x16x32_bf16 a[164:167], a[180:183], v[204:207], a[164:167]
    v_exp_f32 v153, v153
    v_mfma_f32_16x16x32_bf16 a[164:167], a[180:183], v[208:211], a[164:167]
    ds_read_b128 a[208:211], v13 offset:36864
    v_cvt_pk_bf16_f32 v164, v152, v153
    v_mfma_f32_16x16x32_bf16 v[156:159], a[184:187], v[68:71], v[48:51]
    v_exp_f32 v154, v154
    v_mfma_f32_16x16x32_bf16 v[156:159], a[188:191], v[84:87], v[156:159]
    ds_read_b128 a[212:215], v15 offset:36864
    v_mfma_f32_16x16x32_bf16 v[156:159], a[192:195], v[100:103], v[156:159]
    v_exp_f32 v155, v155
    v_mfma_f32_16x16x32_bf16 v[156:159], a[196:199], v[116:119], v[156:159]
    ds_read_b64_tr_b16 a[240:241], v30 offset:16384
    v_cvt_pk_bf16_f32 v165, v154, v155
    v_mfma_f32_16x16x32_bf16 a[20:23], a[224:227], v[196:199], a[20:23]
    ds_read_b64_tr_b16 a[242:243], v30 offset:20480
    v_mfma_f32_16x16x32_bf16 a[20:23], a[228:231], v[200:203], a[20:23]
    ds_read_b64_tr_b16 a[244:245], v31 offset:16384
    v_mfma_f32_16x16x32_bf16 a[52:55], a[228:231], v[208:211], a[52:55]
    ds_read_b64_tr_b16 a[246:247], v31 offset:20480
    v_mfma_f32_16x16x32_bf16 a[52:55], a[224:227], v[204:207], a[52:55]
    v_mfma_f32_16x16x32_bf16 v[144:147], a[184:187], v[72:75], v[52:55]
    v_exp_f32 v156, v156
    v_mfma_f32_16x16x32_bf16 v[144:147], a[188:191], v[88:91], v[144:147]
    v_mfma_f32_16x16x32_bf16 v[144:147], a[192:195], v[104:107], v[144:147]
    v_exp_f32 v157, v157
    v_mfma_f32_16x16x32_bf16 v[144:147], a[196:199], v[120:123], v[144:147]
    v_cvt_pk_bf16_f32 v172, v156, v157
    v_mfma_f32_16x16x32_bf16 a[84:87], a[224:227], v[212:215], a[84:87]
    v_exp_f32 v158, v158
    v_mfma_f32_16x16x32_bf16 a[84:87], a[228:231], v[216:219], a[84:87]
    v_mfma_f32_16x16x32_bf16 a[116:119], a[228:231], v[224:227], a[116:119]
    v_exp_f32 v159, v159
    v_mfma_f32_16x16x32_bf16 a[116:119], a[224:227], v[220:223], a[116:119]
    v_cvt_pk_bf16_f32 v173, v158, v159
    v_mfma_f32_16x16x32_bf16 v[148:151], a[184:187], v[76:79], v[56:59]
    v_exp_f32 v144, v144
    v_mfma_f32_16x16x32_bf16 v[148:151], a[188:191], v[92:95], v[148:151]
    v_mfma_f32_16x16x32_bf16 v[148:151], a[192:195], v[108:111], v[148:151]
    v_exp_f32 v145, v145
    v_mfma_f32_16x16x32_bf16 v[148:151], a[196:199], v[124:127], v[148:151]
    v_cvt_pk_bf16_f32 v180, v144, v145
    s_waitcnt lgkmcnt(0)
    v_mfma_f32_16x16x32_bf16 a[24:27], a[232:235], v[196:199], a[24:27]
    v_exp_f32 v146, v146
    v_mfma_f32_16x16x32_bf16 a[24:27], a[236:239], v[200:203], a[24:27]
    v_mfma_f32_16x16x32_bf16 a[56:59], a[236:239], v[208:211], a[56:59]
    v_exp_f32 v147, v147
    v_mfma_f32_16x16x32_bf16 a[56:59], a[232:235], v[204:207], a[56:59]
    v_cvt_pk_bf16_f32 v181, v146, v147
    v_mfma_f32_16x16x32_bf16 v[152:155], a[200:203], v[64:67], v[44:47]
    v_exp_f32 v148, v148
    v_mfma_f32_16x16x32_bf16 v[152:155], a[204:207], v[80:83], v[152:155]
    v_mfma_f32_16x16x32_bf16 v[152:155], a[208:211], v[96:99], v[152:155]
    v_exp_f32 v149, v149
    v_mfma_f32_16x16x32_bf16 v[152:155], a[212:215], v[112:115], v[152:155]
    v_cvt_pk_bf16_f32 v188, v148, v149
    v_mfma_f32_16x16x32_bf16 a[88:91], a[232:235], v[212:215], a[88:91]
    v_exp_f32 v150, v150
    v_mfma_f32_16x16x32_bf16 a[88:91], a[236:239], v[216:219], a[88:91]
    v_mfma_f32_16x16x32_bf16 a[120:123], a[236:239], v[224:227], a[120:123]
    v_exp_f32 v151, v151
    v_mfma_f32_16x16x32_bf16 a[120:123], a[232:235], v[220:223], a[120:123]
    s_waitcnt lgkmcnt(15)
    s_waitcnt vmcnt(16)
    v_mfma_f32_16x16x32_bf16 v[156:159], a[200:203], v[68:71], v[48:51]
    s_barrier
    v_cvt_pk_bf16_f32 v189, v150, v151
    v_mfma_f32_16x16x32_bf16 v[156:159], a[204:207], v[84:87], v[156:159]
    v_exp_f32 v152, v152
    v_mfma_f32_16x16x32_bf16 v[156:159], a[208:211], v[100:103], v[156:159]
    v_exp_f32 v153, v153
    v_mfma_f32_16x16x32_bf16 v[156:159], a[212:215], v[116:119], v[156:159]
    ds_read_b128 a[184:187], v8 offset:49152
    v_cvt_pk_bf16_f32 v166, v152, v153
    v_mfma_f32_16x16x32_bf16 a[152:155], a[232:235], v[228:231], a[152:155]
    v_exp_f32 v154, v154
    v_mfma_f32_16x16x32_bf16 a[156:159], a[240:243], v[228:231], a[156:159]
    ds_read_b128 a[188:191], v10 offset:49152
    v_mfma_f32_16x16x32_bf16 a[164:167], a[172:175], v[220:223], a[164:167]
    v_exp_f32 v155, v155
    v_mfma_f32_16x16x32_bf16 a[164:167], a[172:175], v[224:227], a[164:167]
    ds_read_b128 a[192:195], v12 offset:49152
    v_cvt_pk_bf16_f32 v167, v154, v155
    v_mfma_f32_16x16x32_bf16 v[144:147], a[200:203], v[72:75], v[52:55]
    v_exp_f32 v156, v156
    v_mfma_f32_16x16x32_bf16 v[144:147], a[204:207], v[88:91], v[144:147]
    ds_read_b128 a[196:199], v14 offset:49152
    v_mfma_f32_16x16x32_bf16 v[144:147], a[208:211], v[104:107], v[144:147]
    v_exp_f32 v157, v157
    v_mfma_f32_16x16x32_bf16 v[144:147], a[212:215], v[120:123], v[144:147]
    ds_read_b64_tr_b16 a[216:217], v16 offset:32768
    v_cvt_pk_bf16_f32 v174, v156, v157
    v_mfma_f32_16x16x32_bf16 a[28:31], a[240:243], v[196:199], a[28:31]
    v_exp_f32 v158, v158
    v_mfma_f32_16x16x32_bf16 a[28:31], a[244:247], v[200:203], a[28:31]
    ds_read_b64_tr_b16 a[218:219], v16 offset:36864
    v_mfma_f32_16x16x32_bf16 a[60:63], a[244:247], v[208:211], a[60:63]
    v_exp_f32 v159, v159
    v_mfma_f32_16x16x32_bf16 a[60:63], a[240:243], v[204:207], a[60:63]
    ds_read_b64_tr_b16 a[220:221], v17 offset:32768
    v_cvt_pk_bf16_f32 v175, v158, v159
    v_mfma_f32_16x16x32_bf16 v[148:151], a[200:203], v[76:79], v[56:59]
    v_exp_f32 v144, v144
    v_mfma_f32_16x16x32_bf16 v[148:151], a[204:207], v[92:95], v[148:151]
    ds_read_b64_tr_b16 a[222:223], v17 offset:36864
    v_mfma_f32_16x16x32_bf16 v[148:151], a[208:211], v[108:111], v[148:151]
    v_exp_f32 v145, v145
    v_mfma_f32_16x16x32_bf16 v[148:151], a[212:215], v[124:127], v[148:151]
    ds_read_b64_tr_b16 a[224:225], v18 offset:32768
    v_cvt_pk_bf16_f32 v182, v144, v145
    v_mfma_f32_16x16x32_bf16 a[92:95], a[240:243], v[212:215], a[92:95]
    v_exp_f32 v146, v146
    v_mfma_f32_16x16x32_bf16 a[92:95], a[244:247], v[216:219], a[92:95]
    ds_read_b64_tr_b16 a[226:227], v18 offset:36864
    s_waitcnt lgkmcnt(2)
    v_mfma_f32_16x16x32_bf16 a[124:127], a[244:247], v[224:227], a[124:127]
    v_exp_f32 v147, v147
    v_mfma_f32_16x16x32_bf16 a[124:127], a[240:243], v[220:223], a[124:127]
    ds_read_b64_tr_b16 a[228:229], v19 offset:32768
    s_waitcnt lgkmcnt(15)
    v_mfma_f32_16x16x32_bf16 v[152:155], a[184:187], v[64:67], v[44:47]
    v_exp_f32 v148, v148
    v_mfma_f32_16x16x32_bf16 v[152:155], a[188:191], v[80:83], v[152:155]
    ds_read_b64_tr_b16 a[230:231], v19 offset:36864
    s_add_u32 m0, s29, 81920
    v_mfma_f32_16x16x32_bf16 v[152:155], a[192:195], v[96:99], v[152:155]
    v_exp_f32 v149, v149
    v_mfma_f32_16x16x32_bf16 v[152:155], a[196:199], v[112:115], v[152:155]
    buffer_load_dwordx4 v36, s[8:11], s31 offen offset:0 nt lds
    v_mfma_f32_16x16x32_bf16 a[0:3], a[216:219], v[160:163], a[0:3]
    v_exp_f32 v150, v150
    v_mfma_f32_16x16x32_bf16 a[0:3], a[220:223], v[164:167], a[0:3]
    v_cvt_pk_bf16_f32 v190, v148, v149
    v_cvt_pk_bf16_f32 v183, v146, v147
    v_mfma_f32_16x16x32_bf16 a[32:35], a[220:223], v[172:175], a[32:35]
    v_exp_f32 v151, v151
    v_mfma_f32_16x16x32_bf16 a[32:35], a[216:219], v[168:171], a[32:35]
    buffer_load_dwordx4 v37, s[8:11], s31 offen offset:1024 nt lds
    v_mfma_f32_16x16x32_bf16 a[64:67], a[216:219], v[176:179], a[64:67]
    v_exp_f32 v152, v152
    v_cvt_pk_bf16_f32 v191, v150, v151
    v_mfma_f32_16x16x32_bf16 a[64:67], a[220:223], v[180:183], a[64:67]
    ds_read_b64_tr_b16 a[232:233], v20 offset:32768
    v_mfma_f32_16x16x32_bf16 a[96:99], a[220:223], v[188:191], a[96:99]
    v_exp_f32 v153, v153
    v_mfma_f32_16x16x32_bf16 a[96:99], a[216:219], v[184:187], a[96:99]
    buffer_load_dwordx4 v36, s[8:11], s31 offen offset:2048 nt lds
    v_mfma_f32_16x16x32_bf16 v[156:159], a[184:187], v[68:71], v[48:51]
    v_exp_f32 v154, v154
    v_mfma_f32_16x16x32_bf16 v[156:159], a[188:191], v[84:87], v[156:159]
    ds_read_b64_tr_b16 a[234:235], v20 offset:36864
    s_waitcnt lgkmcnt(2)
    v_mfma_f32_16x16x32_bf16 v[156:159], a[192:195], v[100:103], v[156:159]
    v_exp_f32 v155, v155
    v_mfma_f32_16x16x32_bf16 v[156:159], a[196:199], v[116:119], v[156:159]
    buffer_load_dwordx4 v37, s[8:11], s31 offen offset:3072 nt lds
    v_mfma_f32_16x16x32_bf16 a[128:131], a[216:219], v[192:195], a[128:131]
    ds_read_b64_tr_b16 a[236:237], v21 offset:32768
    s_add_u32 s31, s31, 16384
    v_mfma_f32_16x16x32_bf16 a[132:135], a[224:227], v[192:195], a[132:135]
    ds_read_b64_tr_b16 a[238:239], v21 offset:36864
    v_cvt_pk_bf16_f32 v197, v154, v155
    v_mfma_f32_16x16x32_bf16 a[160:163], a[180:183], v[160:163], a[160:163]
    ds_read_b128 a[200:203], v8 offset:53248
    v_cvt_pk_bf16_f32 v196, v152, v153
    v_mfma_f32_16x16x32_bf16 a[160:163], a[180:183], v[164:167], a[160:163]
    ds_read_b128 a[204:207], v10 offset:53248
    s_add_u32 m0, s53, 32768
    v_mfma_f32_16x16x32_bf16 v[144:147], a[184:187], v[72:75], v[52:55]
    v_exp_f32 v156, v156
    v_mfma_f32_16x16x32_bf16 v[144:147], a[188:191], v[88:91], v[144:147]
    buffer_load_dwordx4 v32, s[4:7], s30 offen offset:0 nt lds
    v_mfma_f32_16x16x32_bf16 v[144:147], a[192:195], v[104:107], v[144:147]
    v_exp_f32 v157, v157
    v_mfma_f32_16x16x32_bf16 v[144:147], a[196:199], v[120:123], v[144:147]
    ds_read_b128 a[208:211], v12 offset:53248
    v_cvt_pk_bf16_f32 v204, v156, v157
    v_mfma_f32_16x16x32_bf16 a[4:7], a[224:227], v[160:163], a[4:7]
    v_exp_f32 v158, v158
    v_mfma_f32_16x16x32_bf16 a[4:7], a[228:231], v[164:167], a[4:7]
    buffer_load_dwordx4 v33, s[4:7], s30 offen offset:1024 nt lds
    v_mfma_f32_16x16x32_bf16 a[36:39], a[228:231], v[172:175], a[36:39]
    v_exp_f32 v159, v159
    v_mfma_f32_16x16x32_bf16 a[36:39], a[224:227], v[168:171], a[36:39]
    ds_read_b128 a[212:215], v14 offset:53248
    v_cvt_pk_bf16_f32 v205, v158, v159
    v_mfma_f32_16x16x32_bf16 v[148:151], a[184:187], v[76:79], v[56:59]
    v_exp_f32 v144, v144
    v_mfma_f32_16x16x32_bf16 v[148:151], a[188:191], v[92:95], v[148:151]
    buffer_load_dwordx4 v34, s[4:7], s30 offen offset:2048 nt lds
    v_mfma_f32_16x16x32_bf16 v[148:151], a[192:195], v[108:111], v[148:151]
    v_exp_f32 v145, v145
    v_mfma_f32_16x16x32_bf16 v[148:151], a[196:199], v[124:127], v[148:151]
    ds_read_b64_tr_b16 a[240:241], v22 offset:32768
    v_cvt_pk_bf16_f32 v212, v144, v145
    v_mfma_f32_16x16x32_bf16 a[68:71], a[224:227], v[176:179], a[68:71]
    v_exp_f32 v146, v146
    v_mfma_f32_16x16x32_bf16 a[68:71], a[228:231], v[180:183], a[68:71]
    buffer_load_dwordx4 v35, s[4:7], s30 offen offset:3072 nt lds
    v_mfma_f32_16x16x32_bf16 a[100:103], a[228:231], v[188:191], a[100:103]
    v_exp_f32 v147, v147
    v_mfma_f32_16x16x32_bf16 a[100:103], a[224:227], v[184:187], a[100:103]
    ds_read_b64_tr_b16 a[242:243], v22 offset:36864
    s_add_u32 s30, s30, 16384
    v_mfma_f32_16x16x32_bf16 v[152:155], a[184:187], v[128:131], v[60:63]
    v_exp_f32 v148, v148
    v_mfma_f32_16x16x32_bf16 v[152:155], a[188:191], v[132:135], v[152:155]
    ds_read_b64_tr_b16 a[244:245], v23 offset:32768
    v_cvt_pk_bf16_f32 v213, v146, v147
    v_mfma_f32_16x16x32_bf16 v[152:155], a[192:195], v[136:139], v[152:155]
    v_exp_f32 v149, v149
    v_mfma_f32_16x16x32_bf16 v[152:155], a[196:199], v[140:143], v[152:155]
    ds_read_b64_tr_b16 a[246:247], v23 offset:36864
    s_waitcnt lgkmcnt(4)
    v_mfma_f32_16x16x32_bf16 a[8:11], a[232:235], v[160:163], a[8:11]
    v_exp_f32 v150, v150
    v_mfma_f32_16x16x32_bf16 a[8:11], a[236:239], v[164:167], a[8:11]
    v_cvt_pk_bf16_f32 v220, v148, v149
    v_mfma_f32_16x16x32_bf16 a[40:43], a[236:239], v[172:175], a[40:43]
    v_exp_f32 v151, v151
    v_mfma_f32_16x16x32_bf16 a[40:43], a[232:235], v[168:171], a[40:43]
    v_cvt_pk_bf16_f32 v221, v150, v151
    v_mfma_f32_16x16x32_bf16 v[156:159], a[200:203], v[64:67], v[44:47]
    v_exp_f32 v152, v152
    v_mfma_f32_16x16x32_bf16 v[156:159], a[204:207], v[80:83], v[156:159]
    v_mfma_f32_16x16x32_bf16 v[156:159], a[208:211], v[96:99], v[156:159]
    v_exp_f32 v153, v153
    v_mfma_f32_16x16x32_bf16 v[156:159], a[212:215], v[112:115], v[156:159]
    ds_read_b64_tr_b16 a[216:217], v24 offset:32768
    v_cvt_pk_bf16_f32 v228, v152, v153
    v_mfma_f32_16x16x32_bf16 a[72:75], a[232:235], v[176:179], a[72:75]
    v_exp_f32 v154, v154
    v_mfma_f32_16x16x32_bf16 a[72:75], a[236:239], v[180:183], a[72:75]
    ds_read_b64_tr_b16 a[218:219], v24 offset:36864
    v_mfma_f32_16x16x32_bf16 a[104:107], a[236:239], v[188:191], a[104:107]
    v_exp_f32 v155, v155
    v_mfma_f32_16x16x32_bf16 a[104:107], a[232:235], v[184:187], a[104:107]
    ds_read_b64_tr_b16 a[220:221], v25 offset:32768
    v_cvt_pk_bf16_f32 v229, v154, v155
    v_mfma_f32_16x16x32_bf16 v[144:147], a[200:203], v[68:71], v[48:51]
    v_exp_f32 v156, v156
    v_mfma_f32_16x16x32_bf16 v[144:147], a[204:207], v[84:87], v[144:147]
    ds_read_b64_tr_b16 a[222:223], v25 offset:36864
    v_mfma_f32_16x16x32_bf16 v[144:147], a[208:211], v[100:103], v[144:147]
    v_exp_f32 v157, v157
    v_mfma_f32_16x16x32_bf16 v[144:147], a[212:215], v[116:119], v[144:147]
    ds_read_b128 a[184:187], v9 offset:49152
    s_waitcnt lgkmcnt(5)
    v_mfma_f32_16x16x32_bf16 a[136:139], a[232:235], v[192:195], a[136:139]
    v_exp_f32 v158, v158
    v_mfma_f32_16x16x32_bf16 a[140:143], a[240:243], v[192:195], a[140:143]
    ds_read_b128 a[188:191], v11 offset:49152
    v_cvt_pk_bf16_f32 v198, v156, v157
    v_mfma_f32_16x16x32_bf16 a[176:179], a[180:183], v[192:195], a[176:179]
    v_exp_f32 v159, v159
    v_mfma_f32_16x16x32_bf16 a[160:163], a[172:175], v[176:179], a[160:163]
    ds_read_b128 a[192:195], v13 offset:49152
    v_cvt_pk_bf16_f32 v199, v158, v159
    v_mfma_f32_16x16x32_bf16 a[160:163], a[172:175], v[180:183], a[160:163]
    v_exp_f32 v144, v144
    v_mfma_f32_16x16x32_bf16 v[148:151], a[200:203], v[72:75], v[52:55]
    ds_read_b128 a[196:199], v15 offset:49152
    v_mfma_f32_16x16x32_bf16 v[148:151], a[204:207], v[88:91], v[148:151]
    v_exp_f32 v145, v145
    v_mfma_f32_16x16x32_bf16 v[148:151], a[208:211], v[104:107], v[148:151]
    ds_read_b64_tr_b16 a[224:225], v26 offset:32768
    v_cvt_pk_bf16_f32 v206, v144, v145
    v_mfma_f32_16x16x32_bf16 v[148:151], a[212:215], v[120:123], v[148:151]
    v_exp_f32 v146, v146
    v_mfma_f32_16x16x32_bf16 a[12:15], a[240:243], v[160:163], a[12:15]
    ds_read_b64_tr_b16 a[226:227], v26 offset:36864
    v_mfma_f32_16x16x32_bf16 a[12:15], a[244:247], v[164:167], a[12:15]
    v_exp_f32 v147, v147
    v_mfma_f32_16x16x32_bf16 a[44:47], a[244:247], v[172:175], a[44:47]
    ds_read_b64_tr_b16 a[228:229], v27 offset:32768
    v_cvt_pk_bf16_f32 v207, v146, v147
    v_mfma_f32_16x16x32_bf16 a[44:47], a[240:243], v[168:171], a[44:47]
    ds_read_b64_tr_b16 a[230:231], v27 offset:36864
    v_mfma_f32_16x16x32_bf16 v[152:155], a[200:203], v[76:79], v[56:59]
    v_exp_f32 v148, v148
    v_mfma_f32_16x16x32_bf16 v[152:155], a[204:207], v[92:95], v[152:155]
    v_mfma_f32_16x16x32_bf16 v[152:155], a[208:211], v[108:111], v[152:155]
    v_exp_f32 v149, v149
    v_mfma_f32_16x16x32_bf16 v[152:155], a[212:215], v[124:127], v[152:155]
    v_cvt_pk_bf16_f32 v214, v148, v149
    v_mfma_f32_16x16x32_bf16 a[76:79], a[240:243], v[176:179], a[76:79]
    v_exp_f32 v150, v150
    v_mfma_f32_16x16x32_bf16 a[76:79], a[244:247], v[180:183], a[76:79]
    v_mfma_f32_16x16x32_bf16 a[108:111], a[244:247], v[188:191], a[108:111]
    v_exp_f32 v151, v151
    v_mfma_f32_16x16x32_bf16 a[108:111], a[240:243], v[184:187], a[108:111]
    v_cvt_pk_bf16_f32 v215, v150, v151
    v_mfma_f32_16x16x32_bf16 v[156:159], a[200:203], v[128:131], v[60:63]
    v_exp_f32 v152, v152
    v_mfma_f32_16x16x32_bf16 v[156:159], a[204:207], v[132:135], v[156:159]
    v_mfma_f32_16x16x32_bf16 v[156:159], a[208:211], v[136:139], v[156:159]
    v_exp_f32 v153, v153
    v_mfma_f32_16x16x32_bf16 v[156:159], a[212:215], v[140:143], v[156:159]
    v_cvt_pk_bf16_f32 v222, v152, v153
    s_waitcnt lgkmcnt(0)
    v_mfma_f32_16x16x32_bf16 a[16:19], a[216:219], v[160:163], a[16:19]
    v_exp_f32 v154, v154
    v_mfma_f32_16x16x32_bf16 a[16:19], a[220:223], v[164:167], a[16:19]
    v_mfma_f32_16x16x32_bf16 a[48:51], a[220:223], v[172:175], a[48:51]
    v_exp_f32 v155, v155
    v_mfma_f32_16x16x32_bf16 a[48:51], a[216:219], v[168:171], a[48:51]
    ds_read_b64_tr_b16 a[232:233], v28 offset:32768
    v_cvt_pk_bf16_f32 v223, v154, v155
    v_mfma_f32_16x16x32_bf16 v[144:147], a[184:187], v[64:67], v[44:47]
    v_exp_f32 v156, v156
    v_mfma_f32_16x16x32_bf16 v[144:147], a[188:191], v[80:83], v[144:147]
    ds_read_b64_tr_b16 a[234:235], v28 offset:36864
    v_mfma_f32_16x16x32_bf16 v[144:147], a[192:195], v[96:99], v[144:147]
    v_exp_f32 v157, v157
    v_mfma_f32_16x16x32_bf16 v[144:147], a[196:199], v[112:115], v[144:147]
    ds_read_b64_tr_b16 a[236:237], v29 offset:32768
    v_cvt_pk_bf16_f32 v230, v156, v157
    v_mfma_f32_16x16x32_bf16 a[80:83], a[216:219], v[176:179], a[80:83]
    v_exp_f32 v158, v158
    v_mfma_f32_16x16x32_bf16 a[80:83], a[220:223], v[180:183], a[80:83]
    ds_read_b64_tr_b16 a[238:239], v29 offset:36864
    v_mfma_f32_16x16x32_bf16 a[112:115], a[220:223], v[188:191], a[112:115]
    v_exp_f32 v159, v159
    v_mfma_f32_16x16x32_bf16 a[112:115], a[216:219], v[184:187], a[112:115]
    ds_read_b128 a[200:203], v9 offset:53248
    v_cvt_pk_bf16_f32 v231, v158, v159
    v_mfma_f32_16x16x32_bf16 a[144:147], a[216:219], v[192:195], a[144:147]
    v_exp_f32 v144, v144
    v_mfma_f32_16x16x32_bf16 a[148:151], a[224:227], v[192:195], a[148:151]
    ds_read_b128 a[204:207], v11 offset:53248
    v_mfma_f32_16x16x32_bf16 a[164:167], a[180:183], v[168:171], a[164:167]
    v_exp_f32 v145, v145
    v_mfma_f32_16x16x32_bf16 a[164:167], a[180:183], v[172:175], a[164:167]
    ds_read_b128 a[208:211], v13 offset:53248
    v_cvt_pk_bf16_f32 v200, v144, v145
    v_mfma_f32_16x16x32_bf16 v[148:151], a[184:187], v[68:71], v[48:51]
    v_exp_f32 v146, v146
    v_mfma_f32_16x16x32_bf16 v[148:151], a[188:191], v[84:87], v[148:151]
    ds_read_b128 a[212:215], v15 offset:53248
    v_mfma_f32_16x16x32_bf16 v[148:151], a[192:195], v[100:103], v[148:151]
    v_exp_f32 v147, v147
    v_mfma_f32_16x16x32_bf16 v[148:151], a[196:199], v[116:119], v[148:151]
    ds_read_b64_tr_b16 a[240:241], v30 offset:32768
    v_cvt_pk_bf16_f32 v201, v146, v147
    v_mfma_f32_16x16x32_bf16 a[20:23], a[224:227], v[160:163], a[20:23]
    ds_read_b64_tr_b16 a[242:243], v30 offset:36864
    v_mfma_f32_16x16x32_bf16 a[20:23], a[228:231], v[164:167], a[20:23]
    ds_read_b64_tr_b16 a[244:245], v31 offset:32768
    v_mfma_f32_16x16x32_bf16 a[52:55], a[228:231], v[172:175], a[52:55]
    ds_read_b64_tr_b16 a[246:247], v31 offset:36864
    v_mfma_f32_16x16x32_bf16 a[52:55], a[224:227], v[168:171], a[52:55]
    v_mfma_f32_16x16x32_bf16 v[152:155], a[184:187], v[72:75], v[52:55]
    v_exp_f32 v148, v148
    v_mfma_f32_16x16x32_bf16 v[152:155], a[188:191], v[88:91], v[152:155]
    v_mfma_f32_16x16x32_bf16 v[152:155], a[192:195], v[104:107], v[152:155]
    v_exp_f32 v149, v149
    v_mfma_f32_16x16x32_bf16 v[152:155], a[196:199], v[120:123], v[152:155]
    v_cvt_pk_bf16_f32 v208, v148, v149
    v_mfma_f32_16x16x32_bf16 a[84:87], a[224:227], v[176:179], a[84:87]
    v_exp_f32 v150, v150
    v_mfma_f32_16x16x32_bf16 a[84:87], a[228:231], v[180:183], a[84:87]
    v_mfma_f32_16x16x32_bf16 a[116:119], a[228:231], v[188:191], a[116:119]
    v_exp_f32 v151, v151
    v_mfma_f32_16x16x32_bf16 a[116:119], a[224:227], v[184:187], a[116:119]
    v_cvt_pk_bf16_f32 v209, v150, v151
    v_mfma_f32_16x16x32_bf16 v[156:159], a[184:187], v[76:79], v[56:59]
    v_exp_f32 v152, v152
    v_mfma_f32_16x16x32_bf16 v[156:159], a[188:191], v[92:95], v[156:159]
    v_mfma_f32_16x16x32_bf16 v[156:159], a[192:195], v[108:111], v[156:159]
    v_exp_f32 v153, v153
    v_mfma_f32_16x16x32_bf16 v[156:159], a[196:199], v[124:127], v[156:159]
    v_cvt_pk_bf16_f32 v216, v152, v153
    s_waitcnt lgkmcnt(0)
    v_mfma_f32_16x16x32_bf16 a[24:27], a[232:235], v[160:163], a[24:27]
    v_exp_f32 v154, v154
    v_mfma_f32_16x16x32_bf16 a[24:27], a[236:239], v[164:167], a[24:27]
    v_mfma_f32_16x16x32_bf16 a[56:59], a[236:239], v[172:175], a[56:59]
    v_exp_f32 v155, v155
    v_mfma_f32_16x16x32_bf16 a[56:59], a[232:235], v[168:171], a[56:59]
    v_cvt_pk_bf16_f32 v217, v154, v155
    v_mfma_f32_16x16x32_bf16 v[144:147], a[200:203], v[64:67], v[44:47]
    v_exp_f32 v156, v156
    v_mfma_f32_16x16x32_bf16 v[144:147], a[204:207], v[80:83], v[144:147]
    v_mfma_f32_16x16x32_bf16 v[144:147], a[208:211], v[96:99], v[144:147]
    v_exp_f32 v157, v157
    v_mfma_f32_16x16x32_bf16 v[144:147], a[212:215], v[112:115], v[144:147]
    v_cvt_pk_bf16_f32 v224, v156, v157
    v_mfma_f32_16x16x32_bf16 a[88:91], a[232:235], v[176:179], a[88:91]
    v_exp_f32 v158, v158
    v_mfma_f32_16x16x32_bf16 a[88:91], a[236:239], v[180:183], a[88:91]
    v_mfma_f32_16x16x32_bf16 a[120:123], a[236:239], v[188:191], a[120:123]
    v_exp_f32 v159, v159
    v_mfma_f32_16x16x32_bf16 a[120:123], a[232:235], v[184:187], a[120:123]
    s_waitcnt lgkmcnt(15)
    s_waitcnt vmcnt(16)
    v_mfma_f32_16x16x32_bf16 v[148:151], a[200:203], v[68:71], v[48:51]
    s_barrier
    v_cvt_pk_bf16_f32 v225, v158, v159
    v_mfma_f32_16x16x32_bf16 v[148:151], a[204:207], v[84:87], v[148:151]
    v_exp_f32 v144, v144
    v_mfma_f32_16x16x32_bf16 v[148:151], a[208:211], v[100:103], v[148:151]
    v_exp_f32 v145, v145
    v_mfma_f32_16x16x32_bf16 v[148:151], a[212:215], v[116:119], v[148:151]
    ds_read_b128 a[184:187], v8 offset:0
    v_cvt_pk_bf16_f32 v202, v144, v145
    v_mfma_f32_16x16x32_bf16 a[152:155], a[232:235], v[192:195], a[152:155]
    v_exp_f32 v146, v146
    v_mfma_f32_16x16x32_bf16 a[156:159], a[240:243], v[192:195], a[156:159]
    ds_read_b128 a[188:191], v10 offset:0
    v_mfma_f32_16x16x32_bf16 a[164:167], a[172:175], v[184:187], a[164:167]
    v_exp_f32 v147, v147
    v_mfma_f32_16x16x32_bf16 a[164:167], a[172:175], v[188:191], a[164:167]
    ds_read_b128 a[192:195], v12 offset:0
    v_cvt_pk_bf16_f32 v203, v146, v147
    v_mfma_f32_16x16x32_bf16 v[152:155], a[200:203], v[72:75], v[52:55]
    v_exp_f32 v148, v148
    v_mfma_f32_16x16x32_bf16 v[152:155], a[204:207], v[88:91], v[152:155]
    ds_read_b128 a[196:199], v14 offset:0
    v_mfma_f32_16x16x32_bf16 v[152:155], a[208:211], v[104:107], v[152:155]
    v_exp_f32 v149, v149
    v_mfma_f32_16x16x32_bf16 v[152:155], a[212:215], v[120:123], v[152:155]
    ds_read_b64_tr_b16 a[216:217], v16 offset:49152
    v_cvt_pk_bf16_f32 v210, v148, v149
    v_mfma_f32_16x16x32_bf16 a[28:31], a[240:243], v[160:163], a[28:31]
    v_exp_f32 v150, v150
    v_mfma_f32_16x16x32_bf16 a[28:31], a[244:247], v[164:167], a[28:31]
    ds_read_b64_tr_b16 a[218:219], v16 offset:53248
    v_mfma_f32_16x16x32_bf16 a[60:63], a[244:247], v[172:175], a[60:63]
    v_exp_f32 v151, v151
    v_mfma_f32_16x16x32_bf16 a[60:63], a[240:243], v[168:171], a[60:63]
    ds_read_b64_tr_b16 a[220:221], v17 offset:49152
    v_cvt_pk_bf16_f32 v211, v150, v151
    v_mfma_f32_16x16x32_bf16 v[156:159], a[200:203], v[76:79], v[56:59]
    v_exp_f32 v152, v152
    v_mfma_f32_16x16x32_bf16 v[156:159], a[204:207], v[92:95], v[156:159]
    ds_read_b64_tr_b16 a[222:223], v17 offset:53248
    v_mfma_f32_16x16x32_bf16 v[156:159], a[208:211], v[108:111], v[156:159]
    v_exp_f32 v153, v153
    v_mfma_f32_16x16x32_bf16 v[156:159], a[212:215], v[124:127], v[156:159]
    ds_read_b64_tr_b16 a[224:225], v18 offset:49152
    v_cvt_pk_bf16_f32 v218, v152, v153
    v_mfma_f32_16x16x32_bf16 a[92:95], a[240:243], v[176:179], a[92:95]
    v_exp_f32 v154, v154
    v_mfma_f32_16x16x32_bf16 a[92:95], a[244:247], v[180:183], a[92:95]
    ds_read_b64_tr_b16 a[226:227], v18 offset:53248
    s_waitcnt lgkmcnt(2)
    v_mfma_f32_16x16x32_bf16 a[124:127], a[244:247], v[188:191], a[124:127]
    v_exp_f32 v155, v155
    v_mfma_f32_16x16x32_bf16 a[124:127], a[240:243], v[184:187], a[124:127]
    ds_read_b64_tr_b16 a[228:229], v19 offset:49152
    s_waitcnt lgkmcnt(15)
    s_sub_u32 s32, s32, 1
    s_cmp_eq_u32 s32, 0
    s_cbranch_scc1 L_tail
    v_mfma_f32_16x16x32_bf16 v[144:147], a[184:187], v[64:67], v[44:47]
    v_exp_f32 v156, v156
    v_mfma_f32_16x16x32_bf16 v[144:147], a[188:191], v[80:83], v[144:147]
    ds_read_b64_tr_b16 a[230:231], v19 offset:53248
    s_add_u32 m0, s29, 98304
    v_mfma_f32_16x16x32_bf16 v[144:147], a[192:195], v[96:99], v[144:147]
    v_exp_f32 v157, v157
    v_mfma_f32_16x16x32_bf16 v[144:147], a[196:199], v[112:115], v[144:147]
    buffer_load_dwordx4 v36, s[8:11], s31 offen offset:0 nt lds
    v_mfma_f32_16x16x32_bf16 a[0:3], a[216:219], v[196:199], a[0:3]
    v_exp_f32 v158, v158
    v_mfma_f32_16x16x32_bf16 a[0:3], a[220:223], v[200:203], a[0:3]
    v_cvt_pk_bf16_f32 v226, v156, v157
    v_cvt_pk_bf16_f32 v219, v154, v155
    v_mfma_f32_16x16x32_bf16 a[32:35], a[220:223], v[208:211], a[32:35]
    v_exp_f32 v159, v159
    v_mfma_f32_16x16x32_bf16 a[32:35], a[216:219], v[204:207], a[32:35]
    buffer_load_dwordx4 v37, s[8:11], s31 offen offset:1024 nt lds
    v_mfma_f32_16x16x32_bf16 a[64:67], a[216:219], v[212:215], a[64:67]
    v_exp_f32 v144, v144
    v_cvt_pk_bf16_f32 v227, v158, v159
    v_mfma_f32_16x16x32_bf16 a[64:67], a[220:223], v[216:219], a[64:67]
    ds_read_b64_tr_b16 a[232:233], v20 offset:49152
    v_mfma_f32_16x16x32_bf16 a[96:99], a[220:223], v[224:227], a[96:99]
    v_exp_f32 v145, v145
    v_mfma_f32_16x16x32_bf16 a[96:99], a[216:219], v[220:223], a[96:99]
    buffer_load_dwordx4 v36, s[8:11], s31 offen offset:2048 nt lds
    v_mfma_f32_16x16x32_bf16 v[148:151], a[184:187], v[68:71], v[48:51]
    v_exp_f32 v146, v146
    v_mfma_f32_16x16x32_bf16 v[148:151], a[188:191], v[84:87], v[148:151]
    ds_read_b64_tr_b16 a[234:235], v20 offset:53248
    s_waitcnt lgkmcnt(2)
    v_mfma_f32_16x16x32_bf16 v[148:151], a[192:195], v[100:103], v[148:151]
    v_exp_f32 v147, v147
    v_mfma_f32_16x16x32_bf16 v[148:151], a[196:199], v[116:119], v[148:151]
    buffer_load_dwordx4 v37, s[8:11], s31 offen offset:3072 nt lds
    v_mfma_f32_16x16x32_bf16 a[128:131], a[216:219], v[228:231], a[128:131]
    ds_read_b64_tr_b16 a[236:237], v21 offset:49152
    s_add_u32 s31, s31, 16384
    v_mfma_f32_16x16x32_bf16 a[132:135], a[224:227], v[228:231], a[132:135]
    ds_read_b64_tr_b16 a[238:239], v21 offset:53248
    v_cvt_pk_bf16_f32 v161, v146, v147
    v_mfma_f32_16x16x32_bf16 a[160:163], a[180:183], v[196:199], a[160:163]
    ds_read_b128 a[200:203], v8 offset:4096
    v_cvt_pk_bf16_f32 v160, v144, v145
    v_mfma_f32_16x16x32_bf16 a[160:163], a[180:183], v[200:203], a[160:163]
    ds_read_b128 a[204:207], v10 offset:4096
    s_add_u32 m0, s53, 49152
    v_mfma_f32_16x16x32_bf16 v[152:155], a[184:187], v[72:75], v[52:55]
    v_exp_f32 v148, v148
    v_mfma_f32_16x16x32_bf16 v[152:155], a[188:191], v[88:91], v[152:155]
    buffer_load_dwordx4 v32, s[4:7], s30 offen offset:0 nt lds
    v_mfma_f32_16x16x32_bf16 v[152:155], a[192:195], v[104:107], v[152:155]
    v_exp_f32 v149, v149
    v_mfma_f32_16x16x32_bf16 v[152:155], a[196:199], v[120:123], v[152:155]
    ds_read_b128 a[208:211], v12 offset:4096
    v_cvt_pk_bf16_f32 v168, v148, v149
    v_mfma_f32_16x16x32_bf16 a[4:7], a[224:227], v[196:199], a[4:7]
    v_exp_f32 v150, v150
    v_mfma_f32_16x16x32_bf16 a[4:7], a[228:231], v[200:203], a[4:7]
    buffer_load_dwordx4 v33, s[4:7], s30 offen offset:1024 nt lds
    v_mfma_f32_16x16x32_bf16 a[36:39], a[228:231], v[208:211], a[36:39]
    v_exp_f32 v151, v151
    v_mfma_f32_16x16x32_bf16 a[36:39], a[224:227], v[204:207], a[36:39]
    ds_read_b128 a[212:215], v14 offset:4096
    v_cvt_pk_bf16_f32 v169, v150, v151
    v_mfma_f32_16x16x32_bf16 v[156:159], a[184:187], v[76:79], v[56:59]
    v_exp_f32 v152, v152
    v_mfma_f32_16x16x32_bf16 v[156:159], a[188:191], v[92:95], v[156:159]
    buffer_load_dwordx4 v34, s[4:7], s30 offen offset:2048 nt lds
    v_mfma_f32_16x16x32_bf16 v[156:159], a[192:195], v[108:111], v[156:159]
    v_exp_f32 v153, v153
    v_mfma_f32_16x16x32_bf16 v[156:159], a[196:199], v[124:127], v[156:159]
    ds_read_b64_tr_b16 a[240:241], v22 offset:49152
    v_cvt_pk_bf16_f32 v176, v152, v153
    v_mfma_f32_16x16x32_bf16 a[68:71], a[224:227], v[212:215], a[68:71]
    v_exp_f32 v154, v154
    v_mfma_f32_16x16x32_bf16 a[68:71], a[228:231], v[216:219], a[68:71]
    buffer_load_dwordx4 v35, s[4:7], s30 offen offset:3072 nt lds
    v_mfma_f32_16x16x32_bf16 a[100:103], a[228:231], v[224:227], a[100:103]
    v_exp_f32 v155, v155
    v_mfma_f32_16x16x32_bf16 a[100:103], a[224:227], v[220:223], a[100:103]
    ds_read_b64_tr_b16 a[242:243], v22 offset:53248
    s_add_u32 s30, s30, 16384
    v_mfma_f32_16x16x32_bf16 v[144:147], a[184:187], v[128:131], v[60:63]
    v_exp_f32 v156, v156
    v_mfma_f32_16x16x32_bf16 v[144:147], a[188:191], v[132:135], v[144:147]
    ds_read_b64_tr_b16 a[244:245], v23 offset:49152
    v_cvt_pk_bf16_f32 v177, v154, v155
    v_mfma_f32_16x16x32_bf16 v[144:147], a[192:195], v[136:139], v[144:147]
    v_exp_f32 v157, v157
    v_mfma_f32_16x16x32_bf16 v[144:147], a[196:199], v[140:143], v[144:147]
    ds_read_b64_tr_b16 a[246:247], v23 offset:53248
    s_waitcnt lgkmcnt(4)
    v_mfma_f32_16x16x32_bf16 a[8:11], a[232:235], v[196:199], a[8:11]
    v_exp_f32 v158, v158
    v_mfma_f32_16x16x32_bf16 a[8:11], a[236:239], v[200:203], a[8:11]
    v_cvt_pk_bf16_f32 v184, v156, v157
    v_mfma_f32_16x16x32_bf16 a[40:43], a[236:239], v[208:211], a[40:43]
    v_exp_f32 v159, v159
    v_mfma_f32_16x16x32_bf16 a[40:43], a[232:235], v[204:207], a[40:43]
    v_cvt_pk_bf16_f32 v185, v158, v159
    v_mfma_f32_16x16x32_bf16 v[148:151], a[200:203], v[64:67], v[44:47]
    v_exp_f32 v144, v144
    v_mfma_f32_16x16x32_bf16 v[148:151], a[204:207], v[80:83], v[148:151]
    v_mfma_f32_16x16x32_bf16 v[148:151], a[208:211], v[96:99], v[148:151]
    v_exp_f32 v145, v145
    v_mfma_f32_16x16x32_bf16 v[148:151], a[212:215], v[112:115], v[148:151]
    ds_read_b64_tr_b16 a[216:217], v24 offset:49152
    v_cvt_pk_bf16_f32 v192, v144, v145
    v_mfma_f32_16x16x32_bf16 a[72:75], a[232:235], v[212:215], a[72:75]
    v_exp_f32 v146, v146
    v_mfma_f32_16x16x32_bf16 a[72:75], a[236:239], v[216:219], a[72:75]
    ds_read_b64_tr_b16 a[218:219], v24 offset:53248
    v_mfma_f32_16x16x32_bf16 a[104:107], a[236:239], v[224:227], a[104:107]
    v_exp_f32 v147, v147
    v_mfma_f32_16x16x32_bf16 a[104:107], a[232:235], v[220:223], a[104:107]
    ds_read_b64_tr_b16 a[220:221], v25 offset:49152
    v_cvt_pk_bf16_f32 v193, v146, v147
    v_mfma_f32_16x16x32_bf16 v[152:155], a[200:203], v[68:71], v[48:51]
    v_exp_f32 v148, v148
    v_mfma_f32_16x16x32_bf16 v[152:155], a[204:207], v[84:87], v[152:155]
    ds_read_b64_tr_b16 a[222:223], v25 offset:53248
    v_mfma_f32_16x16x32_bf16 v[152:155], a[208:211], v[100:103], v[152:155]
    v_exp_f32 v149, v149
    v_mfma_f32_16x16x32_bf16 v[152:155], a[212:215], v[116:119], v[152:155]
    ds_read_b128 a[184:187], v9 offset:0
    s_waitcnt lgkmcnt(5)
    v_mfma_f32_16x16x32_bf16 a[136:139], a[232:235], v[228:231], a[136:139]
    v_exp_f32 v150, v150
    v_mfma_f32_16x16x32_bf16 a[140:143], a[240:243], v[228:231], a[140:143]
    ds_read_b128 a[188:191], v11 offset:0
    v_cvt_pk_bf16_f32 v162, v148, v149
    v_mfma_f32_16x16x32_bf16 a[176:179], a[180:183], v[228:231], a[176:179]
    v_exp_f32 v151, v151
    v_mfma_f32_16x16x32_bf16 a[160:163], a[172:175], v[212:215], a[160:163]
    ds_read_b128 a[192:195], v13 offset:0
    v_cvt_pk_bf16_f32 v163, v150, v151
    v_mfma_f32_16x16x32_bf16 a[160:163], a[172:175], v[216:219], a[160:163]
    v_exp_f32 v152, v152
    v_mfma_f32_16x16x32_bf16 v[156:159], a[200:203], v[72:75], v[52:55]
    ds_read_b128 a[196:199], v15 offset:0
    v_mfma_f32_16x16x32_bf16 v[156:159], a[204:207], v[88:91], v[156:159]
    v_exp_f32 v153, v153
    v_mfma_f32_16x16x32_bf16 v[156:159], a[208:211], v[104:107], v[156:159]
    ds_read_b64_tr_b16 a[224:225], v26 offset:49152
    v_cvt_pk_bf16_f32 v170, v152, v153
    v_mfma_f32_16x16x32_bf16 v[156:159], a[212:215], v[120:123], v[156:159]
    v_exp_f32 v154, v154
    v_mfma_f32_16x16x32_bf16 a[12:15], a[240:243], v[196:199], a[12:15]
    ds_read_b64_tr_b16 a[226:227], v26 offset:53248
    v_mfma_f32_16x16x32_bf16 a[12:15], a[244:247], v[200:203], a[12:15]
    v_exp_f32 v155, v155
    v_mfma_f32_16x16x32_bf16 a[44:47], a[244:247], v[208:211], a[44:47]
    ds_read_b64_tr_b16 a[228:229], v27 offset:49152
    v_cvt_pk_bf16_f32 v171, v154, v155
    v_mfma_f32_16x16x32_bf16 a[44:47], a[240:243], v[204:207], a[44:47]
    ds_read_b64_tr_b16 a[230:231], v27 offset:53248
    v_mfma_f32_16x16x32_bf16 v[144:147], a[200:203], v[76:79], v[56:59]
    v_exp_f32 v156, v156
    v_mfma_f32_16x16x32_bf16 v[144:147], a[204:207], v[92:95], v[144:147]
    v_mfma_f32_16x16x32_bf16 v[144:147], a[208:211], v[108:111], v[144:147]
    v_exp_f32 v157, v157
    v_mfma_f32_16x16x32_bf16 v[144:147], a[212:215], v[124:127], v[144:147]
    v_cvt_pk_bf16_f32 v178, v156, v157
    v_mfma_f32_16x16x32_bf16 a[76:79], a[240:243], v[212:215], a[76:79]
    v_exp_f32 v158, v158
    v_mfma_f32_16x16x32_bf16 a[76:79], a[244:247], v[216:219], a[76:79]
    v_mfma_f32_16x16x32_bf16 a[108:111], a[244:247], v[224:227], a[108:111]
    v_exp_f32 v159, v159
    v_mfma_f32_16x16x32_bf16 a[108:111], a[240:243], v[220:223], a[108:111]
    v_cvt_pk_bf16_f32 v179, v158, v159
    v_mfma_f32_16x16x32_bf16 v[148:151], a[200:203], v[128:131], v[60:63]
    v_exp_f32 v144, v144
    v_mfma_f32_16x16x32_bf16 v[148:151], a[204:207], v[132:135], v[148:151]
    v_mfma_f32_16x16x32_bf16 v[148:151], a[208:211], v[136:139], v[148:151]
    v_exp_f32 v145, v145
    v_mfma_f32_16x16x32_bf16 v[148:151], a[212:215], v[140:143], v[148:151]
    v_cvt_pk_bf16_f32 v186, v144, v145
    s_waitcnt lgkmcnt(0)
    v_mfma_f32_16x16x32_bf16 a[16:19], a[216:219], v[196:199], a[16:19]
    v_exp_f32 v146, v146
    v_mfma_f32_16x16x32_bf16 a[16:19], a[220:223], v[200:203], a[16:19]
    v_mfma_f32_16x16x32_bf16 a[48:51], a[220:223], v[208:211], a[48:51]
    v_exp_f32 v147, v147
    v_mfma_f32_16x16x32_bf16 a[48:51], a[216:219], v[204:207], a[48:51]
    ds_read_b64_tr_b16 a[232:233], v28 offset:49152
    v_cvt_pk_bf16_f32 v187, v146, v147
    v_mfma_f32_16x16x32_bf16 v[152:155], a[184:187], v[64:67], v[44:47]
    v_exp_f32 v148, v148
    v_mfma_f32_16x16x32_bf16 v[152:155], a[188:191], v[80:83], v[152:155]
    ds_read_b64_tr_b16 a[234:235], v28 offset:53248
    v_mfma_f32_16x16x32_bf16 v[152:155], a[192:195], v[96:99], v[152:155]
    v_exp_f32 v149, v149
    v_mfma_f32_16x16x32_bf16 v[152:155], a[196:199], v[112:115], v[152:155]
    ds_read_b64_tr_b16 a[236:237], v29 offset:49152
    v_cvt_pk_bf16_f32 v194, v148, v149
    v_mfma_f32_16x16x32_bf16 a[80:83], a[216:219], v[212:215], a[80:83]
    v_exp_f32 v150, v150
    v_mfma_f32_16x16x32_bf16 a[80:83], a[220:223], v[216:219], a[80:83]
    ds_read_b64_tr_b16 a[238:239], v29 offset:53248
    v_mfma_f32_16x16x32_bf16 a[112:115], a[220:223], v[224:227], a[112:115]
    v_exp_f32 v151, v151
    v_mfma_f32_16x16x32_bf16 a[112:115], a[216:219], v[220:223], a[112:115]
    ds_read_b128 a[200:203], v9 offset:4096
    v_cvt_pk_bf16_f32 v195, v150, v151
    v_mfma_f32_16x16x32_bf16 a[144:147], a[216:219], v[228:231], a[144:147]
    v_exp_f32 v152, v152
    v_mfma_f32_16x16x32_bf16 a[148:151], a[224:227], v[228:231], a[148:151]
    ds_read_b128 a[204:207], v11 offset:4096
    v_mfma_f32_16x16x32_bf16 a[164:167], a[180:183], v[204:207], a[164:167]
    v_exp_f32 v153, v153
    v_mfma_f32_16x16x32_bf16 a[164:167], a[180:183], v[208:211], a[164:167]
    ds_read_b128 a[208:211], v13 offset:4096
    v_cvt_pk_bf16_f32 v164, v152, v153
    v_mfma_f32_16x16x32_bf16 v[156:159], a[184:187], v[68:71], v[48:51]
    v_exp_f32 v154, v154
    v_mfma_f32_16x16x32_bf16 v[156:159], a[188:191], v[84:87], v[156:159]
    ds_read_b128 a[212:215], v15 offset:4096
    v_mfma_f32_16x16x32_bf16 v[156:159], a[192:195], v[100:103], v[156:159]
    v_exp_f32 v155, v155
    v_mfma_f32_16x16x32_bf16 v[156:159], a[196:199], v[116:119], v[156:159]
    ds_read_b64_tr_b16 a[240:241], v30 offset:49152
    v_cvt_pk_bf16_f32 v165, v154, v155
    v_mfma_f32_16x16x32_bf16 a[20:23], a[224:227], v[196:199], a[20:23]
    ds_read_b64_tr_b16 a[242:243], v30 offset:53248
    v_mfma_f32_16x16x32_bf16 a[20:23], a[228:231], v[200:203], a[20:23]
    ds_read_b64_tr_b16 a[244:245], v31 offset:49152
    v_mfma_f32_16x16x32_bf16 a[52:55], a[228:231], v[208:211], a[52:55]
    ds_read_b64_tr_b16 a[246:247], v31 offset:53248
    v_mfma_f32_16x16x32_bf16 a[52:55], a[224:227], v[204:207], a[52:55]
    v_mfma_f32_16x16x32_bf16 v[144:147], a[184:187], v[72:75], v[52:55]
    v_exp_f32 v156, v156
    v_mfma_f32_16x16x32_bf16 v[144:147], a[188:191], v[88:91], v[144:147]
    v_mfma_f32_16x16x32_bf16 v[144:147], a[192:195], v[104:107], v[144:147]
    v_exp_f32 v157, v157
    v_mfma_f32_16x16x32_bf16 v[144:147], a[196:199], v[120:123], v[144:147]
    v_cvt_pk_bf16_f32 v172, v156, v157
    v_mfma_f32_16x16x32_bf16 a[84:87], a[224:227], v[212:215], a[84:87]
    v_exp_f32 v158, v158
    v_mfma_f32_16x16x32_bf16 a[84:87], a[228:231], v[216:219], a[84:87]
    v_mfma_f32_16x16x32_bf16 a[116:119], a[228:231], v[224:227], a[116:119]
    v_exp_f32 v159, v159
    v_mfma_f32_16x16x32_bf16 a[116:119], a[224:227], v[220:223], a[116:119]
    v_cvt_pk_bf16_f32 v173, v158, v159
    v_mfma_f32_16x16x32_bf16 v[148:151], a[184:187], v[76:79], v[56:59]
    v_exp_f32 v144, v144
    v_mfma_f32_16x16x32_bf16 v[148:151], a[188:191], v[92:95], v[148:151]
    v_mfma_f32_16x16x32_bf16 v[148:151], a[192:195], v[108:111], v[148:151]
    v_exp_f32 v145, v145
    v_mfma_f32_16x16x32_bf16 v[148:151], a[196:199], v[124:127], v[148:151]
    v_cvt_pk_bf16_f32 v180, v144, v145
    s_waitcnt lgkmcnt(0)
    v_mfma_f32_16x16x32_bf16 a[24:27], a[232:235], v[196:199], a[24:27]
    v_exp_f32 v146, v146
    v_mfma_f32_16x16x32_bf16 a[24:27], a[236:239], v[200:203], a[24:27]
    v_mfma_f32_16x16x32_bf16 a[56:59], a[236:239], v[208:211], a[56:59]
    v_exp_f32 v147, v147
    v_mfma_f32_16x16x32_bf16 a[56:59], a[232:235], v[204:207], a[56:59]
    v_cvt_pk_bf16_f32 v181, v146, v147
    v_mfma_f32_16x16x32_bf16 v[152:155], a[200:203], v[64:67], v[44:47]
    v_exp_f32 v148, v148
    v_mfma_f32_16x16x32_bf16 v[152:155], a[204:207], v[80:83], v[152:155]
    v_mfma_f32_16x16x32_bf16 v[152:155], a[208:211], v[96:99], v[152:155]
    v_exp_f32 v149, v149
    v_mfma_f32_16x16x32_bf16 v[152:155], a[212:215], v[112:115], v[152:155]
    v_cvt_pk_bf16_f32 v188, v148, v149
    v_mfma_f32_16x16x32_bf16 a[88:91], a[232:235], v[212:215], a[88:91]
    v_exp_f32 v150, v150
    v_mfma_f32_16x16x32_bf16 a[88:91], a[236:239], v[216:219], a[88:91]
    v_mfma_f32_16x16x32_bf16 a[120:123], a[236:239], v[224:227], a[120:123]
    v_exp_f32 v151, v151
    v_mfma_f32_16x16x32_bf16 a[120:123], a[232:235], v[220:223], a[120:123]
    s_waitcnt lgkmcnt(15)
    s_waitcnt vmcnt(16)
    v_mfma_f32_16x16x32_bf16 v[156:159], a[200:203], v[68:71], v[48:51]
    s_barrier
    v_cvt_pk_bf16_f32 v189, v150, v151
    v_mfma_f32_16x16x32_bf16 v[156:159], a[204:207], v[84:87], v[156:159]
    v_exp_f32 v152, v152
    v_mfma_f32_16x16x32_bf16 v[156:159], a[208:211], v[100:103], v[156:159]
    v_exp_f32 v153, v153
    v_mfma_f32_16x16x32_bf16 v[156:159], a[212:215], v[116:119], v[156:159]
    ds_read_b128 a[184:187], v8 offset:16384
    v_cvt_pk_bf16_f32 v166, v152, v153
    v_mfma_f32_16x16x32_bf16 a[152:155], a[232:235], v[228:231], a[152:155]
    v_exp_f32 v154, v154
    v_mfma_f32_16x16x32_bf16 a[156:159], a[240:243], v[228:231], a[156:159]
    ds_read_b128 a[188:191], v10 offset:16384
    v_mfma_f32_16x16x32_bf16 a[164:167], a[172:175], v[220:223], a[164:167]
    v_exp_f32 v155, v155
    v_mfma_f32_16x16x32_bf16 a[164:167], a[172:175], v[224:227], a[164:167]
    ds_read_b128 a[192:195], v12 offset:16384
    v_cvt_pk_bf16_f32 v167, v154, v155
    v_mfma_f32_16x16x32_bf16 v[144:147], a[200:203], v[72:75], v[52:55]
    v_exp_f32 v156, v156
    v_mfma_f32_16x16x32_bf16 v[144:147], a[204:207], v[88:91], v[144:147]
    ds_read_b128 a[196:199], v14 offset:16384
    v_mfma_f32_16x16x32_bf16 v[144:147], a[208:211], v[104:107], v[144:147]
    v_exp_f32 v157, v157
    v_mfma_f32_16x16x32_bf16 v[144:147], a[212:215], v[120:123], v[144:147]
    ds_read_b64_tr_b16 a[216:217], v16 offset:0
    v_cvt_pk_bf16_f32 v174, v156, v157
    v_mfma_f32_16x16x32_bf16 a[28:31], a[240:243], v[196:199], a[28:31]
    v_exp_f32 v158, v158
    v_mfma_f32_16x16x32_bf16 a[28:31], a[244:247], v[200:203], a[28:31]
    ds_read_b64_tr_b16 a[218:219], v16 offset:4096
    v_mfma_f32_16x16x32_bf16 a[60:63], a[244:247], v[208:211], a[60:63]
    v_exp_f32 v159, v159
    v_mfma_f32_16x16x32_bf16 a[60:63], a[240:243], v[204:207], a[60:63]
    ds_read_b64_tr_b16 a[220:221], v17 offset:0
    v_cvt_pk_bf16_f32 v175, v158, v159
    v_mfma_f32_16x16x32_bf16 v[148:151], a[200:203], v[76:79], v[56:59]
    v_exp_f32 v144, v144
    v_mfma_f32_16x16x32_bf16 v[148:151], a[204:207], v[92:95], v[148:151]
    ds_read_b64_tr_b16 a[222:223], v17 offset:4096
    v_mfma_f32_16x16x32_bf16 v[148:151], a[208:211], v[108:111], v[148:151]
    v_exp_f32 v145, v145
    v_mfma_f32_16x16x32_bf16 v[148:151], a[212:215], v[124:127], v[148:151]
    ds_read_b64_tr_b16 a[224:225], v18 offset:0
    v_cvt_pk_bf16_f32 v182, v144, v145
    v_mfma_f32_16x16x32_bf16 a[92:95], a[240:243], v[212:215], a[92:95]
    v_exp_f32 v146, v146
    v_mfma_f32_16x16x32_bf16 a[92:95], a[244:247], v[216:219], a[92:95]
    ds_read_b64_tr_b16 a[226:227], v18 offset:4096
    s_waitcnt lgkmcnt(2)
    v_mfma_f32_16x16x32_bf16 a[124:127], a[244:247], v[224:227], a[124:127]
    v_exp_f32 v147, v147
    v_mfma_f32_16x16x32_bf16 a[124:127], a[240:243], v[220:223], a[124:127]
    ds_read_b64_tr_b16 a[228:229], v19 offset:0
    s_waitcnt lgkmcnt(15)
    s_and_b32 s35, s33, s32
    s_cbranch_scc0 L_loop
    v_mov_b32 v7, 1
    buffer_atomic_add v7, v38, s[92:95], s52 offen
    s_mov_b32 s52, 0x40000000
    s_cmp_eq_u32 s32, s54
    s_cselect_b32 s53, s90, s29
    s_cselect_b32 s35, 0, s52
    buffer_load_dword v2, off, s[92:95], s35 sc1
    s_branch L_loop
L_tail:
    s_cmp_lg_u32 s33, 0
    s_cbranch_scc1 L_tail1
    v_exp_f32 v156, v156
    ds_read_b64_tr_b16 a[230:231], v19 offset:53248
    s_add_u32 m0, s29, 98304
    v_exp_f32 v157, v157
    buffer_load_dwordx4 v36, s[8:11], s31 offen offset:0 nt lds
    v_mfma_f32_16x16x32_bf16 a[0:3], a[216:219], v[196:199], a[0:3]
    v_exp_f32 v158, v158
    v_mfma_f32_16x16x32_bf16 a[0:3], a[220:223], v[200:203], a[0:3]
    v_cvt_pk_bf16_f32 v226, v156, v157
    v_cvt_pk_bf16_f32 v219, v154, v155
    v_mfma_f32_16x16x32_bf16 a[32:35], a[220:223], v[208:211], a[32:35]
    v_exp_f32 v159, v159
    v_mfma_f32_16x16x32_bf16 a[32:35], a[216:219], v[204:207], a[32:35]
    buffer_load_dwordx4 v37, s[8:11], s31 offen offset:1024 nt lds
    v_mfma_f32_16x16x32_bf16 a[64:67], a[216:219], v[212:215], a[64:67]
    v_cvt_pk_bf16_f32 v227, v158, v159
    v_mfma_f32_16x16x32_bf16 a[64:67], a[220:223], v[216:219], a[64:67]
    ds_read_b64_tr_b16 a[232:233], v20 offset:49152
    v_mfma_f32_16x16x32_bf16 a[96:99], a[220:223], v[224:227], a[96:99]
    v_mfma_f32_16x16x32_bf16 a[96:99], a[216:219], v[220:223], a[96:99]
    buffer_load_dwordx4 v36, s[8:11], s31 offen offset:2048 nt lds
    ds_read_b64_tr_b16 a[234:235], v20 offset:53248
    s_waitcnt lgkmcnt(2)
    buffer_load_dwordx4 v37, s[8:11], s31 offen offset:3072 nt lds
    v_mfma_f32_16x16x32_bf16 a[128:131], a[216:219], v[228:231], a[128:131]
    ds_read_b64_tr_b16 a[236:237], v21 offset:49152
    s_add_u32 s31, s31, 16384
    v_mfma_f32_16x16x32_bf16 a[132:135], a[224:227], v[228:231], a[132:135]
    ds_read_b64_tr_b16 a[238:239], v21 offset:53248
    v_mfma_f32_16x16x32_bf16 a[160:163], a[180:183], v[196:199], a[160:163]
    v_mfma_f32_16x16x32_bf16 a[160:163], a[180:183], v[200:203], a[160:163]
    v_mfma_f32_16x16x32_bf16 a[176:179], a[180:183], v[228:231], a[176:179]
    v_mfma_f32_16x16x32_bf16 a[160:163], a[172:175], v[212:215], a[160:163]
    v_mfma_f32_16x16x32_bf16 a[160:163], a[172:175], v[216:219], a[160:163]
    v_mfma_f32_16x16x32_bf16 a[164:167], a[180:183], v[204:207], a[164:167]
    v_mfma_f32_16x16x32_bf16 a[164:167], a[180:183], v[208:211], a[164:167]
    v_mfma_f32_16x16x32_bf16 a[164:167], a[172:175], v[220:223], a[164:167]
    v_mfma_f32_16x16x32_bf16 a[164:167], a[172:175], v[224:227], a[164:167]
    s_add_u32 m0, s53, 49152
    s_nop 0
    buffer_load_dwordx4 v32, s[4:7], s30 offen offset:0 nt lds
    v_mfma_f32_16x16x32_bf16 a[4:7], a[224:227], v[196:199], a[4:7]
    v_mfma_f32_16x16x32_bf16 a[4:7], a[228:231], v[200:203], a[4:7]
    buffer_load_dwordx4 v33, s[4:7], s30 offen offset:1024 nt lds
    v_mfma_f32_16x16x32_bf16 a[36:39], a[228:231], v[208:211], a[36:39]
    v_mfma_f32_16x16x32_bf16 a[36:39], a[224:227], v[204:207], a[36:39]
    buffer_load_dwordx4 v34, s[4:7], s30 offen offset:2048 nt lds
    ds_read_b64_tr_b16 a[240:241], v22 offset:49152
    v_mfma_f32_16x16x32_bf16 a[68:71], a[224:227], v[212:215], a[68:71]
    v_add_u32 v2, s68, v38
    v_add_u32 v3, 18432, v2
    v_mfma_f32_16x16x32_bf16 a[68:71], a[228:231], v[216:219], a[68:71]
    buffer_load_dwordx4 v35, s[4:7], s30 offen offset:3072 nt lds
    v_mfma_f32_16x16x32_bf16 a[100:103], a[228:231], v[224:227], a[100:103]
    v_add_u32 v4, s69, v38
    v_add_u32 v5, 18432, v4
    v_mfma_f32_16x16x32_bf16 a[100:103], a[224:227], v[220:223], a[100:103]
    ds_read_b64_tr_b16 a[242:243], v22 offset:53248
    s_add_u32 s30, s30, 16384
    ds_read_b64_tr_b16 a[244:245], v23 offset:49152
    ds_read_b64_tr_b16 a[246:247], v23 offset:53248
    s_waitcnt lgkmcnt(4)
    v_mfma_f32_16x16x32_bf16 a[8:11], a[232:235], v[196:199], a[8:11]
    v_accvgpr_read_b32 v184, a160
    v_accvgpr_read_b32 v185, a164
    v_mfma_f32_16x16x32_bf16 a[8:11], a[236:239], v[200:203], a[8:11]
    v_accvgpr_read_b32 v186, a161
    v_accvgpr_read_b32 v187, a165
    v_mfma_f32_16x16x32_bf16 a[40:43], a[236:239], v[208:211], a[40:43]
    v_accvgpr_read_b32 v188, a176
    v_add_f32 v190, v184, v185
    v_mfma_f32_16x16x32_bf16 a[40:43], a[232:235], v[204:207], a[40:43]
    ds_read_b64_tr_b16 a[216:217], v24 offset:49152
    v_add_f32 v190, v190, v186
    v_mfma_f32_16x16x32_bf16 a[72:75], a[232:235], v[212:215], a[72:75]
    v_add_f32 v190, v190, v187
    v_add_f32 v190, v190, v188
    v_mfma_f32_16x16x32_bf16 a[72:75], a[236:239], v[216:219], a[72:75]
    ds_read_b64_tr_b16 a[218:219], v24 offset:53248
    v_cmp_nge_f32 vcc, s72, v190
    v_mfma_f32_16x16x32_bf16 a[104:107], a[236:239], v[224:227], a[104:107]
    v_rcp_f32 v184, v184
    v_mfma_f32_16x16x32_bf16 a[104:107], a[232:235], v[220:223], a[104:107]
    ds_read_b64_tr_b16 a[220:221], v25 offset:49152
    ds_read_b64_tr_b16 a[222:223], v25 offset:53248
    s_waitcnt lgkmcnt(4)
    v_mfma_f32_16x16x32_bf16 a[136:139], a[232:235], v[228:231], a[136:139]
    v_rcp_f32 v185, v185
    v_mfma_f32_16x16x32_bf16 a[140:143], a[240:243], v[228:231], a[140:143]
    ds_read_b64_tr_b16 a[224:225], v26 offset:49152
    v_mfma_f32_16x16x32_bf16 a[12:15], a[240:243], v[196:199], a[12:15]
    ds_read_b64_tr_b16 a[226:227], v26 offset:53248
    v_mfma_f32_16x16x32_bf16 a[12:15], a[244:247], v[200:203], a[12:15]
    v_rcp_f32 v186, v186
    v_mfma_f32_16x16x32_bf16 a[44:47], a[244:247], v[208:211], a[44:47]
    ds_read_b64_tr_b16 a[228:229], v27 offset:49152
    v_mfma_f32_16x16x32_bf16 a[44:47], a[240:243], v[204:207], a[44:47]
    ds_read_b64_tr_b16 a[230:231], v27 offset:53248
    v_mfma_f32_16x16x32_bf16 a[76:79], a[240:243], v[212:215], a[76:79]
    v_rcp_f32 v187, v187
    v_mfma_f32_16x16x32_bf16 a[76:79], a[244:247], v[216:219], a[76:79]
    v_accvgpr_read_b32 v160, a0
    v_accvgpr_read_b32 v161, a1
    v_mfma_f32_16x16x32_bf16 a[108:111], a[244:247], v[224:227], a[108:111]
    v_accvgpr_read_b32 v162, a2
    v_accvgpr_read_b32 v163, a3
    v_mfma_f32_16x16x32_bf16 a[108:111], a[240:243], v[220:223], a[108:111]
    v_accvgpr_read_b32 v164, a4
    s_waitcnt lgkmcnt(0)
    v_mfma_f32_16x16x32_bf16 a[16:19], a[216:219], v[196:199], a[16:19]
    v_accvgpr_read_b32 v165, a5
    v_accvgpr_read_b32 v166, a6
    v_mfma_f32_16x16x32_bf16 a[16:19], a[220:223], v[200:203], a[16:19]
    v_accvgpr_read_b32 v167, a7
    v_mul_f32 v160, v160, v184
    v_mfma_f32_16x16x32_bf16 a[48:51], a[220:223], v[208:211], a[48:51]
    v_mul_f32 v161, v161, v184
    v_mul_f32 v162, v162, v184
    v_mfma_f32_16x16x32_bf16 a[48:51], a[216:219], v[204:207], a[48:51]
    ds_read_b64_tr_b16 a[232:233], v28 offset:49152
    ds_read_b64_tr_b16 a[234:235], v28 offset:53248
    ds_read_b64_tr_b16 a[236:237], v29 offset:49152
    v_mfma_f32_16x16x32_bf16 a[80:83], a[216:219], v[212:215], a[80:83]
    v_mul_f32 v163, v163, v184
    v_mul_f32 v164, v164, v184
    v_mfma_f32_16x16x32_bf16 a[80:83], a[220:223], v[216:219], a[80:83]
    ds_read_b64_tr_b16 a[238:239], v29 offset:53248
    v_mul_f32 v165, v165, v184
    v_mfma_f32_16x16x32_bf16 a[112:115], a[220:223], v[224:227], a[112:115]
    v_mul_f32 v166, v166, v184
    v_mul_f32 v167, v167, v184
    v_mfma_f32_16x16x32_bf16 a[112:115], a[216:219], v[220:223], a[112:115]
    v_cvt_pk_bf16_f32 v160, v160, v161
    v_cvt_pk_bf16_f32 v161, v162, v163
    v_mfma_f32_16x16x32_bf16 a[144:147], a[216:219], v[228:231], a[144:147]
    v_cvt_pk_bf16_f32 v162, v164, v165
    v_cvt_pk_bf16_f32 v163, v166, v167
    v_mfma_f32_16x16x32_bf16 a[148:151], a[224:227], v[228:231], a[148:151]
    ds_read_b64_tr_b16 a[240:241], v30 offset:49152
    v_mfma_f32_16x16x32_bf16 a[20:23], a[224:227], v[196:199], a[20:23]
    ds_read_b64_tr_b16 a[242:243], v30 offset:53248
    v_mfma_f32_16x16x32_bf16 a[20:23], a[228:231], v[200:203], a[20:23]
    ds_read_b64_tr_b16 a[244:245], v31 offset:49152
    v_mfma_f32_16x16x32_bf16 a[52:55], a[228:231], v[208:211], a[52:55]
    ds_read_b64_tr_b16 a[246:247], v31 offset:53248
    v_mfma_f32_16x16x32_bf16 a[52:55], a[224:227], v[204:207], a[52:55]
    buffer_store_dwordx4 v[160:163], v2, s[20:23], s74 offen sc1
    v_mfma_f32_16x16x32_bf16 a[84:87], a[224:227], v[212:215], a[84:87]
    v_accvgpr_read_b32 v168, a32
    v_accvgpr_read_b32 v169, a33
    v_mfma_f32_16x16x32_bf16 a[84:87], a[228:231], v[216:219], a[84:87]
    v_accvgpr_read_b32 v170, a34
    v_accvgpr_read_b32 v171, a35
    v_mfma_f32_16x16x32_bf16 a[116:119], a[228:231], v[224:227], a[116:119]
    v_accvgpr_read_b32 v172, a36
    v_accvgpr_read_b32 v173, a37
    v_mfma_f32_16x16x32_bf16 a[116:119], a[224:227], v[220:223], a[116:119]
    v_accvgpr_read_b32 v174, a38
    s_waitcnt lgkmcnt(0)
    v_mfma_f32_16x16x32_bf16 a[24:27], a[232:235], v[196:199], a[24:27]
    v_accvgpr_read_b32 v175, a39
    v_mul_f32 v168, v168, v185
    v_mfma_f32_16x16x32_bf16 a[24:27], a[236:239], v[200:203], a[24:27]
    v_mul_f32 v169, v169, v185
    v_mul_f32 v170, v170, v185
    v_mfma_f32_16x16x32_bf16 a[56:59], a[236:239], v[208:211], a[56:59]
    v_mul_f32 v171, v171, v185
    v_mul_f32 v172, v172, v185
    v_mfma_f32_16x16x32_bf16 a[56:59], a[232:235], v[204:207], a[56:59]
    v_mul_f32 v173, v173, v185
    v_mul_f32 v174, v174, v185
    v_mfma_f32_16x16x32_bf16 a[88:91], a[232:235], v[212:215], a[88:91]
    v_mul_f32 v175, v175, v185
    v_cvt_pk_bf16_f32 v168, v168, v169
    v_mfma_f32_16x16x32_bf16 a[88:91], a[236:239], v[216:219], a[88:91]
    v_cvt_pk_bf16_f32 v169, v170, v171
    v_cvt_pk_bf16_f32 v170, v172, v173
    v_mfma_f32_16x16x32_bf16 a[120:123], a[236:239], v[224:227], a[120:123]
    v_cvt_pk_bf16_f32 v171, v174, v175
    v_mfma_f32_16x16x32_bf16 a[120:123], a[232:235], v[220:223], a[120:123]
    buffer_store_dwordx4 v[168:171], v2, s[20:23], s75 offen sc1
    v_mfma_f32_16x16x32_bf16 a[152:155], a[232:235], v[228:231], a[152:155]
    v_accvgpr_read_b32 v176, a64
    v_accvgpr_read_b32 v177, a65
    v_mfma_f32_16x16x32_bf16 a[156:159], a[240:243], v[228:231], a[156:159]
    v_accvgpr_read_b32 v178, a66
    v_accvgpr_read_b32 v179, a67
    v_mfma_f32_16x16x32_bf16 a[28:31], a[240:243], v[196:199], a[28:31]
    v_accvgpr_read_b32 v180, a68
    v_accvgpr_read_b32 v181, a69
    v_mfma_f32_16x16x32_bf16 a[28:31], a[244:247], v[200:203], a[28:31]
    v_accvgpr_read_b32 v182, a70
    v_accvgpr_read_b32 v183, a71
    v_mfma_f32_16x16x32_bf16 a[60:63], a[244:247], v[208:211], a[60:63]
    v_mul_f32 v176, v176, v186
    v_mul_f32 v177, v177, v186
    v_mfma_f32_16x16x32_bf16 a[60:63], a[240:243], v[204:207], a[60:63]
    v_mul_f32 v178, v178, v186
    v_mul_f32 v179, v179, v186
    v_mfma_f32_16x16x32_bf16 a[92:95], a[240:243], v[212:215], a[92:95]
    v_mul_f32 v180, v180, v186
    v_mul_f32 v181, v181, v186
    v_mfma_f32_16x16x32_bf16 a[92:95], a[244:247], v[216:219], a[92:95]
    v_mul_f32 v182, v182, v186
    v_mul_f32 v183, v183, v186
    v_mfma_f32_16x16x32_bf16 a[124:127], a[244:247], v[224:227], a[124:127]
    v_cvt_pk_bf16_f32 v176, v176, v177
    v_cvt_pk_bf16_f32 v177, v178, v179
    v_mfma_f32_16x16x32_bf16 a[124:127], a[240:243], v[220:223], a[124:127]
    v_cvt_pk_bf16_f32 v178, v180, v181
    v_cvt_pk_bf16_f32 v179, v182, v183
    ds_read_b128 v[200:203], v39 offset:0
    ds_read_b128 v[204:207], v39 offset:1024
    ds_read_b128 v[208:211], v39 offset:2048
    ds_read_b128 v[212:215], v39 offset:3072
    ds_read_b128 v[216:219], v39 offset:4096
    ds_read_b128 v[220:223], v39 offset:5120
    ds_read_b128 v[224:227], v39 offset:6144
    ds_read_b128 v[228:231], v39 offset:7168
    buffer_store_dwordx4 v[176:179], v2, s[20:23], s0 offen sc1
    v_accvgpr_read_b32 v160, a96
    v_accvgpr_read_b32 v161, a97
    v_accvgpr_read_b32 v162, a98
    v_accvgpr_read_b32 v163, a99
    v_accvgpr_read_b32 v164, a100
    v_accvgpr_read_b32 v165, a101
    v_accvgpr_read_b32 v166, a102
    v_accvgpr_read_b32 v167, a103
    v_pk_mul_f32 v[160:161], v[160:161], v[186:187] op_sel:[0,1] op_sel_hi:[1,1]
    v_pk_mul_f32 v[162:163], v[162:163], v[186:187] op_sel:[0,1] op_sel_hi:[1,1]
    v_pk_mul_f32 v[164:165], v[164:165], v[186:187] op_sel:[0,1] op_sel_hi:[1,1]
    v_pk_mul_f32 v[166:167], v[166:167], v[186:187] op_sel:[0,1] op_sel_hi:[1,1]
    v_cvt_pk_bf16_f32 v160, v160, v161
    v_cvt_pk_bf16_f32 v161, v162, v163
    v_cvt_pk_bf16_f32 v162, v164, v165
    v_cvt_pk_bf16_f32 v163, v166, v167
    s_waitcnt lgkmcnt(0)
    s_cmp_lg_u64 vcc, 0
    s_cselect_b32 s35, 1, 0
    v_mov_b32 v189, s35
    ds_write_b128 v39, a[168:171] offset:5120
    ds_write_b128 v39, v[40:43] offset:6144
    ds_write_b64 v39, v[188:189] offset:4096
    ds_write_b128 v39, a[144:147] offset:0
    ds_write_b128 v39, a[148:151] offset:1024
    ds_write_b128 v39, a[152:155] offset:2048
    ds_write_b128 v39, a[156:159] offset:3072
    buffer_store_dwordx4 v[160:163], v2, s[20:23], s1 offen sc1
    v_accvgpr_read_b32 v168, a8
    v_accvgpr_read_b32 v169, a9
    v_accvgpr_read_b32 v170, a10
    v_accvgpr_read_b32 v171, a11
    v_accvgpr_read_b32 v172, a12
    v_accvgpr_read_b32 v173, a13
    v_accvgpr_read_b32 v174, a14
    v_accvgpr_read_b32 v175, a15
    v_pk_mul_f32 v[168:169], v[168:169], v[184:185] op_sel:[0,0] op_sel_hi:[1,0]
    v_pk_mul_f32 v[170:171], v[170:171], v[184:185] op_sel:[0,0] op_sel_hi:[1,0]
    v_pk_mul_f32 v[172:173], v[172:173], v[184:185] op_sel:[0,0] op_sel_hi:[1,0]
    v_pk_mul_f32 v[174:175], v[174:175], v[184:185] op_sel:[0,0] op_sel_hi:[1,0]
    v_cvt_pk_bf16_f32 v168, v168, v169
    v_cvt_pk_bf16_f32 v169, v170, v171
    v_cvt_pk_bf16_f32 v170, v172, v173
    v_cvt_pk_bf16_f32 v171, v174, v175
    buffer_store_dwordx4 v[168:171], v3, s[20:23], s74 offen sc1
    v_accvgpr_read_b32 v176, a40
    v_accvgpr_read_b32 v177, a41
    v_accvgpr_read_b32 v178, a42
    v_accvgpr_read_b32 v179, a43
    v_accvgpr_read_b32 v180, a44
    v_accvgpr_read_b32 v181, a45
    v_accvgpr_read_b32 v182, a46
    v_accvgpr_read_b32 v183, a47
    v_pk_mul_f32 v[176:177], v[176:177], v[184:185] op_sel:[0,1] op_sel_hi:[1,1]
    v_pk_mul_f32 v[178:179], v[178:179], v[184:185] op_sel:[0,1] op_sel_hi:[1,1]
    v_pk_mul_f32 v[180:181], v[180:181], v[184:185] op_sel:[0,1] op_sel_hi:[1,1]
    v_pk_mul_f32 v[182:183], v[182:183], v[184:185] op_sel:[0,1] op_sel_hi:[1,1]
    v_cvt_pk_bf16_f32 v176, v176, v177
    v_cvt_pk_bf16_f32 v177, v178, v179
    v_cvt_pk_bf16_f32 v178, v180, v181
    v_cvt_pk_bf16_f32 v179, v182, v183
    s_waitcnt lgkmcnt(0)
    s_barrier
    v_xor_b32 v7, 0x4000, v39
    v_mov_b32 v6, 135172
    ds_read_b32 v191, v6 offset:0
    ds_read_b32 v192, v6 offset:8192
    ds_read_b32 v193, v6 offset:16384
    ds_read_b32 v194, v6 offset:24576
    ds_read_b32 v195, v7 offset:4096
    ds_read_b128 v[144:147], v7 offset:0
    ds_read_b128 v[148:151], v7 offset:1024
    ds_read_b128 v[152:155], v7 offset:2048
    ds_read_b128 v[156:159], v7 offset:3072
    buffer_store_dwordx4 v[176:179], v3, s[20:23], s75 offen sc1
    v_accvgpr_read_b32 v160, a72
    v_accvgpr_read_b32 v161, a73
    v_accvgpr_read_b32 v162, a74
    v_accvgpr_read_b32 v163, a75
    v_accvgpr_read_b32 v164, a76
    v_accvgpr_read_b32 v165, a77
    v_accvgpr_read_b32 v166, a78
    v_accvgpr_read_b32 v167, a79
    v_pk_mul_f32 v[160:161], v[160:161], v[186:187] op_sel:[0,0] op_sel_hi:[1,0]
    v_pk_mul_f32 v[162:163], v[162:163], v[186:187] op_sel:[0,0] op_sel_hi:[1,0]
    v_pk_mul_f32 v[164:165], v[164:165], v[186:187] op_sel:[0,0] op_sel_hi:[1,0]
    v_pk_mul_f32 v[166:167], v[166:167], v[186:187] op_sel:[0,0] op_sel_hi:[1,0]
    v_cvt_pk_bf16_f32 v160, v160, v161
    v_cvt_pk_bf16_f32 v161, v162, v163
    v_cvt_pk_bf16_f32 v162, v164, v165
    v_cvt_pk_bf16_f32 v163, v166, v167
    buffer_store_dwordx4 v[160:163], v3, s[20:23], s0 offen sc1
    v_accvgpr_read_b32 v168, a104
    v_accvgpr_read_b32 v169, a105
    v_accvgpr_read_b32 v170, a106
    v_accvgpr_read_b32 v171, a107
    v_accvgpr_read_b32 v172, a108
    v_accvgpr_read_b32 v173, a109
    v_accvgpr_read_b32 v174, a110
    v_accvgpr_read_b32 v175, a111
    v_pk_mul_f32 v[168:169], v[168:169], v[186:187] op_sel:[0,1] op_sel_hi:[1,1]
    v_pk_mul_f32 v[170:171], v[170:171], v[186:187] op_sel:[0,1] op_sel_hi:[1,1]
    v_pk_mul_f32 v[172:173], v[172:173], v[186:187] op_sel:[0,1] op_sel_hi:[1,1]
    v_pk_mul_f32 v[174:175], v[174:175], v[186:187] op_sel:[0,1] op_sel_hi:[1,1]
    v_cvt_pk_bf16_f32 v168, v168, v169
    v_cvt_pk_bf16_f32 v169, v170, v171
    v_cvt_pk_bf16_f32 v170, v172, v173
    v_cvt_pk_bf16_f32 v171, v174, v175
    buffer_store_dwordx4 v[168:171], v3, s[20:23], s1 offen sc1
    v_accvgpr_read_b32 v176, a16
    v_accvgpr_read_b32 v177, a17
    v_accvgpr_read_b32 v178, a18
    v_accvgpr_read_b32 v179, a19
    v_accvgpr_read_b32 v180, a20
    v_accvgpr_read_b32 v181, a21
    v_accvgpr_read_b32 v182, a22
    v_accvgpr_read_b32 v183, a23
    v_pk_mul_f32 v[176:177], v[176:177], v[184:185] op_sel:[0,0] op_sel_hi:[1,0]
    v_pk_mul_f32 v[178:179], v[178:179], v[184:185] op_sel:[0,0] op_sel_hi:[1,0]
    v_pk_mul_f32 v[180:181], v[180:181], v[184:185] op_sel:[0,0] op_sel_hi:[1,0]
    v_pk_mul_f32 v[182:183], v[182:183], v[184:185] op_sel:[0,0] op_sel_hi:[1,0]
    v_cvt_pk_bf16_f32 v176, v176, v177
    v_cvt_pk_bf16_f32 v177, v178, v179
    v_cvt_pk_bf16_f32 v178, v180, v181
    v_cvt_pk_bf16_f32 v179, v182, v183
    buffer_store_dwordx4 v[176:179], v4, s[20:23], s74 offen sc1
    v_accvgpr_read_b32 v160, a48
    v_accvgpr_read_b32 v161, a49
    v_accvgpr_read_b32 v162, a50
    v_accvgpr_read_b32 v163, a51
    v_accvgpr_read_b32 v164, a52
    v_accvgpr_read_b32 v165, a53
    v_accvgpr_read_b32 v166, a54
    v_accvgpr_read_b32 v167, a55
    v_pk_mul_f32 v[160:161], v[160:161], v[184:185] op_sel:[0,1] op_sel_hi:[1,1]
    v_pk_mul_f32 v[162:163], v[162:163], v[184:185] op_sel:[0,1] op_sel_hi:[1,1]
    v_pk_mul_f32 v[164:165], v[164:165], v[184:185] op_sel:[0,1] op_sel_hi:[1,1]
    v_pk_mul_f32 v[166:167], v[166:167], v[184:185] op_sel:[0,1] op_sel_hi:[1,1]
    v_cvt_pk_bf16_f32 v160, v160, v161
    v_cvt_pk_bf16_f32 v161, v162, v163
    v_cvt_pk_bf16_f32 v162, v164, v165
    v_cvt_pk_bf16_f32 v163, v166, v167
    buffer_store_dwordx4 v[160:163], v4, s[20:23], s75 offen sc1
    v_accvgpr_read_b32 v168, a80
    v_accvgpr_read_b32 v169, a81
    v_accvgpr_read_b32 v170, a82
    v_accvgpr_read_b32 v171, a83
    v_accvgpr_read_b32 v172, a84
    v_accvgpr_read_b32 v173, a85
    v_accvgpr_read_b32 v174, a86
    v_accvgpr_read_b32 v175, a87
    v_pk_mul_f32 v[168:169], v[168:169], v[186:187] op_sel:[0,0] op_sel_hi:[1,0]
    v_pk_mul_f32 v[170:171], v[170:171], v[186:187] op_sel:[0,0] op_sel_hi:[1,0]
    v_pk_mul_f32 v[172:173], v[172:173], v[186:187] op_sel:[0,0] op_sel_hi:[1,0]
    v_pk_mul_f32 v[174:175], v[174:175], v[186:187] op_sel:[0,0] op_sel_hi:[1,0]
    v_cvt_pk_bf16_f32 v168, v168, v169
    v_cvt_pk_bf16_f32 v169, v170, v171
    v_cvt_pk_bf16_f32 v170, v172, v173
    v_cvt_pk_bf16_f32 v171, v174, v175
    buffer_store_dwordx4 v[168:171], v4, s[20:23], s0 offen sc1
    v_accvgpr_read_b32 v176, a112
    v_accvgpr_read_b32 v177, a113
    v_accvgpr_read_b32 v178, a114
    v_accvgpr_read_b32 v179, a115
    v_accvgpr_read_b32 v180, a116
    v_accvgpr_read_b32 v181, a117
    v_accvgpr_read_b32 v182, a118
    v_accvgpr_read_b32 v183, a119
    v_pk_mul_f32 v[176:177], v[176:177], v[186:187] op_sel:[0,1] op_sel_hi:[1,1]
    v_pk_mul_f32 v[178:179], v[178:179], v[186:187] op_sel:[0,1] op_sel_hi:[1,1]
    v_pk_mul_f32 v[180:181], v[180:181], v[186:187] op_sel:[0,1] op_sel_hi:[1,1]
    v_pk_mul_f32 v[182:183], v[182:183], v[186:187] op_sel:[0,1] op_sel_hi:[1,1]
    v_cvt_pk_bf16_f32 v176, v176, v177
    v_cvt_pk_bf16_f32 v177, v178, v179
    v_cvt_pk_bf16_f32 v178, v180, v181
    v_cvt_pk_bf16_f32 v179, v182, v183
    buffer_store_dwordx4 v[176:179], v4, s[20:23], s1 offen sc1
    v_accvgpr_read_b32 v160, a24
    v_accvgpr_read_b32 v161, a25
    v_accvgpr_read_b32 v162, a26
    v_accvgpr_read_b32 v163, a27
    v_accvgpr_read_b32 v164, a28
    v_accvgpr_read_b32 v165, a29
    v_accvgpr_read_b32 v166, a30
    v_accvgpr_read_b32 v167, a31
    v_pk_mul_f32 v[160:161], v[160:161], v[184:185] op_sel:[0,0] op_sel_hi:[1,0]
    v_pk_mul_f32 v[162:163], v[162:163], v[184:185] op_sel:[0,0] op_sel_hi:[1,0]
    v_pk_mul_f32 v[164:165], v[164:165], v[184:185] op_sel:[0,0] op_sel_hi:[1,0]
    v_pk_mul_f32 v[166:167], v[166:167], v[184:185] op_sel:[0,0] op_sel_hi:[1,0]
    v_cvt_pk_bf16_f32 v160, v160, v161
    v_cvt_pk_bf16_f32 v161, v162, v163
    v_cvt_pk_bf16_f32 v162, v164, v165
    v_cvt_pk_bf16_f32 v163, v166, v167
    buffer_store_dwordx4 v[160:163], v5, s[20:23], s74 offen sc1
    v_accvgpr_read_b32 v168, a56
    v_accvgpr_read_b32 v169, a57
    v_accvgpr_read_b32 v170, a58
    v_accvgpr_read_b32 v171, a59
    v_accvgpr_read_b32 v172, a60
    v_accvgpr_read_b32 v173, a61
    v_accvgpr_read_b32 v174, a62
    v_accvgpr_read_b32 v175, a63
    v_pk_mul_f32 v[168:169], v[168:169], v[184:185] op_sel:[0,1] op_sel_hi:[1,1]
    v_pk_mul_f32 v[170:171], v[170:171], v[184:185] op_sel:[0,1] op_sel_hi:[1,1]
    v_pk_mul_f32 v[172:173], v[172:173], v[184:185] op_sel:[0,1] op_sel_hi:[1,1]
    v_pk_mul_f32 v[174:175], v[174:175], v[184:185] op_sel:[0,1] op_sel_hi:[1,1]
    v_cvt_pk_bf16_f32 v168, v168, v169
    v_cvt_pk_bf16_f32 v169, v170, v171
    v_cvt_pk_bf16_f32 v170, v172, v173
    v_cvt_pk_bf16_f32 v171, v174, v175
    buffer_store_dwordx4 v[168:171], v5, s[20:23], s75 offen sc1
    v_accvgpr_read_b32 v176, a88
    v_accvgpr_read_b32 v177, a89
    v_accvgpr_read_b32 v178, a90
    v_accvgpr_read_b32 v179, a91
    v_accvgpr_read_b32 v180, a92
    v_accvgpr_read_b32 v181, a93
    v_accvgpr_read_b32 v182, a94
    v_accvgpr_read_b32 v183, a95
    v_pk_mul_f32 v[176:177], v[176:177], v[186:187] op_sel:[0,0] op_sel_hi:[1,0]
    v_pk_mul_f32 v[178:179], v[178:179], v[186:187] op_sel:[0,0] op_sel_hi:[1,0]
    v_pk_mul_f32 v[180:181], v[180:181], v[186:187] op_sel:[0,0] op_sel_hi:[1,0]
    v_pk_mul_f32 v[182:183], v[182:183], v[186:187] op_sel:[0,0] op_sel_hi:[1,0]
    v_cvt_pk_bf16_f32 v176, v176, v177
    v_cvt_pk_bf16_f32 v177, v178, v179
    v_cvt_pk_bf16_f32 v178, v180, v181
    v_cvt_pk_bf16_f32 v179, v182, v183
    buffer_store_dwordx4 v[176:179], v5, s[20:23], s0 offen sc1
    v_accvgpr_read_b32 v160, a120
    v_accvgpr_read_b32 v161, a121
    v_accvgpr_read_b32 v162, a122
    v_accvgpr_read_b32 v163, a123
    v_accvgpr_read_b32 v164, a124
    v_accvgpr_read_b32 v165, a125
    v_accvgpr_read_b32 v166, a126
    v_accvgpr_read_b32 v167, a127
    v_pk_mul_f32 v[160:161], v[160:161], v[186:187] op_sel:[0,1] op_sel_hi:[1,1]
    v_pk_mul_f32 v[162:163], v[162:163], v[186:187] op_sel:[0,1] op_sel_hi:[1,1]
    v_pk_mul_f32 v[164:165], v[164:165], v[186:187] op_sel:[0,1] op_sel_hi:[1,1]
    v_pk_mul_f32 v[166:167], v[166:167], v[186:187] op_sel:[0,1] op_sel_hi:[1,1]
    v_cvt_pk_bf16_f32 v160, v160, v161
    v_cvt_pk_bf16_f32 v161, v162, v163
    v_cvt_pk_bf16_f32 v162, v164, v165
    v_cvt_pk_bf16_f32 v163, v166, v167
    buffer_store_dwordx4 v[160:163], v5, s[20:23], s1 offen sc1
    s_waitcnt lgkmcnt(7)
    v_or_b32 v191, v191, v192
    s_waitcnt lgkmcnt(5)
    v_or3_b32 v191, v191, v193, v194
    s_waitcnt lgkmcnt(4)
    v_add_f32 v188, v188, v195
    v_readfirstlane_b32 s35, v191
    v_rcp_f32 v188, v188
    s_nop 2
    s_andn2_b32 s35, s35, s34
    s_cmp_lg_u32 s35, 0
    s_cbranch_scc1 L_fallback
    s_mov_b32 s34, 0
    v_mov_b64 v[64:65], v[200:201]
    v_mov_b64 v[66:67], v[202:203]
    v_mov_b64 v[68:69], v[204:205]
    v_mov_b64 v[70:71], v[206:207]
    v_mov_b64 v[72:73], v[208:209]
    v_mov_b64 v[74:75], v[210:211]
    v_mov_b64 v[76:77], v[212:213]
    v_mov_b64 v[78:79], v[214:215]
    v_mov_b64 v[80:81], v[216:217]
    v_mov_b64 v[82:83], v[218:219]
    v_mov_b64 v[84:85], v[220:221]
    v_mov_b64 v[86:87], v[222:223]
    v_mov_b64 v[88:89], v[224:225]
    v_mov_b64 v[90:91], v[226:227]
    v_mov_b64 v[92:93], v[228:229]
    v_mov_b64 v[94:95], v[230:231]
    ds_read_b128 v[136:139], v7 offset:5120
    ds_read_b128 v[140:143], v7 offset:6144
    v_accvgpr_read_b32 v168, a128
    v_accvgpr_read_b32 v169, a129
    v_accvgpr_read_b32 v170, a130
    v_accvgpr_read_b32 v171, a131
    v_accvgpr_read_b32 v172, a132
    v_accvgpr_read_b32 v173, a133
    v_accvgpr_read_b32 v174, a134
    v_accvgpr_read_b32 v175, a135
    s_waitcnt lgkmcnt(5)
    v_pk_add_f32 v[168:169], v[168:169], v[144:145]
    v_pk_add_f32 v[170:171], v[170:171], v[146:147]
    s_waitcnt lgkmcnt(4)
    v_pk_add_f32 v[172:173], v[172:173], v[148:149]
    v_pk_add_f32 v[174:175], v[174:175], v[150:151]
    v_pk_mul_f32 v[168:169], v[168:169], v[188:189] op_sel:[0,0] op_sel_hi:[1,0]
    v_pk_mul_f32 v[170:171], v[170:171], v[188:189] op_sel:[0,0] op_sel_hi:[1,0]
    v_pk_mul_f32 v[172:173], v[172:173], v[188:189] op_sel:[0,0] op_sel_hi:[1,0]
    v_pk_mul_f32 v[174:175], v[174:175], v[188:189] op_sel:[0,0] op_sel_hi:[1,0]
    v_cvt_pk_bf16_f32 v168, v168, v169
    v_cvt_pk_bf16_f32 v169, v170, v171
    v_cvt_pk_bf16_f32 v170, v172, v173
    v_cvt_pk_bf16_f32 v171, v174, v175
    buffer_store_dwordx4 v[168:171], v2, s[20:23], s73 offen sc1
    v_accvgpr_read_b32 v176, a136
    v_accvgpr_read_b32 v177, a137
    v_accvgpr_read_b32 v178, a138
    v_accvgpr_read_b32 v179, a139
    v_accvgpr_read_b32 v180, a140
    v_accvgpr_read_b32 v181, a141
    v_accvgpr_read_b32 v182, a142
    v_accvgpr_read_b32 v183, a143
    s_waitcnt lgkmcnt(3)
    v_pk_add_f32 v[176:177], v[176:177], v[152:153]
    v_pk_add_f32 v[178:179], v[178:179], v[154:155]
    s_waitcnt lgkmcnt(2)
    v_pk_add_f32 v[180:181], v[180:181], v[156:157]
    v_pk_add_f32 v[182:183], v[182:183], v[158:159]
    v_pk_mul_f32 v[176:177], v[176:177], v[188:189] op_sel:[0,0] op_sel_hi:[1,0]
    v_pk_mul_f32 v[178:179], v[178:179], v[188:189] op_sel:[0,0] op_sel_hi:[1,0]
    v_pk_mul_f32 v[180:181], v[180:181], v[188:189] op_sel:[0,0] op_sel_hi:[1,0]
    v_pk_mul_f32 v[182:183], v[182:183], v[188:189] op_sel:[0,0] op_sel_hi:[1,0]
    v_cvt_pk_bf16_f32 v176, v176, v177
    v_cvt_pk_bf16_f32 v177, v178, v179
    v_cvt_pk_bf16_f32 v178, v180, v181
    v_cvt_pk_bf16_f32 v179, v182, v183
    buffer_store_dwordx4 v[176:179], v3, s[20:23], s73 offen sc1
    v_mov_b64 v[96:97], v[232:233]
    v_mov_b64 v[98:99], v[234:235]
    v_mov_b64 v[100:101], v[236:237]
    v_mov_b64 v[102:103], v[238:239]
    v_mov_b64 v[104:105], v[240:241]
    v_mov_b64 v[106:107], v[242:243]
    v_mov_b64 v[108:109], v[244:245]
    v_mov_b64 v[110:111], v[246:247]
    v_mov_b64 v[112:113], v[248:249]
    v_mov_b64 v[114:115], v[250:251]
    v_mov_b64 v[116:117], v[252:253]
    v_mov_b64 v[118:119], v[254:255]
    v_accvgpr_read_b32 v120, a248
    v_accvgpr_read_b32 v121, a249
    v_accvgpr_read_b32 v122, a250
    v_accvgpr_read_b32 v123, a251
    v_accvgpr_read_b32 v124, a252
    v_accvgpr_read_b32 v125, a253
    v_accvgpr_read_b32 v126, a254
    v_accvgpr_read_b32 v127, a255
    v_accvgpr_read_b32 v128, a168
    v_accvgpr_read_b32 v129, a169
    v_accvgpr_read_b32 v130, a170
    v_accvgpr_read_b32 v131, a171
    v_mov_b32 v132, v40
    v_mov_b32 v133, v41
    v_mov_b32 v134, v42
    v_mov_b32 v135, v43
    s_cmp_eq_u32 s28, 0
    s_cselect_b32 s52, 0, 0x40000000
    s_add_u32 s68, s68, 1179648
    s_add_u32 s69, s69, 1179648
    s_mov_b32 s33, 1
    s_mov_b32 s54, 1
    s_mov_b32 s74, s100
    s_mov_b32 s75, s101
    s_mov_b32 s0, s67
    s_mov_b32 s1, s70
    s_mov_b32 s73, s71
    s_mul_i32 s35, s50, 294912
    s_add_u32 s100, s35, s44
    s_lshl_b32 s35, s50, 20
    s_lshl_b32 s36, s51, 8
    s_add_u32 s35, s35, s36
    s_lshl_b32 s36, s28, 14
    s_add_u32 s101, s35, s36
    s_branch L_head
L_tail1:
    v_cmp_gt_u32 vcc, 16, v2
    s_nop 3
    s_cbranch_vccnz L_spin0
L_back0:
    v_exp_f32 v156, v156
    ds_read_b64_tr_b16 a[230:231], v19 offset:53248
    v_exp_f32 v157, v157
    v_mfma_f32_16x16x32_bf16 a[0:3], a[216:219], v[196:199], a[0:3]
    v_exp_f32 v158, v158
    v_mfma_f32_16x16x32_bf16 a[0:3], a[220:223], v[200:203], a[0:3]
    v_cvt_pk_bf16_f32 v226, v156, v157
    v_cvt_pk_bf16_f32 v219, v154, v155
    v_mfma_f32_16x16x32_bf16 a[32:35], a[220:223], v[208:211], a[32:35]
    v_exp_f32 v159, v159
    v_mfma_f32_16x16x32_bf16 a[32:35], a[216:219], v[204:207], a[32:35]
    v_and_b32 v48, 15, v0
    v_lshrrev_b32 v49, 4, v0
    v_mfma_f32_16x16x32_bf16 a[64:67], a[216:219], v[212:215], a[64:67]
    v_cvt_pk_bf16_f32 v227, v158, v159
    v_lshlrev_b32 v50, 2, v49
    v_mfma_f32_16x16x32_bf16 a[64:67], a[220:223], v[216:219], a[64:67]
    ds_read_b64_tr_b16 a[232:233], v20 offset:49152
    v_xor_b32 v50, v50, v48
    v_mfma_f32_16x16x32_bf16 a[96:99], a[220:223], v[224:227], a[96:99]
    v_lshlrev_b32 v50, 4, v50
    v_lshl_add_u32 v44, v49, 10, v50
    v_mfma_f32_16x16x32_bf16 a[96:99], a[216:219], v[220:223], a[96:99]
    ds_read_b64_tr_b16 a[234:235], v20 offset:53248
    s_waitcnt lgkmcnt(2)
    v_mfma_f32_16x16x32_bf16 a[128:131], a[216:219], v[228:231], a[128:131]
    ds_read_b64_tr_b16 a[236:237], v21 offset:49152
    v_add_u32 v45, 3072, v44
    v_mfma_f32_16x16x32_bf16 a[132:135], a[224:227], v[228:231], a[132:135]
    ds_read_b64_tr_b16 a[238:239], v21 offset:53248
    v_add_u32 v46, 6144, v44
    v_mfma_f32_16x16x32_bf16 a[160:163], a[180:183], v[196:199], a[160:163]
    v_add_u32 v47, 9216, v44
    s_add_u32 m0, s29, 36864
    v_mfma_f32_16x16x32_bf16 a[160:163], a[180:183], v[200:203], a[160:163]
    s_add_u32 s35, s101, 0
    v_mfma_f32_16x16x32_bf16 a[176:179], a[180:183], v[228:231], a[176:179]
    buffer_load_dwordx4 v44, s[24:27], s35 offen offset:0 lds
    v_mfma_f32_16x16x32_bf16 a[160:163], a[172:175], v[212:215], a[160:163]
    v_mfma_f32_16x16x32_bf16 a[160:163], a[172:175], v[216:219], a[160:163]
    v_mfma_f32_16x16x32_bf16 a[164:167], a[180:183], v[204:207], a[164:167]
    buffer_load_dwordx4 v45, s[24:27], s35 offen offset:1024 lds
    v_mfma_f32_16x16x32_bf16 a[164:167], a[180:183], v[208:211], a[164:167]
    v_mfma_f32_16x16x32_bf16 a[164:167], a[172:175], v[220:223], a[164:167]
    v_mfma_f32_16x16x32_bf16 a[164:167], a[172:175], v[224:227], a[164:167]
    v_mfma_f32_16x16x32_bf16 a[4:7], a[224:227], v[196:199], a[4:7]
    v_mfma_f32_16x16x32_bf16 a[4:7], a[228:231], v[200:203], a[4:7]
    buffer_load_dwordx4 v46, s[24:27], s35 offen offset:2048 lds
    v_mfma_f32_16x16x32_bf16 a[36:39], a[228:231], v[208:211], a[36:39]
    v_mfma_f32_16x16x32_bf16 a[36:39], a[224:227], v[204:207], a[36:39]
    ds_read_b64_tr_b16 a[240:241], v22 offset:49152
    v_mfma_f32_16x16x32_bf16 a[68:71], a[224:227], v[212:215], a[68:71]
    v_add_u32 v2, s68, v38
    v_add_u32 v3, 18432, v2
    v_mfma_f32_16x16x32_bf16 a[68:71], a[228:231], v[216:219], a[68:71]
    v_add_u32 v4, s69, v38
    v_add_u32 v5, 18432, v4
    v_mfma_f32_16x16x32_bf16 a[100:103], a[228:231], v[224:227], a[100:103]
    buffer_load_dwordx4 v47, s[24:27], s35 offen offset:3072 lds
    v_mfma_f32_16x16x32_bf16 a[100:103], a[224:227], v[220:223], a[100:103]
    ds_read_b64_tr_b16 a[242:243], v22 offset:53248
    ds_read_b64_tr_b16 a[244:245], v23 offset:49152
    ds_read_b64_tr_b16 a[246:247], v23 offset:53248
    s_waitcnt lgkmcnt(4)
    v_mfma_f32_16x16x32_bf16 a[8:11], a[232:235], v[196:199], a[8:11]
    v_accvgpr_read_b32 v184, a160
    v_accvgpr_read_b32 v185, a164
    v_mfma_f32_16x16x32_bf16 a[8:11], a[236:239], v[200:203], a[8:11]
    v_accvgpr_read_b32 v186, a161
    v_accvgpr_read_b32 v187, a165
    v_mfma_f32_16x16x32_bf16 a[40:43], a[236:239], v[208:211], a[40:43]
    v_accvgpr_read_b32 v188, a176
    v_add_f32 v190, v184, v185
    v_mfma_f32_16x16x32_bf16 a[40:43], a[232:235], v[204:207], a[40:43]
    ds_read_b64_tr_b16 a[216:217], v24 offset:49152
    s_add_u32 m0, s44, 0
    v_mfma_f32_16x16x32_bf16 a[72:75], a[232:235], v[212:215], a[72:75]
    s_add_u32 s35, s100, 0
    v_add_f32 v190, v190, v186
    v_mfma_f32_16x16x32_bf16 a[72:75], a[236:239], v[216:219], a[72:75]
    ds_read_b64_tr_b16 a[218:219], v24 offset:53248
    v_add_f32 v190, v190, v187
    v_mfma_f32_16x16x32_bf16 a[104:107], a[236:239], v[224:227], a[104:107]
    buffer_load_dwordx4 v38, s[20:23], s35 offen offset:0 sc1 lds
    v_mfma_f32_16x16x32_bf16 a[104:107], a[232:235], v[220:223], a[104:107]
    ds_read_b64_tr_b16 a[220:221], v25 offset:49152
    ds_read_b64_tr_b16 a[222:223], v25 offset:53248
    s_waitcnt lgkmcnt(4)
    v_mfma_f32_16x16x32_bf16 a[136:139], a[232:235], v[228:231], a[136:139]
    buffer_load_dwordx4 v38, s[20:23], s35 offen offset:1024 sc1 lds
    v_mfma_f32_16x16x32_bf16 a[140:143], a[240:243], v[228:231], a[140:143]
    ds_read_b64_tr_b16 a[224:225], v26 offset:49152
    v_add_f32 v190, v190, v188
    v_mfma_f32_16x16x32_bf16 a[12:15], a[240:243], v[196:199], a[12:15]
    ds_read_b64_tr_b16 a[226:227], v26 offset:53248
    v_cmp_nge_f32 vcc, s72, v190
    v_mfma_f32_16x16x32_bf16 a[12:15], a[244:247], v[200:203], a[12:15]
    v_rcp_f32 v184, v184
    v_mfma_f32_16x16x32_bf16 a[44:47], a[244:247], v[208:211], a[44:47]
    ds_read_b64_tr_b16 a[228:229], v27 offset:49152
    v_mfma_f32_16x16x32_bf16 a[44:47], a[240:243], v[204:207], a[44:47]
    ds_read_b64_tr_b16 a[230:231], v27 offset:53248
    v_mfma_f32_16x16x32_bf16 a[76:79], a[240:243], v[212:215], a[76:79]
    buffer_load_dwordx4 v38, s[20:23], s35 offen offset:2048 sc1 lds
    v_mfma_f32_16x16x32_bf16 a[76:79], a[244:247], v[216:219], a[76:79]
    v_rcp_f32 v185, v185
    v_mfma_f32_16x16x32_bf16 a[108:111], a[244:247], v[224:227], a[108:111]
    v_rcp_f32 v186, v186
    v_mfma_f32_16x16x32_bf16 a[108:111], a[240:243], v[220:223], a[108:111]
    s_waitcnt lgkmcnt(0)
    v_mfma_f32_16x16x32_bf16 a[16:19], a[216:219], v[196:199], a[16:19]
    buffer_load_dwordx4 v38, s[20:23], s35 offen offset:3072 sc1 lds
    v_mfma_f32_16x16x32_bf16 a[16:19], a[220:223], v[200:203], a[16:19]
    v_rcp_f32 v187, v187
    v_mfma_f32_16x16x32_bf16 a[48:51], a[220:223], v[208:211], a[48:51]
    v_accvgpr_read_b32 v160, a0
    v_accvgpr_read_b32 v161, a1
    v_mfma_f32_16x16x32_bf16 a[48:51], a[216:219], v[204:207], a[48:51]
    ds_read_b64_tr_b16 a[232:233], v28 offset:49152
    ds_read_b64_tr_b16 a[234:235], v28 offset:53248
    ds_read_b64_tr_b16 a[236:237], v29 offset:49152
    v_mfma_f32_16x16x32_bf16 a[80:83], a[216:219], v[212:215], a[80:83]
    v_accvgpr_read_b32 v162, a2
    v_accvgpr_read_b32 v163, a3
    v_mfma_f32_16x16x32_bf16 a[80:83], a[220:223], v[216:219], a[80:83]
    ds_read_b64_tr_b16 a[238:239], v29 offset:53248
    s_add_u32 m0, s44, 4096
    v_mfma_f32_16x16x32_bf16 a[112:115], a[220:223], v[224:227], a[112:115]
    s_add_u32 s35, s100, 4096
    v_accvgpr_read_b32 v164, a4
    v_mfma_f32_16x16x32_bf16 a[112:115], a[216:219], v[220:223], a[112:115]
    buffer_load_dwordx4 v38, s[20:23], s35 offen offset:0 sc1 lds
    v_mfma_f32_16x16x32_bf16 a[144:147], a[216:219], v[228:231], a[144:147]
    v_accvgpr_read_b32 v165, a5
    v_accvgpr_read_b32 v166, a6
    v_mfma_f32_16x16x32_bf16 a[148:151], a[224:227], v[228:231], a[148:151]
    ds_read_b64_tr_b16 a[240:241], v30 offset:49152
    v_accvgpr_read_b32 v167, a7
    v_mfma_f32_16x16x32_bf16 a[20:23], a[224:227], v[196:199], a[20:23]
    ds_read_b64_tr_b16 a[242:243], v30 offset:53248
    v_mul_f32 v160, v160, v184
    v_mfma_f32_16x16x32_bf16 a[20:23], a[228:231], v[200:203], a[20:23]
    ds_read_b64_tr_b16 a[244:245], v31 offset:49152
    v_mul_f32 v161, v161, v184
    v_mfma_f32_16x16x32_bf16 a[52:55], a[228:231], v[208:211], a[52:55]
    ds_read_b64_tr_b16 a[246:247], v31 offset:53248
    v_mul_f32 v162, v162, v184
    v_mfma_f32_16x16x32_bf16 a[52:55], a[224:227], v[204:207], a[52:55]
    buffer_load_dwordx4 v38, s[20:23], s35 offen offset:1024 sc1 lds
    v_mfma_f32_16x16x32_bf16 a[84:87], a[224:227], v[212:215], a[84:87]
    v_mul_f32 v163, v163, v184
    v_mul_f32 v164, v164, v184
    v_mfma_f32_16x16x32_bf16 a[84:87], a[228:231], v[216:219], a[84:87]
    buffer_load_dwordx4 v38, s[20:23], s35 offen offset:2048 sc1 lds
    v_mfma_f32_16x16x32_bf16 a[116:119], a[228:231], v[224:227], a[116:119]
    v_mul_f32 v165, v165, v184
    v_mul_f32 v166, v166, v184
    v_mfma_f32_16x16x32_bf16 a[116:119], a[224:227], v[220:223], a[116:119]
    v_mul_f32 v167, v167, v184
    s_waitcnt lgkmcnt(0)
    v_mfma_f32_16x16x32_bf16 a[24:27], a[232:235], v[196:199], a[24:27]
    v_cvt_pk_bf16_f32 v160, v160, v161
    v_cvt_pk_bf16_f32 v161, v162, v163
    v_mfma_f32_16x16x32_bf16 a[24:27], a[236:239], v[200:203], a[24:27]
    v_cvt_pk_bf16_f32 v162, v164, v165
    v_cvt_pk_bf16_f32 v163, v166, v167
    v_mfma_f32_16x16x32_bf16 a[56:59], a[236:239], v[208:211], a[56:59]
    buffer_load_dwordx4 v38, s[20:23], s35 offen offset:3072 sc1 lds
    v_mfma_f32_16x16x32_bf16 a[56:59], a[232:235], v[204:207], a[56:59]
    buffer_store_dwordx4 v[160:163], v2, s[20:23], s74 offen sc1
    v_mfma_f32_16x16x32_bf16 a[88:91], a[232:235], v[212:215], a[88:91]
    v_accvgpr_read_b32 v168, a32
    v_accvgpr_read_b32 v169, a33
    v_mfma_f32_16x16x32_bf16 a[88:91], a[236:239], v[216:219], a[88:91]
    v_accvgpr_read_b32 v170, a34
    v_accvgpr_read_b32 v171, a35
    v_mfma_f32_16x16x32_bf16 a[120:123], a[236:239], v[224:227], a[120:123]
    v_accvgpr_read_b32 v172, a36
    v_accvgpr_read_b32 v173, a37
    v_mfma_f32_16x16x32_bf16 a[120:123], a[232:235], v[220:223], a[120:123]
    s_add_u32 m0, s44, 8192
    s_add_u32 s35, s100, 8192
    v_mfma_f32_16x16x32_bf16 a[152:155], a[232:235], v[228:231], a[152:155]
    buffer_load_dwordx4 v38, s[20:23], s35 offen offset:0 sc1 lds
    v_mfma_f32_16x16x32_bf16 a[156:159], a[240:243], v[228:231], a[156:159]
    v_accvgpr_read_b32 v174, a38
    v_accvgpr_read_b32 v175, a39
    v_mfma_f32_16x16x32_bf16 a[28:31], a[240:243], v[196:199], a[28:31]
    v_mul_f32 v168, v168, v185
    v_mul_f32 v169, v169, v185
    v_mfma_f32_16x16x32_bf16 a[28:31], a[244:247], v[200:203], a[28:31]
    v_mul_f32 v170, v170, v185
    v_mul_f32 v171, v171, v185
    v_mfma_f32_16x16x32_bf16 a[60:63], a[244:247], v[208:211], a[60:63]
    v_mul_f32 v172, v172, v185
    v_mul_f32 v173, v173, v185
    v_mfma_f32_16x16x32_bf16 a[60:63], a[240:243], v[204:207], a[60:63]
    v_mul_f32 v174, v174, v185
    v_mul_f32 v175, v175, v185
    v_mfma_f32_16x16x32_bf16 a[92:95], a[240:243], v[212:215], a[92:95]
    v_cvt_pk_bf16_f32 v168, v168, v169
    v_cvt_pk_bf16_f32 v169, v170, v171
    v_mfma_f32_16x16x32_bf16 a[92:95], a[244:247], v[216:219], a[92:95]
    v_cvt_pk_bf16_f32 v170, v172, v173
    v_cvt_pk_bf16_f32 v171, v174, v175
    v_mfma_f32_16x16x32_bf16 a[124:127], a[244:247], v[224:227], a[124:127]
    buffer_store_dwordx4 v[168:171], v2, s[20:23], s75 offen sc1
    v_mfma_f32_16x16x32_bf16 a[124:127], a[240:243], v[220:223], a[124:127]
    v_accvgpr_read_b32 v176, a64
    v_accvgpr_read_b32 v177, a65
    s_cmp_lg_u64 vcc, 0
    s_cselect_b32 s35, 1, 0
    v_mov_b32 v189, s35
    ds_write_b64 v39, v[188:189] offset:4096
    ds_write_b128 v39, a[144:147] offset:0
    ds_write_b128 v39, a[148:151] offset:1024
    ds_write_b128 v39, a[152:155] offset:2048
    ds_write_b128 v39, a[156:159] offset:3072
    v_accvgpr_read_b32 v178, a66
    v_accvgpr_read_b32 v179, a67
    v_accvgpr_read_b32 v180, a68
    v_accvgpr_read_b32 v181, a69
    v_accvgpr_read_b32 v182, a70
    v_accvgpr_read_b32 v183, a71
    v_pk_mul_f32 v[176:177], v[176:177], v[186:187] op_sel:[0,0] op_sel_hi:[1,0]
    v_pk_mul_f32 v[178:179], v[178:179], v[186:187] op_sel:[0,0] op_sel_hi:[1,0]
    v_pk_mul_f32 v[180:181], v[180:181], v[186:187] op_sel:[0,0] op_sel_hi:[1,0]
    v_pk_mul_f32 v[182:183], v[182:183], v[186:187] op_sel:[0,0] op_sel_hi:[1,0]
    v_cvt_pk_bf16_f32 v176, v176, v177
    v_cvt_pk_bf16_f32 v177, v178, v179
    v_cvt_pk_bf16_f32 v178, v180, v181
    v_cvt_pk_bf16_f32 v179, v182, v183
    buffer_store_dwordx4 v[176:179], v2, s[20:23], s0 offen sc1
    v_accvgpr_read_b32 v160, a96
    v_accvgpr_read_b32 v161, a97
    v_accvgpr_read_b32 v162, a98
    v_accvgpr_read_b32 v163, a99
    v_accvgpr_read_b32 v164, a100
    v_accvgpr_read_b32 v165, a101
    v_accvgpr_read_b32 v166, a102
    v_accvgpr_read_b32 v167, a103
    v_pk_mul_f32 v[160:161], v[160:161], v[186:187] op_sel:[0,1] op_sel_hi:[1,1]
    v_pk_mul_f32 v[162:163], v[162:163], v[186:187] op_sel:[0,1] op_sel_hi:[1,1]
    v_pk_mul_f32 v[164:165], v[164:165], v[186:187] op_sel:[0,1] op_sel_hi:[1,1]
    v_pk_mul_f32 v[166:167], v[166:167], v[186:187] op_sel:[0,1] op_sel_hi:[1,1]
    v_cvt_pk_bf16_f32 v160, v160, v161
    v_cvt_pk_bf16_f32 v161, v162, v163
    v_cvt_pk_bf16_f32 v162, v164, v165
    v_cvt_pk_bf16_f32 v163, v166, v167
    buffer_store_dwordx4 v[160:163], v2, s[20:23], s1 offen sc1
    v_accvgpr_read_b32 v168, a8
    v_accvgpr_read_b32 v169, a9
    s_waitcnt vmcnt(17)
    s_waitcnt lgkmcnt(0)
    s_barrier
    v_xor_b32 v7, 0x4000, v39
    v_mov_b32 v6, 135172
    ds_read_b32 v191, v6 offset:0
    ds_read_b32 v192, v6 offset:8192
    ds_read_b32 v193, v6 offset:16384
    ds_read_b32 v194, v6 offset:24576
    ds_read_b32 v195, v7 offset:4096
    ds_read_b128 v[144:147], v7 offset:0
    ds_read_b128 v[148:151], v7 offset:1024
    ds_read_b128 v[152:155], v7 offset:2048
    ds_read_b128 v[156:159], v7 offset:3072
    s_add_u32 m0, s29, 90112
    s_add_u32 s35, s101, 65536
    buffer_load_dwordx4 v44, s[24:27], s35 offen offset:0 lds
    v_accvgpr_read_b32 v170, a10
    v_accvgpr_read_b32 v171, a11
    v_accvgpr_read_b32 v172, a12
    v_accvgpr_read_b32 v173, a13
    v_accvgpr_read_b32 v174, a14
    v_accvgpr_read_b32 v175, a15
    v_pk_mul_f32 v[168:169], v[168:169], v[184:185] op_sel:[0,0] op_sel_hi:[1,0]
    v_pk_mul_f32 v[170:171], v[170:171], v[184:185] op_sel:[0,0] op_sel_hi:[1,0]
    v_pk_mul_f32 v[172:173], v[172:173], v[184:185] op_sel:[0,0] op_sel_hi:[1,0]
    v_pk_mul_f32 v[174:175], v[174:175], v[184:185] op_sel:[0,0] op_sel_hi:[1,0]
    v_cvt_pk_bf16_f32 v168, v168, v169
    v_cvt_pk_bf16_f32 v169, v170, v171
    v_cvt_pk_bf16_f32 v170, v172, v173
    v_cvt_pk_bf16_f32 v171, v174, v175
    buffer_store_dwordx4 v[168:171], v3, s[20:23], s74 offen sc1
    v_accvgpr_read_b32 v176, a40
    buffer_load_dwordx4 v45, s[24:27], s35 offen offset:1024 lds
    v_accvgpr_read_b32 v177, a41
    v_accvgpr_read_b32 v178, a42
    v_accvgpr_read_b32 v179, a43
    v_accvgpr_read_b32 v180, a44
    v_accvgpr_read_b32 v181, a45
    v_accvgpr_read_b32 v182, a46
    v_accvgpr_read_b32 v183, a47
    v_pk_mul_f32 v[176:177], v[176:177], v[184:185] op_sel:[0,1] op_sel_hi:[1,1]
    v_pk_mul_f32 v[178:179], v[178:179], v[184:185] op_sel:[0,1] op_sel_hi:[1,1]
    v_pk_mul_f32 v[180:181], v[180:181], v[184:185] op_sel:[0,1] op_sel_hi:[1,1]
    v_pk_mul_f32 v[182:183], v[182:183], v[184:185] op_sel:[0,1] op_sel_hi:[1,1]
    v_cvt_pk_bf16_f32 v176, v176, v177
    v_cvt_pk_bf16_f32 v177, v178, v179
    v_cvt_pk_bf16_f32 v178, v180, v181
    v_cvt_pk_bf16_f32 v179, v182, v183
    buffer_store_dwordx4 v[176:179], v3, s[20:23], s75 offen sc1
    buffer_load_dwordx4 v46, s[24:27], s35 offen offset:2048 lds
    v_accvgpr_read_b32 v160, a72
    v_accvgpr_read_b32 v161, a73
    v_accvgpr_read_b32 v162, a74
    v_accvgpr_read_b32 v163, a75
    v_accvgpr_read_b32 v164, a76
    v_accvgpr_read_b32 v165, a77
    v_accvgpr_read_b32 v166, a78
    v_accvgpr_read_b32 v167, a79
    v_pk_mul_f32 v[160:161], v[160:161], v[186:187] op_sel:[0,0] op_sel_hi:[1,0]
    v_pk_mul_f32 v[162:163], v[162:163], v[186:187] op_sel:[0,0] op_sel_hi:[1,0]
    v_pk_mul_f32 v[164:165], v[164:165], v[186:187] op_sel:[0,0] op_sel_hi:[1,0]
    v_pk_mul_f32 v[166:167], v[166:167], v[186:187] op_sel:[0,0] op_sel_hi:[1,0]
    v_cvt_pk_bf16_f32 v160, v160, v161
    v_cvt_pk_bf16_f32 v161, v162, v163
    v_cvt_pk_bf16_f32 v162, v164, v165
    buffer_load_dwordx4 v47, s[24:27], s35 offen offset:3072 lds
    v_cvt_pk_bf16_f32 v163, v166, v167
    buffer_store_dwordx4 v[160:163], v3, s[20:23], s0 offen sc1
    v_accvgpr_read_b32 v168, a104
    v_accvgpr_read_b32 v169, a105
    v_accvgpr_read_b32 v170, a106
    v_accvgpr_read_b32 v171, a107
    v_accvgpr_read_b32 v172, a108
    v_accvgpr_read_b32 v173, a109
    v_accvgpr_read_b32 v174, a110
    v_accvgpr_read_b32 v175, a111
    v_pk_mul_f32 v[168:169], v[168:169], v[186:187] op_sel:[0,1] op_sel_hi:[1,1]
    v_pk_mul_f32 v[170:171], v[170:171], v[186:187] op_sel:[0,1] op_sel_hi:[1,1]
    v_pk_mul_f32 v[172:173], v[172:173], v[186:187] op_sel:[0,1] op_sel_hi:[1,1]
    v_pk_mul_f32 v[174:175], v[174:175], v[186:187] op_sel:[0,1] op_sel_hi:[1,1]
    v_cvt_pk_bf16_f32 v168, v168, v169
    v_cvt_pk_bf16_f32 v169, v170, v171
    s_add_u32 m0, s44, 53248
    s_add_u32 s35, s100, 36864
    buffer_load_dwordx4 v38, s[20:23], s35 offen offset:0 sc1 lds
    v_cvt_pk_bf16_f32 v170, v172, v173
    v_cvt_pk_bf16_f32 v171, v174, v175
    buffer_store_dwordx4 v[168:171], v3, s[20:23], s1 offen sc1
    v_accvgpr_read_b32 v176, a16
    v_accvgpr_read_b32 v177, a17
    v_accvgpr_read_b32 v178, a18
    v_accvgpr_read_b32 v179, a19
    v_accvgpr_read_b32 v180, a20
    v_accvgpr_read_b32 v181, a21
    v_accvgpr_read_b32 v182, a22
    v_accvgpr_read_b32 v183, a23
    v_pk_mul_f32 v[176:177], v[176:177], v[184:185] op_sel:[0,0] op_sel_hi:[1,0]
    v_pk_mul_f32 v[178:179], v[178:179], v[184:185] op_sel:[0,0] op_sel_hi:[1,0]
    v_pk_mul_f32 v[180:181], v[180:181], v[184:185] op_sel:[0,0] op_sel_hi:[1,0]
    v_pk_mul_f32 v[182:183], v[182:183], v[184:185] op_sel:[0,0] op_sel_hi:[1,0]
    buffer_load_dwordx4 v38, s[20:23], s35 offen offset:1024 sc1 lds
    v_cvt_pk_bf16_f32 v176, v176, v177
    v_cvt_pk_bf16_f32 v177, v178, v179
    v_cvt_pk_bf16_f32 v178, v180, v181
    v_cvt_pk_bf16_f32 v179, v182, v183
    buffer_store_dwordx4 v[176:179], v4, s[20:23], s74 offen sc1
    v_accvgpr_read_b32 v160, a48
    v_accvgpr_read_b32 v161, a49
    v_accvgpr_read_b32 v162, a50
    v_accvgpr_read_b32 v163, a51
    v_accvgpr_read_b32 v164, a52
    v_accvgpr_read_b32 v165, a53
    v_accvgpr_read_b32 v166, a54
    v_accvgpr_read_b32 v167, a55
    v_pk_mul_f32 v[160:161], v[160:161], v[184:185] op_sel:[0,1] op_sel_hi:[1,1]
    v_pk_mul_f32 v[162:163], v[162:163], v[184:185] op_sel:[0,1] op_sel_hi:[1,1]
    v_pk_mul_f32 v[164:165], v[164:165], v[184:185] op_sel:[0,1] op_sel_hi:[1,1]
    buffer_load_dwordx4 v38, s[20:23], s35 offen offset:2048 sc1 lds
    v_pk_mul_f32 v[166:167], v[166:167], v[184:185] op_sel:[0,1] op_sel_hi:[1,1]
    v_cvt_pk_bf16_f32 v160, v160, v161
    v_cvt_pk_bf16_f32 v161, v162, v163
    v_cvt_pk_bf16_f32 v162, v164, v165
    v_cvt_pk_bf16_f32 v163, v166, v167
    buffer_store_dwordx4 v[160:163], v4, s[20:23], s75 offen sc1
    v_accvgpr_read_b32 v168, a80
    v_accvgpr_read_b32 v169, a81
    v_accvgpr_read_b32 v170, a82
    v_accvgpr_read_b32 v171, a83
    v_accvgpr_read_b32 v172, a84
    v_accvgpr_read_b32 v173, a85
    v_accvgpr_read_b32 v174, a86
    v_accvgpr_read_b32 v175, a87
    v_pk_mul_f32 v[168:169], v[168:169], v[186:187] op_sel:[0,0] op_sel_hi:[1,0]
    buffer_load_dwordx4 v38, s[20:23], s35 offen offset:3072 sc1 lds
    v_pk_mul_f32 v[170:171], v[170:171], v[186:187] op_sel:[0,0] op_sel_hi:[1,0]
    v_pk_mul_f32 v[172:173], v[172:173], v[186:187] op_sel:[0,0] op_sel_hi:[1,0]
    v_pk_mul_f32 v[174:175], v[174:175], v[186:187] op_sel:[0,0] op_sel_hi:[1,0]
    v_cvt_pk_bf16_f32 v168, v168, v169
    v_cvt_pk_bf16_f32 v169, v170, v171
    v_cvt_pk_bf16_f32 v170, v172, v173
    v_cvt_pk_bf16_f32 v171, v174, v175
    buffer_store_dwordx4 v[168:171], v4, s[20:23], s0 offen sc1
    v_accvgpr_read_b32 v176, a112
    v_accvgpr_read_b32 v177, a113
    v_accvgpr_read_b32 v178, a114
    v_accvgpr_read_b32 v179, a115
    v_accvgpr_read_b32 v180, a116
    v_accvgpr_read_b32 v181, a117
    v_accvgpr_read_b32 v182, a118
    v_accvgpr_read_b32 v183, a119
    s_add_u32 m0, s44, 57344
    s_add_u32 s35, s100, 40960
    buffer_load_dwordx4 v38, s[20:23], s35 offen offset:0 sc1 lds
    v_pk_mul_f32 v[176:177], v[176:177], v[186:187] op_sel:[0,1] op_sel_hi:[1,1]
    v_pk_mul_f32 v[178:179], v[178:179], v[186:187] op_sel:[0,1] op_sel_hi:[1,1]
    v_pk_mul_f32 v[180:181], v[180:181], v[186:187] op_sel:[0,1] op_sel_hi:[1,1]
    v_pk_mul_f32 v[182:183], v[182:183], v[186:187] op_sel:[0,1] op_sel_hi:[1,1]
    v_cvt_pk_bf16_f32 v176, v176, v177
    v_cvt_pk_bf16_f32 v177, v178, v179
    v_cvt_pk_bf16_f32 v178, v180, v181
    v_cvt_pk_bf16_f32 v179, v182, v183
    buffer_store_dwordx4 v[176:179], v4, s[20:23], s1 offen sc1
    v_accvgpr_read_b32 v160, a24
    v_accvgpr_read_b32 v161, a25
    v_accvgpr_read_b32 v162, a26
    v_accvgpr_read_b32 v163, a27
    v_accvgpr_read_b32 v164, a28
    v_accvgpr_read_b32 v165, a29
    buffer_load_dwordx4 v38, s[20:23], s35 offen offset:1024 sc1 lds
    v_accvgpr_read_b32 v166, a30
    v_accvgpr_read_b32 v167, a31
    v_pk_mul_f32 v[160:161], v[160:161], v[184:185] op_sel:[0,0] op_sel_hi:[1,0]
    v_pk_mul_f32 v[162:163], v[162:163], v[184:185] op_sel:[0,0] op_sel_hi:[1,0]
    v_pk_mul_f32 v[164:165], v[164:165], v[184:185] op_sel:[0,0] op_sel_hi:[1,0]
    v_pk_mul_f32 v[166:167], v[166:167], v[184:185] op_sel:[0,0] op_sel_hi:[1,0]
    v_cvt_pk_bf16_f32 v160, v160, v161
    v_cvt_pk_bf16_f32 v161, v162, v163
    v_cvt_pk_bf16_f32 v162, v164, v165
    v_cvt_pk_bf16_f32 v163, v166, v167
    buffer_store_dwordx4 v[160:163], v5, s[20:23], s74 offen sc1
    v_accvgpr_read_b32 v168, a56
    v_accvgpr_read_b32 v169, a57
    v_accvgpr_read_b32 v170, a58
    v_accvgpr_read_b32 v171, a59
    v_accvgpr_read_b32 v172, a60
    buffer_load_dwordx4 v38, s[20:23], s35 offen offset:2048 sc1 lds
    v_accvgpr_read_b32 v173, a61
    v_accvgpr_read_b32 v174, a62
    v_accvgpr_read_b32 v175, a63
    v_pk_mul_f32 v[168:169], v[168:169], v[184:185] op_sel:[0,1] op_sel_hi:[1,1]
    v_pk_mul_f32 v[170:171], v[170:171], v[184:185] op_sel:[0,1] op_sel_hi:[1,1]
    v_pk_mul_f32 v[172:173], v[172:173], v[184:185] op_sel:[0,1] op_sel_hi:[1,1]
    v_pk_mul_f32 v[174:175], v[174:175], v[184:185] op_sel:[0,1] op_sel_hi:[1,1]
    v_cvt_pk_bf16_f32 v168, v168, v169
    v_cvt_pk_bf16_f32 v169, v170, v171
    v_cvt_pk_bf16_f32 v170, v172, v173
    v_cvt_pk_bf16_f32 v171, v174, v175
    buffer_store_dwordx4 v[168:171], v5, s[20:23], s75 offen sc1
    v_accvgpr_read_b32 v176, a88
    v_accvgpr_read_b32 v177, a89
    v_accvgpr_read_b32 v178, a90
    buffer_load_dwordx4 v38, s[20:23], s35 offen offset:3072 sc1 lds
    v_accvgpr_read_b32 v179, a91
    v_accvgpr_read_b32 v180, a92
    v_accvgpr_read_b32 v181, a93
    v_accvgpr_read_b32 v182, a94
    v_accvgpr_read_b32 v183, a95
    v_pk_mul_f32 v[176:177], v[176:177], v[186:187] op_sel:[0,0] op_sel_hi:[1,0]
    v_pk_mul_f32 v[178:179], v[178:179], v[186:187] op_sel:[0,0] op_sel_hi:[1,0]
    v_pk_mul_f32 v[180:181], v[180:181], v[186:187] op_sel:[0,0] op_sel_hi:[1,0]
    v_pk_mul_f32 v[182:183], v[182:183], v[186:187] op_sel:[0,0] op_sel_hi:[1,0]
    v_cvt_pk_bf16_f32 v176, v176, v177
    v_cvt_pk_bf16_f32 v177, v178, v179
    v_cvt_pk_bf16_f32 v178, v180, v181
    v_cvt_pk_bf16_f32 v179, v182, v183
    buffer_store_dwordx4 v[176:179], v5, s[20:23], s0 offen sc1
    v_accvgpr_read_b32 v160, a120
    v_accvgpr_read_b32 v161, a121
    s_add_u32 m0, s44, 61440
    s_add_u32 s35, s100, 45056
    buffer_load_dwordx4 v38, s[20:23], s35 offen offset:0 sc1 lds
    v_accvgpr_read_b32 v162, a122
    v_accvgpr_read_b32 v163, a123
    v_accvgpr_read_b32 v164, a124
    v_accvgpr_read_b32 v165, a125
    v_accvgpr_read_b32 v166, a126
    v_accvgpr_read_b32 v167, a127
    v_pk_mul_f32 v[160:161], v[160:161], v[186:187] op_sel:[0,1] op_sel_hi:[1,1]
    v_pk_mul_f32 v[162:163], v[162:163], v[186:187] op_sel:[0,1] op_sel_hi:[1,1]
    v_pk_mul_f32 v[164:165], v[164:165], v[186:187] op_sel:[0,1] op_sel_hi:[1,1]
    v_pk_mul_f32 v[166:167], v[166:167], v[186:187] op_sel:[0,1] op_sel_hi:[1,1]
    v_cvt_pk_bf16_f32 v160, v160, v161
    v_cvt_pk_bf16_f32 v161, v162, v163
    v_cvt_pk_bf16_f32 v162, v164, v165
    v_cvt_pk_bf16_f32 v163, v166, v167
    buffer_store_dwordx4 v[160:163], v5, s[20:23], s1 offen sc1
    s_waitcnt lgkmcnt(7)
    v_or_b32 v191, v191, v192
    s_waitcnt lgkmcnt(5)
    v_or3_b32 v191, v191, v193, v194
    s_waitcnt lgkmcnt(4)
    v_add_f32 v188, v188, v195
    v_readfirstlane_b32 s35, v191
    v_rcp_f32 v188, v188
    s_nop 2
    s_andn2_b32 s35, s35, s34
    s_cmp_lg_u32 s35, 0
    s_cbranch_scc1 L_fallback
    v_accvgpr_read_b32 v168, a128
    v_accvgpr_read_b32 v169, a129
    v_accvgpr_read_b32 v170, a130
    v_accvgpr_read_b32 v171, a131
    v_accvgpr_read_b32 v172, a132
    v_accvgpr_read_b32 v173, a133
    v_accvgpr_read_b32 v174, a134
    v_accvgpr_read_b32 v175, a135
    s_waitcnt lgkmcnt(3)
    v_pk_add_f32 v[168:169], v[168:169], v[144:145]
    v_pk_add_f32 v[170:171], v[170:171], v[146:147]
    s_waitcnt lgkmcnt(2)
    v_pk_add_f32 v[172:173], v[172:173], v[148:149]
    v_pk_add_f32 v[174:175], v[174:175], v[150:151]
    v_pk_mul_f32 v[168:169], v[168:169], v[188:189] op_sel:[0,0] op_sel_hi:[1,0]
    v_pk_mul_f32 v[170:171], v[170:171], v[188:189] op_sel:[0,0] op_sel_hi:[1,0]
    v_pk_mul_f32 v[172:173], v[172:173], v[188:189] op_sel:[0,0] op_sel_hi:[1,0]
    v_pk_mul_f32 v[174:175], v[174:175], v[188:189] op_sel:[0,0] op_sel_hi:[1,0]
    v_cvt_pk_bf16_f32 v168, v168, v169
    v_cvt_pk_bf16_f32 v169, v170, v171
    v_cvt_pk_bf16_f32 v170, v172, v173
    v_cvt_pk_bf16_f32 v171, v174, v175
    buffer_store_dwordx4 v[168:171], v2, s[20:23], s73 offen sc1
    v_accvgpr_read_b32 v176, a136
    v_accvgpr_read_b32 v177, a137
    v_accvgpr_read_b32 v178, a138
    v_accvgpr_read_b32 v179, a139
    v_accvgpr_read_b32 v180, a140
    v_accvgpr_read_b32 v181, a141
    v_accvgpr_read_b32 v182, a142
    v_accvgpr_read_b32 v183, a143
    s_waitcnt lgkmcnt(1)
    v_pk_add_f32 v[176:177], v[176:177], v[152:153]
    v_pk_add_f32 v[178:179], v[178:179], v[154:155]
    s_waitcnt lgkmcnt(0)
    v_pk_add_f32 v[180:181], v[180:181], v[156:157]
    v_pk_add_f32 v[182:183], v[182:183], v[158:159]
    v_pk_mul_f32 v[176:177], v[176:177], v[188:189] op_sel:[0,0] op_sel_hi:[1,0]
    v_pk_mul_f32 v[178:179], v[178:179], v[188:189] op_sel:[0,0] op_sel_hi:[1,0]
    v_pk_mul_f32 v[180:181], v[180:181], v[188:189] op_sel:[0,0] op_sel_hi:[1,0]
    v_pk_mul_f32 v[182:183], v[182:183], v[188:189] op_sel:[0,0] op_sel_hi:[1,0]
    v_cvt_pk_bf16_f32 v176, v176, v177
    v_cvt_pk_bf16_f32 v177, v178, v179
    v_cvt_pk_bf16_f32 v178, v180, v181
    v_cvt_pk_bf16_f32 v179, v182, v183
    buffer_store_dwordx4 v[176:179], v3, s[20:23], s73 offen sc1
    v_lshrrev_b32 v50, 2, v48
    v_and_b32 v51, 3, v48
    v_lshrrev_b32 v7, 1, v1
    v_mul_u32_u24 v7, 9216, v7
    v_add_u32 v7, v7, v38
    v_add_u32 v8, 0, v7
    v_add_u32 v9, 53248, v7
    v_add_u32 v10, 106496, v7
    v_lshlrev_b32 v33, 2, v50
    v_and_b32 v35, 1, v1
    v_lshl_add_u32 v36, v35, 3, v51
    v_xor_b32 v33, v33, v36
    v_lshl_add_u32 v36, v49, 2, v50
    v_lshlrev_b32 v36, 8, v36
    v_xor_b32 v7, 0, v33
    v_lshl_add_u32 v7, v7, 4, v36
    v_add_u32 v11, 36864, v7
    v_add_u32 v12, 90112, v7
    v_add_u32 v13, 143360, v7
    v_xor_b32 v7, 4, v33
    v_lshl_add_u32 v7, v7, 4, v36
    v_add_u32 v14, 36864, v7
    v_add_u32 v15, 90112, v7
    v_add_u32 v16, 143360, v7
    s_xor_b32 s35, s28, s50
    s_xor_b32 s35, s35, 3
    s_mul_i32 s36, s28, 3
    s_add_u32 s35, s35, s36
    s_mul_i32 s35, s35, 20480
    s_add_u32 s35, s35, 16384
    s_cmp_eq_u32 s28, s50
    s_cselect_b32 s59, 0x40000000, s35
    s_mul_i32 s35, s63, 589824
    s_add_u32 s16, s60, s35
    s_addc_u32 s17, s61, 0
    s_mov_b32 s18, 589824
    s_mov_b32 s19, 0x20000
    s_lshl_b32 s35, s3, 2
    s_add_u32 s35, s35, s51
    s_mul_i32 s35, s35, 245760
    s_add_u32 s35, s35, 41943040
    s_add_u32 s12, s64, s35
    s_addc_u32 s13, s65, 0
    s_mov_b32 s14, 245760
    s_mov_b32 s15, 0x20000
    s_waitcnt lgkmcnt(15)
    s_waitcnt vmcnt(30)
    s_barrier
    s_add_u32 m0, s29, 143360
    s_add_u32 s35, s101, 262144
    buffer_load_dwordx4 v44, s[24:27], s35 offen offset:0 lds
    ds_read_b64_tr_b16 a[144:145], v11 offset:0
    ds_read_b64_tr_b16 a[146:147], v11 offset:4096
    ds_read_b128 v[64:67], v8 offset:0
    ds_read_b64_tr_b16 a[148:149], v11 offset:8192
    buffer_load_dwordx4 v45, s[24:27], s35 offen offset:1024 lds
    ds_read_b64_tr_b16 a[150:151], v11 offset:12288
    ds_read_b128 v[68:71], v8 offset:18432
    ds_read_b128 v[72:75], v8 offset:1024
    ds_read_b128 v[76:79], v8 offset:19456
    buffer_load_dwordx4 v46, s[24:27], s35 offen offset:2048 lds
    ds_read_b64_tr_b16 a[152:153], v11 offset:8
    ds_read_b64_tr_b16 a[154:155], v11 offset:4104
    ds_read_b64_tr_b16 a[156:157], v11 offset:8200
    ds_read_b64_tr_b16 a[158:159], v11 offset:12296
    buffer_load_dwordx4 v47, s[24:27], s35 offen offset:3072 lds
    s_add_u32 m0, s44, 106496
    s_add_u32 s35, s100, 73728
    ds_read_b64_tr_b16 a[160:161], v14 offset:0
    ds_read_b64_tr_b16 a[162:163], v14 offset:4096
    ds_read_b64_tr_b16 a[164:165], v14 offset:8192
    s_waitcnt lgkmcnt(9)
    v_mfma_f32_16x16x32_bf16 v[112:115], a[144:147], v[64:67], 0
    buffer_load_dwordx4 v38, s[20:23], s35 offen offset:0 sc1 lds
    v_mfma_f32_16x16x32_bf16 v[112:115], a[148:151], v[68:71], v[112:115]
    ds_read_b64_tr_b16 a[166:167], v14 offset:12288
    s_waitcnt lgkmcnt(8)
    v_mfma_f32_16x16x32_bf16 v[128:131], a[148:151], v[76:79], 0
    ds_read_b64_tr_b16 a[168:169], v14 offset:8
    v_lshl_add_u32 v29, v1, 6, v0
    v_mfma_f32_16x16x32_bf16 v[128:131], a[144:147], v[72:75], v[128:131]
    ds_read_b64_tr_b16 a[170:171], v14 offset:4104
    s_waitcnt lgkmcnt(6)
    v_mfma_f32_16x16x32_bf16 v[132:135], a[152:155], v[72:75], 0
    ds_read_b64_tr_b16 a[172:173], v14 offset:8200
    v_lshlrev_b32 v29, 13, v29
    v_mfma_f32_16x16x32_bf16 v[132:135], a[156:159], v[76:79], v[132:135]
    buffer_load_dwordx4 v38, s[20:23], s35 offen offset:1024 sc1 lds
    v_mfma_f32_16x16x32_bf16 v[116:119], a[156:159], v[68:71], 0
    ds_read_b64_tr_b16 a[174:175], v14 offset:12296
    v_mov_b32 v31, 1
    v_mfma_f32_16x16x32_bf16 v[116:119], a[152:155], v[64:67], v[116:119]
    ds_read_b128 v[80:83], v8 offset:2048
    s_waitcnt lgkmcnt(5)
    v_mfma_f32_16x16x32_bf16 v[120:123], a[160:163], v[64:67], 0
    ds_read_b128 v[84:87], v8 offset:20480
    v_lshlrev_b32 v33, 9, v51
    v_mfma_f32_16x16x32_bf16 v[120:123], a[164:167], v[68:71], v[120:123]
    ds_read_b128 v[88:91], v8 offset:3072
    v_add_u32 v32, s51, v51
    v_mfma_f32_16x16x32_bf16 v[136:139], a[164:167], v[76:79], 0
    buffer_load_dwordx4 v38, s[20:23], s35 offen offset:2048 sc1 lds
    v_mfma_f32_16x16x32_bf16 v[136:139], a[160:163], v[72:75], v[136:139]
    ds_read_b128 v[92:95], v8 offset:21504
    s_waitcnt lgkmcnt(4)
    v_mfma_f32_16x16x32_bf16 v[140:143], a[168:171], v[72:75], 0
    ds_read_b128 v[96:99], v8 offset:4096
    v_and_b32 v32, 3, v32
    v_mfma_f32_16x16x32_bf16 v[140:143], a[172:175], v[76:79], v[140:143]
    ds_read_b128 v[100:103], v8 offset:22528
    v_lshlrev_b32 v32, 9, v32
    v_mfma_f32_16x16x32_bf16 v[124:127], a[172:175], v[68:71], 0
    ds_read_b128 v[104:107], v8 offset:5120
    s_waitcnt lgkmcnt(3)
    v_mfma_f32_16x16x32_bf16 v[124:127], a[168:171], v[64:67], v[124:127]
    buffer_load_dwordx4 v38, s[20:23], s35 offen offset:3072 sc1 lds
    v_mfma_f32_16x16x32_bf16 v[144:147], a[144:147], v[80:83], 0
    s_add_u32 m0, s44, 110592
    s_add_u32 s35, s100, 77824
    v_mfma_f32_16x16x32_bf16 v[144:147], a[148:151], v[84:87], v[144:147]
    ds_read_b128 v[108:111], v8 offset:23552
    s_and_b32 s91, s62, 12
    v_mfma_f32_16x16x32_bf16 v[160:163], a[148:151], v[92:95], 0
    s_lshl_b32 s91, s91, 9
    v_xor_b32 v37, s50, v51
    v_mfma_f32_16x16x32_bf16 v[160:163], a[144:147], v[88:91], v[160:163]
    v_xor_b32 v37, 3, v37
    v_lshlrev_b32 v37, 11, v37
    v_mfma_f32_16x16x32_bf16 v[164:167], a[152:155], v[88:91], 0
    buffer_load_dwordx4 v38, s[20:23], s35 offen offset:0 sc1 lds
    v_mfma_f32_16x16x32_bf16 v[164:167], a[156:159], v[92:95], v[164:167]
    v_lshrrev_b32 v7, 1, v1
    v_mul_u32_u24 v7, 144, v7
    v_mfma_f32_16x16x32_bf16 v[148:151], a[156:159], v[84:87], 0
    v_add_u32 v7, v7, v48
    v_lshlrev_b32 v7, 11, v7
    v_mfma_f32_16x16x32_bf16 v[148:151], a[152:155], v[80:83], v[148:151]
    v_lshl_add_u32 v7, v35, 7, v7
    v_lshl_add_u32 v34, v49, 4, v7
    v_mfma_f32_16x16x32_bf16 v[152:155], a[160:163], v[80:83], 0
    v_mfma_f32_16x16x32_bf16 v[152:155], a[164:167], v[84:87], v[152:155]
    buffer_load_dwordx4 v38, s[20:23], s35 offen offset:1024 sc1 lds
    v_mfma_f32_16x16x32_bf16 v[168:171], a[164:167], v[92:95], 0
    v_mfma_f32_16x16x32_bf16 v[168:171], a[160:163], v[88:91], v[168:171]
    v_mfma_f32_16x16x32_bf16 v[172:175], a[168:171], v[88:91], 0
    ds_read_b128 v[64:67], v8 offset:6144
    v_mfma_f32_16x16x32_bf16 v[172:175], a[172:175], v[92:95], v[172:175]
    ds_read_b128 v[68:71], v8 offset:24576
    v_mfma_f32_16x16x32_bf16 v[156:159], a[172:175], v[84:87], 0
    buffer_load_dwordx4 v38, s[20:23], s35 offen offset:2048 sc1 lds
    v_mfma_f32_16x16x32_bf16 v[156:159], a[168:171], v[80:83], v[156:159]
    s_waitcnt lgkmcnt(2)
    v_mfma_f32_16x16x32_bf16 v[176:179], a[144:147], v[96:99], 0
    v_mfma_f32_16x16x32_bf16 v[176:179], a[148:151], v[100:103], v[176:179]
    v_mfma_f32_16x16x32_bf16 v[192:195], a[148:151], v[108:111], 0
    v_mfma_f32_16x16x32_bf16 v[192:195], a[144:147], v[104:107], v[192:195]
    buffer_load_dwordx4 v38, s[20:23], s35 offen offset:3072 sc1 lds
    v_mfma_f32_16x16x32_bf16 v[196:199], a[152:155], v[104:107], 0
    s_add_u32 m0, s44, 114688
    s_add_u32 s35, s100, 81920
    v_mfma_f32_16x16x32_bf16 v[196:199], a[156:159], v[108:111], v[196:199]
    ds_read_b128 v[72:75], v8 offset:7168
    v_mfma_f32_16x16x32_bf16 v[180:183], a[156:159], v[100:103], 0
    ds_read_b128 v[76:79], v8 offset:25600
    v_mfma_f32_16x16x32_bf16 v[180:183], a[152:155], v[96:99], v[180:183]
    ds_read_b128 v[80:83], v8 offset:8192
    v_mfma_f32_16x16x32_bf16 v[184:187], a[160:163], v[96:99], 0
    buffer_load_dwordx4 v38, s[20:23], s35 offen offset:0 sc1 lds
    v_mfma_f32_16x16x32_bf16 v[184:187], a[164:167], v[100:103], v[184:187]
    ds_read_b128 v[84:87], v8 offset:26624
    v_mfma_f32_16x16x32_bf16 v[200:203], a[164:167], v[108:111], 0
    v_mfma_f32_16x16x32_bf16 v[200:203], a[160:163], v[104:107], v[200:203]
    v_mfma_f32_16x16x32_bf16 v[204:207], a[168:171], v[104:107], 0
    v_mfma_f32_16x16x32_bf16 v[204:207], a[172:175], v[108:111], v[204:207]
    v_mfma_f32_16x16x32_bf16 v[188:191], a[172:175], v[100:103], 0
    v_mfma_f32_16x16x32_bf16 v[188:191], a[168:171], v[96:99], v[188:191]
    s_waitcnt lgkmcnt(0)
    v_mfma_f32_16x16x32_bf16 v[208:211], a[144:147], v[64:67], 0
    v_mfma_f32_16x16x32_bf16 v[208:211], a[148:151], v[68:71], v[208:211]
    s_waitcnt lgkmcnt(15)
    s_waitcnt vmcnt(13)
    v_mfma_f32_16x16x32_bf16 v[212:215], a[156:159], v[68:71], 0
    s_barrier
    v_mfma_f32_16x16x32_bf16 v[212:215], a[152:155], v[64:67], v[212:215]
    s_add_u32 m0, s29, 36864
    s_add_u32 s35, s101, 327680
    v_mfma_f32_16x16x32_bf16 v[216:219], a[160:163], v[64:67], 0
    buffer_load_dwordx4 v44, s[24:27], s35 offen offset:0 lds
    v_mfma_f32_16x16x32_bf16 v[216:219], a[164:167], v[68:71], v[216:219]
    ds_read_b64_tr_b16 a[176:177], v12 offset:0
    v_mfma_f32_16x16x32_bf16 v[220:223], a[172:175], v[68:71], 0
    ds_read_b64_tr_b16 a[178:179], v12 offset:4096
    v_mfma_f32_16x16x32_bf16 v[220:223], a[168:171], v[64:67], v[220:223]
    ds_read_b128 v[88:91], v9 offset:0
    v_mfma_f32_16x16x32_bf16 v[224:227], a[144:147], v[72:75], 0
    ds_read_b64_tr_b16 a[180:181], v12 offset:8192
    v_mfma_f32_16x16x32_bf16 v[224:227], a[148:151], v[76:79], v[224:227]
    buffer_load_dwordx4 v45, s[24:27], s35 offen offset:1024 lds
    v_mfma_f32_16x16x32_bf16 v[240:243], a[148:151], v[84:87], 0
    ds_read_b64_tr_b16 a[182:183], v12 offset:12288
    v_mfma_f32_16x16x32_bf16 v[240:243], a[144:147], v[80:83], v[240:243]
    ds_read_b128 v[92:95], v9 offset:18432
    v_mfma_f32_16x16x32_bf16 v[244:247], a[152:155], v[80:83], 0
    ds_read_b128 v[96:99], v9 offset:1024
    v_mfma_f32_16x16x32_bf16 v[244:247], a[156:159], v[84:87], v[244:247]
    ds_read_b128 v[100:103], v9 offset:19456
    v_mfma_f32_16x16x32_bf16 v[228:231], a[156:159], v[76:79], 0
    buffer_load_dwordx4 v46, s[24:27], s35 offen offset:2048 lds
    v_mfma_f32_16x16x32_bf16 v[228:231], a[152:155], v[72:75], v[228:231]
    ds_read_b64_tr_b16 a[184:185], v12 offset:8
    v_mfma_f32_16x16x32_bf16 v[232:235], a[160:163], v[72:75], 0
    ds_read_b64_tr_b16 a[186:187], v12 offset:4104
    v_mfma_f32_16x16x32_bf16 v[232:235], a[164:167], v[76:79], v[232:235]
    ds_read_b64_tr_b16 a[188:189], v12 offset:8200
    v_mfma_f32_16x16x32_bf16 v[248:251], a[164:167], v[84:87], 0
    ds_read_b64_tr_b16 a[190:191], v12 offset:12296
    v_mfma_f32_16x16x32_bf16 v[248:251], a[160:163], v[80:83], v[248:251]
    buffer_load_dwordx4 v47, s[24:27], s35 offen offset:3072 lds
    v_mfma_f32_16x16x32_bf16 v[252:255], a[168:171], v[80:83], 0
    s_add_u32 m0, s44, 0
    s_add_u32 s35, s100, 110592
    v_mfma_f32_16x16x32_bf16 v[252:255], a[172:175], v[84:87], v[252:255]
    ds_read_b64_tr_b16 a[192:193], v15 offset:0
    v_mfma_f32_16x16x32_bf16 v[236:239], a[172:175], v[76:79], 0
    ds_read_b64_tr_b16 a[194:195], v15 offset:4096
    v_mfma_f32_16x16x32_bf16 v[236:239], a[168:171], v[72:75], v[236:239]
    ds_read_b64_tr_b16 a[196:197], v15 offset:8192
    s_waitcnt lgkmcnt(9)
    v_mfma_f32_16x16x32_bf16 v[112:115], a[176:179], v[88:91], v[112:115]
    s_lshl_b32 s89, s62, 9
    buffer_store_dword v31, v29, s[96:99], s89 offen sc1
    buffer_load_dwordx4 v38, s[20:23], s35 offen offset:0 sc1 lds
    v_mfma_f32_16x16x32_bf16 v[112:115], a[180:183], v[92:95], v[112:115]
    ds_read_b64_tr_b16 a[198:199], v15 offset:12288
    s_waitcnt lgkmcnt(8)
    v_mfma_f32_16x16x32_bf16 v[128:131], a[180:183], v[100:103], v[128:131]
    ds_read_b64_tr_b16 a[200:201], v15 offset:8
    v_mfma_f32_16x16x32_bf16 v[128:131], a[176:179], v[96:99], v[128:131]
    ds_read_b64_tr_b16 a[202:203], v15 offset:4104
    s_waitcnt lgkmcnt(6)
    v_mfma_f32_16x16x32_bf16 v[132:135], a[184:187], v[96:99], v[132:135]
    ds_read_b64_tr_b16 a[204:205], v15 offset:8200
    v_mfma_f32_16x16x32_bf16 v[132:135], a[188:191], v[100:103], v[132:135]
    buffer_load_dwordx4 v38, s[20:23], s35 offen offset:1024 sc1 lds
    v_mfma_f32_16x16x32_bf16 v[116:119], a[188:191], v[92:95], v[116:119]
    ds_read_b64_tr_b16 a[206:207], v15 offset:12296
    v_mfma_f32_16x16x32_bf16 v[116:119], a[184:187], v[88:91], v[116:119]
    ds_read_b128 v[104:107], v9 offset:2048
    s_waitcnt lgkmcnt(5)
    v_mfma_f32_16x16x32_bf16 v[120:123], a[192:195], v[88:91], v[120:123]
    ds_read_b128 v[108:111], v9 offset:20480
    v_mfma_f32_16x16x32_bf16 v[120:123], a[196:199], v[92:95], v[120:123]
    ds_read_b128 v[64:67], v9 offset:3072
    v_mfma_f32_16x16x32_bf16 v[136:139], a[196:199], v[100:103], v[136:139]
    buffer_load_dwordx4 v38, s[20:23], s35 offen offset:2048 sc1 lds
    v_mfma_f32_16x16x32_bf16 v[136:139], a[192:195], v[96:99], v[136:139]
    ds_read_b128 v[68:71], v9 offset:21504
    s_waitcnt lgkmcnt(4)
    v_mfma_f32_16x16x32_bf16 v[140:143], a[200:203], v[96:99], v[140:143]
    ds_read_b128 v[72:75], v9 offset:4096
    v_mfma_f32_16x16x32_bf16 v[140:143], a[204:207], v[100:103], v[140:143]
    ds_read_b128 v[76:79], v9 offset:22528
    v_mfma_f32_16x16x32_bf16 v[124:127], a[204:207], v[92:95], v[124:127]
    ds_read_b128 v[80:83], v9 offset:5120
    s_waitcnt lgkmcnt(3)
    v_mfma_f32_16x16x32_bf16 v[124:127], a[200:203], v[88:91], v[124:127]
    buffer_load_dwordx4 v38, s[20:23], s35 offen offset:3072 sc1 lds
    v_mfma_f32_16x16x32_bf16 v[144:147], a[176:179], v[104:107], v[144:147]
    s_add_u32 m0, s44, 4096
    s_add_u32 s35, s100, 114688
    v_mfma_f32_16x16x32_bf16 v[144:147], a[180:183], v[108:111], v[144:147]
    ds_read_b128 v[84:87], v9 offset:23552
    v_mfma_f32_16x16x32_bf16 v[160:163], a[180:183], v[68:71], v[160:163]
    v_mfma_f32_16x16x32_bf16 v[160:163], a[176:179], v[64:67], v[160:163]
    v_mfma_f32_16x16x32_bf16 v[164:167], a[184:187], v[64:67], v[164:167]
    buffer_load_dwordx4 v38, s[20:23], s35 offen offset:0 sc1 lds
    v_mfma_f32_16x16x32_bf16 v[164:167], a[188:191], v[68:71], v[164:167]
    v_mfma_f32_16x16x32_bf16 v[148:151], a[188:191], v[108:111], v[148:151]
    v_mfma_f32_16x16x32_bf16 v[148:151], a[184:187], v[104:107], v[148:151]
    v_mfma_f32_16x16x32_bf16 v[152:155], a[192:195], v[104:107], v[152:155]
    v_mfma_f32_16x16x32_bf16 v[152:155], a[196:199], v[108:111], v[152:155]
    buffer_load_dwordx4 v38, s[20:23], s35 offen offset:1024 sc1 lds
    v_mfma_f32_16x16x32_bf16 v[168:171], a[196:199], v[68:71], v[168:171]
    v_mfma_f32_16x16x32_bf16 v[168:171], a[192:195], v[64:67], v[168:171]
    v_mfma_f32_16x16x32_bf16 v[172:175], a[200:203], v[64:67], v[172:175]
    ds_read_b128 v[88:91], v9 offset:6144
    v_mfma_f32_16x16x32_bf16 v[172:175], a[204:207], v[68:71], v[172:175]
    ds_read_b128 v[92:95], v9 offset:24576
    v_mfma_f32_16x16x32_bf16 v[156:159], a[204:207], v[108:111], v[156:159]
    buffer_load_dwordx4 v38, s[20:23], s35 offen offset:2048 sc1 lds
    v_mfma_f32_16x16x32_bf16 v[156:159], a[200:203], v[104:107], v[156:159]
    s_waitcnt lgkmcnt(2)
    v_mfma_f32_16x16x32_bf16 v[176:179], a[176:179], v[72:75], v[176:179]
    v_mfma_f32_16x16x32_bf16 v[176:179], a[180:183], v[76:79], v[176:179]
    v_mfma_f32_16x16x32_bf16 v[192:195], a[180:183], v[84:87], v[192:195]
    v_mfma_f32_16x16x32_bf16 v[192:195], a[176:179], v[80:83], v[192:195]
    buffer_load_dwordx4 v38, s[20:23], s35 offen offset:3072 sc1 lds
    v_mfma_f32_16x16x32_bf16 v[196:199], a[184:187], v[80:83], v[196:199]
    s_add_u32 m0, s44, 8192
    s_add_u32 s35, s100, 118784
    v_mfma_f32_16x16x32_bf16 v[196:199], a[188:191], v[84:87], v[196:199]
    ds_read_b128 v[96:99], v9 offset:7168
    v_mfma_f32_16x16x32_bf16 v[180:183], a[188:191], v[76:79], v[180:183]
    ds_read_b128 v[100:103], v9 offset:25600
    v_mfma_f32_16x16x32_bf16 v[180:183], a[184:187], v[72:75], v[180:183]
    ds_read_b128 v[104:107], v9 offset:8192
    v_mfma_f32_16x16x32_bf16 v[184:187], a[192:195], v[72:75], v[184:187]
    buffer_load_dwordx4 v38, s[20:23], s35 offen offset:0 sc1 lds
    v_mfma_f32_16x16x32_bf16 v[184:187], a[196:199], v[76:79], v[184:187]
    ds_read_b128 v[108:111], v9 offset:26624
    v_mfma_f32_16x16x32_bf16 v[200:203], a[196:199], v[84:87], v[200:203]
    v_mfma_f32_16x16x32_bf16 v[200:203], a[192:195], v[80:83], v[200:203]
    v_mfma_f32_16x16x32_bf16 v[204:207], a[200:203], v[80:83], v[204:207]
    v_mfma_f32_16x16x32_bf16 v[204:207], a[204:207], v[84:87], v[204:207]
    v_mfma_f32_16x16x32_bf16 v[188:191], a[204:207], v[76:79], v[188:191]
    v_mfma_f32_16x16x32_bf16 v[188:191], a[200:203], v[72:75], v[188:191]
    s_waitcnt lgkmcnt(0)
    v_mfma_f32_16x16x32_bf16 v[208:211], a[176:179], v[88:91], v[208:211]
    v_mfma_f32_16x16x32_bf16 v[208:211], a[180:183], v[92:95], v[208:211]
    s_waitcnt lgkmcnt(15)
    s_waitcnt vmcnt(14)
    v_mfma_f32_16x16x32_bf16 v[212:215], a[188:191], v[92:95], v[212:215]
    s_barrier
    v_mfma_f32_16x16x32_bf16 v[212:215], a[184:187], v[88:91], v[212:215]
    s_add_u32 m0, s29, 90112
    s_add_u32 s35, s101, 524288
    v_mfma_f32_16x16x32_bf16 v[216:219], a[192:195], v[88:91], v[216:219]
    buffer_load_dwordx4 v44, s[24:27], s35 offen offset:0 lds
    v_mfma_f32_16x16x32_bf16 v[216:219], a[196:199], v[92:95], v[216:219]
    ds_read_b64_tr_b16 a[144:145], v13 offset:0
    v_mfma_f32_16x16x32_bf16 v[220:223], a[204:207], v[92:95], v[220:223]
    ds_read_b64_tr_b16 a[146:147], v13 offset:4096
    v_mfma_f32_16x16x32_bf16 v[220:223], a[200:203], v[88:91], v[220:223]
    ds_read_b128 v[64:67], v10 offset:0
    v_mfma_f32_16x16x32_bf16 v[224:227], a[176:179], v[96:99], v[224:227]
    ds_read_b64_tr_b16 a[148:149], v13 offset:8192
    v_mfma_f32_16x16x32_bf16 v[224:227], a[180:183], v[100:103], v[224:227]
    buffer_load_dwordx4 v45, s[24:27], s35 offen offset:1024 lds
    v_mfma_f32_16x16x32_bf16 v[240:243], a[180:183], v[108:111], v[240:243]
    ds_read_b64_tr_b16 a[150:151], v13 offset:12288
    v_mfma_f32_16x16x32_bf16 v[240:243], a[176:179], v[104:107], v[240:243]
    ds_read_b128 v[68:71], v10 offset:18432
    v_mfma_f32_16x16x32_bf16 v[244:247], a[184:187], v[104:107], v[244:247]
    ds_read_b128 v[72:75], v10 offset:1024
    v_mfma_f32_16x16x32_bf16 v[244:247], a[188:191], v[108:111], v[244:247]
    ds_read_b128 v[76:79], v10 offset:19456
    v_mfma_f32_16x16x32_bf16 v[228:231], a[188:191], v[100:103], v[228:231]
    buffer_load_dwordx4 v46, s[24:27], s35 offen offset:2048 lds
    v_mfma_f32_16x16x32_bf16 v[228:231], a[184:187], v[96:99], v[228:231]
    ds_read_b64_tr_b16 a[152:153], v13 offset:8
    v_mfma_f32_16x16x32_bf16 v[232:235], a[192:195], v[96:99], v[232:235]
    ds_read_b64_tr_b16 a[154:155], v13 offset:4104
    v_mfma_f32_16x16x32_bf16 v[232:235], a[196:199], v[100:103], v[232:235]
    ds_read_b64_tr_b16 a[156:157], v13 offset:8200
    v_mfma_f32_16x16x32_bf16 v[248:251], a[196:199], v[108:111], v[248:251]
    ds_read_b64_tr_b16 a[158:159], v13 offset:12296
    v_mfma_f32_16x16x32_bf16 v[248:251], a[192:195], v[104:107], v[248:251]
    buffer_load_dwordx4 v47, s[24:27], s35 offen offset:3072 lds
    v_mfma_f32_16x16x32_bf16 v[252:255], a[200:203], v[104:107], v[252:255]
    s_add_u32 m0, s44, 53248
    s_add_u32 s35, s100, 147456
    v_mfma_f32_16x16x32_bf16 v[252:255], a[204:207], v[108:111], v[252:255]
    ds_read_b64_tr_b16 a[160:161], v16 offset:0
    v_mfma_f32_16x16x32_bf16 v[236:239], a[204:207], v[100:103], v[236:239]
    ds_read_b64_tr_b16 a[162:163], v16 offset:4096
    v_mfma_f32_16x16x32_bf16 v[236:239], a[200:203], v[96:99], v[236:239]
    ds_read_b64_tr_b16 a[164:165], v16 offset:8192
    s_waitcnt lgkmcnt(9)
    v_mfma_f32_16x16x32_bf16 v[112:115], a[144:147], v[64:67], v[112:115]
    buffer_load_dwordx4 v38, s[20:23], s35 offen offset:0 sc1 lds
    v_mfma_f32_16x16x32_bf16 v[112:115], a[148:151], v[68:71], v[112:115]
    ds_read_b64_tr_b16 a[166:167], v16 offset:12288
    s_waitcnt lgkmcnt(8)
    v_mfma_f32_16x16x32_bf16 v[128:131], a[148:151], v[76:79], v[128:131]
    ds_read_b64_tr_b16 a[168:169], v16 offset:8
    v_mfma_f32_16x16x32_bf16 v[128:131], a[144:147], v[72:75], v[128:131]
    ds_read_b64_tr_b16 a[170:171], v16 offset:4104
    s_waitcnt lgkmcnt(6)
    v_mfma_f32_16x16x32_bf16 v[132:135], a[152:155], v[72:75], v[132:135]
    ds_read_b64_tr_b16 a[172:173], v16 offset:8200
    v_mfma_f32_16x16x32_bf16 v[132:135], a[156:159], v[76:79], v[132:135]
    buffer_load_dwordx4 v38, s[20:23], s35 offen offset:1024 sc1 lds
    v_mfma_f32_16x16x32_bf16 v[116:119], a[156:159], v[68:71], v[116:119]
    ds_read_b64_tr_b16 a[174:175], v16 offset:12296
    v_mfma_f32_16x16x32_bf16 v[116:119], a[152:155], v[64:67], v[116:119]
    ds_read_b128 v[80:83], v10 offset:2048
    s_waitcnt lgkmcnt(5)
    v_mfma_f32_16x16x32_bf16 v[120:123], a[160:163], v[64:67], v[120:123]
    ds_read_b128 v[84:87], v10 offset:20480
    v_mfma_f32_16x16x32_bf16 v[120:123], a[164:167], v[68:71], v[120:123]
    ds_read_b128 v[88:91], v10 offset:3072
    v_mfma_f32_16x16x32_bf16 v[136:139], a[164:167], v[76:79], v[136:139]
    buffer_load_dwordx4 v38, s[20:23], s35 offen offset:2048 sc1 lds
    v_mfma_f32_16x16x32_bf16 v[136:139], a[160:163], v[72:75], v[136:139]
    ds_read_b128 v[92:95], v10 offset:21504
    s_waitcnt lgkmcnt(4)
    v_mfma_f32_16x16x32_bf16 v[140:143], a[168:171], v[72:75], v[140:143]
    ds_read_b128 v[96:99], v10 offset:4096
    v_mfma_f32_16x16x32_bf16 v[140:143], a[172:175], v[76:79], v[140:143]
    ds_read_b128 v[100:103], v10 offset:22528
    v_mfma_f32_16x16x32_bf16 v[124:127], a[172:175], v[68:71], v[124:127]
    ds_read_b128 v[104:107], v10 offset:5120
    s_waitcnt lgkmcnt(3)
    v_mfma_f32_16x16x32_bf16 v[124:127], a[168:171], v[64:67], v[124:127]
    buffer_load_dwordx4 v38, s[20:23], s35 offen offset:3072 sc1 lds
    v_mfma_f32_16x16x32_bf16 v[144:147], a[144:147], v[80:83], v[144:147]
    s_add_u32 m0, s44, 57344
    s_add_u32 s35, s100, 151552
    v_mfma_f32_16x16x32_bf16 v[144:147], a[148:151], v[84:87], v[144:147]
    ds_read_b128 v[108:111], v10 offset:23552
    v_mfma_f32_16x16x32_bf16 v[160:163], a[148:151], v[92:95], v[160:163]
    v_mfma_f32_16x16x32_bf16 v[160:163], a[144:147], v[88:91], v[160:163]
    v_mfma_f32_16x16x32_bf16 v[164:167], a[152:155], v[88:91], v[164:167]
    buffer_load_dwordx4 v38, s[20:23], s35 offen offset:0 sc1 lds
    v_mfma_f32_16x16x32_bf16 v[164:167], a[156:159], v[92:95], v[164:167]
    v_mfma_f32_16x16x32_bf16 v[148:151], a[156:159], v[84:87], v[148:151]
    v_mfma_f32_16x16x32_bf16 v[148:151], a[152:155], v[80:83], v[148:151]
    v_mfma_f32_16x16x32_bf16 v[152:155], a[160:163], v[80:83], v[152:155]
    v_mfma_f32_16x16x32_bf16 v[152:155], a[164:167], v[84:87], v[152:155]
    buffer_load_dwordx4 v38, s[20:23], s35 offen offset:1024 sc1 lds
    v_mfma_f32_16x16x32_bf16 v[168:171], a[164:167], v[92:95], v[168:171]
    v_mfma_f32_16x16x32_bf16 v[168:171], a[160:163], v[88:91], v[168:171]
    v_mfma_f32_16x16x32_bf16 v[172:175], a[168:171], v[88:91], v[172:175]
    ds_read_b128 v[64:67], v10 offset:6144
    v_mfma_f32_16x16x32_bf16 v[172:175], a[172:175], v[92:95], v[172:175]
    ds_read_b128 v[68:71], v10 offset:24576
    v_mfma_f32_16x16x32_bf16 v[156:159], a[172:175], v[84:87], v[156:159]
    buffer_load_dwordx4 v38, s[20:23], s35 offen offset:2048 sc1 lds
    v_mfma_f32_16x16x32_bf16 v[156:159], a[168:171], v[80:83], v[156:159]
    s_waitcnt lgkmcnt(2)
    v_mfma_f32_16x16x32_bf16 v[176:179], a[144:147], v[96:99], v[176:179]
    v_mfma_f32_16x16x32_bf16 v[176:179], a[148:151], v[100:103], v[176:179]
    v_mfma_f32_16x16x32_bf16 v[192:195], a[148:151], v[108:111], v[192:195]
    v_mfma_f32_16x16x32_bf16 v[192:195], a[144:147], v[104:107], v[192:195]
    buffer_load_dwordx4 v38, s[20:23], s35 offen offset:3072 sc1 lds
    v_mfma_f32_16x16x32_bf16 v[196:199], a[152:155], v[104:107], v[196:199]
    s_add_u32 m0, s44, 61440
    s_add_u32 s35, s100, 155648
    v_mfma_f32_16x16x32_bf16 v[196:199], a[156:159], v[108:111], v[196:199]
    ds_read_b128 v[72:75], v10 offset:7168
    v_mfma_f32_16x16x32_bf16 v[180:183], a[156:159], v[100:103], v[180:183]
    ds_read_b128 v[76:79], v10 offset:25600
    v_mfma_f32_16x16x32_bf16 v[180:183], a[152:155], v[96:99], v[180:183]
    ds_read_b128 v[80:83], v10 offset:8192
    v_mfma_f32_16x16x32_bf16 v[184:187], a[160:163], v[96:99], v[184:187]
    buffer_load_dwordx4 v38, s[20:23], s35 offen offset:0 sc1 lds
    v_mfma_f32_16x16x32_bf16 v[184:187], a[164:167], v[100:103], v[184:187]
    ds_read_b128 v[84:87], v10 offset:26624
    v_mfma_f32_16x16x32_bf16 v[200:203], a[164:167], v[108:111], v[200:203]
    v_mfma_f32_16x16x32_bf16 v[200:203], a[160:163], v[104:107], v[200:203]
    v_mfma_f32_16x16x32_bf16 v[204:207], a[168:171], v[104:107], v[204:207]
    v_mfma_f32_16x16x32_bf16 v[204:207], a[172:175], v[108:111], v[204:207]
    v_mfma_f32_16x16x32_bf16 v[188:191], a[172:175], v[100:103], v[188:191]
    v_mfma_f32_16x16x32_bf16 v[188:191], a[168:171], v[96:99], v[188:191]
    s_waitcnt lgkmcnt(0)
    v_mfma_f32_16x16x32_bf16 v[208:211], a[144:147], v[64:67], v[208:211]
    v_mfma_f32_16x16x32_bf16 v[208:211], a[148:151], v[68:71], v[208:211]
    s_waitcnt lgkmcnt(15)
    s_waitcnt vmcnt(13)
    v_mfma_f32_16x16x32_bf16 v[212:215], a[156:159], v[68:71], v[212:215]
    s_barrier
    v_mfma_f32_16x16x32_bf16 v[212:215], a[152:155], v[64:67], v[212:215]
    s_add_u32 m0, s29, 143360
    s_add_u32 s35, s101, 589824
    v_mfma_f32_16x16x32_bf16 v[216:219], a[160:163], v[64:67], v[216:219]
    buffer_load_dwordx4 v44, s[24:27], s35 offen offset:0 lds
    v_mfma_f32_16x16x32_bf16 v[216:219], a[164:167], v[68:71], v[216:219]
    ds_read_b64_tr_b16 a[176:177], v11 offset:0
    v_mfma_f32_16x16x32_bf16 v[220:223], a[172:175], v[68:71], v[220:223]
    ds_read_b64_tr_b16 a[178:179], v11 offset:4096
    v_mfma_f32_16x16x32_bf16 v[220:223], a[168:171], v[64:67], v[220:223]
    ds_read_b128 v[88:91], v8 offset:0
    v_mfma_f32_16x16x32_bf16 v[224:227], a[144:147], v[72:75], v[224:227]
    ds_read_b64_tr_b16 a[180:181], v11 offset:8192
    v_mfma_f32_16x16x32_bf16 v[224:227], a[148:151], v[76:79], v[224:227]
    buffer_load_dwordx4 v45, s[24:27], s35 offen offset:1024 lds
    v_mfma_f32_16x16x32_bf16 v[240:243], a[148:151], v[84:87], v[240:243]
    ds_read_b64_tr_b16 a[182:183], v11 offset:12288
    v_mfma_f32_16x16x32_bf16 v[240:243], a[144:147], v[80:83], v[240:243]
    ds_read_b128 v[92:95], v8 offset:18432
    v_mfma_f32_16x16x32_bf16 v[244:247], a[152:155], v[80:83], v[244:247]
    ds_read_b128 v[96:99], v8 offset:1024
    v_mfma_f32_16x16x32_bf16 v[244:247], a[156:159], v[84:87], v[244:247]
    ds_read_b128 v[100:103], v8 offset:19456
    v_mfma_f32_16x16x32_bf16 v[228:231], a[156:159], v[76:79], v[228:231]
    buffer_load_dwordx4 v46, s[24:27], s35 offen offset:2048 lds
    v_mfma_f32_16x16x32_bf16 v[228:231], a[152:155], v[72:75], v[228:231]
    ds_read_b64_tr_b16 a[184:185], v11 offset:8
    v_mfma_f32_16x16x32_bf16 v[232:235], a[160:163], v[72:75], v[232:235]
    ds_read_b64_tr_b16 a[186:187], v11 offset:4104
    v_mfma_f32_16x16x32_bf16 v[232:235], a[164:167], v[76:79], v[232:235]
    ds_read_b64_tr_b16 a[188:189], v11 offset:8200
    v_mfma_f32_16x16x32_bf16 v[248:251], a[164:167], v[84:87], v[248:251]
    ds_read_b64_tr_b16 a[190:191], v11 offset:12296
    v_mfma_f32_16x16x32_bf16 v[248:251], a[160:163], v[80:83], v[248:251]
    buffer_load_dwordx4 v47, s[24:27], s35 offen offset:3072 lds
    v_mfma_f32_16x16x32_bf16 v[252:255], a[168:171], v[80:83], v[252:255]
    s_add_u32 m0, s44, 106496
    s_add_u32 s35, s100, 184320
    v_mfma_f32_16x16x32_bf16 v[252:255], a[172:175], v[84:87], v[252:255]
    ds_read_b64_tr_b16 a[192:193], v14 offset:0
    v_mfma_f32_16x16x32_bf16 v[236:239], a[172:175], v[76:79], v[236:239]
    ds_read_b64_tr_b16 a[194:195], v14 offset:4096
    v_mfma_f32_16x16x32_bf16 v[236:239], a[168:171], v[72:75], v[236:239]
    ds_read_b64_tr_b16 a[196:197], v14 offset:8192
    s_waitcnt lgkmcnt(9)
    s_bitcmp1_b32 s50, 0
    s_cbranch_scc1 L_p3short
    v_mfma_f32_16x16x32_bf16 v[112:115], a[176:179], v[88:91], v[112:115]
    buffer_load_dwordx4 v38, s[20:23], s35 offen offset:0 sc1 lds
    v_mfma_f32_16x16x32_bf16 v[112:115], a[180:183], v[92:95], v[112:115]
    ds_read_b64_tr_b16 a[198:199], v14 offset:12288
    s_waitcnt lgkmcnt(8)
    v_mfma_f32_16x16x32_bf16 v[128:131], a[180:183], v[100:103], v[128:131]
    ds_read_b64_tr_b16 a[200:201], v14 offset:8
    v_mfma_f32_16x16x32_bf16 v[128:131], a[176:179], v[96:99], v[128:131]
    ds_read_b64_tr_b16 a[202:203], v14 offset:4104
    s_waitcnt lgkmcnt(6)
    v_mfma_f32_16x16x32_bf16 v[132:135], a[184:187], v[96:99], v[132:135]
    ds_read_b64_tr_b16 a[204:205], v14 offset:8200
    v_mfma_f32_16x16x32_bf16 v[132:135], a[188:191], v[100:103], v[132:135]
    buffer_load_dwordx4 v38, s[20:23], s35 offen offset:1024 sc1 lds
    v_mfma_f32_16x16x32_bf16 v[116:119], a[188:191], v[92:95], v[116:119]
    ds_read_b64_tr_b16 a[206:207], v14 offset:12296
    v_mfma_f32_16x16x32_bf16 v[116:119], a[184:187], v[88:91], v[116:119]
    ds_read_b128 v[104:107], v8 offset:2048
    s_waitcnt lgkmcnt(5)
    v_mfma_f32_16x16x32_bf16 v[120:123], a[192:195], v[88:91], v[120:123]
    ds_read_b128 v[108:111], v8 offset:20480
    v_mfma_f32_16x16x32_bf16 v[120:123], a[196:199], v[92:95], v[120:123]
    ds_read_b128 v[64:67], v8 offset:3072
    v_mfma_f32_16x16x32_bf16 v[136:139], a[196:199], v[100:103], v[136:139]
    buffer_load_dwordx4 v38, s[20:23], s35 offen offset:2048 sc1 lds
    v_mfma_f32_16x16x32_bf16 v[136:139], a[192:195], v[96:99], v[136:139]
    ds_read_b128 v[68:71], v8 offset:21504
    s_waitcnt lgkmcnt(4)
    v_mfma_f32_16x16x32_bf16 v[140:143], a[200:203], v[96:99], v[140:143]
    ds_read_b128 v[72:75], v8 offset:4096
    v_mfma_f32_16x16x32_bf16 v[140:143], a[204:207], v[100:103], v[140:143]
    ds_read_b128 v[76:79], v8 offset:22528
    v_mfma_f32_16x16x32_bf16 v[124:127], a[204:207], v[92:95], v[124:127]
    ds_read_b128 v[80:83], v8 offset:5120
    s_waitcnt lgkmcnt(3)
    v_mfma_f32_16x16x32_bf16 v[124:127], a[200:203], v[88:91], v[124:127]
    buffer_load_dwordx4 v38, s[20:23], s35 offen offset:3072 sc1 lds
    v_mfma_f32_16x16x32_bf16 v[144:147], a[176:179], v[104:107], v[144:147]
    s_add_u32 m0, s44, 110592
    s_add_u32 s35, s100, 188416
    v_mfma_f32_16x16x32_bf16 v[144:147], a[180:183], v[108:111], v[144:147]
    ds_read_b128 v[84:87], v8 offset:23552
    v_mfma_f32_16x16x32_bf16 v[160:163], a[180:183], v[68:71], v[160:163]
    v_mfma_f32_16x16x32_bf16 v[160:163], a[176:179], v[64:67], v[160:163]
    v_mfma_f32_16x16x32_bf16 v[164:167], a[184:187], v[64:67], v[164:167]
    buffer_load_dwordx4 v38, s[20:23], s35 offen offset:0 sc1 lds
    v_mfma_f32_16x16x32_bf16 v[164:167], a[188:191], v[68:71], v[164:167]
    v_mfma_f32_16x16x32_bf16 v[148:151], a[188:191], v[108:111], v[148:151]
    v_mfma_f32_16x16x32_bf16 v[148:151], a[184:187], v[104:107], v[148:151]
    v_mfma_f32_16x16x32_bf16 v[152:155], a[192:195], v[104:107], v[152:155]
    v_mfma_f32_16x16x32_bf16 v[152:155], a[196:199], v[108:111], v[152:155]
    buffer_load_dwordx4 v38, s[20:23], s35 offen offset:1024 sc1 lds
    v_mfma_f32_16x16x32_bf16 v[168:171], a[196:199], v[68:71], v[168:171]
    v_mfma_f32_16x16x32_bf16 v[168:171], a[192:195], v[64:67], v[168:171]
    v_mfma_f32_16x16x32_bf16 v[172:175], a[200:203], v[64:67], v[172:175]
    ds_read_b128 v[88:91], v8 offset:6144
    v_mfma_f32_16x16x32_bf16 v[172:175], a[204:207], v[68:71], v[172:175]
    ds_read_b128 v[92:95], v8 offset:24576
    v_mfma_f32_16x16x32_bf16 v[156:159], a[204:207], v[108:111], v[156:159]
    buffer_load_dwordx4 v38, s[20:23], s35 offen offset:2048 sc1 lds
    v_mfma_f32_16x16x32_bf16 v[156:159], a[200:203], v[104:107], v[156:159]
    s_waitcnt lgkmcnt(2)
    v_mfma_f32_16x16x32_bf16 v[176:179], a[176:179], v[72:75], v[176:179]
    v_mfma_f32_16x16x32_bf16 v[176:179], a[180:183], v[76:79], v[176:179]
    v_mfma_f32_16x16x32_bf16 v[192:195], a[180:183], v[84:87], v[192:195]
    v_mfma_f32_16x16x32_bf16 v[192:195], a[176:179], v[80:83], v[192:195]
    buffer_load_dwordx4 v38, s[20:23], s35 offen offset:3072 sc1 lds
    v_mfma_f32_16x16x32_bf16 v[196:199], a[184:187], v[80:83], v[196:199]
    s_add_u32 m0, s44, 114688
    s_add_u32 s35, s100, 192512
    v_mfma_f32_16x16x32_bf16 v[196:199], a[188:191], v[84:87], v[196:199]
    ds_read_b128 v[96:99], v8 offset:7168
    v_mfma_f32_16x16x32_bf16 v[180:183], a[188:191], v[76:79], v[180:183]
    ds_read_b128 v[100:103], v8 offset:25600
    v_mfma_f32_16x16x32_bf16 v[180:183], a[184:187], v[72:75], v[180:183]
    ds_read_b128 v[104:107], v8 offset:8192
    v_mfma_f32_16x16x32_bf16 v[184:187], a[192:195], v[72:75], v[184:187]
    buffer_load_dwordx4 v38, s[20:23], s35 offen offset:0 sc1 lds
    v_mfma_f32_16x16x32_bf16 v[184:187], a[196:199], v[76:79], v[184:187]
    ds_read_b128 v[108:111], v8 offset:26624
    v_mfma_f32_16x16x32_bf16 v[200:203], a[196:199], v[84:87], v[200:203]
    v_mfma_f32_16x16x32_bf16 v[200:203], a[192:195], v[80:83], v[200:203]
    v_mfma_f32_16x16x32_bf16 v[204:207], a[200:203], v[80:83], v[204:207]
    v_mfma_f32_16x16x32_bf16 v[204:207], a[204:207], v[84:87], v[204:207]
    v_mfma_f32_16x16x32_bf16 v[188:191], a[204:207], v[76:79], v[188:191]
    v_mfma_f32_16x16x32_bf16 v[188:191], a[200:203], v[72:75], v[188:191]
    s_waitcnt lgkmcnt(0)
    v_mfma_f32_16x16x32_bf16 v[208:211], a[176:179], v[88:91], v[208:211]
    v_mfma_f32_16x16x32_bf16 v[208:211], a[180:183], v[92:95], v[208:211]
    s_waitcnt lgkmcnt(15)
    s_waitcnt vmcnt(13)
    v_mfma_f32_16x16x32_bf16 v[212:215], a[188:191], v[92:95], v[212:215]
    s_barrier
    v_mfma_f32_16x16x32_bf16 v[212:215], a[184:187], v[88:91], v[212:215]
    s_add_u32 m0, s29, 36864
    s_add_u32 s35, s101, 786432
    v_mfma_f32_16x16x32_bf16 v[216:219], a[192:195], v[88:91], v[216:219]
    buffer_load_dwordx4 v44, s[24:27], s35 offen offset:0 lds
    v_mfma_f32_16x16x32_bf16 v[216:219], a[196:199], v[92:95], v[216:219]
    ds_read_b64_tr_b16 a[144:145], v12 offset:0
    v_mfma_f32_16x16x32_bf16 v[220:223], a[204:207], v[92:95], v[220:223]
    ds_read_b64_tr_b16 a[146:147], v12 offset:4096
    v_mfma_f32_16x16x32_bf16 v[220:223], a[200:203], v[88:91], v[220:223]
    ds_read_b128 v[64:67], v9 offset:0
    v_mfma_f32_16x16x32_bf16 v[224:227], a[176:179], v[96:99], v[224:227]
    ds_read_b64_tr_b16 a[148:149], v12 offset:8192
    v_mfma_f32_16x16x32_bf16 v[224:227], a[180:183], v[100:103], v[224:227]
    buffer_load_dwordx4 v45, s[24:27], s35 offen offset:1024 lds
    v_mfma_f32_16x16x32_bf16 v[240:243], a[180:183], v[108:111], v[240:243]
    ds_read_b64_tr_b16 a[150:151], v12 offset:12288
    v_mfma_f32_16x16x32_bf16 v[240:243], a[176:179], v[104:107], v[240:243]
    ds_read_b128 v[68:71], v9 offset:18432
    v_mfma_f32_16x16x32_bf16 v[244:247], a[184:187], v[104:107], v[244:247]
    ds_read_b128 v[72:75], v9 offset:1024
    v_mfma_f32_16x16x32_bf16 v[244:247], a[188:191], v[108:111], v[244:247]
    ds_read_b128 v[76:79], v9 offset:19456
    v_mfma_f32_16x16x32_bf16 v[228:231], a[188:191], v[100:103], v[228:231]
    buffer_load_dwordx4 v46, s[24:27], s35 offen offset:2048 lds
    v_mfma_f32_16x16x32_bf16 v[228:231], a[184:187], v[96:99], v[228:231]
    ds_read_b64_tr_b16 a[152:153], v12 offset:8
    v_mfma_f32_16x16x32_bf16 v[232:235], a[192:195], v[96:99], v[232:235]
    ds_read_b64_tr_b16 a[154:155], v12 offset:4104
    v_mfma_f32_16x16x32_bf16 v[232:235], a[196:199], v[100:103], v[232:235]
    ds_read_b64_tr_b16 a[156:157], v12 offset:8200
    v_mfma_f32_16x16x32_bf16 v[248:251], a[196:199], v[108:111], v[248:251]
    ds_read_b64_tr_b16 a[158:159], v12 offset:12296
    v_mfma_f32_16x16x32_bf16 v[248:251], a[192:195], v[104:107], v[248:251]
    buffer_load_dwordx4 v47, s[24:27], s35 offen offset:3072 lds
    v_mfma_f32_16x16x32_bf16 v[252:255], a[200:203], v[104:107], v[252:255]
    s_add_u32 m0, s44, 0
    s_add_u32 s35, s100, 221184
    v_mfma_f32_16x16x32_bf16 v[252:255], a[204:207], v[108:111], v[252:255]
    ds_read_b64_tr_b16 a[160:161], v15 offset:0
    v_mfma_f32_16x16x32_bf16 v[236:239], a[204:207], v[100:103], v[236:239]
    ds_read_b64_tr_b16 a[162:163], v15 offset:4096
    v_mfma_f32_16x16x32_bf16 v[236:239], a[200:203], v[96:99], v[236:239]
    ds_read_b64_tr_b16 a[164:165], v15 offset:8192
    s_waitcnt lgkmcnt(9)
    v_mfma_f32_16x16x32_bf16 v[112:115], a[144:147], v[64:67], v[112:115]
    buffer_load_dwordx4 v38, s[20:23], s35 offen offset:0 sc1 lds
    v_mfma_f32_16x16x32_bf16 v[112:115], a[148:151], v[68:71], v[112:115]
    ds_read_b64_tr_b16 a[166:167], v15 offset:12288
    s_waitcnt lgkmcnt(8)
    v_mfma_f32_16x16x32_bf16 v[128:131], a[148:151], v[76:79], v[128:131]
    ds_read_b64_tr_b16 a[168:169], v15 offset:8
    v_mfma_f32_16x16x32_bf16 v[128:131], a[144:147], v[72:75], v[128:131]
    ds_read_b64_tr_b16 a[170:171], v15 offset:4104
    s_waitcnt lgkmcnt(6)
    v_mfma_f32_16x16x32_bf16 v[132:135], a[152:155], v[72:75], v[132:135]
    ds_read_b64_tr_b16 a[172:173], v15 offset:8200
    v_mfma_f32_16x16x32_bf16 v[132:135], a[156:159], v[76:79], v[132:135]
    buffer_load_dwordx4 v38, s[20:23], s35 offen offset:1024 sc1 lds
    v_mfma_f32_16x16x32_bf16 v[116:119], a[156:159], v[68:71], v[116:119]
    ds_read_b64_tr_b16 a[174:175], v15 offset:12296
    v_mfma_f32_16x16x32_bf16 v[116:119], a[152:155], v[64:67], v[116:119]
    ds_read_b128 v[80:83], v9 offset:2048
    s_waitcnt lgkmcnt(5)
    v_mfma_f32_16x16x32_bf16 v[120:123], a[160:163], v[64:67], v[120:123]
    ds_read_b128 v[84:87], v9 offset:20480
    v_mfma_f32_16x16x32_bf16 v[120:123], a[164:167], v[68:71], v[120:123]
    ds_read_b128 v[88:91], v9 offset:3072
    v_mfma_f32_16x16x32_bf16 v[136:139], a[164:167], v[76:79], v[136:139]
    buffer_load_dwordx4 v38, s[20:23], s35 offen offset:2048 sc1 lds
    v_mfma_f32_16x16x32_bf16 v[136:139], a[160:163], v[72:75], v[136:139]
    ds_read_b128 v[92:95], v9 offset:21504
    s_waitcnt lgkmcnt(4)
    v_mfma_f32_16x16x32_bf16 v[140:143], a[168:171], v[72:75], v[140:143]
    ds_read_b128 v[96:99], v9 offset:4096
    v_mfma_f32_16x16x32_bf16 v[140:143], a[172:175], v[76:79], v[140:143]
    ds_read_b128 v[100:103], v9 offset:22528
    v_mfma_f32_16x16x32_bf16 v[124:127], a[172:175], v[68:71], v[124:127]
    ds_read_b128 v[104:107], v9 offset:5120
    s_waitcnt lgkmcnt(3)
    v_mfma_f32_16x16x32_bf16 v[124:127], a[168:171], v[64:67], v[124:127]
    buffer_load_dwordx4 v38, s[20:23], s35 offen offset:3072 sc1 lds
    v_mfma_f32_16x16x32_bf16 v[144:147], a[144:147], v[80:83], v[144:147]
    s_add_u32 m0, s44, 4096
    s_add_u32 s35, s100, 225280
    v_mfma_f32_16x16x32_bf16 v[144:147], a[148:151], v[84:87], v[144:147]
    ds_read_b128 v[108:111], v9 offset:23552
    v_mfma_f32_16x16x32_bf16 v[160:163], a[148:151], v[92:95], v[160:163]
    v_mfma_f32_16x16x32_bf16 v[160:163], a[144:147], v[88:91], v[160:163]
    v_mfma_f32_16x16x32_bf16 v[164:167], a[152:155], v[88:91], v[164:167]
    buffer_load_dwordx4 v38, s[20:23], s35 offen offset:0 sc1 lds
    v_mfma_f32_16x16x32_bf16 v[164:167], a[156:159], v[92:95], v[164:167]
    v_mfma_f32_16x16x32_bf16 v[148:151], a[156:159], v[84:87], v[148:151]
    v_mfma_f32_16x16x32_bf16 v[148:151], a[152:155], v[80:83], v[148:151]
    v_mfma_f32_16x16x32_bf16 v[152:155], a[160:163], v[80:83], v[152:155]
    v_mfma_f32_16x16x32_bf16 v[152:155], a[164:167], v[84:87], v[152:155]
    buffer_load_dwordx4 v38, s[20:23], s35 offen offset:1024 sc1 lds
    v_mfma_f32_16x16x32_bf16 v[168:171], a[164:167], v[92:95], v[168:171]
    v_mfma_f32_16x16x32_bf16 v[168:171], a[160:163], v[88:91], v[168:171]
    v_mfma_f32_16x16x32_bf16 v[172:175], a[168:171], v[88:91], v[172:175]
    ds_read_b128 v[64:67], v9 offset:6144
    v_mfma_f32_16x16x32_bf16 v[172:175], a[172:175], v[92:95], v[172:175]
    ds_read_b128 v[68:71], v9 offset:24576
    v_mfma_f32_16x16x32_bf16 v[156:159], a[172:175], v[84:87], v[156:159]
    buffer_load_dwordx4 v38, s[20:23], s35 offen offset:2048 sc1 lds
    v_mfma_f32_16x16x32_bf16 v[156:159], a[168:171], v[80:83], v[156:159]
    s_waitcnt lgkmcnt(2)
    v_mfma_f32_16x16x32_bf16 v[176:179], a[144:147], v[96:99], v[176:179]
    v_mfma_f32_16x16x32_bf16 v[176:179], a[148:151], v[100:103], v[176:179]
    v_mfma_f32_16x16x32_bf16 v[192:195], a[148:151], v[108:111], v[192:195]
    v_mfma_f32_16x16x32_bf16 v[192:195], a[144:147], v[104:107], v[192:195]
    buffer_load_dwordx4 v38, s[20:23], s35 offen offset:3072 sc1 lds
    v_mfma_f32_16x16x32_bf16 v[196:199], a[152:155], v[104:107], v[196:199]
    s_add_u32 m0, s44, 8192
    s_add_u32 s35, s100, 229376
    v_mfma_f32_16x16x32_bf16 v[196:199], a[156:159], v[108:111], v[196:199]
    ds_read_b128 v[72:75], v9 offset:7168
    v_mfma_f32_16x16x32_bf16 v[180:183], a[156:159], v[100:103], v[180:183]
    ds_read_b128 v[76:79], v9 offset:25600
    v_mfma_f32_16x16x32_bf16 v[180:183], a[152:155], v[96:99], v[180:183]
    ds_read_b128 v[80:83], v9 offset:8192
    v_mfma_f32_16x16x32_bf16 v[184:187], a[160:163], v[96:99], v[184:187]
    buffer_load_dwordx4 v38, s[20:23], s35 offen offset:0 sc1 lds
    v_mfma_f32_16x16x32_bf16 v[184:187], a[164:167], v[100:103], v[184:187]
    ds_read_b128 v[84:87], v9 offset:26624
    v_mfma_f32_16x16x32_bf16 v[200:203], a[164:167], v[108:111], v[200:203]
    v_mfma_f32_16x16x32_bf16 v[200:203], a[160:163], v[104:107], v[200:203]
    v_mfma_f32_16x16x32_bf16 v[204:207], a[168:171], v[104:107], v[204:207]
    v_mfma_f32_16x16x32_bf16 v[204:207], a[172:175], v[108:111], v[204:207]
    v_mfma_f32_16x16x32_bf16 v[188:191], a[172:175], v[100:103], v[188:191]
    v_mfma_f32_16x16x32_bf16 v[188:191], a[168:171], v[96:99], v[188:191]
    s_waitcnt lgkmcnt(0)
    v_mfma_f32_16x16x32_bf16 v[208:211], a[144:147], v[64:67], v[208:211]
    v_mfma_f32_16x16x32_bf16 v[208:211], a[148:151], v[68:71], v[208:211]
    s_waitcnt lgkmcnt(15)
    s_waitcnt vmcnt(13)
    v_mfma_f32_16x16x32_bf16 v[212:215], a[156:159], v[68:71], v[212:215]
    s_barrier
    v_mfma_f32_16x16x32_bf16 v[212:215], a[152:155], v[64:67], v[212:215]
    s_add_u32 m0, s29, 90112
    s_add_u32 s35, s101, 851968
    v_mfma_f32_16x16x32_bf16 v[216:219], a[160:163], v[64:67], v[216:219]
    buffer_load_dwordx4 v44, s[24:27], s35 offen offset:0 lds
    v_mfma_f32_16x16x32_bf16 v[216:219], a[164:167], v[68:71], v[216:219]
    ds_read_b64_tr_b16 a[176:177], v13 offset:0
    v_mfma_f32_16x16x32_bf16 v[220:223], a[172:175], v[68:71], v[220:223]
    ds_read_b64_tr_b16 a[178:179], v13 offset:4096
    v_mfma_f32_16x16x32_bf16 v[220:223], a[168:171], v[64:67], v[220:223]
    ds_read_b128 v[88:91], v10 offset:0
    v_mfma_f32_16x16x32_bf16 v[224:227], a[144:147], v[72:75], v[224:227]
    ds_read_b64_tr_b16 a[180:181], v13 offset:8192
    v_mfma_f32_16x16x32_bf16 v[224:227], a[148:151], v[76:79], v[224:227]
    buffer_load_dwordx4 v45, s[24:27], s35 offen offset:1024 lds
    v_mfma_f32_16x16x32_bf16 v[240:243], a[148:151], v[84:87], v[240:243]
    ds_read_b64_tr_b16 a[182:183], v13 offset:12288
    v_mfma_f32_16x16x32_bf16 v[240:243], a[144:147], v[80:83], v[240:243]
    ds_read_b128 v[92:95], v10 offset:18432
    v_mfma_f32_16x16x32_bf16 v[244:247], a[152:155], v[80:83], v[244:247]
    ds_read_b128 v[96:99], v10 offset:1024
    v_mfma_f32_16x16x32_bf16 v[244:247], a[156:159], v[84:87], v[244:247]
    ds_read_b128 v[100:103], v10 offset:19456
    v_mfma_f32_16x16x32_bf16 v[228:231], a[156:159], v[76:79], v[228:231]
    buffer_load_dwordx4 v46, s[24:27], s35 offen offset:2048 lds
    v_mfma_f32_16x16x32_bf16 v[228:231], a[152:155], v[72:75], v[228:231]
    ds_read_b64_tr_b16 a[184:185], v13 offset:8
    v_mfma_f32_16x16x32_bf16 v[232:235], a[160:163], v[72:75], v[232:235]
    ds_read_b64_tr_b16 a[186:187], v13 offset:4104
    v_mfma_f32_16x16x32_bf16 v[232:235], a[164:167], v[76:79], v[232:235]
    ds_read_b64_tr_b16 a[188:189], v13 offset:8200
    v_mfma_f32_16x16x32_bf16 v[248:251], a[164:167], v[84:87], v[248:251]
    ds_read_b64_tr_b16 a[190:191], v13 offset:12296
    v_mfma_f32_16x16x32_bf16 v[248:251], a[160:163], v[80:83], v[248:251]
    buffer_load_dwordx4 v47, s[24:27], s35 offen offset:3072 lds
    v_mfma_f32_16x16x32_bf16 v[252:255], a[168:171], v[80:83], v[252:255]
    s_add_u32 m0, s44, 53248
    s_add_u32 s35, s100, 258048
    v_mfma_f32_16x16x32_bf16 v[252:255], a[172:175], v[84:87], v[252:255]
    ds_read_b64_tr_b16 a[192:193], v16 offset:0
    v_mfma_f32_16x16x32_bf16 v[236:239], a[172:175], v[76:79], v[236:239]
    ds_read_b64_tr_b16 a[194:195], v16 offset:4096
    v_mfma_f32_16x16x32_bf16 v[236:239], a[168:171], v[72:75], v[236:239]
    ds_read_b64_tr_b16 a[196:197], v16 offset:8192
    s_waitcnt lgkmcnt(9)
    v_mfma_f32_16x16x32_bf16 v[112:115], a[176:179], v[88:91], v[112:115]
    buffer_load_dwordx4 v38, s[20:23], s35 offen offset:0 sc1 lds
    v_mfma_f32_16x16x32_bf16 v[112:115], a[180:183], v[92:95], v[112:115]
    ds_read_b64_tr_b16 a[198:199], v16 offset:12288
    s_waitcnt lgkmcnt(8)
    v_mfma_f32_16x16x32_bf16 v[128:131], a[180:183], v[100:103], v[128:131]
    ds_read_b64_tr_b16 a[200:201], v16 offset:8
    v_mfma_f32_16x16x32_bf16 v[128:131], a[176:179], v[96:99], v[128:131]
    ds_read_b64_tr_b16 a[202:203], v16 offset:4104
    s_waitcnt lgkmcnt(6)
    v_mfma_f32_16x16x32_bf16 v[132:135], a[184:187], v[96:99], v[132:135]
    ds_read_b64_tr_b16 a[204:205], v16 offset:8200
    v_mfma_f32_16x16x32_bf16 v[132:135], a[188:191], v[100:103], v[132:135]
    buffer_load_dwordx4 v38, s[20:23], s35 offen offset:1024 sc1 lds
    v_mfma_f32_16x16x32_bf16 v[116:119], a[188:191], v[92:95], v[116:119]
    ds_read_b64_tr_b16 a[206:207], v16 offset:12296
    v_mfma_f32_16x16x32_bf16 v[116:119], a[184:187], v[88:91], v[116:119]
    ds_read_b128 v[104:107], v10 offset:2048
    s_waitcnt lgkmcnt(5)
    v_mfma_f32_16x16x32_bf16 v[120:123], a[192:195], v[88:91], v[120:123]
    ds_read_b128 v[108:111], v10 offset:20480
    v_mfma_f32_16x16x32_bf16 v[120:123], a[196:199], v[92:95], v[120:123]
    ds_read_b128 v[64:67], v10 offset:3072
    v_mfma_f32_16x16x32_bf16 v[136:139], a[196:199], v[100:103], v[136:139]
    buffer_load_dwordx4 v38, s[20:23], s35 offen offset:2048 sc1 lds
    v_mfma_f32_16x16x32_bf16 v[136:139], a[192:195], v[96:99], v[136:139]
    ds_read_b128 v[68:71], v10 offset:21504
    s_waitcnt lgkmcnt(4)
    v_mfma_f32_16x16x32_bf16 v[140:143], a[200:203], v[96:99], v[140:143]
    ds_read_b128 v[72:75], v10 offset:4096
    v_mfma_f32_16x16x32_bf16 v[140:143], a[204:207], v[100:103], v[140:143]
    ds_read_b128 v[76:79], v10 offset:22528
    v_mfma_f32_16x16x32_bf16 v[124:127], a[204:207], v[92:95], v[124:127]
    ds_read_b128 v[80:83], v10 offset:5120
    s_waitcnt lgkmcnt(3)
    v_mfma_f32_16x16x32_bf16 v[124:127], a[200:203], v[88:91], v[124:127]
    buffer_load_dwordx4 v38, s[20:23], s35 offen offset:3072 sc1 lds
    v_mfma_f32_16x16x32_bf16 v[144:147], a[176:179], v[104:107], v[144:147]
    s_add_u32 m0, s44, 57344
    s_add_u32 s35, s100, 262144
    v_mfma_f32_16x16x32_bf16 v[144:147], a[180:183], v[108:111], v[144:147]
    ds_read_b128 v[84:87], v10 offset:23552
    v_mfma_f32_16x16x32_bf16 v[160:163], a[180:183], v[68:71], v[160:163]
    v_mfma_f32_16x16x32_bf16 v[160:163], a[176:179], v[64:67], v[160:163]
    v_mfma_f32_16x16x32_bf16 v[164:167], a[184:187], v[64:67], v[164:167]
    buffer_load_dwordx4 v38, s[20:23], s35 offen offset:0 sc1 lds
    v_mfma_f32_16x16x32_bf16 v[164:167], a[188:191], v[68:71], v[164:167]
    v_mfma_f32_16x16x32_bf16 v[148:151], a[188:191], v[108:111], v[148:151]
    v_mfma_f32_16x16x32_bf16 v[148:151], a[184:187], v[104:107], v[148:151]
    v_mfma_f32_16x16x32_bf16 v[152:155], a[192:195], v[104:107], v[152:155]
    v_mfma_f32_16x16x32_bf16 v[152:155], a[196:199], v[108:111], v[152:155]
    buffer_load_dwordx4 v38, s[20:23], s35 offen offset:1024 sc1 lds
    v_mfma_f32_16x16x32_bf16 v[168:171], a[196:199], v[68:71], v[168:171]
    v_mfma_f32_16x16x32_bf16 v[168:171], a[192:195], v[64:67], v[168:171]
    v_mfma_f32_16x16x32_bf16 v[172:175], a[200:203], v[64:67], v[172:175]
    ds_read_b128 v[88:91], v10 offset:6144
    v_mfma_f32_16x16x32_bf16 v[172:175], a[204:207], v[68:71], v[172:175]
    ds_read_b128 v[92:95], v10 offset:24576
    v_mfma_f32_16x16x32_bf16 v[156:159], a[204:207], v[108:111], v[156:159]
    buffer_load_dwordx4 v38, s[20:23], s35 offen offset:2048 sc1 lds
    v_mfma_f32_16x16x32_bf16 v[156:159], a[200:203], v[104:107], v[156:159]
    s_waitcnt lgkmcnt(2)
    v_mfma_f32_16x16x32_bf16 v[176:179], a[176:179], v[72:75], v[176:179]
    v_mfma_f32_16x16x32_bf16 v[176:179], a[180:183], v[76:79], v[176:179]
    v_mfma_f32_16x16x32_bf16 v[192:195], a[180:183], v[84:87], v[192:195]
    v_mfma_f32_16x16x32_bf16 v[192:195], a[176:179], v[80:83], v[192:195]
    buffer_load_dwordx4 v38, s[20:23], s35 offen offset:3072 sc1 lds
    v_mfma_f32_16x16x32_bf16 v[196:199], a[184:187], v[80:83], v[196:199]
    s_add_u32 m0, s44, 61440
    s_add_u32 s35, s100, 266240
    v_mfma_f32_16x16x32_bf16 v[196:199], a[188:191], v[84:87], v[196:199]
    ds_read_b128 v[96:99], v10 offset:7168
    v_mfma_f32_16x16x32_bf16 v[180:183], a[188:191], v[76:79], v[180:183]
    ds_read_b128 v[100:103], v10 offset:25600
    v_mfma_f32_16x16x32_bf16 v[180:183], a[184:187], v[72:75], v[180:183]
    ds_read_b128 v[104:107], v10 offset:8192
    v_mfma_f32_16x16x32_bf16 v[184:187], a[192:195], v[72:75], v[184:187]
    buffer_load_dwordx4 v38, s[20:23], s35 offen offset:0 sc1 lds
    v_mfma_f32_16x16x32_bf16 v[184:187], a[196:199], v[76:79], v[184:187]
    ds_read_b128 v[108:111], v10 offset:26624
    v_mfma_f32_16x16x32_bf16 v[200:203], a[196:199], v[84:87], v[200:203]
    v_mfma_f32_16x16x32_bf16 v[200:203], a[192:195], v[80:83], v[200:203]
    v_mfma_f32_16x16x32_bf16 v[204:207], a[200:203], v[80:83], v[204:207]
    v_mfma_f32_16x16x32_bf16 v[204:207], a[204:207], v[84:87], v[204:207]
    v_mfma_f32_16x16x32_bf16 v[188:191], a[204:207], v[76:79], v[188:191]
    v_mfma_f32_16x16x32_bf16 v[188:191], a[200:203], v[72:75], v[188:191]
    s_waitcnt lgkmcnt(0)
    v_mfma_f32_16x16x32_bf16 v[208:211], a[176:179], v[88:91], v[208:211]
    v_mfma_f32_16x16x32_bf16 v[208:211], a[180:183], v[92:95], v[208:211]
    s_waitcnt lgkmcnt(15)
    s_waitcnt vmcnt(13)
    v_mfma_f32_16x16x32_bf16 v[212:215], a[188:191], v[92:95], v[212:215]
    s_barrier
    v_mfma_f32_16x16x32_bf16 v[212:215], a[184:187], v[88:91], v[212:215]
    s_add_u32 m0, s29, 143360
    s_add_u32 s35, s101, 1835008
    v_mfma_f32_16x16x32_bf16 v[216:219], a[192:195], v[88:91], v[216:219]
    buffer_load_dwordx4 v44, s[24:27], s35 offen offset:0 lds
    v_mfma_f32_16x16x32_bf16 v[216:219], a[196:199], v[92:95], v[216:219]
    ds_read_b64_tr_b16 a[144:145], v11 offset:0
    v_mfma_f32_16x16x32_bf16 v[220:223], a[204:207], v[92:95], v[220:223]
    ds_read_b64_tr_b16 a[146:147], v11 offset:4096
    v_mfma_f32_16x16x32_bf16 v[220:223], a[200:203], v[88:91], v[220:223]
    ds_read_b128 v[64:67], v8 offset:0
    v_mfma_f32_16x16x32_bf16 v[224:227], a[176:179], v[96:99], v[224:227]
    ds_read_b64_tr_b16 a[148:149], v11 offset:8192
    v_mfma_f32_16x16x32_bf16 v[224:227], a[180:183], v[100:103], v[224:227]
    buffer_load_dwordx4 v45, s[24:27], s35 offen offset:1024 lds
    v_mfma_f32_16x16x32_bf16 v[240:243], a[180:183], v[108:111], v[240:243]
    ds_read_b64_tr_b16 a[150:151], v11 offset:12288
    v_mfma_f32_16x16x32_bf16 v[240:243], a[176:179], v[104:107], v[240:243]
    ds_read_b128 v[68:71], v8 offset:18432
    v_mfma_f32_16x16x32_bf16 v[244:247], a[184:187], v[104:107], v[244:247]
    ds_read_b128 v[72:75], v8 offset:1024
    v_mfma_f32_16x16x32_bf16 v[244:247], a[188:191], v[108:111], v[244:247]
    ds_read_b128 v[76:79], v8 offset:19456
    v_mfma_f32_16x16x32_bf16 v[228:231], a[188:191], v[100:103], v[228:231]
    buffer_load_dwordx4 v46, s[24:27], s35 offen offset:2048 lds
    v_mfma_f32_16x16x32_bf16 v[228:231], a[184:187], v[96:99], v[228:231]
    ds_read_b64_tr_b16 a[152:153], v11 offset:8
    v_mfma_f32_16x16x32_bf16 v[232:235], a[192:195], v[96:99], v[232:235]
    ds_read_b64_tr_b16 a[154:155], v11 offset:4104
    v_mfma_f32_16x16x32_bf16 v[232:235], a[196:199], v[100:103], v[232:235]
    ds_read_b64_tr_b16 a[156:157], v11 offset:8200
    v_mfma_f32_16x16x32_bf16 v[248:251], a[196:199], v[108:111], v[248:251]
    ds_read_b64_tr_b16 a[158:159], v11 offset:12296
    v_mfma_f32_16x16x32_bf16 v[248:251], a[192:195], v[104:107], v[248:251]
    buffer_load_dwordx4 v47, s[24:27], s35 offen offset:3072 lds
    v_mfma_f32_16x16x32_bf16 v[252:255], a[200:203], v[104:107], v[252:255]
    s_add_u32 m0, s44, 106496
    s_add_u32 s35, s100, 516096
    v_mfma_f32_16x16x32_bf16 v[252:255], a[204:207], v[108:111], v[252:255]
    ds_read_b64_tr_b16 a[160:161], v14 offset:0
    v_mfma_f32_16x16x32_bf16 v[236:239], a[204:207], v[100:103], v[236:239]
    ds_read_b64_tr_b16 a[162:163], v14 offset:4096
    v_mfma_f32_16x16x32_bf16 v[236:239], a[200:203], v[96:99], v[236:239]
    ds_read_b64_tr_b16 a[164:165], v14 offset:8192
    s_waitcnt lgkmcnt(9)
    v_mfma_f32_16x16x32_bf16 v[112:115], a[144:147], v[64:67], v[112:115]
    buffer_load_dwordx4 v38, s[20:23], s35 offen offset:0 sc1 lds
    v_mfma_f32_16x16x32_bf16 v[112:115], a[148:151], v[68:71], v[112:115]
    ds_read_b64_tr_b16 a[166:167], v14 offset:12288
    s_waitcnt lgkmcnt(8)
    v_mfma_f32_16x16x32_bf16 v[128:131], a[148:151], v[76:79], v[128:131]
    ds_read_b64_tr_b16 a[168:169], v14 offset:8
    v_mfma_f32_16x16x32_bf16 v[128:131], a[144:147], v[72:75], v[128:131]
    ds_read_b64_tr_b16 a[170:171], v14 offset:4104
    s_waitcnt lgkmcnt(6)
    v_mfma_f32_16x16x32_bf16 v[132:135], a[152:155], v[72:75], v[132:135]
    ds_read_b64_tr_b16 a[172:173], v14 offset:8200
    v_mfma_f32_16x16x32_bf16 v[132:135], a[156:159], v[76:79], v[132:135]
    buffer_load_dwordx4 v38, s[20:23], s35 offen offset:1024 sc1 lds
    v_mfma_f32_16x16x32_bf16 v[116:119], a[156:159], v[68:71], v[116:119]
    ds_read_b64_tr_b16 a[174:175], v14 offset:12296
    v_mfma_f32_16x16x32_bf16 v[116:119], a[152:155], v[64:67], v[116:119]
    ds_read_b128 v[80:83], v8 offset:2048
    s_waitcnt lgkmcnt(5)
    v_mfma_f32_16x16x32_bf16 v[120:123], a[160:163], v[64:67], v[120:123]
    ds_read_b128 v[84:87], v8 offset:20480
    v_mfma_f32_16x16x32_bf16 v[120:123], a[164:167], v[68:71], v[120:123]
    ds_read_b128 v[88:91], v8 offset:3072
    v_mfma_f32_16x16x32_bf16 v[136:139], a[164:167], v[76:79], v[136:139]
    buffer_load_dwordx4 v38, s[20:23], s35 offen offset:2048 sc1 lds
    v_mfma_f32_16x16x32_bf16 v[136:139], a[160:163], v[72:75], v[136:139]
    ds_read_b128 v[92:95], v8 offset:21504
    s_waitcnt lgkmcnt(4)
    v_mfma_f32_16x16x32_bf16 v[140:143], a[168:171], v[72:75], v[140:143]
    ds_read_b128 v[96:99], v8 offset:4096
    v_mfma_f32_16x16x32_bf16 v[140:143], a[172:175], v[76:79], v[140:143]
    ds_read_b128 v[100:103], v8 offset:22528
    v_mfma_f32_16x16x32_bf16 v[124:127], a[172:175], v[68:71], v[124:127]
    ds_read_b128 v[104:107], v8 offset:5120
    s_waitcnt lgkmcnt(3)
    v_mfma_f32_16x16x32_bf16 v[124:127], a[168:171], v[64:67], v[124:127]
    buffer_load_dwordx4 v38, s[20:23], s35 offen offset:3072 sc1 lds
    v_mfma_f32_16x16x32_bf16 v[144:147], a[144:147], v[80:83], v[144:147]
    s_add_u32 m0, s44, 110592
    s_add_u32 s35, s100, 520192
    v_mfma_f32_16x16x32_bf16 v[144:147], a[148:151], v[84:87], v[144:147]
    ds_read_b128 v[108:111], v8 offset:23552
    v_mfma_f32_16x16x32_bf16 v[160:163], a[148:151], v[92:95], v[160:163]
    v_mfma_f32_16x16x32_bf16 v[160:163], a[144:147], v[88:91], v[160:163]
    v_mfma_f32_16x16x32_bf16 v[164:167], a[152:155], v[88:91], v[164:167]
    buffer_load_dwordx4 v38, s[20:23], s35 offen offset:0 sc1 lds
    v_mfma_f32_16x16x32_bf16 v[164:167], a[156:159], v[92:95], v[164:167]
    v_mfma_f32_16x16x32_bf16 v[148:151], a[156:159], v[84:87], v[148:151]
    v_mfma_f32_16x16x32_bf16 v[148:151], a[152:155], v[80:83], v[148:151]
    v_mfma_f32_16x16x32_bf16 v[152:155], a[160:163], v[80:83], v[152:155]
    v_mfma_f32_16x16x32_bf16 v[152:155], a[164:167], v[84:87], v[152:155]
    buffer_load_dwordx4 v38, s[20:23], s35 offen offset:1024 sc1 lds
    v_mfma_f32_16x16x32_bf16 v[168:171], a[164:167], v[92:95], v[168:171]
    v_mfma_f32_16x16x32_bf16 v[168:171], a[160:163], v[88:91], v[168:171]
    v_mfma_f32_16x16x32_bf16 v[172:175], a[168:171], v[88:91], v[172:175]
    ds_read_b128 v[64:67], v8 offset:6144
    v_mfma_f32_16x16x32_bf16 v[172:175], a[172:175], v[92:95], v[172:175]
    ds_read_b128 v[68:71], v8 offset:24576
    v_mfma_f32_16x16x32_bf16 v[156:159], a[172:175], v[84:87], v[156:159]
    buffer_load_dwordx4 v38, s[20:23], s35 offen offset:2048 sc1 lds
    v_mfma_f32_16x16x32_bf16 v[156:159], a[168:171], v[80:83], v[156:159]
    s_waitcnt lgkmcnt(2)
    v_mfma_f32_16x16x32_bf16 v[176:179], a[144:147], v[96:99], v[176:179]
    v_mfma_f32_16x16x32_bf16 v[176:179], a[148:151], v[100:103], v[176:179]
    v_mfma_f32_16x16x32_bf16 v[192:195], a[148:151], v[108:111], v[192:195]
    v_mfma_f32_16x16x32_bf16 v[192:195], a[144:147], v[104:107], v[192:195]
    buffer_load_dwordx4 v38, s[20:23], s35 offen offset:3072 sc1 lds
    v_mfma_f32_16x16x32_bf16 v[196:199], a[152:155], v[104:107], v[196:199]
    s_add_u32 m0, s44, 114688
    s_add_u32 s35, s100, 524288
    v_mfma_f32_16x16x32_bf16 v[196:199], a[156:159], v[108:111], v[196:199]
    ds_read_b128 v[72:75], v8 offset:7168
    v_mfma_f32_16x16x32_bf16 v[180:183], a[156:159], v[100:103], v[180:183]
    ds_read_b128 v[76:79], v8 offset:25600
    v_mfma_f32_16x16x32_bf16 v[180:183], a[152:155], v[96:99], v[180:183]
    ds_read_b128 v[80:83], v8 offset:8192
    v_mfma_f32_16x16x32_bf16 v[184:187], a[160:163], v[96:99], v[184:187]
    buffer_load_dwordx4 v38, s[20:23], s35 offen offset:0 sc1 lds
    v_mfma_f32_16x16x32_bf16 v[184:187], a[164:167], v[100:103], v[184:187]
    ds_read_b128 v[84:87], v8 offset:26624
    v_mfma_f32_16x16x32_bf16 v[200:203], a[164:167], v[108:111], v[200:203]
    v_mfma_f32_16x16x32_bf16 v[200:203], a[160:163], v[104:107], v[200:203]
    v_mfma_f32_16x16x32_bf16 v[204:207], a[168:171], v[104:107], v[204:207]
    v_mfma_f32_16x16x32_bf16 v[204:207], a[172:175], v[108:111], v[204:207]
    v_mfma_f32_16x16x32_bf16 v[188:191], a[172:175], v[100:103], v[188:191]
    buffer_load_dword v30, v33, s[96:99], s91 offen sc1
    v_mfma_f32_16x16x32_bf16 v[188:191], a[168:171], v[96:99], v[188:191]
    s_waitcnt lgkmcnt(0)
    v_mfma_f32_16x16x32_bf16 v[208:211], a[144:147], v[64:67], v[208:211]
    v_mfma_f32_16x16x32_bf16 v[208:211], a[148:151], v[68:71], v[208:211]
    s_waitcnt lgkmcnt(15)
    s_waitcnt vmcnt(14)
    v_mfma_f32_16x16x32_bf16 v[212:215], a[156:159], v[68:71], v[212:215]
    s_barrier
    v_mfma_f32_16x16x32_bf16 v[212:215], a[152:155], v[64:67], v[212:215]
    s_add_u32 m0, s29, 36864
    s_add_u32 s35, s101, 1900544
    v_mfma_f32_16x16x32_bf16 v[216:219], a[160:163], v[64:67], v[216:219]
    buffer_load_dwordx4 v44, s[24:27], s35 offen offset:0 lds
    v_mfma_f32_16x16x32_bf16 v[216:219], a[164:167], v[68:71], v[216:219]
    ds_read_b64_tr_b16 a[176:177], v12 offset:0
    v_mfma_f32_16x16x32_bf16 v[220:223], a[172:175], v[68:71], v[220:223]
    ds_read_b64_tr_b16 a[178:179], v12 offset:4096
    v_mfma_f32_16x16x32_bf16 v[220:223], a[168:171], v[64:67], v[220:223]
    ds_read_b128 v[88:91], v9 offset:0
    v_mfma_f32_16x16x32_bf16 v[224:227], a[144:147], v[72:75], v[224:227]
    ds_read_b64_tr_b16 a[180:181], v12 offset:8192
    v_mfma_f32_16x16x32_bf16 v[224:227], a[148:151], v[76:79], v[224:227]
    buffer_load_dwordx4 v45, s[24:27], s35 offen offset:1024 lds
    v_mfma_f32_16x16x32_bf16 v[240:243], a[148:151], v[84:87], v[240:243]
    ds_read_b64_tr_b16 a[182:183], v12 offset:12288
    v_mfma_f32_16x16x32_bf16 v[240:243], a[144:147], v[80:83], v[240:243]
    ds_read_b128 v[92:95], v9 offset:18432
    v_mfma_f32_16x16x32_bf16 v[244:247], a[152:155], v[80:83], v[244:247]
    ds_read_b128 v[96:99], v9 offset:1024
    v_mfma_f32_16x16x32_bf16 v[244:247], a[156:159], v[84:87], v[244:247]
    ds_read_b128 v[100:103], v9 offset:19456
    v_mfma_f32_16x16x32_bf16 v[228:231], a[156:159], v[76:79], v[228:231]
    buffer_load_dwordx4 v46, s[24:27], s35 offen offset:2048 lds
    v_mfma_f32_16x16x32_bf16 v[228:231], a[152:155], v[72:75], v[228:231]
    ds_read_b64_tr_b16 a[184:185], v12 offset:8
    v_mfma_f32_16x16x32_bf16 v[232:235], a[160:163], v[72:75], v[232:235]
    ds_read_b64_tr_b16 a[186:187], v12 offset:4104
    v_mfma_f32_16x16x32_bf16 v[232:235], a[164:167], v[76:79], v[232:235]
    ds_read_b64_tr_b16 a[188:189], v12 offset:8200
    v_mfma_f32_16x16x32_bf16 v[248:251], a[164:167], v[84:87], v[248:251]
    ds_read_b64_tr_b16 a[190:191], v12 offset:12296
    v_mfma_f32_16x16x32_bf16 v[248:251], a[160:163], v[80:83], v[248:251]
    buffer_load_dwordx4 v47, s[24:27], s35 offen offset:3072 lds
    v_mfma_f32_16x16x32_bf16 v[252:255], a[168:171], v[80:83], v[252:255]
    s_add_u32 m0, s44, 0
    s_add_u32 s35, s100, 552960
    v_mfma_f32_16x16x32_bf16 v[252:255], a[172:175], v[84:87], v[252:255]
    ds_read_b64_tr_b16 a[192:193], v15 offset:0
    v_mfma_f32_16x16x32_bf16 v[236:239], a[172:175], v[76:79], v[236:239]
    ds_read_b64_tr_b16 a[194:195], v15 offset:4096
    v_mfma_f32_16x16x32_bf16 v[236:239], a[168:171], v[72:75], v[236:239]
    ds_read_b64_tr_b16 a[196:197], v15 offset:8192
    s_waitcnt lgkmcnt(9)
    v_mfma_f32_16x16x32_bf16 v[112:115], a[176:179], v[88:91], v[112:115]
    buffer_load_dwordx4 v38, s[20:23], s35 offen offset:0 sc1 lds
    v_mfma_f32_16x16x32_bf16 v[112:115], a[180:183], v[92:95], v[112:115]
    ds_read_b64_tr_b16 a[198:199], v15 offset:12288
    s_waitcnt lgkmcnt(8)
    v_mfma_f32_16x16x32_bf16 v[128:131], a[180:183], v[100:103], v[128:131]
    ds_read_b64_tr_b16 a[200:201], v15 offset:8
    v_mfma_f32_16x16x32_bf16 v[128:131], a[176:179], v[96:99], v[128:131]
    ds_read_b64_tr_b16 a[202:203], v15 offset:4104
    s_waitcnt lgkmcnt(6)
    v_mfma_f32_16x16x32_bf16 v[132:135], a[184:187], v[96:99], v[132:135]
    ds_read_b64_tr_b16 a[204:205], v15 offset:8200
    v_mfma_f32_16x16x32_bf16 v[132:135], a[188:191], v[100:103], v[132:135]
    buffer_load_dwordx4 v38, s[20:23], s35 offen offset:1024 sc1 lds
    v_mfma_f32_16x16x32_bf16 v[116:119], a[188:191], v[92:95], v[116:119]
    ds_read_b64_tr_b16 a[206:207], v15 offset:12296
    v_mfma_f32_16x16x32_bf16 v[116:119], a[184:187], v[88:91], v[116:119]
    ds_read_b128 v[104:107], v9 offset:2048
    s_waitcnt lgkmcnt(5)
    v_mfma_f32_16x16x32_bf16 v[120:123], a[192:195], v[88:91], v[120:123]
    ds_read_b128 v[108:111], v9 offset:20480
    v_mfma_f32_16x16x32_bf16 v[120:123], a[196:199], v[92:95], v[120:123]
    ds_read_b128 v[64:67], v9 offset:3072
    v_mfma_f32_16x16x32_bf16 v[136:139], a[196:199], v[100:103], v[136:139]
    buffer_load_dwordx4 v38, s[20:23], s35 offen offset:2048 sc1 lds
    v_mfma_f32_16x16x32_bf16 v[136:139], a[192:195], v[96:99], v[136:139]
    ds_read_b128 v[68:71], v9 offset:21504
    s_waitcnt lgkmcnt(4)
    v_mfma_f32_16x16x32_bf16 v[140:143], a[200:203], v[96:99], v[140:143]
    ds_read_b128 v[72:75], v9 offset:4096
    v_mfma_f32_16x16x32_bf16 v[140:143], a[204:207], v[100:103], v[140:143]
    ds_read_b128 v[76:79], v9 offset:22528
    v_mfma_f32_16x16x32_bf16 v[124:127], a[204:207], v[92:95], v[124:127]
    ds_read_b128 v[80:83], v9 offset:5120
    s_waitcnt lgkmcnt(3)
    v_mfma_f32_16x16x32_bf16 v[124:127], a[200:203], v[88:91], v[124:127]
    buffer_load_dwordx4 v38, s[20:23], s35 offen offset:3072 sc1 lds
    v_mfma_f32_16x16x32_bf16 v[144:147], a[176:179], v[104:107], v[144:147]
    s_add_u32 m0, s44, 4096
    s_add_u32 s35, s100, 557056
    v_mfma_f32_16x16x32_bf16 v[144:147], a[180:183], v[108:111], v[144:147]
    ds_read_b128 v[84:87], v9 offset:23552
    v_mfma_f32_16x16x32_bf16 v[160:163], a[180:183], v[68:71], v[160:163]
    v_mfma_f32_16x16x32_bf16 v[160:163], a[176:179], v[64:67], v[160:163]
    v_mfma_f32_16x16x32_bf16 v[164:167], a[184:187], v[64:67], v[164:167]
    buffer_load_dwordx4 v38, s[20:23], s35 offen offset:0 sc1 lds
    v_mfma_f32_16x16x32_bf16 v[164:167], a[188:191], v[68:71], v[164:167]
    v_mfma_f32_16x16x32_bf16 v[148:151], a[188:191], v[108:111], v[148:151]
    v_mfma_f32_16x16x32_bf16 v[148:151], a[184:187], v[104:107], v[148:151]
    v_mfma_f32_16x16x32_bf16 v[152:155], a[192:195], v[104:107], v[152:155]
    v_mfma_f32_16x16x32_bf16 v[152:155], a[196:199], v[108:111], v[152:155]
    buffer_load_dwordx4 v38, s[20:23], s35 offen offset:1024 sc1 lds
    v_mfma_f32_16x16x32_bf16 v[168:171], a[196:199], v[68:71], v[168:171]
    v_mfma_f32_16x16x32_bf16 v[168:171], a[192:195], v[64:67], v[168:171]
    v_mfma_f32_16x16x32_bf16 v[172:175], a[200:203], v[64:67], v[172:175]
    ds_read_b128 v[88:91], v9 offset:6144
    v_mfma_f32_16x16x32_bf16 v[172:175], a[204:207], v[68:71], v[172:175]
    ds_read_b128 v[92:95], v9 offset:24576
    v_mfma_f32_16x16x32_bf16 v[156:159], a[204:207], v[108:111], v[156:159]
    buffer_load_dwordx4 v38, s[20:23], s35 offen offset:2048 sc1 lds
    v_mfma_f32_16x16x32_bf16 v[156:159], a[200:203], v[104:107], v[156:159]
    s_waitcnt lgkmcnt(2)
    v_mfma_f32_16x16x32_bf16 v[176:179], a[176:179], v[72:75], v[176:179]
    v_mfma_f32_16x16x32_bf16 v[176:179], a[180:183], v[76:79], v[176:179]
    v_mfma_f32_16x16x32_bf16 v[192:195], a[180:183], v[84:87], v[192:195]
    v_mfma_f32_16x16x32_bf16 v[192:195], a[176:179], v[80:83], v[192:195]
    buffer_load_dwordx4 v38, s[20:23], s35 offen offset:3072 sc1 lds
    v_mfma_f32_16x16x32_bf16 v[196:199], a[184:187], v[80:83], v[196:199]
    s_add_u32 m0, s44, 8192
    s_add_u32 s35, s100, 561152
    v_mfma_f32_16x16x32_bf16 v[196:199], a[188:191], v[84:87], v[196:199]
    ds_read_b128 v[96:99], v9 offset:7168
    v_mfma_f32_16x16x32_bf16 v[180:183], a[188:191], v[76:79], v[180:183]
    ds_read_b128 v[100:103], v9 offset:25600
    v_mfma_f32_16x16x32_bf16 v[180:183], a[184:187], v[72:75], v[180:183]
    ds_read_b128 v[104:107], v9 offset:8192
    v_mfma_f32_16x16x32_bf16 v[184:187], a[192:195], v[72:75], v[184:187]
    buffer_load_dwordx4 v38, s[20:23], s35 offen offset:0 sc1 lds
    v_mfma_f32_16x16x32_bf16 v[184:187], a[196:199], v[76:79], v[184:187]
    ds_read_b128 v[108:111], v9 offset:26624
    v_mfma_f32_16x16x32_bf16 v[200:203], a[196:199], v[84:87], v[200:203]
    v_mfma_f32_16x16x32_bf16 v[200:203], a[192:195], v[80:83], v[200:203]
    v_mfma_f32_16x16x32_bf16 v[204:207], a[200:203], v[80:83], v[204:207]
    v_mfma_f32_16x16x32_bf16 v[204:207], a[204:207], v[84:87], v[204:207]
    v_mfma_f32_16x16x32_bf16 v[188:191], a[204:207], v[76:79], v[188:191]
    v_mfma_f32_16x16x32_bf16 v[188:191], a[200:203], v[72:75], v[188:191]
    s_waitcnt vmcnt(13)
    v_cmp_ne_u32 vcc, 1, v30
    s_nop 3
    s_bitcmp1_b32 vcc_lo, 0
    s_cbranch_scc1 L_spin18_0
L_back18_0:
    s_waitcnt lgkmcnt(0)
    v_mfma_f32_16x16x32_bf16 v[208:211], a[176:179], v[88:91], v[208:211]
    v_mfma_f32_16x16x32_bf16 v[208:211], a[180:183], v[92:95], v[208:211]
    s_waitcnt lgkmcnt(15)
    s_waitcnt vmcnt(63)
    v_mfma_f32_16x16x32_bf16 v[212:215], a[188:191], v[92:95], v[212:215]
    s_barrier
    v_mfma_f32_16x16x32_bf16 v[212:215], a[184:187], v[88:91], v[212:215]
    s_add_u32 m0, s29, 90112
    s_add_u32 s35, s101, 131072
    v_mfma_f32_16x16x32_bf16 v[216:219], a[192:195], v[88:91], v[216:219]
    buffer_load_dwordx4 v44, s[24:27], s35 offen offset:0 lds
    v_mfma_f32_16x16x32_bf16 v[216:219], a[196:199], v[92:95], v[216:219]
    ds_read_b64_tr_b16 a[144:145], v13 offset:0
    v_mfma_f32_16x16x32_bf16 v[220:223], a[204:207], v[92:95], v[220:223]
    ds_read_b64_tr_b16 a[146:147], v13 offset:4096
    v_mfma_f32_16x16x32_bf16 v[220:223], a[200:203], v[88:91], v[220:223]
    ds_read_b128 v[64:67], v10 offset:0
    v_mfma_f32_16x16x32_bf16 v[224:227], a[176:179], v[96:99], v[224:227]
    ds_read_b64_tr_b16 a[148:149], v13 offset:8192
    v_mfma_f32_16x16x32_bf16 v[224:227], a[180:183], v[100:103], v[224:227]
    buffer_load_dwordx4 v45, s[24:27], s35 offen offset:1024 lds
    v_mfma_f32_16x16x32_bf16 v[240:243], a[180:183], v[108:111], v[240:243]
    ds_read_b64_tr_b16 a[150:151], v13 offset:12288
    v_mfma_f32_16x16x32_bf16 v[240:243], a[176:179], v[104:107], v[240:243]
    ds_read_b128 v[68:71], v10 offset:18432
    v_mfma_f32_16x16x32_bf16 v[244:247], a[184:187], v[104:107], v[244:247]
    ds_read_b128 v[72:75], v10 offset:1024
    v_mfma_f32_16x16x32_bf16 v[244:247], a[188:191], v[108:111], v[244:247]
    ds_read_b128 v[76:79], v10 offset:19456
    v_mfma_f32_16x16x32_bf16 v[228:231], a[188:191], v[100:103], v[228:231]
    buffer_load_dwordx4 v46, s[24:27], s35 offen offset:2048 lds
    v_mfma_f32_16x16x32_bf16 v[228:231], a[184:187], v[96:99], v[228:231]
    ds_read_b64_tr_b16 a[152:153], v13 offset:8
    v_mfma_f32_16x16x32_bf16 v[232:235], a[192:195], v[96:99], v[232:235]
    ds_read_b64_tr_b16 a[154:155], v13 offset:4104
    v_mfma_f32_16x16x32_bf16 v[232:235], a[196:199], v[100:103], v[232:235]
    ds_read_b64_tr_b16 a[156:157], v13 offset:8200
    v_mfma_f32_16x16x32_bf16 v[248:251], a[196:199], v[108:111], v[248:251]
    ds_read_b64_tr_b16 a[158:159], v13 offset:12296
    v_mfma_f32_16x16x32_bf16 v[248:251], a[192:195], v[104:107], v[248:251]
    buffer_load_dwordx4 v47, s[24:27], s35 offen offset:3072 lds
    v_mfma_f32_16x16x32_bf16 v[252:255], a[200:203], v[104:107], v[252:255]
    s_add_u32 m0, s44, 53248
    s_add_u32 s35, s100, 1179648
    v_mfma_f32_16x16x32_bf16 v[252:255], a[204:207], v[108:111], v[252:255]
    ds_read_b64_tr_b16 a[160:161], v16 offset:0
    v_mfma_f32_16x16x32_bf16 v[236:239], a[204:207], v[100:103], v[236:239]
    ds_read_b64_tr_b16 a[162:163], v16 offset:4096
    v_mfma_f32_16x16x32_bf16 v[236:239], a[200:203], v[96:99], v[236:239]
    ds_read_b64_tr_b16 a[164:165], v16 offset:8192
    s_waitcnt lgkmcnt(9)
    v_mfma_f32_16x16x32_bf16 v[112:115], a[144:147], v[64:67], v[112:115]
    buffer_load_dwordx4 v38, s[20:23], s35 offen offset:0 sc1 lds
    v_mfma_f32_16x16x32_bf16 v[112:115], a[148:151], v[68:71], v[112:115]
    ds_read_b64_tr_b16 a[166:167], v16 offset:12288
    s_waitcnt lgkmcnt(8)
    v_mfma_f32_16x16x32_bf16 v[128:131], a[148:151], v[76:79], v[128:131]
    ds_read_b64_tr_b16 a[168:169], v16 offset:8
    v_mfma_f32_16x16x32_bf16 v[128:131], a[144:147], v[72:75], v[128:131]
    ds_read_b64_tr_b16 a[170:171], v16 offset:4104
    s_waitcnt lgkmcnt(6)
    v_mfma_f32_16x16x32_bf16 v[132:135], a[152:155], v[72:75], v[132:135]
    ds_read_b64_tr_b16 a[172:173], v16 offset:8200
    v_mfma_f32_16x16x32_bf16 v[132:135], a[156:159], v[76:79], v[132:135]
    buffer_load_dwordx4 v38, s[20:23], s35 offen offset:1024 sc1 lds
    v_mfma_f32_16x16x32_bf16 v[116:119], a[156:159], v[68:71], v[116:119]
    ds_read_b64_tr_b16 a[174:175], v16 offset:12296
    v_mfma_f32_16x16x32_bf16 v[116:119], a[152:155], v[64:67], v[116:119]
    ds_read_b128 v[80:83], v10 offset:2048
    s_waitcnt lgkmcnt(5)
    v_mfma_f32_16x16x32_bf16 v[120:123], a[160:163], v[64:67], v[120:123]
    ds_read_b128 v[84:87], v10 offset:20480
    v_mfma_f32_16x16x32_bf16 v[120:123], a[164:167], v[68:71], v[120:123]
    ds_read_b128 v[88:91], v10 offset:3072
    v_mfma_f32_16x16x32_bf16 v[136:139], a[164:167], v[76:79], v[136:139]
    buffer_load_dwordx4 v38, s[20:23], s35 offen offset:2048 sc1 lds
    v_mfma_f32_16x16x32_bf16 v[136:139], a[160:163], v[72:75], v[136:139]
    ds_read_b128 v[92:95], v10 offset:21504
    s_waitcnt lgkmcnt(4)
    v_mfma_f32_16x16x32_bf16 v[140:143], a[168:171], v[72:75], v[140:143]
    ds_read_b128 v[96:99], v10 offset:4096
    v_mfma_f32_16x16x32_bf16 v[140:143], a[172:175], v[76:79], v[140:143]
    ds_read_b128 v[100:103], v10 offset:22528
    v_mfma_f32_16x16x32_bf16 v[124:127], a[172:175], v[68:71], v[124:127]
    ds_read_b128 v[104:107], v10 offset:5120
    s_waitcnt lgkmcnt(3)
    v_mfma_f32_16x16x32_bf16 v[124:127], a[168:171], v[64:67], v[124:127]
    buffer_load_dwordx4 v38, s[20:23], s35 offen offset:3072 sc1 lds
    v_mfma_f32_16x16x32_bf16 v[144:147], a[144:147], v[80:83], v[144:147]
    s_add_u32 m0, s44, 57344
    s_add_u32 s35, s100, 1183744
    v_mfma_f32_16x16x32_bf16 v[144:147], a[148:151], v[84:87], v[144:147]
    ds_read_b128 v[108:111], v10 offset:23552
    v_mfma_f32_16x16x32_bf16 v[160:163], a[148:151], v[92:95], v[160:163]
    v_mfma_f32_16x16x32_bf16 v[160:163], a[144:147], v[88:91], v[160:163]
    v_mfma_f32_16x16x32_bf16 v[164:167], a[152:155], v[88:91], v[164:167]
    buffer_load_dwordx4 v38, s[20:23], s35 offen offset:0 sc1 lds
    v_mfma_f32_16x16x32_bf16 v[164:167], a[156:159], v[92:95], v[164:167]
    v_mfma_f32_16x16x32_bf16 v[148:151], a[156:159], v[84:87], v[148:151]
    v_mfma_f32_16x16x32_bf16 v[148:151], a[152:155], v[80:83], v[148:151]
    v_mfma_f32_16x16x32_bf16 v[152:155], a[160:163], v[80:83], v[152:155]
    v_mfma_f32_16x16x32_bf16 v[152:155], a[164:167], v[84:87], v[152:155]
    buffer_load_dwordx4 v38, s[20:23], s35 offen offset:1024 sc1 lds
    v_mfma_f32_16x16x32_bf16 v[168:171], a[164:167], v[92:95], v[168:171]
    v_mfma_f32_16x16x32_bf16 v[168:171], a[160:163], v[88:91], v[168:171]
    v_mfma_f32_16x16x32_bf16 v[172:175], a[168:171], v[88:91], v[172:175]
    ds_read_b128 v[64:67], v10 offset:6144
    v_mfma_f32_16x16x32_bf16 v[172:175], a[172:175], v[92:95], v[172:175]
    ds_read_b128 v[68:71], v10 offset:24576
    v_mfma_f32_16x16x32_bf16 v[156:159], a[172:175], v[84:87], v[156:159]
    buffer_load_dwordx4 v38, s[20:23], s35 offen offset:2048 sc1 lds
    v_mfma_f32_16x16x32_bf16 v[156:159], a[168:171], v[80:83], v[156:159]
    s_waitcnt lgkmcnt(2)
    v_mfma_f32_16x16x32_bf16 v[176:179], a[144:147], v[96:99], v[176:179]
    v_mfma_f32_16x16x32_bf16 v[176:179], a[148:151], v[100:103], v[176:179]
    v_mfma_f32_16x16x32_bf16 v[192:195], a[148:151], v[108:111], v[192:195]
    v_mfma_f32_16x16x32_bf16 v[192:195], a[144:147], v[104:107], v[192:195]
    buffer_load_dwordx4 v38, s[20:23], s35 offen offset:3072 sc1 lds
    v_mfma_f32_16x16x32_bf16 v[196:199], a[152:155], v[104:107], v[196:199]
    s_add_u32 m0, s44, 61440
    s_add_u32 s35, s100, 1187840
    v_mfma_f32_16x16x32_bf16 v[196:199], a[156:159], v[108:111], v[196:199]
    ds_read_b128 v[72:75], v10 offset:7168
    v_mfma_f32_16x16x32_bf16 v[180:183], a[156:159], v[100:103], v[180:183]
    ds_read_b128 v[76:79], v10 offset:25600
    v_mfma_f32_16x16x32_bf16 v[180:183], a[152:155], v[96:99], v[180:183]
    ds_read_b128 v[80:83], v10 offset:8192
    v_mfma_f32_16x16x32_bf16 v[184:187], a[160:163], v[96:99], v[184:187]
    buffer_load_dwordx4 v38, s[20:23], s35 offen offset:0 sc1 lds
    v_mfma_f32_16x16x32_bf16 v[184:187], a[164:167], v[100:103], v[184:187]
    ds_read_b128 v[84:87], v10 offset:26624
    v_mfma_f32_16x16x32_bf16 v[200:203], a[164:167], v[108:111], v[200:203]
    v_mfma_f32_16x16x32_bf16 v[200:203], a[160:163], v[104:107], v[200:203]
    v_mfma_f32_16x16x32_bf16 v[204:207], a[168:171], v[104:107], v[204:207]
    v_mfma_f32_16x16x32_bf16 v[204:207], a[172:175], v[108:111], v[204:207]
    v_mfma_f32_16x16x32_bf16 v[188:191], a[172:175], v[100:103], v[188:191]
    buffer_load_dword v30, v33, s[96:99], s91 offen sc1
    v_mfma_f32_16x16x32_bf16 v[188:191], a[168:171], v[96:99], v[188:191]
    s_waitcnt lgkmcnt(0)
    v_mfma_f32_16x16x32_bf16 v[208:211], a[144:147], v[64:67], v[208:211]
    v_mfma_f32_16x16x32_bf16 v[208:211], a[148:151], v[68:71], v[208:211]
    s_waitcnt lgkmcnt(15)
    s_waitcnt vmcnt(14)
    v_mfma_f32_16x16x32_bf16 v[212:215], a[156:159], v[68:71], v[212:215]
    s_barrier
    v_mfma_f32_16x16x32_bf16 v[212:215], a[152:155], v[64:67], v[212:215]
    s_add_u32 m0, s29, 143360
    s_add_u32 s35, s101, 196608
    v_mfma_f32_16x16x32_bf16 v[216:219], a[160:163], v[64:67], v[216:219]
    buffer_load_dwordx4 v44, s[24:27], s35 offen offset:0 lds
    v_mfma_f32_16x16x32_bf16 v[216:219], a[164:167], v[68:71], v[216:219]
    ds_read_b64_tr_b16 a[176:177], v11 offset:0
    v_mfma_f32_16x16x32_bf16 v[220:223], a[172:175], v[68:71], v[220:223]
    ds_read_b64_tr_b16 a[178:179], v11 offset:4096
    v_mfma_f32_16x16x32_bf16 v[220:223], a[168:171], v[64:67], v[220:223]
    ds_read_b128 v[88:91], v8 offset:0
    v_mfma_f32_16x16x32_bf16 v[224:227], a[144:147], v[72:75], v[224:227]
    ds_read_b64_tr_b16 a[180:181], v11 offset:8192
    v_mfma_f32_16x16x32_bf16 v[224:227], a[148:151], v[76:79], v[224:227]
    buffer_load_dwordx4 v45, s[24:27], s35 offen offset:1024 lds
    v_mfma_f32_16x16x32_bf16 v[240:243], a[148:151], v[84:87], v[240:243]
    ds_read_b64_tr_b16 a[182:183], v11 offset:12288
    v_mfma_f32_16x16x32_bf16 v[240:243], a[144:147], v[80:83], v[240:243]
    ds_read_b128 v[92:95], v8 offset:18432
    v_mfma_f32_16x16x32_bf16 v[244:247], a[152:155], v[80:83], v[244:247]
    ds_read_b128 v[96:99], v8 offset:1024
    v_mfma_f32_16x16x32_bf16 v[244:247], a[156:159], v[84:87], v[244:247]
    ds_read_b128 v[100:103], v8 offset:19456
    v_mfma_f32_16x16x32_bf16 v[228:231], a[156:159], v[76:79], v[228:231]
    buffer_load_dwordx4 v46, s[24:27], s35 offen offset:2048 lds
    v_mfma_f32_16x16x32_bf16 v[228:231], a[152:155], v[72:75], v[228:231]
    ds_read_b64_tr_b16 a[184:185], v11 offset:8
    v_mfma_f32_16x16x32_bf16 v[232:235], a[160:163], v[72:75], v[232:235]
    ds_read_b64_tr_b16 a[186:187], v11 offset:4104
    v_mfma_f32_16x16x32_bf16 v[232:235], a[164:167], v[76:79], v[232:235]
    ds_read_b64_tr_b16 a[188:189], v11 offset:8200
    v_mfma_f32_16x16x32_bf16 v[248:251], a[164:167], v[84:87], v[248:251]
    ds_read_b64_tr_b16 a[190:191], v11 offset:12296
    v_mfma_f32_16x16x32_bf16 v[248:251], a[160:163], v[80:83], v[248:251]
    buffer_load_dwordx4 v47, s[24:27], s35 offen offset:3072 lds
    v_mfma_f32_16x16x32_bf16 v[252:255], a[168:171], v[80:83], v[252:255]
    s_add_u32 m0, s44, 106496
    s_add_u32 s35, s100, 1216512
    v_mfma_f32_16x16x32_bf16 v[252:255], a[172:175], v[84:87], v[252:255]
    ds_read_b64_tr_b16 a[192:193], v14 offset:0
    v_mfma_f32_16x16x32_bf16 v[236:239], a[172:175], v[76:79], v[236:239]
    ds_read_b64_tr_b16 a[194:195], v14 offset:4096
    v_mfma_f32_16x16x32_bf16 v[236:239], a[168:171], v[72:75], v[236:239]
    ds_read_b64_tr_b16 a[196:197], v14 offset:8192
    s_waitcnt lgkmcnt(9)
    v_mfma_f32_16x16x32_bf16 v[112:115], a[176:179], v[88:91], v[112:115]
    buffer_load_dwordx4 v38, s[20:23], s35 offen offset:0 sc1 lds
    v_mfma_f32_16x16x32_bf16 v[112:115], a[180:183], v[92:95], v[112:115]
    ds_read_b64_tr_b16 a[198:199], v14 offset:12288
    s_waitcnt lgkmcnt(8)
    v_mfma_f32_16x16x32_bf16 v[128:131], a[180:183], v[100:103], v[128:131]
    ds_read_b64_tr_b16 a[200:201], v14 offset:8
    v_mfma_f32_16x16x32_bf16 v[128:131], a[176:179], v[96:99], v[128:131]
    ds_read_b64_tr_b16 a[202:203], v14 offset:4104
    s_waitcnt lgkmcnt(6)
    v_mfma_f32_16x16x32_bf16 v[132:135], a[184:187], v[96:99], v[132:135]
    ds_read_b64_tr_b16 a[204:205], v14 offset:8200
    v_mfma_f32_16x16x32_bf16 v[132:135], a[188:191], v[100:103], v[132:135]
    buffer_load_dwordx4 v38, s[20:23], s35 offen offset:1024 sc1 lds
    v_mfma_f32_16x16x32_bf16 v[116:119], a[188:191], v[92:95], v[116:119]
    ds_read_b64_tr_b16 a[206:207], v14 offset:12296
    v_mfma_f32_16x16x32_bf16 v[116:119], a[184:187], v[88:91], v[116:119]
    ds_read_b128 v[104:107], v8 offset:2048
    s_waitcnt lgkmcnt(5)
    v_mfma_f32_16x16x32_bf16 v[120:123], a[192:195], v[88:91], v[120:123]
    ds_read_b128 v[108:111], v8 offset:20480
    v_mfma_f32_16x16x32_bf16 v[120:123], a[196:199], v[92:95], v[120:123]
    ds_read_b128 v[64:67], v8 offset:3072
    v_mfma_f32_16x16x32_bf16 v[136:139], a[196:199], v[100:103], v[136:139]
    buffer_load_dwordx4 v38, s[20:23], s35 offen offset:2048 sc1 lds
    v_mfma_f32_16x16x32_bf16 v[136:139], a[192:195], v[96:99], v[136:139]
    ds_read_b128 v[68:71], v8 offset:21504
    s_waitcnt lgkmcnt(4)
    v_mfma_f32_16x16x32_bf16 v[140:143], a[200:203], v[96:99], v[140:143]
    ds_read_b128 v[72:75], v8 offset:4096
    v_mfma_f32_16x16x32_bf16 v[140:143], a[204:207], v[100:103], v[140:143]
    ds_read_b128 v[76:79], v8 offset:22528
    v_mfma_f32_16x16x32_bf16 v[124:127], a[204:207], v[92:95], v[124:127]
    ds_read_b128 v[80:83], v8 offset:5120
    s_waitcnt lgkmcnt(3)
    v_mfma_f32_16x16x32_bf16 v[124:127], a[200:203], v[88:91], v[124:127]
    buffer_load_dwordx4 v38, s[20:23], s35 offen offset:3072 sc1 lds
    v_mfma_f32_16x16x32_bf16 v[144:147], a[176:179], v[104:107], v[144:147]
    s_add_u32 m0, s44, 110592
    s_add_u32 s35, s100, 1220608
    v_mfma_f32_16x16x32_bf16 v[144:147], a[180:183], v[108:111], v[144:147]
    ds_read_b128 v[84:87], v8 offset:23552
    v_mfma_f32_16x16x32_bf16 v[160:163], a[180:183], v[68:71], v[160:163]
    v_mfma_f32_16x16x32_bf16 v[160:163], a[176:179], v[64:67], v[160:163]
    v_mfma_f32_16x16x32_bf16 v[164:167], a[184:187], v[64:67], v[164:167]
    buffer_load_dwordx4 v38, s[20:23], s35 offen offset:0 sc1 lds
    v_mfma_f32_16x16x32_bf16 v[164:167], a[188:191], v[68:71], v[164:167]
    v_mfma_f32_16x16x32_bf16 v[148:151], a[188:191], v[108:111], v[148:151]
    v_mfma_f32_16x16x32_bf16 v[148:151], a[184:187], v[104:107], v[148:151]
    v_mfma_f32_16x16x32_bf16 v[152:155], a[192:195], v[104:107], v[152:155]
    v_mfma_f32_16x16x32_bf16 v[152:155], a[196:199], v[108:111], v[152:155]
    buffer_load_dwordx4 v38, s[20:23], s35 offen offset:1024 sc1 lds
    v_mfma_f32_16x16x32_bf16 v[168:171], a[196:199], v[68:71], v[168:171]
    v_mfma_f32_16x16x32_bf16 v[168:171], a[192:195], v[64:67], v[168:171]
    v_mfma_f32_16x16x32_bf16 v[172:175], a[200:203], v[64:67], v[172:175]
    ds_read_b128 v[88:91], v8 offset:6144
    v_mfma_f32_16x16x32_bf16 v[172:175], a[204:207], v[68:71], v[172:175]
    ds_read_b128 v[92:95], v8 offset:24576
    v_mfma_f32_16x16x32_bf16 v[156:159], a[204:207], v[108:111], v[156:159]
    buffer_load_dwordx4 v38, s[20:23], s35 offen offset:2048 sc1 lds
    v_mfma_f32_16x16x32_bf16 v[156:159], a[200:203], v[104:107], v[156:159]
    s_waitcnt lgkmcnt(2)
    v_mfma_f32_16x16x32_bf16 v[176:179], a[176:179], v[72:75], v[176:179]
    v_mfma_f32_16x16x32_bf16 v[176:179], a[180:183], v[76:79], v[176:179]
    v_mfma_f32_16x16x32_bf16 v[192:195], a[180:183], v[84:87], v[192:195]
    v_mfma_f32_16x16x32_bf16 v[192:195], a[176:179], v[80:83], v[192:195]
    buffer_load_dwordx4 v38, s[20:23], s35 offen offset:3072 sc1 lds
    v_mfma_f32_16x16x32_bf16 v[196:199], a[184:187], v[80:83], v[196:199]
    s_add_u32 m0, s44, 114688
    s_add_u32 s35, s100, 1224704
    v_mfma_f32_16x16x32_bf16 v[196:199], a[188:191], v[84:87], v[196:199]
    ds_read_b128 v[96:99], v8 offset:7168
    v_mfma_f32_16x16x32_bf16 v[180:183], a[188:191], v[76:79], v[180:183]
    ds_read_b128 v[100:103], v8 offset:25600
    v_mfma_f32_16x16x32_bf16 v[180:183], a[184:187], v[72:75], v[180:183]
    ds_read_b128 v[104:107], v8 offset:8192
    v_mfma_f32_16x16x32_bf16 v[184:187], a[192:195], v[72:75], v[184:187]
    buffer_load_dwordx4 v38, s[20:23], s35 offen offset:0 sc1 lds
    v_mfma_f32_16x16x32_bf16 v[184:187], a[196:199], v[76:79], v[184:187]
    ds_read_b128 v[108:111], v8 offset:26624
    v_mfma_f32_16x16x32_bf16 v[200:203], a[196:199], v[84:87], v[200:203]
    v_mfma_f32_16x16x32_bf16 v[200:203], a[192:195], v[80:83], v[200:203]
    v_mfma_f32_16x16x32_bf16 v[204:207], a[200:203], v[80:83], v[204:207]
    v_mfma_f32_16x16x32_bf16 v[204:207], a[204:207], v[84:87], v[204:207]
    v_mfma_f32_16x16x32_bf16 v[188:191], a[204:207], v[76:79], v[188:191]
    v_mfma_f32_16x16x32_bf16 v[188:191], a[200:203], v[72:75], v[188:191]
    s_waitcnt vmcnt(13)
    v_cmp_ne_u32 vcc, 1, v30
    s_nop 3
    s_bitcmp1_b32 vcc_lo, 1
    s_cbranch_scc1 L_spin18_1
L_back18_1:
    s_waitcnt lgkmcnt(0)
    v_mfma_f32_16x16x32_bf16 v[208:211], a[176:179], v[88:91], v[208:211]
    v_mfma_f32_16x16x32_bf16 v[208:211], a[180:183], v[92:95], v[208:211]
    s_waitcnt lgkmcnt(15)
    s_waitcnt vmcnt(63)
    v_mfma_f32_16x16x32_bf16 v[212:215], a[188:191], v[92:95], v[212:215]
    s_barrier
    v_mfma_f32_16x16x32_bf16 v[212:215], a[184:187], v[88:91], v[212:215]
    s_add_u32 m0, s29, 36864
    s_add_u32 s35, s101, 393216
    v_mfma_f32_16x16x32_bf16 v[216:219], a[192:195], v[88:91], v[216:219]
    buffer_load_dwordx4 v44, s[24:27], s35 offen offset:0 lds
    v_mfma_f32_16x16x32_bf16 v[216:219], a[196:199], v[92:95], v[216:219]
    ds_read_b64_tr_b16 a[144:145], v12 offset:0
    v_mfma_f32_16x16x32_bf16 v[220:223], a[204:207], v[92:95], v[220:223]
    ds_read_b64_tr_b16 a[146:147], v12 offset:4096
    v_mfma_f32_16x16x32_bf16 v[220:223], a[200:203], v[88:91], v[220:223]
    ds_read_b128 v[64:67], v9 offset:0
    v_mfma_f32_16x16x32_bf16 v[224:227], a[176:179], v[96:99], v[224:227]
    ds_read_b64_tr_b16 a[148:149], v12 offset:8192
    v_mfma_f32_16x16x32_bf16 v[224:227], a[180:183], v[100:103], v[224:227]
    buffer_load_dwordx4 v45, s[24:27], s35 offen offset:1024 lds
    v_mfma_f32_16x16x32_bf16 v[240:243], a[180:183], v[108:111], v[240:243]
    ds_read_b64_tr_b16 a[150:151], v12 offset:12288
    v_mfma_f32_16x16x32_bf16 v[240:243], a[176:179], v[104:107], v[240:243]
    ds_read_b128 v[68:71], v9 offset:18432
    v_mfma_f32_16x16x32_bf16 v[244:247], a[184:187], v[104:107], v[244:247]
    ds_read_b128 v[72:75], v9 offset:1024
    v_mfma_f32_16x16x32_bf16 v[244:247], a[188:191], v[108:111], v[244:247]
    ds_read_b128 v[76:79], v9 offset:19456
    v_mfma_f32_16x16x32_bf16 v[228:231], a[188:191], v[100:103], v[228:231]
    buffer_load_dwordx4 v46, s[24:27], s35 offen offset:2048 lds
    v_mfma_f32_16x16x32_bf16 v[228:231], a[184:187], v[96:99], v[228:231]
    ds_read_b64_tr_b16 a[152:153], v12 offset:8
    v_mfma_f32_16x16x32_bf16 v[232:235], a[192:195], v[96:99], v[232:235]
    ds_read_b64_tr_b16 a[154:155], v12 offset:4104
    v_mfma_f32_16x16x32_bf16 v[232:235], a[196:199], v[100:103], v[232:235]
    ds_read_b64_tr_b16 a[156:157], v12 offset:8200
    v_mfma_f32_16x16x32_bf16 v[248:251], a[196:199], v[108:111], v[248:251]
    ds_read_b64_tr_b16 a[158:159], v12 offset:12296
    v_mfma_f32_16x16x32_bf16 v[248:251], a[192:195], v[104:107], v[248:251]
    buffer_load_dwordx4 v47, s[24:27], s35 offen offset:3072 lds
    v_mfma_f32_16x16x32_bf16 v[252:255], a[200:203], v[104:107], v[252:255]
    s_add_u32 m0, s44, 0
    s_add_u32 s35, s100, 1253376
    v_mfma_f32_16x16x32_bf16 v[252:255], a[204:207], v[108:111], v[252:255]
    ds_read_b64_tr_b16 a[160:161], v15 offset:0
    v_mfma_f32_16x16x32_bf16 v[236:239], a[204:207], v[100:103], v[236:239]
    ds_read_b64_tr_b16 a[162:163], v15 offset:4096
    v_mfma_f32_16x16x32_bf16 v[236:239], a[200:203], v[96:99], v[236:239]
    ds_read_b64_tr_b16 a[164:165], v15 offset:8192
    s_waitcnt lgkmcnt(9)
    v_mfma_f32_16x16x32_bf16 v[112:115], a[144:147], v[64:67], v[112:115]
    buffer_load_dwordx4 v38, s[20:23], s35 offen offset:0 sc1 lds
    v_mfma_f32_16x16x32_bf16 v[112:115], a[148:151], v[68:71], v[112:115]
    ds_read_b64_tr_b16 a[166:167], v15 offset:12288
    s_waitcnt lgkmcnt(8)
    v_mfma_f32_16x16x32_bf16 v[128:131], a[148:151], v[76:79], v[128:131]
    ds_read_b64_tr_b16 a[168:169], v15 offset:8
    v_mfma_f32_16x16x32_bf16 v[128:131], a[144:147], v[72:75], v[128:131]
    ds_read_b64_tr_b16 a[170:171], v15 offset:4104
    s_waitcnt lgkmcnt(6)
    v_mfma_f32_16x16x32_bf16 v[132:135], a[152:155], v[72:75], v[132:135]
    ds_read_b64_tr_b16 a[172:173], v15 offset:8200
    v_mfma_f32_16x16x32_bf16 v[132:135], a[156:159], v[76:79], v[132:135]
    buffer_load_dwordx4 v38, s[20:23], s35 offen offset:1024 sc1 lds
    v_mfma_f32_16x16x32_bf16 v[116:119], a[156:159], v[68:71], v[116:119]
    ds_read_b64_tr_b16 a[174:175], v15 offset:12296
    v_mfma_f32_16x16x32_bf16 v[116:119], a[152:155], v[64:67], v[116:119]
    ds_read_b128 v[80:83], v9 offset:2048
    s_waitcnt lgkmcnt(5)
    v_mfma_f32_16x16x32_bf16 v[120:123], a[160:163], v[64:67], v[120:123]
    ds_read_b128 v[84:87], v9 offset:20480
    v_mfma_f32_16x16x32_bf16 v[120:123], a[164:167], v[68:71], v[120:123]
    ds_read_b128 v[88:91], v9 offset:3072
    v_mfma_f32_16x16x32_bf16 v[136:139], a[164:167], v[76:79], v[136:139]
    buffer_load_dwordx4 v38, s[20:23], s35 offen offset:2048 sc1 lds
    v_mfma_f32_16x16x32_bf16 v[136:139], a[160:163], v[72:75], v[136:139]
    ds_read_b128 v[92:95], v9 offset:21504
    s_waitcnt lgkmcnt(4)
    v_mfma_f32_16x16x32_bf16 v[140:143], a[168:171], v[72:75], v[140:143]
    ds_read_b128 v[96:99], v9 offset:4096
    v_mfma_f32_16x16x32_bf16 v[140:143], a[172:175], v[76:79], v[140:143]
    ds_read_b128 v[100:103], v9 offset:22528
    v_mfma_f32_16x16x32_bf16 v[124:127], a[172:175], v[68:71], v[124:127]
    ds_read_b128 v[104:107], v9 offset:5120
    s_waitcnt lgkmcnt(3)
    v_mfma_f32_16x16x32_bf16 v[124:127], a[168:171], v[64:67], v[124:127]
    buffer_load_dwordx4 v38, s[20:23], s35 offen offset:3072 sc1 lds
    v_mfma_f32_16x16x32_bf16 v[144:147], a[144:147], v[80:83], v[144:147]
    s_add_u32 m0, s44, 4096
    s_add_u32 s35, s100, 1257472
    v_mfma_f32_16x16x32_bf16 v[144:147], a[148:151], v[84:87], v[144:147]
    ds_read_b128 v[108:111], v9 offset:23552
    v_mfma_f32_16x16x32_bf16 v[160:163], a[148:151], v[92:95], v[160:163]
    v_mfma_f32_16x16x32_bf16 v[160:163], a[144:147], v[88:91], v[160:163]
    v_mfma_f32_16x16x32_bf16 v[164:167], a[152:155], v[88:91], v[164:167]
    buffer_load_dwordx4 v38, s[20:23], s35 offen offset:0 sc1 lds
    v_mfma_f32_16x16x32_bf16 v[164:167], a[156:159], v[92:95], v[164:167]
    v_mfma_f32_16x16x32_bf16 v[148:151], a[156:159], v[84:87], v[148:151]
    v_mfma_f32_16x16x32_bf16 v[148:151], a[152:155], v[80:83], v[148:151]
    v_mfma_f32_16x16x32_bf16 v[152:155], a[160:163], v[80:83], v[152:155]
    v_mfma_f32_16x16x32_bf16 v[152:155], a[164:167], v[84:87], v[152:155]
    buffer_load_dwordx4 v38, s[20:23], s35 offen offset:1024 sc1 lds
    v_mfma_f32_16x16x32_bf16 v[168:171], a[164:167], v[92:95], v[168:171]
    v_mfma_f32_16x16x32_bf16 v[168:171], a[160:163], v[88:91], v[168:171]
    v_mfma_f32_16x16x32_bf16 v[172:175], a[168:171], v[88:91], v[172:175]
    ds_read_b128 v[64:67], v9 offset:6144
    v_mfma_f32_16x16x32_bf16 v[172:175], a[172:175], v[92:95], v[172:175]
    ds_read_b128 v[68:71], v9 offset:24576
    v_mfma_f32_16x16x32_bf16 v[156:159], a[172:175], v[84:87], v[156:159]
    buffer_load_dwordx4 v38, s[20:23], s35 offen offset:2048 sc1 lds
    v_mfma_f32_16x16x32_bf16 v[156:159], a[168:171], v[80:83], v[156:159]
    s_waitcnt lgkmcnt(2)
    v_mfma_f32_16x16x32_bf16 v[176:179], a[144:147], v[96:99], v[176:179]
    v_mfma_f32_16x16x32_bf16 v[176:179], a[148:151], v[100:103], v[176:179]
    v_mfma_f32_16x16x32_bf16 v[192:195], a[148:151], v[108:111], v[192:195]
    v_mfma_f32_16x16x32_bf16 v[192:195], a[144:147], v[104:107], v[192:195]
    buffer_load_dwordx4 v38, s[20:23], s35 offen offset:3072 sc1 lds
    v_mfma_f32_16x16x32_bf16 v[196:199], a[152:155], v[104:107], v[196:199]
    s_add_u32 m0, s44, 8192
    s_add_u32 s35, s100, 1261568
    v_mfma_f32_16x16x32_bf16 v[196:199], a[156:159], v[108:111], v[196:199]
    ds_read_b128 v[72:75], v9 offset:7168
    v_mfma_f32_16x16x32_bf16 v[180:183], a[156:159], v[100:103], v[180:183]
    ds_read_b128 v[76:79], v9 offset:25600
    v_mfma_f32_16x16x32_bf16 v[180:183], a[152:155], v[96:99], v[180:183]
    ds_read_b128 v[80:83], v9 offset:8192
    v_mfma_f32_16x16x32_bf16 v[184:187], a[160:163], v[96:99], v[184:187]
    buffer_load_dwordx4 v38, s[20:23], s35 offen offset:0 sc1 lds
    v_mfma_f32_16x16x32_bf16 v[184:187], a[164:167], v[100:103], v[184:187]
    ds_read_b128 v[84:87], v9 offset:26624
    v_mfma_f32_16x16x32_bf16 v[200:203], a[164:167], v[108:111], v[200:203]
    v_mfma_f32_16x16x32_bf16 v[200:203], a[160:163], v[104:107], v[200:203]
    v_mfma_f32_16x16x32_bf16 v[204:207], a[168:171], v[104:107], v[204:207]
    v_mfma_f32_16x16x32_bf16 v[204:207], a[172:175], v[108:111], v[204:207]
    v_mfma_f32_16x16x32_bf16 v[188:191], a[172:175], v[100:103], v[188:191]
    buffer_load_dword v30, v33, s[96:99], s91 offen sc1
    v_mfma_f32_16x16x32_bf16 v[188:191], a[168:171], v[96:99], v[188:191]
    s_waitcnt lgkmcnt(0)
    v_mfma_f32_16x16x32_bf16 v[208:211], a[144:147], v[64:67], v[208:211]
    v_mfma_f32_16x16x32_bf16 v[208:211], a[148:151], v[68:71], v[208:211]
    s_waitcnt lgkmcnt(15)
    s_waitcnt vmcnt(14)
    v_mfma_f32_16x16x32_bf16 v[212:215], a[156:159], v[68:71], v[212:215]
    s_barrier
    v_mfma_f32_16x16x32_bf16 v[212:215], a[152:155], v[64:67], v[212:215]
    s_add_u32 m0, s29, 90112
    s_add_u32 s35, s101, 458752
    v_mfma_f32_16x16x32_bf16 v[216:219], a[160:163], v[64:67], v[216:219]
    buffer_load_dwordx4 v44, s[24:27], s35 offen offset:0 lds
    v_mfma_f32_16x16x32_bf16 v[216:219], a[164:167], v[68:71], v[216:219]
    ds_read_b64_tr_b16 a[176:177], v13 offset:0
    v_mfma_f32_16x16x32_bf16 v[220:223], a[172:175], v[68:71], v[220:223]
    ds_read_b64_tr_b16 a[178:179], v13 offset:4096
    v_mfma_f32_16x16x32_bf16 v[220:223], a[168:171], v[64:67], v[220:223]
    ds_read_b128 v[88:91], v10 offset:0
    v_mfma_f32_16x16x32_bf16 v[224:227], a[144:147], v[72:75], v[224:227]
    ds_read_b64_tr_b16 a[180:181], v13 offset:8192
    v_mfma_f32_16x16x32_bf16 v[224:227], a[148:151], v[76:79], v[224:227]
    buffer_load_dwordx4 v45, s[24:27], s35 offen offset:1024 lds
    v_mfma_f32_16x16x32_bf16 v[240:243], a[148:151], v[84:87], v[240:243]
    ds_read_b64_tr_b16 a[182:183], v13 offset:12288
    v_mfma_f32_16x16x32_bf16 v[240:243], a[144:147], v[80:83], v[240:243]
    ds_read_b128 v[92:95], v10 offset:18432
    v_mfma_f32_16x16x32_bf16 v[244:247], a[152:155], v[80:83], v[244:247]
    ds_read_b128 v[96:99], v10 offset:1024
    v_mfma_f32_16x16x32_bf16 v[244:247], a[156:159], v[84:87], v[244:247]
    ds_read_b128 v[100:103], v10 offset:19456
    v_mfma_f32_16x16x32_bf16 v[228:231], a[156:159], v[76:79], v[228:231]
    buffer_load_dwordx4 v46, s[24:27], s35 offen offset:2048 lds
    v_mfma_f32_16x16x32_bf16 v[228:231], a[152:155], v[72:75], v[228:231]
    ds_read_b64_tr_b16 a[184:185], v13 offset:8
    v_mfma_f32_16x16x32_bf16 v[232:235], a[160:163], v[72:75], v[232:235]
    ds_read_b64_tr_b16 a[186:187], v13 offset:4104
    v_mfma_f32_16x16x32_bf16 v[232:235], a[164:167], v[76:79], v[232:235]
    ds_read_b64_tr_b16 a[188:189], v13 offset:8200
    v_mfma_f32_16x16x32_bf16 v[248:251], a[164:167], v[84:87], v[248:251]
    ds_read_b64_tr_b16 a[190:191], v13 offset:12296
    v_mfma_f32_16x16x32_bf16 v[248:251], a[160:163], v[80:83], v[248:251]
    buffer_load_dwordx4 v47, s[24:27], s35 offen offset:3072 lds
    v_mfma_f32_16x16x32_bf16 v[252:255], a[168:171], v[80:83], v[252:255]
    s_add_u32 m0, s44, 53248
    s_add_u32 s35, s100, 1290240
    v_mfma_f32_16x16x32_bf16 v[252:255], a[172:175], v[84:87], v[252:255]
    ds_read_b64_tr_b16 a[192:193], v16 offset:0
    v_mfma_f32_16x16x32_bf16 v[236:239], a[172:175], v[76:79], v[236:239]
    ds_read_b64_tr_b16 a[194:195], v16 offset:4096
    v_mfma_f32_16x16x32_bf16 v[236:239], a[168:171], v[72:75], v[236:239]
    ds_read_b64_tr_b16 a[196:197], v16 offset:8192
    s_waitcnt lgkmcnt(9)
    v_mfma_f32_16x16x32_bf16 v[112:115], a[176:179], v[88:91], v[112:115]
    buffer_load_dwordx4 v38, s[20:23], s35 offen offset:0 sc1 lds
    v_mfma_f32_16x16x32_bf16 v[112:115], a[180:183], v[92:95], v[112:115]
    ds_read_b64_tr_b16 a[198:199], v16 offset:12288
    s_waitcnt lgkmcnt(8)
    v_mfma_f32_16x16x32_bf16 v[128:131], a[180:183], v[100:103], v[128:131]
    ds_read_b64_tr_b16 a[200:201], v16 offset:8
    v_mfma_f32_16x16x32_bf16 v[128:131], a[176:179], v[96:99], v[128:131]
    ds_read_b64_tr_b16 a[202:203], v16 offset:4104
    s_waitcnt lgkmcnt(6)
    v_mfma_f32_16x16x32_bf16 v[132:135], a[184:187], v[96:99], v[132:135]
    ds_read_b64_tr_b16 a[204:205], v16 offset:8200
    v_mfma_f32_16x16x32_bf16 v[132:135], a[188:191], v[100:103], v[132:135]
    buffer_load_dwordx4 v38, s[20:23], s35 offen offset:1024 sc1 lds
    v_mfma_f32_16x16x32_bf16 v[116:119], a[188:191], v[92:95], v[116:119]
    ds_read_b64_tr_b16 a[206:207], v16 offset:12296
    v_mfma_f32_16x16x32_bf16 v[116:119], a[184:187], v[88:91], v[116:119]
    ds_read_b128 v[104:107], v10 offset:2048
    s_waitcnt lgkmcnt(5)
    v_mfma_f32_16x16x32_bf16 v[120:123], a[192:195], v[88:91], v[120:123]
    ds_read_b128 v[108:111], v10 offset:20480
    v_mfma_f32_16x16x32_bf16 v[120:123], a[196:199], v[92:95], v[120:123]
    ds_read_b128 v[64:67], v10 offset:3072
    v_mfma_f32_16x16x32_bf16 v[136:139], a[196:199], v[100:103], v[136:139]
    buffer_load_dwordx4 v38, s[20:23], s35 offen offset:2048 sc1 lds
    v_mfma_f32_16x16x32_bf16 v[136:139], a[192:195], v[96:99], v[136:139]
    ds_read_b128 v[68:71], v10 offset:21504
    s_waitcnt lgkmcnt(4)
    v_mfma_f32_16x16x32_bf16 v[140:143], a[200:203], v[96:99], v[140:143]
    ds_read_b128 v[72:75], v10 offset:4096
    v_mfma_f32_16x16x32_bf16 v[140:143], a[204:207], v[100:103], v[140:143]
    ds_read_b128 v[76:79], v10 offset:22528
    v_mfma_f32_16x16x32_bf16 v[124:127], a[204:207], v[92:95], v[124:127]
    ds_read_b128 v[80:83], v10 offset:5120
    s_waitcnt lgkmcnt(3)
    v_mfma_f32_16x16x32_bf16 v[124:127], a[200:203], v[88:91], v[124:127]
    buffer_load_dwordx4 v38, s[20:23], s35 offen offset:3072 sc1 lds
    v_mfma_f32_16x16x32_bf16 v[144:147], a[176:179], v[104:107], v[144:147]
    s_add_u32 m0, s44, 57344
    s_add_u32 s35, s100, 1294336
    v_mfma_f32_16x16x32_bf16 v[144:147], a[180:183], v[108:111], v[144:147]
    ds_read_b128 v[84:87], v10 offset:23552
    v_mfma_f32_16x16x32_bf16 v[160:163], a[180:183], v[68:71], v[160:163]
    v_mfma_f32_16x16x32_bf16 v[160:163], a[176:179], v[64:67], v[160:163]
    v_mfma_f32_16x16x32_bf16 v[164:167], a[184:187], v[64:67], v[164:167]
    buffer_load_dwordx4 v38, s[20:23], s35 offen offset:0 sc1 lds
    v_mfma_f32_16x16x32_bf16 v[164:167], a[188:191], v[68:71], v[164:167]
    v_mfma_f32_16x16x32_bf16 v[148:151], a[188:191], v[108:111], v[148:151]
    v_mfma_f32_16x16x32_bf16 v[148:151], a[184:187], v[104:107], v[148:151]
    v_mfma_f32_16x16x32_bf16 v[152:155], a[192:195], v[104:107], v[152:155]
    v_mfma_f32_16x16x32_bf16 v[152:155], a[196:199], v[108:111], v[152:155]
    buffer_load_dwordx4 v38, s[20:23], s35 offen offset:1024 sc1 lds
    v_mfma_f32_16x16x32_bf16 v[168:171], a[196:199], v[68:71], v[168:171]
    v_mfma_f32_16x16x32_bf16 v[168:171], a[192:195], v[64:67], v[168:171]
    v_mfma_f32_16x16x32_bf16 v[172:175], a[200:203], v[64:67], v[172:175]
    ds_read_b128 v[88:91], v10 offset:6144
    v_mfma_f32_16x16x32_bf16 v[172:175], a[204:207], v[68:71], v[172:175]
    ds_read_b128 v[92:95], v10 offset:24576
    v_mfma_f32_16x16x32_bf16 v[156:159], a[204:207], v[108:111], v[156:159]
    buffer_load_dwordx4 v38, s[20:23], s35 offen offset:2048 sc1 lds
    v_mfma_f32_16x16x32_bf16 v[156:159], a[200:203], v[104:107], v[156:159]
    s_waitcnt lgkmcnt(2)
    v_mfma_f32_16x16x32_bf16 v[176:179], a[176:179], v[72:75], v[176:179]
    v_mfma_f32_16x16x32_bf16 v[176:179], a[180:183], v[76:79], v[176:179]
    v_mfma_f32_16x16x32_bf16 v[192:195], a[180:183], v[84:87], v[192:195]
    v_mfma_f32_16x16x32_bf16 v[192:195], a[176:179], v[80:83], v[192:195]
    buffer_load_dwordx4 v38, s[20:23], s35 offen offset:3072 sc1 lds
    v_mfma_f32_16x16x32_bf16 v[196:199], a[184:187], v[80:83], v[196:199]
    s_add_u32 m0, s44, 61440
    s_add_u32 s35, s100, 1298432
    v_mfma_f32_16x16x32_bf16 v[196:199], a[188:191], v[84:87], v[196:199]
    ds_read_b128 v[96:99], v10 offset:7168
    v_mfma_f32_16x16x32_bf16 v[180:183], a[188:191], v[76:79], v[180:183]
    ds_read_b128 v[100:103], v10 offset:25600
    v_mfma_f32_16x16x32_bf16 v[180:183], a[184:187], v[72:75], v[180:183]
    ds_read_b128 v[104:107], v10 offset:8192
    v_mfma_f32_16x16x32_bf16 v[184:187], a[192:195], v[72:75], v[184:187]
    buffer_load_dwordx4 v38, s[20:23], s35 offen offset:0 sc1 lds
    v_mfma_f32_16x16x32_bf16 v[184:187], a[196:199], v[76:79], v[184:187]
    ds_read_b128 v[108:111], v10 offset:26624
    v_mfma_f32_16x16x32_bf16 v[200:203], a[196:199], v[84:87], v[200:203]
    v_mfma_f32_16x16x32_bf16 v[200:203], a[192:195], v[80:83], v[200:203]
    v_mfma_f32_16x16x32_bf16 v[204:207], a[200:203], v[80:83], v[204:207]
    v_mfma_f32_16x16x32_bf16 v[204:207], a[204:207], v[84:87], v[204:207]
    v_mfma_f32_16x16x32_bf16 v[188:191], a[204:207], v[76:79], v[188:191]
    v_mfma_f32_16x16x32_bf16 v[188:191], a[200:203], v[72:75], v[188:191]
    s_waitcnt vmcnt(13)
    v_cmp_ne_u32 vcc, 1, v30
    s_nop 3
    s_bitcmp1_b32 vcc_lo, 2
    s_cbranch_scc1 L_spin18_2
L_back18_2:
    s_waitcnt lgkmcnt(0)
    v_mfma_f32_16x16x32_bf16 v[208:211], a[176:179], v[88:91], v[208:211]
    v_mfma_f32_16x16x32_bf16 v[208:211], a[180:183], v[92:95], v[208:211]
    s_waitcnt lgkmcnt(15)
    s_waitcnt vmcnt(63)
    v_mfma_f32_16x16x32_bf16 v[212:215], a[188:191], v[92:95], v[212:215]
    s_barrier
    v_mfma_f32_16x16x32_bf16 v[212:215], a[184:187], v[88:91], v[212:215]
    s_add_u32 m0, s29, 143360
    s_add_u32 s35, s101, 655360
    v_mfma_f32_16x16x32_bf16 v[216:219], a[192:195], v[88:91], v[216:219]
    buffer_load_dwordx4 v44, s[24:27], s35 offen offset:0 lds
    v_mfma_f32_16x16x32_bf16 v[216:219], a[196:199], v[92:95], v[216:219]
    ds_read_b64_tr_b16 a[144:145], v11 offset:0
    v_mfma_f32_16x16x32_bf16 v[220:223], a[204:207], v[92:95], v[220:223]
    ds_read_b64_tr_b16 a[146:147], v11 offset:4096
    v_mfma_f32_16x16x32_bf16 v[220:223], a[200:203], v[88:91], v[220:223]
    ds_read_b128 v[64:67], v8 offset:0
    v_mfma_f32_16x16x32_bf16 v[224:227], a[176:179], v[96:99], v[224:227]
    ds_read_b64_tr_b16 a[148:149], v11 offset:8192
    v_mfma_f32_16x16x32_bf16 v[224:227], a[180:183], v[100:103], v[224:227]
    buffer_load_dwordx4 v45, s[24:27], s35 offen offset:1024 lds
    v_mfma_f32_16x16x32_bf16 v[240:243], a[180:183], v[108:111], v[240:243]
    ds_read_b64_tr_b16 a[150:151], v11 offset:12288
    v_mfma_f32_16x16x32_bf16 v[240:243], a[176:179], v[104:107], v[240:243]
    ds_read_b128 v[68:71], v8 offset:18432
    v_mfma_f32_16x16x32_bf16 v[244:247], a[184:187], v[104:107], v[244:247]
    ds_read_b128 v[72:75], v8 offset:1024
    v_mfma_f32_16x16x32_bf16 v[244:247], a[188:191], v[108:111], v[244:247]
    ds_read_b128 v[76:79], v8 offset:19456
    v_mfma_f32_16x16x32_bf16 v[228:231], a[188:191], v[100:103], v[228:231]
    buffer_load_dwordx4 v46, s[24:27], s35 offen offset:2048 lds
    v_mfma_f32_16x16x32_bf16 v[228:231], a[184:187], v[96:99], v[228:231]
    ds_read_b64_tr_b16 a[152:153], v11 offset:8
    v_mfma_f32_16x16x32_bf16 v[232:235], a[192:195], v[96:99], v[232:235]
    ds_read_b64_tr_b16 a[154:155], v11 offset:4104
    v_mfma_f32_16x16x32_bf16 v[232:235], a[196:199], v[100:103], v[232:235]
    ds_read_b64_tr_b16 a[156:157], v11 offset:8200
    v_mfma_f32_16x16x32_bf16 v[248:251], a[196:199], v[108:111], v[248:251]
    ds_read_b64_tr_b16 a[158:159], v11 offset:12296
    v_mfma_f32_16x16x32_bf16 v[248:251], a[192:195], v[104:107], v[248:251]
    buffer_load_dwordx4 v47, s[24:27], s35 offen offset:3072 lds
    v_mfma_f32_16x16x32_bf16 v[252:255], a[200:203], v[104:107], v[252:255]
    s_add_u32 m0, s44, 106496
    s_add_u32 s35, s100, 1327104
    v_mfma_f32_16x16x32_bf16 v[252:255], a[204:207], v[108:111], v[252:255]
    ds_read_b64_tr_b16 a[160:161], v14 offset:0
    v_mfma_f32_16x16x32_bf16 v[236:239], a[204:207], v[100:103], v[236:239]
    ds_read_b64_tr_b16 a[162:163], v14 offset:4096
    v_mfma_f32_16x16x32_bf16 v[236:239], a[200:203], v[96:99], v[236:239]
    ds_read_b64_tr_b16 a[164:165], v14 offset:8192
    s_waitcnt lgkmcnt(9)
    v_mfma_f32_16x16x32_bf16 v[112:115], a[144:147], v[64:67], v[112:115]
    buffer_load_dwordx4 v38, s[20:23], s35 offen offset:0 sc1 lds
    v_mfma_f32_16x16x32_bf16 v[112:115], a[148:151], v[68:71], v[112:115]
    ds_read_b64_tr_b16 a[166:167], v14 offset:12288
    s_waitcnt lgkmcnt(8)
    v_mfma_f32_16x16x32_bf16 v[128:131], a[148:151], v[76:79], v[128:131]
    ds_read_b64_tr_b16 a[168:169], v14 offset:8
    v_mfma_f32_16x16x32_bf16 v[128:131], a[144:147], v[72:75], v[128:131]
    ds_read_b64_tr_b16 a[170:171], v14 offset:4104
    s_waitcnt lgkmcnt(6)
    v_mfma_f32_16x16x32_bf16 v[132:135], a[152:155], v[72:75], v[132:135]
    ds_read_b64_tr_b16 a[172:173], v14 offset:8200
    v_mfma_f32_16x16x32_bf16 v[132:135], a[156:159], v[76:79], v[132:135]
    buffer_load_dwordx4 v38, s[20:23], s35 offen offset:1024 sc1 lds
    v_mfma_f32_16x16x32_bf16 v[116:119], a[156:159], v[68:71], v[116:119]
    ds_read_b64_tr_b16 a[174:175], v14 offset:12296
    v_mfma_f32_16x16x32_bf16 v[116:119], a[152:155], v[64:67], v[116:119]
    ds_read_b128 v[80:83], v8 offset:2048
    s_waitcnt lgkmcnt(5)
    v_mfma_f32_16x16x32_bf16 v[120:123], a[160:163], v[64:67], v[120:123]
    ds_read_b128 v[84:87], v8 offset:20480
    v_mfma_f32_16x16x32_bf16 v[120:123], a[164:167], v[68:71], v[120:123]
    ds_read_b128 v[88:91], v8 offset:3072
    v_mfma_f32_16x16x32_bf16 v[136:139], a[164:167], v[76:79], v[136:139]
    buffer_load_dwordx4 v38, s[20:23], s35 offen offset:2048 sc1 lds
    v_mfma_f32_16x16x32_bf16 v[136:139], a[160:163], v[72:75], v[136:139]
    ds_read_b128 v[92:95], v8 offset:21504
    s_waitcnt lgkmcnt(4)
    v_mfma_f32_16x16x32_bf16 v[140:143], a[168:171], v[72:75], v[140:143]
    ds_read_b128 v[96:99], v8 offset:4096
    v_mfma_f32_16x16x32_bf16 v[140:143], a[172:175], v[76:79], v[140:143]
    ds_read_b128 v[100:103], v8 offset:22528
    v_mfma_f32_16x16x32_bf16 v[124:127], a[172:175], v[68:71], v[124:127]
    ds_read_b128 v[104:107], v8 offset:5120
    s_waitcnt lgkmcnt(3)
    v_mfma_f32_16x16x32_bf16 v[124:127], a[168:171], v[64:67], v[124:127]
    buffer_load_dwordx4 v38, s[20:23], s35 offen offset:3072 sc1 lds
    v_mfma_f32_16x16x32_bf16 v[144:147], a[144:147], v[80:83], v[144:147]
    s_add_u32 m0, s44, 110592
    s_add_u32 s35, s100, 1331200
    v_mfma_f32_16x16x32_bf16 v[144:147], a[148:151], v[84:87], v[144:147]
    ds_read_b128 v[108:111], v8 offset:23552
    v_mfma_f32_16x16x32_bf16 v[160:163], a[148:151], v[92:95], v[160:163]
    v_mfma_f32_16x16x32_bf16 v[160:163], a[144:147], v[88:91], v[160:163]
    v_mfma_f32_16x16x32_bf16 v[164:167], a[152:155], v[88:91], v[164:167]
    buffer_load_dwordx4 v38, s[20:23], s35 offen offset:0 sc1 lds
    v_mfma_f32_16x16x32_bf16 v[164:167], a[156:159], v[92:95], v[164:167]
    v_mfma_f32_16x16x32_bf16 v[148:151], a[156:159], v[84:87], v[148:151]
    v_mfma_f32_16x16x32_bf16 v[148:151], a[152:155], v[80:83], v[148:151]
    v_mfma_f32_16x16x32_bf16 v[152:155], a[160:163], v[80:83], v[152:155]
    v_mfma_f32_16x16x32_bf16 v[152:155], a[164:167], v[84:87], v[152:155]
    buffer_load_dwordx4 v38, s[20:23], s35 offen offset:1024 sc1 lds
    v_mfma_f32_16x16x32_bf16 v[168:171], a[164:167], v[92:95], v[168:171]
    v_mfma_f32_16x16x32_bf16 v[168:171], a[160:163], v[88:91], v[168:171]
    v_mfma_f32_16x16x32_bf16 v[172:175], a[168:171], v[88:91], v[172:175]
    ds_read_b128 v[64:67], v8 offset:6144
    v_mfma_f32_16x16x32_bf16 v[172:175], a[172:175], v[92:95], v[172:175]
    ds_read_b128 v[68:71], v8 offset:24576
    v_mfma_f32_16x16x32_bf16 v[156:159], a[172:175], v[84:87], v[156:159]
    buffer_load_dwordx4 v38, s[20:23], s35 offen offset:2048 sc1 lds
    v_mfma_f32_16x16x32_bf16 v[156:159], a[168:171], v[80:83], v[156:159]
    s_waitcnt lgkmcnt(2)
    v_mfma_f32_16x16x32_bf16 v[176:179], a[144:147], v[96:99], v[176:179]
    v_mfma_f32_16x16x32_bf16 v[176:179], a[148:151], v[100:103], v[176:179]
    v_mfma_f32_16x16x32_bf16 v[192:195], a[148:151], v[108:111], v[192:195]
    v_mfma_f32_16x16x32_bf16 v[192:195], a[144:147], v[104:107], v[192:195]
    buffer_load_dwordx4 v38, s[20:23], s35 offen offset:3072 sc1 lds
    v_mfma_f32_16x16x32_bf16 v[196:199], a[152:155], v[104:107], v[196:199]
    s_add_u32 m0, s44, 114688
    s_add_u32 s35, s100, 1335296
    v_mfma_f32_16x16x32_bf16 v[196:199], a[156:159], v[108:111], v[196:199]
    ds_read_b128 v[72:75], v8 offset:7168
    v_mfma_f32_16x16x32_bf16 v[180:183], a[156:159], v[100:103], v[180:183]
    ds_read_b128 v[76:79], v8 offset:25600
    v_mfma_f32_16x16x32_bf16 v[180:183], a[152:155], v[96:99], v[180:183]
    ds_read_b128 v[80:83], v8 offset:8192
    v_mfma_f32_16x16x32_bf16 v[184:187], a[160:163], v[96:99], v[184:187]
    buffer_load_dwordx4 v38, s[20:23], s35 offen offset:0 sc1 lds
    v_mfma_f32_16x16x32_bf16 v[184:187], a[164:167], v[100:103], v[184:187]
    ds_read_b128 v[84:87], v8 offset:26624
    v_mfma_f32_16x16x32_bf16 v[200:203], a[164:167], v[108:111], v[200:203]
    v_mfma_f32_16x16x32_bf16 v[200:203], a[160:163], v[104:107], v[200:203]
    v_mfma_f32_16x16x32_bf16 v[204:207], a[168:171], v[104:107], v[204:207]
    v_mfma_f32_16x16x32_bf16 v[204:207], a[172:175], v[108:111], v[204:207]
    v_mfma_f32_16x16x32_bf16 v[188:191], a[172:175], v[100:103], v[188:191]
    buffer_load_dword v30, v33, s[96:99], s91 offen sc1
    v_mfma_f32_16x16x32_bf16 v[188:191], a[168:171], v[96:99], v[188:191]
    s_waitcnt lgkmcnt(0)
    v_mfma_f32_16x16x32_bf16 v[208:211], a[144:147], v[64:67], v[208:211]
    v_mfma_f32_16x16x32_bf16 v[208:211], a[148:151], v[68:71], v[208:211]
    s_waitcnt lgkmcnt(15)
    s_waitcnt vmcnt(14)
    v_mfma_f32_16x16x32_bf16 v[212:215], a[156:159], v[68:71], v[212:215]
    s_barrier
    v_mfma_f32_16x16x32_bf16 v[212:215], a[152:155], v[64:67], v[212:215]
    s_add_u32 m0, s29, 36864
    s_add_u32 s35, s101, 720896
    v_mfma_f32_16x16x32_bf16 v[216:219], a[160:163], v[64:67], v[216:219]
    buffer_load_dwordx4 v44, s[24:27], s35 offen offset:0 lds
    v_mfma_f32_16x16x32_bf16 v[216:219], a[164:167], v[68:71], v[216:219]
    ds_read_b64_tr_b16 a[176:177], v12 offset:0
    v_mfma_f32_16x16x32_bf16 v[220:223], a[172:175], v[68:71], v[220:223]
    ds_read_b64_tr_b16 a[178:179], v12 offset:4096
    v_mfma_f32_16x16x32_bf16 v[220:223], a[168:171], v[64:67], v[220:223]
    ds_read_b128 v[88:91], v9 offset:0
    v_mfma_f32_16x16x32_bf16 v[224:227], a[144:147], v[72:75], v[224:227]
    ds_read_b64_tr_b16 a[180:181], v12 offset:8192
    v_mfma_f32_16x16x32_bf16 v[224:227], a[148:151], v[76:79], v[224:227]
    buffer_load_dwordx4 v45, s[24:27], s35 offen offset:1024 lds
    v_mfma_f32_16x16x32_bf16 v[240:243], a[148:151], v[84:87], v[240:243]
    ds_read_b64_tr_b16 a[182:183], v12 offset:12288
    v_mfma_f32_16x16x32_bf16 v[240:243], a[144:147], v[80:83], v[240:243]
    ds_read_b128 v[92:95], v9 offset:18432
    v_mfma_f32_16x16x32_bf16 v[244:247], a[152:155], v[80:83], v[244:247]
    ds_read_b128 v[96:99], v9 offset:1024
    v_mfma_f32_16x16x32_bf16 v[244:247], a[156:159], v[84:87], v[244:247]
    ds_read_b128 v[100:103], v9 offset:19456
    v_mfma_f32_16x16x32_bf16 v[228:231], a[156:159], v[76:79], v[228:231]
    buffer_load_dwordx4 v46, s[24:27], s35 offen offset:2048 lds
    v_mfma_f32_16x16x32_bf16 v[228:231], a[152:155], v[72:75], v[228:231]
    ds_read_b64_tr_b16 a[184:185], v12 offset:8
    v_mfma_f32_16x16x32_bf16 v[232:235], a[160:163], v[72:75], v[232:235]
    ds_read_b64_tr_b16 a[186:187], v12 offset:4104
    v_mfma_f32_16x16x32_bf16 v[232:235], a[164:167], v[76:79], v[232:235]
    ds_read_b64_tr_b16 a[188:189], v12 offset:8200
    v_mfma_f32_16x16x32_bf16 v[248:251], a[164:167], v[84:87], v[248:251]
    ds_read_b64_tr_b16 a[190:191], v12 offset:12296
    v_mfma_f32_16x16x32_bf16 v[248:251], a[160:163], v[80:83], v[248:251]
    buffer_load_dwordx4 v47, s[24:27], s35 offen offset:3072 lds
    v_mfma_f32_16x16x32_bf16 v[252:255], a[168:171], v[80:83], v[252:255]
    s_add_u32 m0, s44, 0
    s_add_u32 s35, s100, 1363968
    v_mfma_f32_16x16x32_bf16 v[252:255], a[172:175], v[84:87], v[252:255]
    ds_read_b64_tr_b16 a[192:193], v15 offset:0
    v_mfma_f32_16x16x32_bf16 v[236:239], a[172:175], v[76:79], v[236:239]
    ds_read_b64_tr_b16 a[194:195], v15 offset:4096
    v_mfma_f32_16x16x32_bf16 v[236:239], a[168:171], v[72:75], v[236:239]
    ds_read_b64_tr_b16 a[196:197], v15 offset:8192
    s_waitcnt lgkmcnt(9)
    v_mfma_f32_16x16x32_bf16 v[112:115], a[176:179], v[88:91], v[112:115]
    buffer_load_dwordx4 v38, s[20:23], s35 offen offset:0 sc1 lds
    v_mfma_f32_16x16x32_bf16 v[112:115], a[180:183], v[92:95], v[112:115]
    ds_read_b64_tr_b16 a[198:199], v15 offset:12288
    s_waitcnt lgkmcnt(8)
    v_mfma_f32_16x16x32_bf16 v[128:131], a[180:183], v[100:103], v[128:131]
    ds_read_b64_tr_b16 a[200:201], v15 offset:8
    v_mfma_f32_16x16x32_bf16 v[128:131], a[176:179], v[96:99], v[128:131]
    ds_read_b64_tr_b16 a[202:203], v15 offset:4104
    s_waitcnt lgkmcnt(6)
    v_mfma_f32_16x16x32_bf16 v[132:135], a[184:187], v[96:99], v[132:135]
    ds_read_b64_tr_b16 a[204:205], v15 offset:8200
    v_mfma_f32_16x16x32_bf16 v[132:135], a[188:191], v[100:103], v[132:135]
    buffer_load_dwordx4 v38, s[20:23], s35 offen offset:1024 sc1 lds
    v_mfma_f32_16x16x32_bf16 v[116:119], a[188:191], v[92:95], v[116:119]
    ds_read_b64_tr_b16 a[206:207], v15 offset:12296
    v_mfma_f32_16x16x32_bf16 v[116:119], a[184:187], v[88:91], v[116:119]
    ds_read_b128 v[104:107], v9 offset:2048
    s_waitcnt lgkmcnt(5)
    v_mfma_f32_16x16x32_bf16 v[120:123], a[192:195], v[88:91], v[120:123]
    ds_read_b128 v[108:111], v9 offset:20480
    v_mfma_f32_16x16x32_bf16 v[120:123], a[196:199], v[92:95], v[120:123]
    ds_read_b128 v[64:67], v9 offset:3072
    v_mfma_f32_16x16x32_bf16 v[136:139], a[196:199], v[100:103], v[136:139]
    buffer_load_dwordx4 v38, s[20:23], s35 offen offset:2048 sc1 lds
    v_mfma_f32_16x16x32_bf16 v[136:139], a[192:195], v[96:99], v[136:139]
    ds_read_b128 v[68:71], v9 offset:21504
    s_waitcnt lgkmcnt(4)
    v_mfma_f32_16x16x32_bf16 v[140:143], a[200:203], v[96:99], v[140:143]
    ds_read_b128 v[72:75], v9 offset:4096
    v_mfma_f32_16x16x32_bf16 v[140:143], a[204:207], v[100:103], v[140:143]
    ds_read_b128 v[76:79], v9 offset:22528
    v_mfma_f32_16x16x32_bf16 v[124:127], a[204:207], v[92:95], v[124:127]
    ds_read_b128 v[80:83], v9 offset:5120
    s_waitcnt lgkmcnt(3)
    v_mfma_f32_16x16x32_bf16 v[124:127], a[200:203], v[88:91], v[124:127]
    buffer_load_dwordx4 v38, s[20:23], s35 offen offset:3072 sc1 lds
    v_mfma_f32_16x16x32_bf16 v[144:147], a[176:179], v[104:107], v[144:147]
    s_add_u32 m0, s44, 4096
    s_add_u32 s35, s100, 1368064
    v_mfma_f32_16x16x32_bf16 v[144:147], a[180:183], v[108:111], v[144:147]
    ds_read_b128 v[84:87], v9 offset:23552
    v_mfma_f32_16x16x32_bf16 v[160:163], a[180:183], v[68:71], v[160:163]
    v_mfma_f32_16x16x32_bf16 v[160:163], a[176:179], v[64:67], v[160:163]
    v_mfma_f32_16x16x32_bf16 v[164:167], a[184:187], v[64:67], v[164:167]
    buffer_load_dwordx4 v38, s[20:23], s35 offen offset:0 sc1 lds
    v_mfma_f32_16x16x32_bf16 v[164:167], a[188:191], v[68:71], v[164:167]
    v_mfma_f32_16x16x32_bf16 v[148:151], a[188:191], v[108:111], v[148:151]
    v_mfma_f32_16x16x32_bf16 v[148:151], a[184:187], v[104:107], v[148:151]
    v_mfma_f32_16x16x32_bf16 v[152:155], a[192:195], v[104:107], v[152:155]
    v_mfma_f32_16x16x32_bf16 v[152:155], a[196:199], v[108:111], v[152:155]
    buffer_load_dwordx4 v38, s[20:23], s35 offen offset:1024 sc1 lds
    v_mfma_f32_16x16x32_bf16 v[168:171], a[196:199], v[68:71], v[168:171]
    v_mfma_f32_16x16x32_bf16 v[168:171], a[192:195], v[64:67], v[168:171]
    v_mfma_f32_16x16x32_bf16 v[172:175], a[200:203], v[64:67], v[172:175]
    ds_read_b128 v[88:91], v9 offset:6144
    v_mfma_f32_16x16x32_bf16 v[172:175], a[204:207], v[68:71], v[172:175]
    ds_read_b128 v[92:95], v9 offset:24576
    v_mfma_f32_16x16x32_bf16 v[156:159], a[204:207], v[108:111], v[156:159]
    buffer_load_dwordx4 v38, s[20:23], s35 offen offset:2048 sc1 lds
    v_mfma_f32_16x16x32_bf16 v[156:159], a[200:203], v[104:107], v[156:159]
    s_waitcnt lgkmcnt(2)
    v_mfma_f32_16x16x32_bf16 v[176:179], a[176:179], v[72:75], v[176:179]
    v_mfma_f32_16x16x32_bf16 v[176:179], a[180:183], v[76:79], v[176:179]
    v_mfma_f32_16x16x32_bf16 v[192:195], a[180:183], v[84:87], v[192:195]
    v_mfma_f32_16x16x32_bf16 v[192:195], a[176:179], v[80:83], v[192:195]
    buffer_load_dwordx4 v38, s[20:23], s35 offen offset:3072 sc1 lds
    v_mfma_f32_16x16x32_bf16 v[196:199], a[184:187], v[80:83], v[196:199]
    s_add_u32 m0, s44, 8192
    s_add_u32 s35, s100, 1372160
    v_mfma_f32_16x16x32_bf16 v[196:199], a[188:191], v[84:87], v[196:199]
    ds_read_b128 v[96:99], v9 offset:7168
    v_mfma_f32_16x16x32_bf16 v[180:183], a[188:191], v[76:79], v[180:183]
    ds_read_b128 v[100:103], v9 offset:25600
    v_mfma_f32_16x16x32_bf16 v[180:183], a[184:187], v[72:75], v[180:183]
    ds_read_b128 v[104:107], v9 offset:8192
    v_mfma_f32_16x16x32_bf16 v[184:187], a[192:195], v[72:75], v[184:187]
    buffer_load_dwordx4 v38, s[20:23], s35 offen offset:0 sc1 lds
    v_mfma_f32_16x16x32_bf16 v[184:187], a[196:199], v[76:79], v[184:187]
    ds_read_b128 v[108:111], v9 offset:26624
    v_mfma_f32_16x16x32_bf16 v[200:203], a[196:199], v[84:87], v[200:203]
    v_mfma_f32_16x16x32_bf16 v[200:203], a[192:195], v[80:83], v[200:203]
    v_mfma_f32_16x16x32_bf16 v[204:207], a[200:203], v[80:83], v[204:207]
    v_mfma_f32_16x16x32_bf16 v[204:207], a[204:207], v[84:87], v[204:207]
    v_mfma_f32_16x16x32_bf16 v[188:191], a[204:207], v[76:79], v[188:191]
    v_mfma_f32_16x16x32_bf16 v[188:191], a[200:203], v[72:75], v[188:191]
    s_waitcnt vmcnt(13)
    v_cmp_ne_u32 vcc, 1, v30
    s_nop 3
    s_bitcmp1_b32 vcc_lo, 3
    s_cbranch_scc1 L_spin18_3
L_back18_3:
    s_waitcnt lgkmcnt(0)
    v_mfma_f32_16x16x32_bf16 v[208:211], a[176:179], v[88:91], v[208:211]
    v_mfma_f32_16x16x32_bf16 v[208:211], a[180:183], v[92:95], v[208:211]
    s_waitcnt lgkmcnt(15)
    s_waitcnt vmcnt(63)
    v_mfma_f32_16x16x32_bf16 v[212:215], a[188:191], v[92:95], v[212:215]
    s_barrier
    v_mfma_f32_16x16x32_bf16 v[212:215], a[184:187], v[88:91], v[212:215]
    s_add_u32 m0, s29, 90112
    s_add_u32 s35, s101, 917504
    v_mfma_f32_16x16x32_bf16 v[216:219], a[192:195], v[88:91], v[216:219]
    buffer_load_dwordx4 v44, s[24:27], s35 offen offset:0 lds
    v_mfma_f32_16x16x32_bf16 v[216:219], a[196:199], v[92:95], v[216:219]
    ds_read_b64_tr_b16 a[144:145], v13 offset:0
    v_mfma_f32_16x16x32_bf16 v[220:223], a[204:207], v[92:95], v[220:223]
    ds_read_b64_tr_b16 a[146:147], v13 offset:4096
    v_mfma_f32_16x16x32_bf16 v[220:223], a[200:203], v[88:91], v[220:223]
    ds_read_b128 v[64:67], v10 offset:0
    v_mfma_f32_16x16x32_bf16 v[224:227], a[176:179], v[96:99], v[224:227]
    ds_read_b64_tr_b16 a[148:149], v13 offset:8192
    v_mfma_f32_16x16x32_bf16 v[224:227], a[180:183], v[100:103], v[224:227]
    buffer_load_dwordx4 v45, s[24:27], s35 offen offset:1024 lds
    v_mfma_f32_16x16x32_bf16 v[240:243], a[180:183], v[108:111], v[240:243]
    ds_read_b64_tr_b16 a[150:151], v13 offset:12288
    v_mfma_f32_16x16x32_bf16 v[240:243], a[176:179], v[104:107], v[240:243]
    ds_read_b128 v[68:71], v10 offset:18432
    v_mfma_f32_16x16x32_bf16 v[244:247], a[184:187], v[104:107], v[244:247]
    ds_read_b128 v[72:75], v10 offset:1024
    v_mfma_f32_16x16x32_bf16 v[244:247], a[188:191], v[108:111], v[244:247]
    ds_read_b128 v[76:79], v10 offset:19456
    v_mfma_f32_16x16x32_bf16 v[228:231], a[188:191], v[100:103], v[228:231]
    buffer_load_dwordx4 v46, s[24:27], s35 offen offset:2048 lds
    v_mfma_f32_16x16x32_bf16 v[228:231], a[184:187], v[96:99], v[228:231]
    ds_read_b64_tr_b16 a[152:153], v13 offset:8
    v_mfma_f32_16x16x32_bf16 v[232:235], a[192:195], v[96:99], v[232:235]
    ds_read_b64_tr_b16 a[154:155], v13 offset:4104
    v_mfma_f32_16x16x32_bf16 v[232:235], a[196:199], v[100:103], v[232:235]
    ds_read_b64_tr_b16 a[156:157], v13 offset:8200
    v_mfma_f32_16x16x32_bf16 v[248:251], a[196:199], v[108:111], v[248:251]
    ds_read_b64_tr_b16 a[158:159], v13 offset:12296
    v_mfma_f32_16x16x32_bf16 v[248:251], a[192:195], v[104:107], v[248:251]
    buffer_load_dwordx4 v47, s[24:27], s35 offen offset:3072 lds
    v_mfma_f32_16x16x32_bf16 v[252:255], a[200:203], v[104:107], v[252:255]
    s_add_u32 m0, s44, 53248
    s_add_u32 s35, s100, 1400832
    v_mfma_f32_16x16x32_bf16 v[252:255], a[204:207], v[108:111], v[252:255]
    ds_read_b64_tr_b16 a[160:161], v16 offset:0
    v_mfma_f32_16x16x32_bf16 v[236:239], a[204:207], v[100:103], v[236:239]
    ds_read_b64_tr_b16 a[162:163], v16 offset:4096
    v_mfma_f32_16x16x32_bf16 v[236:239], a[200:203], v[96:99], v[236:239]
    ds_read_b64_tr_b16 a[164:165], v16 offset:8192
    s_waitcnt lgkmcnt(9)
    v_mfma_f32_16x16x32_bf16 v[112:115], a[144:147], v[64:67], v[112:115]
    buffer_load_dwordx4 v38, s[20:23], s35 offen offset:0 sc1 lds
    v_mfma_f32_16x16x32_bf16 v[112:115], a[148:151], v[68:71], v[112:115]
    ds_read_b64_tr_b16 a[166:167], v16 offset:12288
    s_waitcnt lgkmcnt(8)
    v_mfma_f32_16x16x32_bf16 v[128:131], a[148:151], v[76:79], v[128:131]
    ds_read_b64_tr_b16 a[168:169], v16 offset:8
    v_mfma_f32_16x16x32_bf16 v[128:131], a[144:147], v[72:75], v[128:131]
    ds_read_b64_tr_b16 a[170:171], v16 offset:4104
    s_waitcnt lgkmcnt(6)
    v_mfma_f32_16x16x32_bf16 v[132:135], a[152:155], v[72:75], v[132:135]
    ds_read_b64_tr_b16 a[172:173], v16 offset:8200
    v_mfma_f32_16x16x32_bf16 v[132:135], a[156:159], v[76:79], v[132:135]
    buffer_load_dwordx4 v38, s[20:23], s35 offen offset:1024 sc1 lds
    v_mfma_f32_16x16x32_bf16 v[116:119], a[156:159], v[68:71], v[116:119]
    ds_read_b64_tr_b16 a[174:175], v16 offset:12296
    v_mfma_f32_16x16x32_bf16 v[116:119], a[152:155], v[64:67], v[116:119]
    ds_read_b128 v[80:83], v10 offset:2048
    s_waitcnt lgkmcnt(5)
    v_mfma_f32_16x16x32_bf16 v[120:123], a[160:163], v[64:67], v[120:123]
    ds_read_b128 v[84:87], v10 offset:20480
    v_mfma_f32_16x16x32_bf16 v[120:123], a[164:167], v[68:71], v[120:123]
    ds_read_b128 v[88:91], v10 offset:3072
    v_mfma_f32_16x16x32_bf16 v[136:139], a[164:167], v[76:79], v[136:139]
    buffer_load_dwordx4 v38, s[20:23], s35 offen offset:2048 sc1 lds
    v_mfma_f32_16x16x32_bf16 v[136:139], a[160:163], v[72:75], v[136:139]
    ds_read_b128 v[92:95], v10 offset:21504
    s_waitcnt lgkmcnt(4)
    v_mfma_f32_16x16x32_bf16 v[140:143], a[168:171], v[72:75], v[140:143]
    ds_read_b128 v[96:99], v10 offset:4096
    v_mfma_f32_16x16x32_bf16 v[140:143], a[172:175], v[76:79], v[140:143]
    ds_read_b128 v[100:103], v10 offset:22528
    v_mfma_f32_16x16x32_bf16 v[124:127], a[172:175], v[68:71], v[124:127]
    ds_read_b128 v[104:107], v10 offset:5120
    s_waitcnt lgkmcnt(3)
    v_mfma_f32_16x16x32_bf16 v[124:127], a[168:171], v[64:67], v[124:127]
    buffer_load_dwordx4 v38, s[20:23], s35 offen offset:3072 sc1 lds
    v_mfma_f32_16x16x32_bf16 v[144:147], a[144:147], v[80:83], v[144:147]
    s_add_u32 m0, s44, 57344
    s_add_u32 s35, s100, 1404928
    v_mfma_f32_16x16x32_bf16 v[144:147], a[148:151], v[84:87], v[144:147]
    ds_read_b128 v[108:111], v10 offset:23552
    v_mfma_f32_16x16x32_bf16 v[160:163], a[148:151], v[92:95], v[160:163]
    v_mfma_f32_16x16x32_bf16 v[160:163], a[144:147], v[88:91], v[160:163]
    v_mfma_f32_16x16x32_bf16 v[164:167], a[152:155], v[88:91], v[164:167]
    buffer_load_dwordx4 v38, s[20:23], s35 offen offset:0 sc1 lds
    v_mfma_f32_16x16x32_bf16 v[164:167], a[156:159], v[92:95], v[164:167]
    v_mfma_f32_16x16x32_bf16 v[148:151], a[156:159], v[84:87], v[148:151]
    v_mfma_f32_16x16x32_bf16 v[148:151], a[152:155], v[80:83], v[148:151]
    v_mfma_f32_16x16x32_bf16 v[152:155], a[160:163], v[80:83], v[152:155]
    v_mfma_f32_16x16x32_bf16 v[152:155], a[164:167], v[84:87], v[152:155]
    buffer_load_dwordx4 v38, s[20:23], s35 offen offset:1024 sc1 lds
    v_mfma_f32_16x16x32_bf16 v[168:171], a[164:167], v[92:95], v[168:171]
    v_mfma_f32_16x16x32_bf16 v[168:171], a[160:163], v[88:91], v[168:171]
    v_mfma_f32_16x16x32_bf16 v[172:175], a[168:171], v[88:91], v[172:175]
    ds_read_b128 v[64:67], v10 offset:6144
    v_mfma_f32_16x16x32_bf16 v[172:175], a[172:175], v[92:95], v[172:175]
    ds_read_b128 v[68:71], v10 offset:24576
    v_mfma_f32_16x16x32_bf16 v[156:159], a[172:175], v[84:87], v[156:159]
    buffer_load_dwordx4 v38, s[20:23], s35 offen offset:2048 sc1 lds
    v_mfma_f32_16x16x32_bf16 v[156:159], a[168:171], v[80:83], v[156:159]
    s_waitcnt lgkmcnt(2)
    v_mfma_f32_16x16x32_bf16 v[176:179], a[144:147], v[96:99], v[176:179]
    v_mfma_f32_16x16x32_bf16 v[176:179], a[148:151], v[100:103], v[176:179]
    v_mfma_f32_16x16x32_bf16 v[192:195], a[148:151], v[108:111], v[192:195]
    v_mfma_f32_16x16x32_bf16 v[192:195], a[144:147], v[104:107], v[192:195]
    buffer_load_dwordx4 v38, s[20:23], s35 offen offset:3072 sc1 lds
    v_mfma_f32_16x16x32_bf16 v[196:199], a[152:155], v[104:107], v[196:199]
    s_add_u32 m0, s44, 61440
    s_add_u32 s35, s100, 1409024
    v_mfma_f32_16x16x32_bf16 v[196:199], a[156:159], v[108:111], v[196:199]
    ds_read_b128 v[72:75], v10 offset:7168
    v_mfma_f32_16x16x32_bf16 v[180:183], a[156:159], v[100:103], v[180:183]
    ds_read_b128 v[76:79], v10 offset:25600
    v_mfma_f32_16x16x32_bf16 v[180:183], a[152:155], v[96:99], v[180:183]
    ds_read_b128 v[80:83], v10 offset:8192
    v_mfma_f32_16x16x32_bf16 v[184:187], a[160:163], v[96:99], v[184:187]
    buffer_load_dwordx4 v38, s[20:23], s35 offen offset:0 sc1 lds
    v_mfma_f32_16x16x32_bf16 v[184:187], a[164:167], v[100:103], v[184:187]
    ds_read_b128 v[84:87], v10 offset:26624
    v_mfma_f32_16x16x32_bf16 v[200:203], a[164:167], v[108:111], v[200:203]
    v_mfma_f32_16x16x32_bf16 v[200:203], a[160:163], v[104:107], v[200:203]
    v_mfma_f32_16x16x32_bf16 v[204:207], a[168:171], v[104:107], v[204:207]
    v_mfma_f32_16x16x32_bf16 v[204:207], a[172:175], v[108:111], v[204:207]
    v_mfma_f32_16x16x32_bf16 v[188:191], a[172:175], v[100:103], v[188:191]
    v_mfma_f32_16x16x32_bf16 v[188:191], a[168:171], v[96:99], v[188:191]
    s_waitcnt lgkmcnt(0)
    v_mfma_f32_16x16x32_bf16 v[208:211], a[144:147], v[64:67], v[208:211]
    v_mfma_f32_16x16x32_bf16 v[208:211], a[148:151], v[68:71], v[208:211]
    s_waitcnt lgkmcnt(15)
    s_waitcnt vmcnt(13)
    v_mfma_f32_16x16x32_bf16 v[212:215], a[156:159], v[68:71], v[212:215]
    s_barrier
    v_mfma_f32_16x16x32_bf16 v[212:215], a[152:155], v[64:67], v[212:215]
    s_add_u32 m0, s29, 143360
    s_add_u32 s35, s101, 983040
    v_mfma_f32_16x16x32_bf16 v[216:219], a[160:163], v[64:67], v[216:219]
    buffer_load_dwordx4 v44, s[24:27], s35 offen offset:0 lds
    v_mfma_f32_16x16x32_bf16 v[216:219], a[164:167], v[68:71], v[216:219]
    ds_read_b64_tr_b16 a[176:177], v11 offset:0
    v_mfma_f32_16x16x32_bf16 v[220:223], a[172:175], v[68:71], v[220:223]
    ds_read_b64_tr_b16 a[178:179], v11 offset:4096
    v_mfma_f32_16x16x32_bf16 v[220:223], a[168:171], v[64:67], v[220:223]
    ds_read_b128 v[88:91], v8 offset:0
    v_mfma_f32_16x16x32_bf16 v[224:227], a[144:147], v[72:75], v[224:227]
    ds_read_b64_tr_b16 a[180:181], v11 offset:8192
    v_mfma_f32_16x16x32_bf16 v[224:227], a[148:151], v[76:79], v[224:227]
    buffer_load_dwordx4 v45, s[24:27], s35 offen offset:1024 lds
    v_mfma_f32_16x16x32_bf16 v[240:243], a[148:151], v[84:87], v[240:243]
    ds_read_b64_tr_b16 a[182:183], v11 offset:12288
    v_mfma_f32_16x16x32_bf16 v[240:243], a[144:147], v[80:83], v[240:243]
    ds_read_b128 v[92:95], v8 offset:18432
    v_mfma_f32_16x16x32_bf16 v[244:247], a[152:155], v[80:83], v[244:247]
    ds_read_b128 v[96:99], v8 offset:1024
    v_mfma_f32_16x16x32_bf16 v[244:247], a[156:159], v[84:87], v[244:247]
    ds_read_b128 v[100:103], v8 offset:19456
    v_mfma_f32_16x16x32_bf16 v[228:231], a[156:159], v[76:79], v[228:231]
    buffer_load_dwordx4 v46, s[24:27], s35 offen offset:2048 lds
    v_mfma_f32_16x16x32_bf16 v[228:231], a[152:155], v[72:75], v[228:231]
    ds_read_b64_tr_b16 a[184:185], v11 offset:8
    v_mfma_f32_16x16x32_bf16 v[232:235], a[160:163], v[72:75], v[232:235]
    ds_read_b64_tr_b16 a[186:187], v11 offset:4104
    v_mfma_f32_16x16x32_bf16 v[232:235], a[164:167], v[76:79], v[232:235]
    ds_read_b64_tr_b16 a[188:189], v11 offset:8200
    v_mfma_f32_16x16x32_bf16 v[248:251], a[164:167], v[84:87], v[248:251]
    ds_read_b64_tr_b16 a[190:191], v11 offset:12296
    v_mfma_f32_16x16x32_bf16 v[248:251], a[160:163], v[80:83], v[248:251]
    buffer_load_dwordx4 v47, s[24:27], s35 offen offset:3072 lds
    v_mfma_f32_16x16x32_bf16 v[252:255], a[168:171], v[80:83], v[252:255]
    s_add_u32 m0, s44, 106496
    s_add_u32 s35, s100, 1437696
    v_mfma_f32_16x16x32_bf16 v[252:255], a[172:175], v[84:87], v[252:255]
    ds_read_b64_tr_b16 a[192:193], v14 offset:0
    v_mfma_f32_16x16x32_bf16 v[236:239], a[172:175], v[76:79], v[236:239]
    ds_read_b64_tr_b16 a[194:195], v14 offset:4096
    v_mfma_f32_16x16x32_bf16 v[236:239], a[168:171], v[72:75], v[236:239]
    ds_read_b64_tr_b16 a[196:197], v14 offset:8192
    s_waitcnt lgkmcnt(9)
    v_mfma_f32_16x16x32_bf16 v[112:115], a[176:179], v[88:91], v[112:115]
    buffer_load_dwordx4 v38, s[20:23], s35 offen offset:0 sc1 lds
    v_mfma_f32_16x16x32_bf16 v[112:115], a[180:183], v[92:95], v[112:115]
    ds_read_b64_tr_b16 a[198:199], v14 offset:12288
    s_waitcnt lgkmcnt(8)
    v_mfma_f32_16x16x32_bf16 v[128:131], a[180:183], v[100:103], v[128:131]
    ds_read_b64_tr_b16 a[200:201], v14 offset:8
    v_mfma_f32_16x16x32_bf16 v[128:131], a[176:179], v[96:99], v[128:131]
    ds_read_b64_tr_b16 a[202:203], v14 offset:4104
    s_waitcnt lgkmcnt(6)
    v_mfma_f32_16x16x32_bf16 v[132:135], a[184:187], v[96:99], v[132:135]
    ds_read_b64_tr_b16 a[204:205], v14 offset:8200
    v_mfma_f32_16x16x32_bf16 v[132:135], a[188:191], v[100:103], v[132:135]
    buffer_load_dwordx4 v38, s[20:23], s35 offen offset:1024 sc1 lds
    v_mfma_f32_16x16x32_bf16 v[116:119], a[188:191], v[92:95], v[116:119]
    ds_read_b64_tr_b16 a[206:207], v14 offset:12296
    v_mfma_f32_16x16x32_bf16 v[116:119], a[184:187], v[88:91], v[116:119]
    ds_read_b128 v[104:107], v8 offset:2048
    s_waitcnt lgkmcnt(5)
    v_mfma_f32_16x16x32_bf16 v[120:123], a[192:195], v[88:91], v[120:123]
    ds_read_b128 v[108:111], v8 offset:20480
    v_mfma_f32_16x16x32_bf16 v[120:123], a[196:199], v[92:95], v[120:123]
    ds_read_b128 v[64:67], v8 offset:3072
    v_mfma_f32_16x16x32_bf16 v[136:139], a[196:199], v[100:103], v[136:139]
    buffer_load_dwordx4 v38, s[20:23], s35 offen offset:2048 sc1 lds
    v_mfma_f32_16x16x32_bf16 v[136:139], a[192:195], v[96:99], v[136:139]
    ds_read_b128 v[68:71], v8 offset:21504
    s_waitcnt lgkmcnt(4)
    v_mfma_f32_16x16x32_bf16 v[140:143], a[200:203], v[96:99], v[140:143]
    ds_read_b128 v[72:75], v8 offset:4096
    v_mfma_f32_16x16x32_bf16 v[140:143], a[204:207], v[100:103], v[140:143]
    ds_read_b128 v[76:79], v8 offset:22528
    v_mfma_f32_16x16x32_bf16 v[124:127], a[204:207], v[92:95], v[124:127]
    ds_read_b128 v[80:83], v8 offset:5120
    s_waitcnt lgkmcnt(3)
    v_mfma_f32_16x16x32_bf16 v[124:127], a[200:203], v[88:91], v[124:127]
    buffer_load_dwordx4 v38, s[20:23], s35 offen offset:3072 sc1 lds
    v_mfma_f32_16x16x32_bf16 v[144:147], a[176:179], v[104:107], v[144:147]
    s_add_u32 m0, s44, 110592
    s_add_u32 s35, s100, 1441792
    v_mfma_f32_16x16x32_bf16 v[144:147], a[180:183], v[108:111], v[144:147]
    ds_read_b128 v[84:87], v8 offset:23552
    v_mfma_f32_16x16x32_bf16 v[160:163], a[180:183], v[68:71], v[160:163]
    v_mfma_f32_16x16x32_bf16 v[160:163], a[176:179], v[64:67], v[160:163]
    v_mfma_f32_16x16x32_bf16 v[164:167], a[184:187], v[64:67], v[164:167]
    buffer_load_dwordx4 v38, s[20:23], s35 offen offset:0 sc1 lds
    v_mfma_f32_16x16x32_bf16 v[164:167], a[188:191], v[68:71], v[164:167]
    v_mfma_f32_16x16x32_bf16 v[148:151], a[188:191], v[108:111], v[148:151]
    v_mfma_f32_16x16x32_bf16 v[148:151], a[184:187], v[104:107], v[148:151]
    v_mfma_f32_16x16x32_bf16 v[152:155], a[192:195], v[104:107], v[152:155]
    v_mfma_f32_16x16x32_bf16 v[152:155], a[196:199], v[108:111], v[152:155]
    buffer_load_dwordx4 v38, s[20:23], s35 offen offset:1024 sc1 lds
    v_mfma_f32_16x16x32_bf16 v[168:171], a[196:199], v[68:71], v[168:171]
    v_mfma_f32_16x16x32_bf16 v[168:171], a[192:195], v[64:67], v[168:171]
    v_mfma_f32_16x16x32_bf16 v[172:175], a[200:203], v[64:67], v[172:175]
    ds_read_b128 v[88:91], v8 offset:6144
    v_mfma_f32_16x16x32_bf16 v[172:175], a[204:207], v[68:71], v[172:175]
    ds_read_b128 v[92:95], v8 offset:24576
    v_mfma_f32_16x16x32_bf16 v[156:159], a[204:207], v[108:111], v[156:159]
    buffer_load_dwordx4 v38, s[20:23], s35 offen offset:2048 sc1 lds
    v_mfma_f32_16x16x32_bf16 v[156:159], a[200:203], v[104:107], v[156:159]
    s_waitcnt lgkmcnt(2)
    v_mfma_f32_16x16x32_bf16 v[176:179], a[176:179], v[72:75], v[176:179]
    v_mfma_f32_16x16x32_bf16 v[176:179], a[180:183], v[76:79], v[176:179]
    v_mfma_f32_16x16x32_bf16 v[192:195], a[180:183], v[84:87], v[192:195]
    v_mfma_f32_16x16x32_bf16 v[192:195], a[176:179], v[80:83], v[192:195]
    buffer_load_dwordx4 v38, s[20:23], s35 offen offset:3072 sc1 lds
    v_mfma_f32_16x16x32_bf16 v[196:199], a[184:187], v[80:83], v[196:199]
    s_add_u32 m0, s44, 114688
    s_add_u32 s35, s100, 1445888
    v_mfma_f32_16x16x32_bf16 v[196:199], a[188:191], v[84:87], v[196:199]
    ds_read_b128 v[96:99], v8 offset:7168
    v_mfma_f32_16x16x32_bf16 v[180:183], a[188:191], v[76:79], v[180:183]
    ds_read_b128 v[100:103], v8 offset:25600
    v_mfma_f32_16x16x32_bf16 v[180:183], a[184:187], v[72:75], v[180:183]
    ds_read_b128 v[104:107], v8 offset:8192
    v_mfma_f32_16x16x32_bf16 v[184:187], a[192:195], v[72:75], v[184:187]
    buffer_load_dwordx4 v38, s[20:23], s35 offen offset:0 sc1 lds
    v_mfma_f32_16x16x32_bf16 v[184:187], a[196:199], v[76:79], v[184:187]
    ds_read_b128 v[108:111], v8 offset:26624
    v_mfma_f32_16x16x32_bf16 v[200:203], a[196:199], v[84:87], v[200:203]
    v_mfma_f32_16x16x32_bf16 v[200:203], a[192:195], v[80:83], v[200:203]
    v_mfma_f32_16x16x32_bf16 v[204:207], a[200:203], v[80:83], v[204:207]
    v_mfma_f32_16x16x32_bf16 v[204:207], a[204:207], v[84:87], v[204:207]
    v_mfma_f32_16x16x32_bf16 v[188:191], a[204:207], v[76:79], v[188:191]
    v_mfma_f32_16x16x32_bf16 v[188:191], a[200:203], v[72:75], v[188:191]
    s_waitcnt lgkmcnt(0)
    v_mfma_f32_16x16x32_bf16 v[208:211], a[176:179], v[88:91], v[208:211]
    v_mfma_f32_16x16x32_bf16 v[208:211], a[180:183], v[92:95], v[208:211]
    s_waitcnt lgkmcnt(15)
    s_waitcnt vmcnt(13)
    v_mfma_f32_16x16x32_bf16 v[212:215], a[188:191], v[92:95], v[212:215]
    s_barrier
    v_mfma_f32_16x16x32_bf16 v[212:215], a[184:187], v[88:91], v[212:215]
    v_mfma_f32_16x16x32_bf16 v[216:219], a[192:195], v[88:91], v[216:219]
    v_mfma_f32_16x16x32_bf16 v[216:219], a[196:199], v[92:95], v[216:219]
    ds_read_b64_tr_b16 a[144:145], v12 offset:0
    v_mfma_f32_16x16x32_bf16 v[220:223], a[204:207], v[92:95], v[220:223]
    ds_read_b64_tr_b16 a[146:147], v12 offset:4096
    v_mfma_f32_16x16x32_bf16 v[220:223], a[200:203], v[88:91], v[220:223]
    ds_read_b128 v[64:67], v9 offset:0
    v_mfma_f32_16x16x32_bf16 v[224:227], a[176:179], v[96:99], v[224:227]
    ds_read_b64_tr_b16 a[148:149], v12 offset:8192
    v_mfma_f32_16x16x32_bf16 v[224:227], a[180:183], v[100:103], v[224:227]
    v_mfma_f32_16x16x32_bf16 v[240:243], a[180:183], v[108:111], v[240:243]
    ds_read_b64_tr_b16 a[150:151], v12 offset:12288
    v_mfma_f32_16x16x32_bf16 v[240:243], a[176:179], v[104:107], v[240:243]
    ds_read_b128 v[68:71], v9 offset:18432
    v_mfma_f32_16x16x32_bf16 v[244:247], a[184:187], v[104:107], v[244:247]
    ds_read_b128 v[72:75], v9 offset:1024
    v_mfma_f32_16x16x32_bf16 v[244:247], a[188:191], v[108:111], v[244:247]
    ds_read_b128 v[76:79], v9 offset:19456
    v_mfma_f32_16x16x32_bf16 v[228:231], a[188:191], v[100:103], v[228:231]
    v_mfma_f32_16x16x32_bf16 v[228:231], a[184:187], v[96:99], v[228:231]
    ds_read_b64_tr_b16 a[152:153], v12 offset:8
    v_mfma_f32_16x16x32_bf16 v[232:235], a[192:195], v[96:99], v[232:235]
    ds_read_b64_tr_b16 a[154:155], v12 offset:4104
    v_mfma_f32_16x16x32_bf16 v[232:235], a[196:199], v[100:103], v[232:235]
    ds_read_b64_tr_b16 a[156:157], v12 offset:8200
    v_mfma_f32_16x16x32_bf16 v[248:251], a[196:199], v[108:111], v[248:251]
    ds_read_b64_tr_b16 a[158:159], v12 offset:12296
    v_mfma_f32_16x16x32_bf16 v[248:251], a[192:195], v[104:107], v[248:251]
    v_mfma_f32_16x16x32_bf16 v[252:255], a[200:203], v[104:107], v[252:255]
    v_mfma_f32_16x16x32_bf16 v[252:255], a[204:207], v[108:111], v[252:255]
    ds_read_b64_tr_b16 a[160:161], v15 offset:0
    v_mfma_f32_16x16x32_bf16 v[236:239], a[204:207], v[100:103], v[236:239]
    ds_read_b64_tr_b16 a[162:163], v15 offset:4096
    v_mfma_f32_16x16x32_bf16 v[236:239], a[200:203], v[96:99], v[236:239]
    ds_read_b64_tr_b16 a[164:165], v15 offset:8192
    s_waitcnt lgkmcnt(9)
    v_mfma_f32_16x16x32_bf16 v[112:115], a[144:147], v[64:67], v[112:115]
    v_mfma_f32_16x16x32_bf16 v[112:115], a[148:151], v[68:71], v[112:115]
    ds_read_b64_tr_b16 a[166:167], v15 offset:12288
    s_waitcnt lgkmcnt(8)
    v_mfma_f32_16x16x32_bf16 v[128:131], a[148:151], v[76:79], v[128:131]
    ds_read_b64_tr_b16 a[168:169], v15 offset:8
    v_mfma_f32_16x16x32_bf16 v[128:131], a[144:147], v[72:75], v[128:131]
    ds_read_b64_tr_b16 a[170:171], v15 offset:4104
    s_waitcnt lgkmcnt(6)
    v_mfma_f32_16x16x32_bf16 v[132:135], a[152:155], v[72:75], v[132:135]
    ds_read_b64_tr_b16 a[172:173], v15 offset:8200
    v_mfma_f32_16x16x32_bf16 v[132:135], a[156:159], v[76:79], v[132:135]
    v_mfma_f32_16x16x32_bf16 v[116:119], a[156:159], v[68:71], v[116:119]
    ds_read_b64_tr_b16 a[174:175], v15 offset:12296
    v_mfma_f32_16x16x32_bf16 v[116:119], a[152:155], v[64:67], v[116:119]
    ds_read_b128 v[80:83], v9 offset:2048
    s_waitcnt lgkmcnt(5)
    v_mfma_f32_16x16x32_bf16 v[120:123], a[160:163], v[64:67], v[120:123]
    ds_read_b128 v[84:87], v9 offset:20480
    v_mfma_f32_16x16x32_bf16 v[120:123], a[164:167], v[68:71], v[120:123]
    ds_read_b128 v[88:91], v9 offset:3072
    v_mfma_f32_16x16x32_bf16 v[136:139], a[164:167], v[76:79], v[136:139]
    v_mfma_f32_16x16x32_bf16 v[136:139], a[160:163], v[72:75], v[136:139]
    ds_read_b128 v[92:95], v9 offset:21504
    s_waitcnt lgkmcnt(4)
    v_mfma_f32_16x16x32_bf16 v[140:143], a[168:171], v[72:75], v[140:143]
    ds_read_b128 v[96:99], v9 offset:4096
    v_mfma_f32_16x16x32_bf16 v[140:143], a[172:175], v[76:79], v[140:143]
    ds_read_b128 v[100:103], v9 offset:22528
    v_mfma_f32_16x16x32_bf16 v[124:127], a[172:175], v[68:71], v[124:127]
    ds_read_b128 v[104:107], v9 offset:5120
    s_waitcnt lgkmcnt(3)
    v_mfma_f32_16x16x32_bf16 v[124:127], a[168:171], v[64:67], v[124:127]
    v_mfma_f32_16x16x32_bf16 v[144:147], a[144:147], v[80:83], v[144:147]
    v_mfma_f32_16x16x32_bf16 v[144:147], a[148:151], v[84:87], v[144:147]
    ds_read_b128 v[108:111], v9 offset:23552
    v_mfma_f32_16x16x32_bf16 v[160:163], a[148:151], v[92:95], v[160:163]
    v_mfma_f32_16x16x32_bf16 v[160:163], a[144:147], v[88:91], v[160:163]
    v_mfma_f32_16x16x32_bf16 v[164:167], a[152:155], v[88:91], v[164:167]
    v_mfma_f32_16x16x32_bf16 v[164:167], a[156:159], v[92:95], v[164:167]
    v_mfma_f32_16x16x32_bf16 v[148:151], a[156:159], v[84:87], v[148:151]
    v_mfma_f32_16x16x32_bf16 v[148:151], a[152:155], v[80:83], v[148:151]
    v_mfma_f32_16x16x32_bf16 v[152:155], a[160:163], v[80:83], v[152:155]
    v_mfma_f32_16x16x32_bf16 v[152:155], a[164:167], v[84:87], v[152:155]
    v_mfma_f32_16x16x32_bf16 v[168:171], a[164:167], v[92:95], v[168:171]
    v_mfma_f32_16x16x32_bf16 v[168:171], a[160:163], v[88:91], v[168:171]
    v_mfma_f32_16x16x32_bf16 v[172:175], a[168:171], v[88:91], v[172:175]
    ds_read_b128 v[64:67], v9 offset:6144
    v_mfma_f32_16x16x32_bf16 v[172:175], a[172:175], v[92:95], v[172:175]
    ds_read_b128 v[68:71], v9 offset:24576
    v_mfma_f32_16x16x32_bf16 v[156:159], a[172:175], v[84:87], v[156:159]
    v_mfma_f32_16x16x32_bf16 v[156:159], a[168:171], v[80:83], v[156:159]
    s_waitcnt lgkmcnt(2)
    v_mfma_f32_16x16x32_bf16 v[176:179], a[144:147], v[96:99], v[176:179]
    v_mfma_f32_16x16x32_bf16 v[176:179], a[148:151], v[100:103], v[176:179]
    v_mfma_f32_16x16x32_bf16 v[192:195], a[148:151], v[108:111], v[192:195]
    v_mfma_f32_16x16x32_bf16 v[192:195], a[144:147], v[104:107], v[192:195]
    v_mfma_f32_16x16x32_bf16 v[196:199], a[152:155], v[104:107], v[196:199]
    v_mfma_f32_16x16x32_bf16 v[196:199], a[156:159], v[108:111], v[196:199]
    ds_read_b128 v[72:75], v9 offset:7168
    v_mfma_f32_16x16x32_bf16 v[180:183], a[156:159], v[100:103], v[180:183]
    ds_read_b128 v[76:79], v9 offset:25600
    v_mfma_f32_16x16x32_bf16 v[180:183], a[152:155], v[96:99], v[180:183]
    ds_read_b128 v[80:83], v9 offset:8192
    v_mfma_f32_16x16x32_bf16 v[184:187], a[160:163], v[96:99], v[184:187]
    v_mfma_f32_16x16x32_bf16 v[184:187], a[164:167], v[100:103], v[184:187]
    ds_read_b128 v[84:87], v9 offset:26624
    v_mfma_f32_16x16x32_bf16 v[200:203], a[164:167], v[108:111], v[200:203]
    v_mfma_f32_16x16x32_bf16 v[200:203], a[160:163], v[104:107], v[200:203]
    v_mfma_f32_16x16x32_bf16 v[204:207], a[168:171], v[104:107], v[204:207]
    v_mfma_f32_16x16x32_bf16 v[204:207], a[172:175], v[108:111], v[204:207]
    v_mfma_f32_16x16x32_bf16 v[188:191], a[172:175], v[100:103], v[188:191]
    v_mfma_f32_16x16x32_bf16 v[188:191], a[168:171], v[96:99], v[188:191]
    s_waitcnt lgkmcnt(0)
    v_mfma_f32_16x16x32_bf16 v[208:211], a[144:147], v[64:67], v[208:211]
    v_mfma_f32_16x16x32_bf16 v[208:211], a[148:151], v[68:71], v[208:211]
    s_waitcnt lgkmcnt(15)
    s_waitcnt vmcnt(0)
    v_mfma_f32_16x16x32_bf16 v[212:215], a[156:159], v[68:71], v[212:215]
    s_barrier
    v_mfma_f32_16x16x32_bf16 v[212:215], a[152:155], v[64:67], v[212:215]
    v_mfma_f32_16x16x32_bf16 v[216:219], a[160:163], v[64:67], v[216:219]
    v_mfma_f32_16x16x32_bf16 v[216:219], a[164:167], v[68:71], v[216:219]
    ds_read_b64_tr_b16 a[176:177], v13 offset:0
    v_mfma_f32_16x16x32_bf16 v[220:223], a[172:175], v[68:71], v[220:223]
    ds_read_b64_tr_b16 a[178:179], v13 offset:4096
    v_mfma_f32_16x16x32_bf16 v[220:223], a[168:171], v[64:67], v[220:223]
    ds_read_b128 v[88:91], v10 offset:0
    v_mfma_f32_16x16x32_bf16 v[224:227], a[144:147], v[72:75], v[224:227]
    ds_read_b64_tr_b16 a[180:181], v13 offset:8192
    v_mfma_f32_16x16x32_bf16 v[224:227], a[148:151], v[76:79], v[224:227]
    v_mfma_f32_16x16x32_bf16 v[240:243], a[148:151], v[84:87], v[240:243]
    ds_read_b64_tr_b16 a[182:183], v13 offset:12288
    v_mfma_f32_16x16x32_bf16 v[240:243], a[144:147], v[80:83], v[240:243]
    ds_read_b128 v[92:95], v10 offset:18432
    v_mfma_f32_16x16x32_bf16 v[244:247], a[152:155], v[80:83], v[244:247]
    ds_read_b128 v[96:99], v10 offset:1024
    v_mfma_f32_16x16x32_bf16 v[244:247], a[156:159], v[84:87], v[244:247]
    ds_read_b128 v[100:103], v10 offset:19456
    v_mfma_f32_16x16x32_bf16 v[228:231], a[156:159], v[76:79], v[228:231]
    v_mfma_f32_16x16x32_bf16 v[228:231], a[152:155], v[72:75], v[228:231]
    ds_read_b64_tr_b16 a[184:185], v13 offset:8
    v_mfma_f32_16x16x32_bf16 v[232:235], a[160:163], v[72:75], v[232:235]
    ds_read_b64_tr_b16 a[186:187], v13 offset:4104
    v_mfma_f32_16x16x32_bf16 v[232:235], a[164:167], v[76:79], v[232:235]
    ds_read_b64_tr_b16 a[188:189], v13 offset:8200
    v_mfma_f32_16x16x32_bf16 v[248:251], a[164:167], v[84:87], v[248:251]
    ds_read_b64_tr_b16 a[190:191], v13 offset:12296
    v_mfma_f32_16x16x32_bf16 v[248:251], a[160:163], v[80:83], v[248:251]
    v_mfma_f32_16x16x32_bf16 v[252:255], a[168:171], v[80:83], v[252:255]
    v_mfma_f32_16x16x32_bf16 v[252:255], a[172:175], v[84:87], v[252:255]
    ds_read_b64_tr_b16 a[192:193], v16 offset:0
    v_mfma_f32_16x16x32_bf16 v[236:239], a[172:175], v[76:79], v[236:239]
    ds_read_b64_tr_b16 a[194:195], v16 offset:4096
    v_mfma_f32_16x16x32_bf16 v[236:239], a[168:171], v[72:75], v[236:239]
    ds_read_b64_tr_b16 a[196:197], v16 offset:8192
    s_waitcnt lgkmcnt(9)
    v_mfma_f32_16x16x32_bf16 v[112:115], a[176:179], v[88:91], v[112:115]
    v_mfma_f32_16x16x32_bf16 v[112:115], a[180:183], v[92:95], v[112:115]
    ds_read_b64_tr_b16 a[198:199], v16 offset:12288
    s_waitcnt lgkmcnt(8)
    v_mfma_f32_16x16x32_bf16 v[128:131], a[180:183], v[100:103], v[128:131]
    ds_read_b64_tr_b16 a[200:201], v16 offset:8
    v_mfma_f32_16x16x32_bf16 v[128:131], a[176:179], v[96:99], v[128:131]
    ds_read_b64_tr_b16 a[202:203], v16 offset:4104
    s_waitcnt lgkmcnt(6)
    v_mfma_f32_16x16x32_bf16 v[132:135], a[184:187], v[96:99], v[132:135]
    ds_read_b64_tr_b16 a[204:205], v16 offset:8200
    v_mfma_f32_16x16x32_bf16 v[132:135], a[188:191], v[100:103], v[132:135]
    v_mfma_f32_16x16x32_bf16 v[116:119], a[188:191], v[92:95], v[116:119]
    ds_read_b64_tr_b16 a[206:207], v16 offset:12296
    v_mfma_f32_16x16x32_bf16 v[116:119], a[184:187], v[88:91], v[116:119]
    ds_read_b128 v[104:107], v10 offset:2048
    s_waitcnt lgkmcnt(5)
    v_mfma_f32_16x16x32_bf16 v[120:123], a[192:195], v[88:91], v[120:123]
    ds_read_b128 v[108:111], v10 offset:20480
    v_mfma_f32_16x16x32_bf16 v[120:123], a[196:199], v[92:95], v[120:123]
    ds_read_b128 v[64:67], v10 offset:3072
    v_mfma_f32_16x16x32_bf16 v[136:139], a[196:199], v[100:103], v[136:139]
    v_mfma_f32_16x16x32_bf16 v[136:139], a[192:195], v[96:99], v[136:139]
    ds_read_b128 v[68:71], v10 offset:21504
    s_waitcnt lgkmcnt(4)
    v_mfma_f32_16x16x32_bf16 v[140:143], a[200:203], v[96:99], v[140:143]
    ds_read_b128 v[72:75], v10 offset:4096
    v_cvt_pk_bf16_f32 v112, v112, v113
    v_mfma_f32_16x16x32_bf16 v[140:143], a[204:207], v[100:103], v[140:143]
    ds_read_b128 v[76:79], v10 offset:22528
    v_cvt_pk_bf16_f32 v113, v114, v115
    v_mfma_f32_16x16x32_bf16 v[124:127], a[204:207], v[92:95], v[124:127]
    ds_read_b128 v[80:83], v10 offset:5120
    s_waitcnt lgkmcnt(3)
    v_mfma_f32_16x16x32_bf16 v[124:127], a[200:203], v[88:91], v[124:127]
    v_cvt_pk_bf16_f32 v114, v116, v117
    v_cvt_pk_bf16_f32 v115, v118, v119
    v_mfma_f32_16x16x32_bf16 v[144:147], a[176:179], v[104:107], v[144:147]
    buffer_store_dwordx4 v[112:115], v38, s[12:15], s45 offen offset:0 sc1
    v_mfma_f32_16x16x32_bf16 v[144:147], a[180:183], v[108:111], v[144:147]
    ds_read_b128 v[84:87], v10 offset:23552
    v_cvt_pk_bf16_f32 v128, v128, v129
    v_mfma_f32_16x16x32_bf16 v[160:163], a[180:183], v[68:71], v[160:163]
    v_cvt_pk_bf16_f32 v129, v130, v131
    v_cvt_pk_bf16_f32 v130, v132, v133
    v_mfma_f32_16x16x32_bf16 v[160:163], a[176:179], v[64:67], v[160:163]
    v_cvt_pk_bf16_f32 v131, v134, v135
    v_mfma_f32_16x16x32_bf16 v[164:167], a[184:187], v[64:67], v[164:167]
    buffer_store_dwordx4 v[128:131], v38, s[12:15], s45 offen offset:2048 sc1
    v_mfma_f32_16x16x32_bf16 v[164:167], a[188:191], v[68:71], v[164:167]
    v_cvt_pk_bf16_f32 v120, v120, v121
    v_cvt_pk_bf16_f32 v121, v122, v123
    v_mfma_f32_16x16x32_bf16 v[148:151], a[188:191], v[108:111], v[148:151]
    v_cvt_pk_bf16_f32 v122, v124, v125
    v_cvt_pk_bf16_f32 v123, v126, v127
    v_mfma_f32_16x16x32_bf16 v[148:151], a[184:187], v[104:107], v[148:151]
    buffer_store_dwordx4 v[120:123], v38, s[12:15], s45 offen offset:1024 sc1
    v_mfma_f32_16x16x32_bf16 v[152:155], a[192:195], v[104:107], v[152:155]
    v_cvt_pk_bf16_f32 v136, v136, v137
    v_cvt_pk_bf16_f32 v137, v138, v139
    v_mfma_f32_16x16x32_bf16 v[152:155], a[196:199], v[108:111], v[152:155]
    v_cvt_pk_bf16_f32 v138, v140, v141
    v_cvt_pk_bf16_f32 v139, v142, v143
    v_mfma_f32_16x16x32_bf16 v[168:171], a[196:199], v[68:71], v[168:171]
    buffer_store_dwordx4 v[136:139], v38, s[12:15], s45 offen offset:3072 sc1
    v_mfma_f32_16x16x32_bf16 v[168:171], a[192:195], v[64:67], v[168:171]
    v_mfma_f32_16x16x32_bf16 v[172:175], a[200:203], v[64:67], v[172:175]
    ds_read_b128 v[88:91], v10 offset:6144
    v_cvt_pk_bf16_f32 v144, v144, v145
    v_mfma_f32_16x16x32_bf16 v[172:175], a[204:207], v[68:71], v[172:175]
    ds_read_b128 v[92:95], v10 offset:24576
    v_cvt_pk_bf16_f32 v145, v146, v147
    v_mfma_f32_16x16x32_bf16 v[156:159], a[204:207], v[108:111], v[156:159]
    v_cvt_pk_bf16_f32 v146, v148, v149
    v_cvt_pk_bf16_f32 v147, v150, v151
    v_mfma_f32_16x16x32_bf16 v[156:159], a[200:203], v[104:107], v[156:159]
    s_waitcnt lgkmcnt(2)
    v_mfma_f32_16x16x32_bf16 v[176:179], a[176:179], v[72:75], v[176:179]
    buffer_store_dwordx4 v[144:147], v38, s[12:15], s46 offen offset:0 sc1
    v_mfma_f32_16x16x32_bf16 v[176:179], a[180:183], v[76:79], v[176:179]
    v_cvt_pk_bf16_f32 v160, v160, v161
    v_cvt_pk_bf16_f32 v161, v162, v163
    v_mfma_f32_16x16x32_bf16 v[192:195], a[180:183], v[84:87], v[192:195]
    v_cvt_pk_bf16_f32 v162, v164, v165
    v_cvt_pk_bf16_f32 v163, v166, v167
    v_mfma_f32_16x16x32_bf16 v[192:195], a[176:179], v[80:83], v[192:195]
    buffer_store_dwordx4 v[160:163], v38, s[12:15], s46 offen offset:2048 sc1
    v_mfma_f32_16x16x32_bf16 v[196:199], a[184:187], v[80:83], v[196:199]
    v_cvt_pk_bf16_f32 v152, v152, v153
    v_cvt_pk_bf16_f32 v153, v154, v155
    v_mfma_f32_16x16x32_bf16 v[196:199], a[188:191], v[84:87], v[196:199]
    ds_read_b128 v[96:99], v10 offset:7168
    v_cvt_pk_bf16_f32 v154, v156, v157
    v_mfma_f32_16x16x32_bf16 v[180:183], a[188:191], v[76:79], v[180:183]
    ds_read_b128 v[100:103], v10 offset:25600
    v_cvt_pk_bf16_f32 v155, v158, v159
    v_mfma_f32_16x16x32_bf16 v[180:183], a[184:187], v[72:75], v[180:183]
    ds_read_b128 v[104:107], v10 offset:8192
    v_mfma_f32_16x16x32_bf16 v[184:187], a[192:195], v[72:75], v[184:187]
    buffer_store_dwordx4 v[152:155], v38, s[12:15], s46 offen offset:1024 sc1
    v_mfma_f32_16x16x32_bf16 v[184:187], a[196:199], v[76:79], v[184:187]
    ds_read_b128 v[108:111], v10 offset:26624
    v_cvt_pk_bf16_f32 v168, v168, v169
    v_mfma_f32_16x16x32_bf16 v[200:203], a[196:199], v[84:87], v[200:203]
    v_cvt_pk_bf16_f32 v169, v170, v171
    v_cvt_pk_bf16_f32 v170, v172, v173
    v_mfma_f32_16x16x32_bf16 v[200:203], a[192:195], v[80:83], v[200:203]
    v_cvt_pk_bf16_f32 v171, v174, v175
    v_mfma_f32_16x16x32_bf16 v[204:207], a[200:203], v[80:83], v[204:207]
    buffer_store_dwordx4 v[168:171], v38, s[12:15], s46 offen offset:3072 sc1
    v_mfma_f32_16x16x32_bf16 v[204:207], a[204:207], v[84:87], v[204:207]
    v_cvt_pk_bf16_f32 v176, v176, v177
    v_cvt_pk_bf16_f32 v177, v178, v179
    v_mfma_f32_16x16x32_bf16 v[188:191], a[204:207], v[76:79], v[188:191]
    v_cvt_pk_bf16_f32 v178, v180, v181
    v_cvt_pk_bf16_f32 v179, v182, v183
    v_mfma_f32_16x16x32_bf16 v[188:191], a[200:203], v[72:75], v[188:191]
    s_waitcnt lgkmcnt(0)
    v_mfma_f32_16x16x32_bf16 v[208:211], a[176:179], v[88:91], v[208:211]
    buffer_store_dwordx4 v[176:179], v38, s[12:15], s47 offen offset:0 sc1
    v_mfma_f32_16x16x32_bf16 v[208:211], a[180:183], v[92:95], v[208:211]
    v_cvt_pk_bf16_f32 v192, v192, v193
    v_cvt_pk_bf16_f32 v193, v194, v195
    v_mfma_f32_16x16x32_bf16 v[212:215], a[188:191], v[92:95], v[212:215]
    v_cvt_pk_bf16_f32 v194, v196, v197
    v_cvt_pk_bf16_f32 v195, v198, v199
    v_mfma_f32_16x16x32_bf16 v[212:215], a[184:187], v[88:91], v[212:215]
    buffer_store_dwordx4 v[192:195], v38, s[12:15], s47 offen offset:2048 sc1
    v_mfma_f32_16x16x32_bf16 v[216:219], a[192:195], v[88:91], v[216:219]
    v_cvt_pk_bf16_f32 v184, v184, v185
    v_cvt_pk_bf16_f32 v185, v186, v187
    v_mfma_f32_16x16x32_bf16 v[216:219], a[196:199], v[92:95], v[216:219]
    v_cvt_pk_bf16_f32 v186, v188, v189
    v_cvt_pk_bf16_f32 v187, v190, v191
    v_mfma_f32_16x16x32_bf16 v[220:223], a[204:207], v[92:95], v[220:223]
    buffer_store_dwordx4 v[184:187], v38, s[12:15], s47 offen offset:1024 sc1
    v_mfma_f32_16x16x32_bf16 v[220:223], a[200:203], v[88:91], v[220:223]
    v_cvt_pk_bf16_f32 v200, v200, v201
    v_cvt_pk_bf16_f32 v201, v202, v203
    v_mfma_f32_16x16x32_bf16 v[224:227], a[176:179], v[96:99], v[224:227]
    v_cvt_pk_bf16_f32 v202, v204, v205
    v_cvt_pk_bf16_f32 v203, v206, v207
    v_mfma_f32_16x16x32_bf16 v[224:227], a[180:183], v[100:103], v[224:227]
    buffer_store_dwordx4 v[200:203], v38, s[12:15], s47 offen offset:3072 sc1
    v_mfma_f32_16x16x32_bf16 v[240:243], a[180:183], v[108:111], v[240:243]
    v_cvt_pk_bf16_f32 v56, v208, v209
    v_cvt_pk_bf16_f32 v57, v210, v211
    v_mfma_f32_16x16x32_bf16 v[240:243], a[176:179], v[104:107], v[240:243]
    v_cvt_pk_bf16_f32 v58, v212, v213
    v_cvt_pk_bf16_f32 v59, v214, v215
    v_mfma_f32_16x16x32_bf16 v[244:247], a[184:187], v[104:107], v[244:247]
    buffer_store_dwordx4 v[56:59], v38, s[12:15], s59 offen offset:0 sc1
    v_mfma_f32_16x16x32_bf16 v[244:247], a[188:191], v[108:111], v[244:247]
    v_cvt_pk_bf16_f32 v60, v216, v217
    v_cvt_pk_bf16_f32 v61, v218, v219
    v_mfma_f32_16x16x32_bf16 v[228:231], a[188:191], v[100:103], v[228:231]
    v_cvt_pk_bf16_f32 v62, v220, v221
    v_cvt_pk_bf16_f32 v63, v222, v223
    v_mfma_f32_16x16x32_bf16 v[228:231], a[184:187], v[96:99], v[228:231]
    buffer_store_dwordx4 v[60:63], v38, s[12:15], s59 offen offset:1024 sc1
    v_mfma_f32_16x16x32_bf16 v[232:235], a[192:195], v[96:99], v[232:235]
    v_mfma_f32_16x16x32_bf16 v[232:235], a[196:199], v[100:103], v[232:235]
    v_mfma_f32_16x16x32_bf16 v[248:251], a[196:199], v[108:111], v[248:251]
    v_mfma_f32_16x16x32_bf16 v[248:251], a[192:195], v[104:107], v[248:251]
    v_mfma_f32_16x16x32_bf16 v[252:255], a[200:203], v[104:107], v[252:255]
    v_mfma_f32_16x16x32_bf16 v[252:255], a[204:207], v[108:111], v[252:255]
    v_mfma_f32_16x16x32_bf16 v[236:239], a[204:207], v[100:103], v[236:239]
    v_mfma_f32_16x16x32_bf16 v[236:239], a[200:203], v[96:99], v[236:239]
L_p3done:
    s_cmp_eq_u32 s28, s50
    s_cselect_b32 s35, 16384, 0x40000000
    s_add_u32 s56, s48, 0
    s_add_u32 s45, s56, s35
    s_add_u32 s56, s56, s29
    s_add_u32 s57, s48, 20480
    s_add_u32 s46, s57, s35
    s_add_u32 s57, s57, s29
    s_add_u32 s58, s48, 40960
    s_add_u32 s47, s58, s35
    s_add_u32 s58, s58, s29
    s_lshl_b32 s89, s62, 9
    s_and_b32 s91, s62, 3
    s_lshl_b32 s91, s91, 9
    s_add_u32 s91, s91, 128
    s_mov_b32 s55, 7
    s_mov_b32 s36, 65536
    s_waitcnt vmcnt(0)
    s_barrier
    buffer_store_dword v31, v29, s[96:99], s89 offen offset:128 sc1
L_poll2:
    buffer_load_dword v30, v37, s[96:99], s91 offen sc1
    s_waitcnt vmcnt(0)
    v_cmp_eq_u32 vcc, 1, v30
    s_nop 0
    s_sub_u32 s36, s36, 1
    s_cmp_eq_u32 s36, 0
    s_cselect_b32 s35, 7, 0
    s_or_b32 s35, s35, vcc_lo
    s_and_b32 s35, s35, s55
    s_bitcmp1_b32 s35, 0
    s_cbranch_scc0 L_poll2_0
    buffer_load_dwordx4 v[112:115], v38, s[12:15], s56 offen offset:0 sc1
    buffer_load_dwordx4 v[116:119], v38, s[12:15], s56 offen offset:1024 sc1
    buffer_load_dwordx4 v[120:123], v38, s[12:15], s56 offen offset:2048 sc1
    buffer_load_dwordx4 v[124:127], v38, s[12:15], s56 offen offset:3072 sc1
    buffer_load_dwordx4 v[128:131], v38, s[12:15], s45 offen offset:0 sc1
    buffer_load_dwordx4 v[132:135], v38, s[12:15], s45 offen offset:1024 sc1
L_poll2_0:
    s_bitcmp1_b32 s35, 1
    s_cbranch_scc0 L_poll2_1
    buffer_load_dwordx4 v[136:139], v38, s[12:15], s57 offen offset:0 sc1
    buffer_load_dwordx4 v[140:143], v38, s[12:15], s57 offen offset:1024 sc1
    buffer_load_dwordx4 v[144:147], v38, s[12:15], s57 offen offset:2048 sc1
    buffer_load_dwordx4 v[148:151], v38, s[12:15], s57 offen offset:3072 sc1
    buffer_load_dwordx4 v[152:155], v38, s[12:15], s46 offen offset:0 sc1
    buffer_load_dwordx4 v[156:159], v38, s[12:15], s46 offen offset:1024 sc1
L_poll2_1:
    s_bitcmp1_b32 s35, 2
    s_cbranch_scc0 L_poll2_2
    buffer_load_dwordx4 v[160:163], v38, s[12:15], s58 offen offset:0 sc1
    buffer_load_dwordx4 v[164:167], v38, s[12:15], s58 offen offset:1024 sc1
    buffer_load_dwordx4 v[168:171], v38, s[12:15], s58 offen offset:2048 sc1
    buffer_load_dwordx4 v[172:175], v38, s[12:15], s58 offen offset:3072 sc1
    buffer_load_dwordx4 v[176:179], v38, s[12:15], s47 offen offset:0 sc1
    buffer_load_dwordx4 v[180:183], v38, s[12:15], s47 offen offset:1024 sc1
L_poll2_2:
    s_andn2_b32 s55, s55, s35
    s_cbranch_scc0 L_back2
    s_sleep 1
    s_branch L_poll2
L_back2:
    s_lshl_b32 s35, s50, 16
    s_add_u32 s35, s35, s49
    s_waitcnt vmcnt(0)
    v_lshlrev_b32 v184, 16, v112
    v_and_b32 v185, 0xffff0000, v112
    v_lshlrev_b32 v186, 16, v113
    v_and_b32 v187, 0xffff0000, v113
    v_lshlrev_b32 v188, 16, v114
    v_and_b32 v189, 0xffff0000, v114
    v_lshlrev_b32 v190, 16, v115
    v_and_b32 v191, 0xffff0000, v115
    v_lshlrev_b32 v192, 16, v136
    v_and_b32 v193, 0xffff0000, v136
    v_lshlrev_b32 v194, 16, v137
    v_and_b32 v195, 0xffff0000, v137
    v_lshlrev_b32 v196, 16, v138
    v_and_b32 v197, 0xffff0000, v138
    v_lshlrev_b32 v198, 16, v139
    v_and_b32 v199, 0xffff0000, v139
    v_lshlrev_b32 v200, 16, v160
    v_and_b32 v201, 0xffff0000, v160
    v_lshlrev_b32 v202, 16, v161
    v_and_b32 v203, 0xffff0000, v161
    v_lshlrev_b32 v204, 16, v162
    v_and_b32 v205, 0xffff0000, v162
    v_lshlrev_b32 v206, 16, v163
    v_and_b32 v207, 0xffff0000, v163
    v_pk_add_f32 v[224:225], v[224:225], v[184:185]
    v_pk_add_f32 v[226:227], v[226:227], v[186:187]
    v_pk_add_f32 v[228:229], v[228:229], v[188:189]
    v_pk_add_f32 v[230:231], v[230:231], v[190:191]
    v_pk_add_f32 v[224:225], v[224:225], v[192:193]
    v_pk_add_f32 v[226:227], v[226:227], v[194:195]
    v_pk_add_f32 v[228:229], v[228:229], v[196:197]
    v_pk_add_f32 v[230:231], v[230:231], v[198:199]
    v_pk_add_f32 v[224:225], v[224:225], v[200:201]
    v_pk_add_f32 v[226:227], v[226:227], v[202:203]
    v_pk_add_f32 v[228:229], v[228:229], v[204:205]
    v_pk_add_f32 v[230:231], v[230:231], v[206:207]
    v_cvt_pk_bf16_f32 v224, v224, v225
    v_cvt_pk_bf16_f32 v225, v226, v227
    v_cvt_pk_bf16_f32 v226, v228, v229
    v_cvt_pk_bf16_f32 v227, v230, v231
    buffer_store_dwordx4 v[224:227], v34, s[16:19], s35 offen offset:0 sc1
    v_lshlrev_b32 v184, 16, v116
    v_and_b32 v185, 0xffff0000, v116
    v_lshlrev_b32 v186, 16, v117
    v_and_b32 v187, 0xffff0000, v117
    v_lshlrev_b32 v188, 16, v118
    v_and_b32 v189, 0xffff0000, v118
    v_lshlrev_b32 v190, 16, v119
    v_and_b32 v191, 0xffff0000, v119
    v_lshlrev_b32 v192, 16, v140
    v_and_b32 v193, 0xffff0000, v140
    v_lshlrev_b32 v194, 16, v141
    v_and_b32 v195, 0xffff0000, v141
    v_lshlrev_b32 v196, 16, v142
    v_and_b32 v197, 0xffff0000, v142
    v_lshlrev_b32 v198, 16, v143
    v_and_b32 v199, 0xffff0000, v143
    v_lshlrev_b32 v200, 16, v164
    v_and_b32 v201, 0xffff0000, v164
    v_lshlrev_b32 v202, 16, v165
    v_and_b32 v203, 0xffff0000, v165
    v_lshlrev_b32 v204, 16, v166
    v_and_b32 v205, 0xffff0000, v166
    v_lshlrev_b32 v206, 16, v167
    v_and_b32 v207, 0xffff0000, v167
    v_pk_add_f32 v[232:233], v[232:233], v[184:185]
    v_pk_add_f32 v[234:235], v[234:235], v[186:187]
    v_pk_add_f32 v[236:237], v[236:237], v[188:189]
    v_pk_add_f32 v[238:239], v[238:239], v[190:191]
    v_pk_add_f32 v[232:233], v[232:233], v[192:193]
    v_pk_add_f32 v[234:235], v[234:235], v[194:195]
    v_pk_add_f32 v[236:237], v[236:237], v[196:197]
    v_pk_add_f32 v[238:239], v[238:239], v[198:199]
    v_pk_add_f32 v[232:233], v[232:233], v[200:201]
    v_pk_add_f32 v[234:235], v[234:235], v[202:203]
    v_pk_add_f32 v[236:237], v[236:237], v[204:205]
    v_pk_add_f32 v[238:239], v[238:239], v[206:207]
    v_cvt_pk_bf16_f32 v232, v232, v233
    v_cvt_pk_bf16_f32 v233, v234, v235
    v_cvt_pk_bf16_f32 v234, v236, v237
    v_cvt_pk_bf16_f32 v235, v238, v239
    buffer_store_dwordx4 v[232:235], v34, s[16:19], s35 offen offset:64 sc1
    s_add_u32 s35, s35, 32768
    v_lshlrev_b32 v184, 16, v120
    v_and_b32 v185, 0xffff0000, v120
    v_lshlrev_b32 v186, 16, v121
    v_and_b32 v187, 0xffff0000, v121
    v_lshlrev_b32 v188, 16, v122
    v_and_b32 v189, 0xffff0000, v122
    v_lshlrev_b32 v190, 16, v123
    v_and_b32 v191, 0xffff0000, v123
    v_lshlrev_b32 v192, 16, v144
    v_and_b32 v193, 0xffff0000, v144
    v_lshlrev_b32 v194, 16, v145
    v_and_b32 v195, 0xffff0000, v145
    v_lshlrev_b32 v196, 16, v146
    v_and_b32 v197, 0xffff0000, v146
    v_lshlrev_b32 v198, 16, v147
    v_and_b32 v199, 0xffff0000, v147
    v_lshlrev_b32 v200, 16, v168
    v_and_b32 v201, 0xffff0000, v168
    v_lshlrev_b32 v202, 16, v169
    v_and_b32 v203, 0xffff0000, v169
    v_lshlrev_b32 v204, 16, v170
    v_and_b32 v205, 0xffff0000, v170
    v_lshlrev_b32 v206, 16, v171
    v_and_b32 v207, 0xffff0000, v171
    v_pk_add_f32 v[240:241], v[240:241], v[184:185]
    v_pk_add_f32 v[242:243], v[242:243], v[186:187]
    v_pk_add_f32 v[244:245], v[244:245], v[188:189]
    v_pk_add_f32 v[246:247], v[246:247], v[190:191]
    v_pk_add_f32 v[240:241], v[240:241], v[192:193]
    v_pk_add_f32 v[242:243], v[242:243], v[194:195]
    v_pk_add_f32 v[244:245], v[244:245], v[196:197]
    v_pk_add_f32 v[246:247], v[246:247], v[198:199]
    v_pk_add_f32 v[240:241], v[240:241], v[200:201]
    v_pk_add_f32 v[242:243], v[242:243], v[202:203]
    v_pk_add_f32 v[244:245], v[244:245], v[204:205]
    v_pk_add_f32 v[246:247], v[246:247], v[206:207]
    v_cvt_pk_bf16_f32 v240, v240, v241
    v_cvt_pk_bf16_f32 v241, v242, v243
    v_cvt_pk_bf16_f32 v242, v244, v245
    v_cvt_pk_bf16_f32 v243, v246, v247
    buffer_store_dwordx4 v[240:243], v34, s[16:19], s35 offen offset:0 sc1
    v_lshlrev_b32 v184, 16, v124
    v_and_b32 v185, 0xffff0000, v124
    v_lshlrev_b32 v186, 16, v125
    v_and_b32 v187, 0xffff0000, v125
    v_lshlrev_b32 v188, 16, v126
    v_and_b32 v189, 0xffff0000, v126
    v_lshlrev_b32 v190, 16, v127
    v_and_b32 v191, 0xffff0000, v127
    v_lshlrev_b32 v192, 16, v148
    v_and_b32 v193, 0xffff0000, v148
    v_lshlrev_b32 v194, 16, v149
    v_and_b32 v195, 0xffff0000, v149
    v_lshlrev_b32 v196, 16, v150
    v_and_b32 v197, 0xffff0000, v150
    v_lshlrev_b32 v198, 16, v151
    v_and_b32 v199, 0xffff0000, v151
    v_lshlrev_b32 v200, 16, v172
    v_and_b32 v201, 0xffff0000, v172
    v_lshlrev_b32 v202, 16, v173
    v_and_b32 v203, 0xffff0000, v173
    v_lshlrev_b32 v204, 16, v174
    v_and_b32 v205, 0xffff0000, v174
    v_lshlrev_b32 v206, 16, v175
    v_and_b32 v207, 0xffff0000, v175
    v_pk_add_f32 v[248:249], v[248:249], v[184:185]
    v_pk_add_f32 v[250:251], v[250:251], v[186:187]
    v_pk_add_f32 v[252:253], v[252:253], v[188:189]
    v_pk_add_f32 v[254:255], v[254:255], v[190:191]
    v_pk_add_f32 v[248:249], v[248:249], v[192:193]
    v_pk_add_f32 v[250:251], v[250:251], v[194:195]
    v_pk_add_f32 v[252:253], v[252:253], v[196:197]
    v_pk_add_f32 v[254:255], v[254:255], v[198:199]
    v_pk_add_f32 v[248:249], v[248:249], v[200:201]
    v_pk_add_f32 v[250:251], v[250:251], v[202:203]
    v_pk_add_f32 v[252:253], v[252:253], v[204:205]
    v_pk_add_f32 v[254:255], v[254:255], v[206:207]
    v_cvt_pk_bf16_f32 v248, v248, v249
    v_cvt_pk_bf16_f32 v249, v250, v251
    v_cvt_pk_bf16_f32 v250, v252, v253
    v_cvt_pk_bf16_f32 v251, v254, v255
    buffer_store_dwordx4 v[248:251], v34, s[16:19], s35 offen offset:64 sc1
    s_add_u32 s35, s49, 262144
    s_cmp_lg_u32 s28, s50
    s_cbranch_scc1 L_fin
    v_lshlrev_b32 v184, 16, v128
    v_and_b32 v185, 0xffff0000, v128
    v_lshlrev_b32 v186, 16, v129
    v_and_b32 v187, 0xffff0000, v129
    v_lshlrev_b32 v188, 16, v130
    v_and_b32 v189, 0xffff0000, v130
    v_lshlrev_b32 v190, 16, v131
    v_and_b32 v191, 0xffff0000, v131
    v_lshlrev_b32 v192, 16, v152
    v_and_b32 v193, 0xffff0000, v152
    v_lshlrev_b32 v194, 16, v153
    v_and_b32 v195, 0xffff0000, v153
    v_lshlrev_b32 v196, 16, v154
    v_and_b32 v197, 0xffff0000, v154
    v_lshlrev_b32 v198, 16, v155
    v_and_b32 v199, 0xffff0000, v155
    v_lshlrev_b32 v200, 16, v176
    v_and_b32 v201, 0xffff0000, v176
    v_lshlrev_b32 v202, 16, v177
    v_and_b32 v203, 0xffff0000, v177
    v_lshlrev_b32 v204, 16, v178
    v_and_b32 v205, 0xffff0000, v178
    v_lshlrev_b32 v206, 16, v179
    v_and_b32 v207, 0xffff0000, v179
    v_pk_add_f32 v[208:209], v[208:209], v[184:185]
    v_pk_add_f32 v[210:211], v[210:211], v[186:187]
    v_pk_add_f32 v[212:213], v[212:213], v[188:189]
    v_pk_add_f32 v[214:215], v[214:215], v[190:191]
    v_pk_add_f32 v[208:209], v[208:209], v[192:193]
    v_pk_add_f32 v[210:211], v[210:211], v[194:195]
    v_pk_add_f32 v[212:213], v[212:213], v[196:197]
    v_pk_add_f32 v[214:215], v[214:215], v[198:199]
    v_pk_add_f32 v[208:209], v[208:209], v[200:201]
    v_pk_add_f32 v[210:211], v[210:211], v[202:203]
    v_pk_add_f32 v[212:213], v[212:213], v[204:205]
    v_pk_add_f32 v[214:215], v[214:215], v[206:207]
    v_cvt_pk_bf16_f32 v208, v208, v209
    v_cvt_pk_bf16_f32 v209, v210, v211
    v_cvt_pk_bf16_f32 v210, v212, v213
    v_cvt_pk_bf16_f32 v211, v214, v215
    buffer_store_dwordx4 v[208:211], v34, s[16:19], s35 offen offset:0 sc1
    v_lshlrev_b32 v184, 16, v132
    v_and_b32 v185, 0xffff0000, v132
    v_lshlrev_b32 v186, 16, v133
    v_and_b32 v187, 0xffff0000, v133
    v_lshlrev_b32 v188, 16, v134
    v_and_b32 v189, 0xffff0000, v134
    v_lshlrev_b32 v190, 16, v135
    v_and_b32 v191, 0xffff0000, v135
    v_lshlrev_b32 v192, 16, v156
    v_and_b32 v193, 0xffff0000, v156
    v_lshlrev_b32 v194, 16, v157
    v_and_b32 v195, 0xffff0000, v157
    v_lshlrev_b32 v196, 16, v158
    v_and_b32 v197, 0xffff0000, v158
    v_lshlrev_b32 v198, 16, v159
    v_and_b32 v199, 0xffff0000, v159
    v_lshlrev_b32 v200, 16, v180
    v_and_b32 v201, 0xffff0000, v180
    v_lshlrev_b32 v202, 16, v181
    v_and_b32 v203, 0xffff0000, v181
    v_lshlrev_b32 v204, 16, v182
    v_and_b32 v205, 0xffff0000, v182
    v_lshlrev_b32 v206, 16, v183
    v_and_b32 v207, 0xffff0000, v183
    v_pk_add_f32 v[216:217], v[216:217], v[184:185]
    v_pk_add_f32 v[218:219], v[218:219], v[186:187]
    v_pk_add_f32 v[220:221], v[220:221], v[188:189]
    v_pk_add_f32 v[222:223], v[222:223], v[190:191]
    v_pk_add_f32 v[216:217], v[216:217], v[192:193]
    v_pk_add_f32 v[218:219], v[218:219], v[194:195]
    v_pk_add_f32 v[220:221], v[220:221], v[196:197]
    v_pk_add_f32 v[222:223], v[222:223], v[198:199]
    v_pk_add_f32 v[216:217], v[216:217], v[200:201]
    v_pk_add_f32 v[218:219], v[218:219], v[202:203]
    v_pk_add_f32 v[220:221], v[220:221], v[204:205]
    v_pk_add_f32 v[222:223], v[222:223], v[206:207]
    v_cvt_pk_bf16_f32 v216, v216, v217
    v_cvt_pk_bf16_f32 v217, v218, v219
    v_cvt_pk_bf16_f32 v218, v220, v221
    v_cvt_pk_bf16_f32 v219, v222, v223
    buffer_store_dwordx4 v[216:219], v34, s[16:19], s35 offen offset:64 sc1
L_fin:
    s_waitcnt vmcnt(0)
concat_heads__mha_block_cached__gqa_block_cached__near_ridge_kernel_end:
    s_endpgm
L_p3short:
    v_mfma_f32_16x16x32_bf16 v[112:115], a[176:179], v[88:91], v[112:115]
    buffer_load_dwordx4 v38, s[20:23], s35 offen offset:0 sc1 lds
    v_mfma_f32_16x16x32_bf16 v[112:115], a[180:183], v[92:95], v[112:115]
    ds_read_b64_tr_b16 a[198:199], v14 offset:12288
    s_waitcnt lgkmcnt(8)
    v_mfma_f32_16x16x32_bf16 v[128:131], a[180:183], v[100:103], v[128:131]
    ds_read_b64_tr_b16 a[200:201], v14 offset:8
    v_mfma_f32_16x16x32_bf16 v[128:131], a[176:179], v[96:99], v[128:131]
    ds_read_b64_tr_b16 a[202:203], v14 offset:4104
    s_waitcnt lgkmcnt(6)
    v_mfma_f32_16x16x32_bf16 v[132:135], a[184:187], v[96:99], v[132:135]
    ds_read_b64_tr_b16 a[204:205], v14 offset:8200
    v_mfma_f32_16x16x32_bf16 v[132:135], a[188:191], v[100:103], v[132:135]
    buffer_load_dwordx4 v38, s[20:23], s35 offen offset:1024 sc1 lds
    v_mfma_f32_16x16x32_bf16 v[116:119], a[188:191], v[92:95], v[116:119]
    ds_read_b64_tr_b16 a[206:207], v14 offset:12296
    v_mfma_f32_16x16x32_bf16 v[116:119], a[184:187], v[88:91], v[116:119]
    ds_read_b128 v[104:107], v8 offset:2048
    s_waitcnt lgkmcnt(5)
    v_mfma_f32_16x16x32_bf16 v[120:123], a[192:195], v[88:91], v[120:123]
    ds_read_b128 v[108:111], v8 offset:20480
    v_mfma_f32_16x16x32_bf16 v[120:123], a[196:199], v[92:95], v[120:123]
    ds_read_b128 v[64:67], v8 offset:3072
    v_mfma_f32_16x16x32_bf16 v[136:139], a[196:199], v[100:103], v[136:139]
    buffer_load_dwordx4 v38, s[20:23], s35 offen offset:2048 sc1 lds
    v_mfma_f32_16x16x32_bf16 v[136:139], a[192:195], v[96:99], v[136:139]
    ds_read_b128 v[68:71], v8 offset:21504
    s_waitcnt lgkmcnt(4)
    v_mfma_f32_16x16x32_bf16 v[140:143], a[200:203], v[96:99], v[140:143]
    ds_read_b128 v[72:75], v8 offset:4096
    v_mfma_f32_16x16x32_bf16 v[140:143], a[204:207], v[100:103], v[140:143]
    ds_read_b128 v[76:79], v8 offset:22528
    v_mfma_f32_16x16x32_bf16 v[124:127], a[204:207], v[92:95], v[124:127]
    ds_read_b128 v[80:83], v8 offset:5120
    s_waitcnt lgkmcnt(3)
    v_mfma_f32_16x16x32_bf16 v[124:127], a[200:203], v[88:91], v[124:127]
    buffer_load_dwordx4 v38, s[20:23], s35 offen offset:3072 sc1 lds
    v_mfma_f32_16x16x32_bf16 v[144:147], a[176:179], v[104:107], v[144:147]
    s_add_u32 m0, s44, 110592
    s_add_u32 s35, s100, 188416
    v_mfma_f32_16x16x32_bf16 v[144:147], a[180:183], v[108:111], v[144:147]
    ds_read_b128 v[84:87], v8 offset:23552
    v_mfma_f32_16x16x32_bf16 v[160:163], a[180:183], v[68:71], v[160:163]
    v_mfma_f32_16x16x32_bf16 v[160:163], a[176:179], v[64:67], v[160:163]
    v_mfma_f32_16x16x32_bf16 v[164:167], a[184:187], v[64:67], v[164:167]
    buffer_load_dwordx4 v38, s[20:23], s35 offen offset:0 sc1 lds
    v_mfma_f32_16x16x32_bf16 v[164:167], a[188:191], v[68:71], v[164:167]
    v_mfma_f32_16x16x32_bf16 v[148:151], a[188:191], v[108:111], v[148:151]
    v_mfma_f32_16x16x32_bf16 v[148:151], a[184:187], v[104:107], v[148:151]
    v_mfma_f32_16x16x32_bf16 v[152:155], a[192:195], v[104:107], v[152:155]
    v_mfma_f32_16x16x32_bf16 v[152:155], a[196:199], v[108:111], v[152:155]
    buffer_load_dwordx4 v38, s[20:23], s35 offen offset:1024 sc1 lds
    v_mfma_f32_16x16x32_bf16 v[168:171], a[196:199], v[68:71], v[168:171]
    v_mfma_f32_16x16x32_bf16 v[168:171], a[192:195], v[64:67], v[168:171]
    v_mfma_f32_16x16x32_bf16 v[172:175], a[200:203], v[64:67], v[172:175]
    ds_read_b128 v[88:91], v8 offset:6144
    v_mfma_f32_16x16x32_bf16 v[172:175], a[204:207], v[68:71], v[172:175]
    ds_read_b128 v[92:95], v8 offset:24576
    v_mfma_f32_16x16x32_bf16 v[156:159], a[204:207], v[108:111], v[156:159]
    buffer_load_dwordx4 v38, s[20:23], s35 offen offset:2048 sc1 lds
    v_mfma_f32_16x16x32_bf16 v[156:159], a[200:203], v[104:107], v[156:159]
    s_waitcnt lgkmcnt(2)
    v_mfma_f32_16x16x32_bf16 v[176:179], a[176:179], v[72:75], v[176:179]
    v_mfma_f32_16x16x32_bf16 v[176:179], a[180:183], v[76:79], v[176:179]
    v_mfma_f32_16x16x32_bf16 v[192:195], a[180:183], v[84:87], v[192:195]
    v_mfma_f32_16x16x32_bf16 v[192:195], a[176:179], v[80:83], v[192:195]
    buffer_load_dwordx4 v38, s[20:23], s35 offen offset:3072 sc1 lds
    v_mfma_f32_16x16x32_bf16 v[196:199], a[184:187], v[80:83], v[196:199]
    s_add_u32 m0, s44, 114688
    s_add_u32 s35, s100, 192512
    v_mfma_f32_16x16x32_bf16 v[196:199], a[188:191], v[84:87], v[196:199]
    ds_read_b128 v[96:99], v8 offset:7168
    v_mfma_f32_16x16x32_bf16 v[180:183], a[188:191], v[76:79], v[180:183]
    ds_read_b128 v[100:103], v8 offset:25600
    v_mfma_f32_16x16x32_bf16 v[180:183], a[184:187], v[72:75], v[180:183]
    ds_read_b128 v[104:107], v8 offset:8192
    v_mfma_f32_16x16x32_bf16 v[184:187], a[192:195], v[72:75], v[184:187]
    buffer_load_dwordx4 v38, s[20:23], s35 offen offset:0 sc1 lds
    v_mfma_f32_16x16x32_bf16 v[184:187], a[196:199], v[76:79], v[184:187]
    ds_read_b128 v[108:111], v8 offset:26624
    v_mfma_f32_16x16x32_bf16 v[200:203], a[196:199], v[84:87], v[200:203]
    v_mfma_f32_16x16x32_bf16 v[200:203], a[192:195], v[80:83], v[200:203]
    v_mfma_f32_16x16x32_bf16 v[204:207], a[200:203], v[80:83], v[204:207]
    v_mfma_f32_16x16x32_bf16 v[204:207], a[204:207], v[84:87], v[204:207]
    v_mfma_f32_16x16x32_bf16 v[188:191], a[204:207], v[76:79], v[188:191]
    v_mfma_f32_16x16x32_bf16 v[188:191], a[200:203], v[72:75], v[188:191]
    s_waitcnt lgkmcnt(0)
    v_mfma_f32_16x16x32_bf16 v[208:211], a[176:179], v[88:91], v[208:211]
    v_mfma_f32_16x16x32_bf16 v[208:211], a[180:183], v[92:95], v[208:211]
    s_waitcnt lgkmcnt(15)
    s_waitcnt vmcnt(13)
    v_mfma_f32_16x16x32_bf16 v[212:215], a[188:191], v[92:95], v[212:215]
    s_barrier
    v_mfma_f32_16x16x32_bf16 v[212:215], a[184:187], v[88:91], v[212:215]
    s_add_u32 m0, s29, 36864
    s_add_u32 s35, s40, 131072
    v_mfma_f32_16x16x32_bf16 v[216:219], a[192:195], v[88:91], v[216:219]
    buffer_load_dwordx4 v44, s[24:27], s35 offen offset:0 lds
    v_mfma_f32_16x16x32_bf16 v[216:219], a[196:199], v[92:95], v[216:219]
    ds_read_b64_tr_b16 a[144:145], v12 offset:0
    v_mfma_f32_16x16x32_bf16 v[220:223], a[204:207], v[92:95], v[220:223]
    ds_read_b64_tr_b16 a[146:147], v12 offset:4096
    v_mfma_f32_16x16x32_bf16 v[220:223], a[200:203], v[88:91], v[220:223]
    ds_read_b128 v[64:67], v9 offset:0
    v_mfma_f32_16x16x32_bf16 v[224:227], a[176:179], v[96:99], v[224:227]
    ds_read_b64_tr_b16 a[148:149], v12 offset:8192
    v_mfma_f32_16x16x32_bf16 v[224:227], a[180:183], v[100:103], v[224:227]
    buffer_load_dwordx4 v45, s[24:27], s35 offen offset:1024 lds
    v_mfma_f32_16x16x32_bf16 v[240:243], a[180:183], v[108:111], v[240:243]
    ds_read_b64_tr_b16 a[150:151], v12 offset:12288
    v_mfma_f32_16x16x32_bf16 v[240:243], a[176:179], v[104:107], v[240:243]
    ds_read_b128 v[68:71], v9 offset:18432
    v_mfma_f32_16x16x32_bf16 v[244:247], a[184:187], v[104:107], v[244:247]
    ds_read_b128 v[72:75], v9 offset:1024
    v_mfma_f32_16x16x32_bf16 v[244:247], a[188:191], v[108:111], v[244:247]
    ds_read_b128 v[76:79], v9 offset:19456
    v_mfma_f32_16x16x32_bf16 v[228:231], a[188:191], v[100:103], v[228:231]
    buffer_load_dwordx4 v46, s[24:27], s35 offen offset:2048 lds
    v_mfma_f32_16x16x32_bf16 v[228:231], a[184:187], v[96:99], v[228:231]
    ds_read_b64_tr_b16 a[152:153], v12 offset:8
    v_mfma_f32_16x16x32_bf16 v[232:235], a[192:195], v[96:99], v[232:235]
    ds_read_b64_tr_b16 a[154:155], v12 offset:4104
    v_mfma_f32_16x16x32_bf16 v[232:235], a[196:199], v[100:103], v[232:235]
    ds_read_b64_tr_b16 a[156:157], v12 offset:8200
    v_mfma_f32_16x16x32_bf16 v[248:251], a[196:199], v[108:111], v[248:251]
    ds_read_b64_tr_b16 a[158:159], v12 offset:12296
    v_mfma_f32_16x16x32_bf16 v[248:251], a[192:195], v[104:107], v[248:251]
    buffer_load_dwordx4 v47, s[24:27], s35 offen offset:3072 lds
    v_mfma_f32_16x16x32_bf16 v[252:255], a[200:203], v[104:107], v[252:255]
    s_add_u32 m0, s44, 0
    s_add_u32 s35, s84, 1179648
    v_mfma_f32_16x16x32_bf16 v[252:255], a[204:207], v[108:111], v[252:255]
    ds_read_b64_tr_b16 a[160:161], v15 offset:0
    v_mfma_f32_16x16x32_bf16 v[236:239], a[204:207], v[100:103], v[236:239]
    ds_read_b64_tr_b16 a[162:163], v15 offset:4096
    v_mfma_f32_16x16x32_bf16 v[236:239], a[200:203], v[96:99], v[236:239]
    ds_read_b64_tr_b16 a[164:165], v15 offset:8192
    s_waitcnt lgkmcnt(9)
    v_mfma_f32_16x16x32_bf16 v[112:115], a[144:147], v[64:67], v[112:115]
    buffer_load_dwordx4 v38, s[20:23], s35 offen offset:0 sc1 lds
    v_mfma_f32_16x16x32_bf16 v[112:115], a[148:151], v[68:71], v[112:115]
    ds_read_b64_tr_b16 a[166:167], v15 offset:12288
    s_waitcnt lgkmcnt(8)
    v_mfma_f32_16x16x32_bf16 v[128:131], a[148:151], v[76:79], v[128:131]
    ds_read_b64_tr_b16 a[168:169], v15 offset:8
    v_mfma_f32_16x16x32_bf16 v[128:131], a[144:147], v[72:75], v[128:131]
    ds_read_b64_tr_b16 a[170:171], v15 offset:4104
    s_waitcnt lgkmcnt(6)
    v_mfma_f32_16x16x32_bf16 v[132:135], a[152:155], v[72:75], v[132:135]
    ds_read_b64_tr_b16 a[172:173], v15 offset:8200
    v_mfma_f32_16x16x32_bf16 v[132:135], a[156:159], v[76:79], v[132:135]
    buffer_load_dwordx4 v38, s[20:23], s35 offen offset:1024 sc1 lds
    v_mfma_f32_16x16x32_bf16 v[116:119], a[156:159], v[68:71], v[116:119]
    ds_read_b64_tr_b16 a[174:175], v15 offset:12296
    v_mfma_f32_16x16x32_bf16 v[116:119], a[152:155], v[64:67], v[116:119]
    ds_read_b128 v[80:83], v9 offset:2048
    s_waitcnt lgkmcnt(5)
    v_mfma_f32_16x16x32_bf16 v[120:123], a[160:163], v[64:67], v[120:123]
    ds_read_b128 v[84:87], v9 offset:20480
    v_mfma_f32_16x16x32_bf16 v[120:123], a[164:167], v[68:71], v[120:123]
    ds_read_b128 v[88:91], v9 offset:3072
    v_mfma_f32_16x16x32_bf16 v[136:139], a[164:167], v[76:79], v[136:139]
    buffer_load_dwordx4 v38, s[20:23], s35 offen offset:2048 sc1 lds
    v_mfma_f32_16x16x32_bf16 v[136:139], a[160:163], v[72:75], v[136:139]
    ds_read_b128 v[92:95], v9 offset:21504
    s_waitcnt lgkmcnt(4)
    v_mfma_f32_16x16x32_bf16 v[140:143], a[168:171], v[72:75], v[140:143]
    ds_read_b128 v[96:99], v9 offset:4096
    v_mfma_f32_16x16x32_bf16 v[140:143], a[172:175], v[76:79], v[140:143]
    ds_read_b128 v[100:103], v9 offset:22528
    v_mfma_f32_16x16x32_bf16 v[124:127], a[172:175], v[68:71], v[124:127]
    ds_read_b128 v[104:107], v9 offset:5120
    s_waitcnt lgkmcnt(3)
    v_mfma_f32_16x16x32_bf16 v[124:127], a[168:171], v[64:67], v[124:127]
    buffer_load_dwordx4 v38, s[20:23], s35 offen offset:3072 sc1 lds
    v_mfma_f32_16x16x32_bf16 v[144:147], a[144:147], v[80:83], v[144:147]
    s_add_u32 m0, s44, 4096
    s_add_u32 s35, s84, 1183744
    v_mfma_f32_16x16x32_bf16 v[144:147], a[148:151], v[84:87], v[144:147]
    ds_read_b128 v[108:111], v9 offset:23552
    v_mfma_f32_16x16x32_bf16 v[160:163], a[148:151], v[92:95], v[160:163]
    v_mfma_f32_16x16x32_bf16 v[160:163], a[144:147], v[88:91], v[160:163]
    v_mfma_f32_16x16x32_bf16 v[164:167], a[152:155], v[88:91], v[164:167]
    buffer_load_dwordx4 v38, s[20:23], s35 offen offset:0 sc1 lds
    v_mfma_f32_16x16x32_bf16 v[164:167], a[156:159], v[92:95], v[164:167]
    v_mfma_f32_16x16x32_bf16 v[148:151], a[156:159], v[84:87], v[148:151]
    v_mfma_f32_16x16x32_bf16 v[148:151], a[152:155], v[80:83], v[148:151]
    v_mfma_f32_16x16x32_bf16 v[152:155], a[160:163], v[80:83], v[152:155]
    v_mfma_f32_16x16x32_bf16 v[152:155], a[164:167], v[84:87], v[152:155]
    buffer_load_dwordx4 v38, s[20:23], s35 offen offset:1024 sc1 lds
    v_mfma_f32_16x16x32_bf16 v[168:171], a[164:167], v[92:95], v[168:171]
    v_mfma_f32_16x16x32_bf16 v[168:171], a[160:163], v[88:91], v[168:171]
    v_mfma_f32_16x16x32_bf16 v[172:175], a[168:171], v[88:91], v[172:175]
    ds_read_b128 v[64:67], v9 offset:6144
    v_mfma_f32_16x16x32_bf16 v[172:175], a[172:175], v[92:95], v[172:175]
    ds_read_b128 v[68:71], v9 offset:24576
    v_mfma_f32_16x16x32_bf16 v[156:159], a[172:175], v[84:87], v[156:159]
    buffer_load_dwordx4 v38, s[20:23], s35 offen offset:2048 sc1 lds
    v_mfma_f32_16x16x32_bf16 v[156:159], a[168:171], v[80:83], v[156:159]
    s_waitcnt lgkmcnt(2)
    v_mfma_f32_16x16x32_bf16 v[176:179], a[144:147], v[96:99], v[176:179]
    v_mfma_f32_16x16x32_bf16 v[176:179], a[148:151], v[100:103], v[176:179]
    v_mfma_f32_16x16x32_bf16 v[192:195], a[148:151], v[108:111], v[192:195]
    v_mfma_f32_16x16x32_bf16 v[192:195], a[144:147], v[104:107], v[192:195]
    buffer_load_dwordx4 v38, s[20:23], s35 offen offset:3072 sc1 lds
    v_mfma_f32_16x16x32_bf16 v[196:199], a[152:155], v[104:107], v[196:199]
    s_add_u32 m0, s44, 8192
    s_add_u32 s35, s84, 1187840
    v_mfma_f32_16x16x32_bf16 v[196:199], a[156:159], v[108:111], v[196:199]
    ds_read_b128 v[72:75], v9 offset:7168
    v_mfma_f32_16x16x32_bf16 v[180:183], a[156:159], v[100:103], v[180:183]
    ds_read_b128 v[76:79], v9 offset:25600
    v_mfma_f32_16x16x32_bf16 v[180:183], a[152:155], v[96:99], v[180:183]
    ds_read_b128 v[80:83], v9 offset:8192
    v_mfma_f32_16x16x32_bf16 v[184:187], a[160:163], v[96:99], v[184:187]
    buffer_load_dwordx4 v38, s[20:23], s35 offen offset:0 sc1 lds
    v_mfma_f32_16x16x32_bf16 v[184:187], a[164:167], v[100:103], v[184:187]
    ds_read_b128 v[84:87], v9 offset:26624
    v_mfma_f32_16x16x32_bf16 v[200:203], a[164:167], v[108:111], v[200:203]
    v_mfma_f32_16x16x32_bf16 v[200:203], a[160:163], v[104:107], v[200:203]
    v_mfma_f32_16x16x32_bf16 v[204:207], a[168:171], v[104:107], v[204:207]
    v_mfma_f32_16x16x32_bf16 v[204:207], a[172:175], v[108:111], v[204:207]
    v_mfma_f32_16x16x32_bf16 v[188:191], a[172:175], v[100:103], v[188:191]
    buffer_load_dword v30, v32, s[96:99], s91 offen sc1
    v_mfma_f32_16x16x32_bf16 v[188:191], a[168:171], v[96:99], v[188:191]
    s_waitcnt lgkmcnt(0)
    v_mfma_f32_16x16x32_bf16 v[208:211], a[144:147], v[64:67], v[208:211]
    v_mfma_f32_16x16x32_bf16 v[208:211], a[148:151], v[68:71], v[208:211]
    s_waitcnt lgkmcnt(15)
    s_waitcnt vmcnt(14)
    v_mfma_f32_16x16x32_bf16 v[212:215], a[156:159], v[68:71], v[212:215]
    s_barrier
    v_mfma_f32_16x16x32_bf16 v[212:215], a[152:155], v[64:67], v[212:215]
    s_add_u32 m0, s29, 90112
    s_add_u32 s35, s40, 196608
    v_mfma_f32_16x16x32_bf16 v[216:219], a[160:163], v[64:67], v[216:219]
    buffer_load_dwordx4 v44, s[24:27], s35 offen offset:0 lds
    v_mfma_f32_16x16x32_bf16 v[216:219], a[164:167], v[68:71], v[216:219]
    ds_read_b64_tr_b16 a[176:177], v13 offset:0
    v_mfma_f32_16x16x32_bf16 v[220:223], a[172:175], v[68:71], v[220:223]
    ds_read_b64_tr_b16 a[178:179], v13 offset:4096
    v_mfma_f32_16x16x32_bf16 v[220:223], a[168:171], v[64:67], v[220:223]
    ds_read_b128 v[88:91], v10 offset:0
    v_mfma_f32_16x16x32_bf16 v[224:227], a[144:147], v[72:75], v[224:227]
    ds_read_b64_tr_b16 a[180:181], v13 offset:8192
    v_mfma_f32_16x16x32_bf16 v[224:227], a[148:151], v[76:79], v[224:227]
    buffer_load_dwordx4 v45, s[24:27], s35 offen offset:1024 lds
    v_mfma_f32_16x16x32_bf16 v[240:243], a[148:151], v[84:87], v[240:243]
    ds_read_b64_tr_b16 a[182:183], v13 offset:12288
    v_mfma_f32_16x16x32_bf16 v[240:243], a[144:147], v[80:83], v[240:243]
    ds_read_b128 v[92:95], v10 offset:18432
    v_mfma_f32_16x16x32_bf16 v[244:247], a[152:155], v[80:83], v[244:247]
    ds_read_b128 v[96:99], v10 offset:1024
    v_mfma_f32_16x16x32_bf16 v[244:247], a[156:159], v[84:87], v[244:247]
    ds_read_b128 v[100:103], v10 offset:19456
    v_mfma_f32_16x16x32_bf16 v[228:231], a[156:159], v[76:79], v[228:231]
    buffer_load_dwordx4 v46, s[24:27], s35 offen offset:2048 lds
    v_mfma_f32_16x16x32_bf16 v[228:231], a[152:155], v[72:75], v[228:231]
    ds_read_b64_tr_b16 a[184:185], v13 offset:8
    v_mfma_f32_16x16x32_bf16 v[232:235], a[160:163], v[72:75], v[232:235]
    ds_read_b64_tr_b16 a[186:187], v13 offset:4104
    v_mfma_f32_16x16x32_bf16 v[232:235], a[164:167], v[76:79], v[232:235]
    ds_read_b64_tr_b16 a[188:189], v13 offset:8200
    v_mfma_f32_16x16x32_bf16 v[248:251], a[164:167], v[84:87], v[248:251]
    ds_read_b64_tr_b16 a[190:191], v13 offset:12296
    v_mfma_f32_16x16x32_bf16 v[248:251], a[160:163], v[80:83], v[248:251]
    buffer_load_dwordx4 v47, s[24:27], s35 offen offset:3072 lds
    v_mfma_f32_16x16x32_bf16 v[252:255], a[168:171], v[80:83], v[252:255]
    s_add_u32 m0, s44, 53248
    s_add_u32 s35, s84, 1216512
    v_mfma_f32_16x16x32_bf16 v[252:255], a[172:175], v[84:87], v[252:255]
    ds_read_b64_tr_b16 a[192:193], v16 offset:0
    v_mfma_f32_16x16x32_bf16 v[236:239], a[172:175], v[76:79], v[236:239]
    ds_read_b64_tr_b16 a[194:195], v16 offset:4096
    v_mfma_f32_16x16x32_bf16 v[236:239], a[168:171], v[72:75], v[236:239]
    ds_read_b64_tr_b16 a[196:197], v16 offset:8192
    s_waitcnt lgkmcnt(9)
    v_mfma_f32_16x16x32_bf16 v[112:115], a[176:179], v[88:91], v[112:115]
    buffer_load_dwordx4 v38, s[20:23], s35 offen offset:0 sc1 lds
    v_mfma_f32_16x16x32_bf16 v[112:115], a[180:183], v[92:95], v[112:115]
    ds_read_b64_tr_b16 a[198:199], v16 offset:12288
    s_waitcnt lgkmcnt(8)
    v_mfma_f32_16x16x32_bf16 v[128:131], a[180:183], v[100:103], v[128:131]
    ds_read_b64_tr_b16 a[200:201], v16 offset:8
    v_mfma_f32_16x16x32_bf16 v[128:131], a[176:179], v[96:99], v[128:131]
    ds_read_b64_tr_b16 a[202:203], v16 offset:4104
    s_waitcnt lgkmcnt(6)
    v_mfma_f32_16x16x32_bf16 v[132:135], a[184:187], v[96:99], v[132:135]
    ds_read_b64_tr_b16 a[204:205], v16 offset:8200
    v_mfma_f32_16x16x32_bf16 v[132:135], a[188:191], v[100:103], v[132:135]
    buffer_load_dwordx4 v38, s[20:23], s35 offen offset:1024 sc1 lds
    v_mfma_f32_16x16x32_bf16 v[116:119], a[188:191], v[92:95], v[116:119]
    ds_read_b64_tr_b16 a[206:207], v16 offset:12296
    v_mfma_f32_16x16x32_bf16 v[116:119], a[184:187], v[88:91], v[116:119]
    ds_read_b128 v[104:107], v10 offset:2048
    s_waitcnt lgkmcnt(5)
    v_mfma_f32_16x16x32_bf16 v[120:123], a[192:195], v[88:91], v[120:123]
    ds_read_b128 v[108:111], v10 offset:20480
    v_mfma_f32_16x16x32_bf16 v[120:123], a[196:199], v[92:95], v[120:123]
    ds_read_b128 v[64:67], v10 offset:3072
    v_mfma_f32_16x16x32_bf16 v[136:139], a[196:199], v[100:103], v[136:139]
    buffer_load_dwordx4 v38, s[20:23], s35 offen offset:2048 sc1 lds
    v_mfma_f32_16x16x32_bf16 v[136:139], a[192:195], v[96:99], v[136:139]
    ds_read_b128 v[68:71], v10 offset:21504
    s_waitcnt lgkmcnt(4)
    v_mfma_f32_16x16x32_bf16 v[140:143], a[200:203], v[96:99], v[140:143]
    ds_read_b128 v[72:75], v10 offset:4096
    v_mfma_f32_16x16x32_bf16 v[140:143], a[204:207], v[100:103], v[140:143]
    ds_read_b128 v[76:79], v10 offset:22528
    v_mfma_f32_16x16x32_bf16 v[124:127], a[204:207], v[92:95], v[124:127]
    ds_read_b128 v[80:83], v10 offset:5120
    s_waitcnt lgkmcnt(3)
    v_mfma_f32_16x16x32_bf16 v[124:127], a[200:203], v[88:91], v[124:127]
    buffer_load_dwordx4 v38, s[20:23], s35 offen offset:3072 sc1 lds
    v_mfma_f32_16x16x32_bf16 v[144:147], a[176:179], v[104:107], v[144:147]
    s_add_u32 m0, s44, 57344
    s_add_u32 s35, s84, 1220608
    v_mfma_f32_16x16x32_bf16 v[144:147], a[180:183], v[108:111], v[144:147]
    ds_read_b128 v[84:87], v10 offset:23552
    v_mfma_f32_16x16x32_bf16 v[160:163], a[180:183], v[68:71], v[160:163]
    v_mfma_f32_16x16x32_bf16 v[160:163], a[176:179], v[64:67], v[160:163]
    v_mfma_f32_16x16x32_bf16 v[164:167], a[184:187], v[64:67], v[164:167]
    buffer_load_dwordx4 v38, s[20:23], s35 offen offset:0 sc1 lds
    v_mfma_f32_16x16x32_bf16 v[164:167], a[188:191], v[68:71], v[164:167]
    v_mfma_f32_16x16x32_bf16 v[148:151], a[188:191], v[108:111], v[148:151]
    v_mfma_f32_16x16x32_bf16 v[148:151], a[184:187], v[104:107], v[148:151]
    v_mfma_f32_16x16x32_bf16 v[152:155], a[192:195], v[104:107], v[152:155]
    v_mfma_f32_16x16x32_bf16 v[152:155], a[196:199], v[108:111], v[152:155]
    buffer_load_dwordx4 v38, s[20:23], s35 offen offset:1024 sc1 lds
    v_mfma_f32_16x16x32_bf16 v[168:171], a[196:199], v[68:71], v[168:171]
    v_mfma_f32_16x16x32_bf16 v[168:171], a[192:195], v[64:67], v[168:171]
    v_mfma_f32_16x16x32_bf16 v[172:175], a[200:203], v[64:67], v[172:175]
    ds_read_b128 v[88:91], v10 offset:6144
    v_mfma_f32_16x16x32_bf16 v[172:175], a[204:207], v[68:71], v[172:175]
    ds_read_b128 v[92:95], v10 offset:24576
    v_mfma_f32_16x16x32_bf16 v[156:159], a[204:207], v[108:111], v[156:159]
    buffer_load_dwordx4 v38, s[20:23], s35 offen offset:2048 sc1 lds
    v_mfma_f32_16x16x32_bf16 v[156:159], a[200:203], v[104:107], v[156:159]
    s_waitcnt lgkmcnt(2)
    v_mfma_f32_16x16x32_bf16 v[176:179], a[176:179], v[72:75], v[176:179]
    v_mfma_f32_16x16x32_bf16 v[176:179], a[180:183], v[76:79], v[176:179]
    v_mfma_f32_16x16x32_bf16 v[192:195], a[180:183], v[84:87], v[192:195]
    v_mfma_f32_16x16x32_bf16 v[192:195], a[176:179], v[80:83], v[192:195]
    buffer_load_dwordx4 v38, s[20:23], s35 offen offset:3072 sc1 lds
    v_mfma_f32_16x16x32_bf16 v[196:199], a[184:187], v[80:83], v[196:199]
    s_add_u32 m0, s44, 61440
    s_add_u32 s35, s84, 1224704
    v_mfma_f32_16x16x32_bf16 v[196:199], a[188:191], v[84:87], v[196:199]
    ds_read_b128 v[96:99], v10 offset:7168
    v_mfma_f32_16x16x32_bf16 v[180:183], a[188:191], v[76:79], v[180:183]
    ds_read_b128 v[100:103], v10 offset:25600
    v_mfma_f32_16x16x32_bf16 v[180:183], a[184:187], v[72:75], v[180:183]
    ds_read_b128 v[104:107], v10 offset:8192
    v_mfma_f32_16x16x32_bf16 v[184:187], a[192:195], v[72:75], v[184:187]
    buffer_load_dwordx4 v38, s[20:23], s35 offen offset:0 sc1 lds
    v_mfma_f32_16x16x32_bf16 v[184:187], a[196:199], v[76:79], v[184:187]
    ds_read_b128 v[108:111], v10 offset:26624
    v_mfma_f32_16x16x32_bf16 v[200:203], a[196:199], v[84:87], v[200:203]
    v_mfma_f32_16x16x32_bf16 v[200:203], a[192:195], v[80:83], v[200:203]
    v_mfma_f32_16x16x32_bf16 v[204:207], a[200:203], v[80:83], v[204:207]
    v_mfma_f32_16x16x32_bf16 v[204:207], a[204:207], v[84:87], v[204:207]
    v_mfma_f32_16x16x32_bf16 v[188:191], a[204:207], v[76:79], v[188:191]
    v_mfma_f32_16x16x32_bf16 v[188:191], a[200:203], v[72:75], v[188:191]
    s_waitcnt vmcnt(13)
    v_cmp_ne_u32 vcc, 1, v30
    s_nop 3
    s_bitcmp1_b32 vcc_lo, 1
    s_cbranch_scc1 L_spin14_1
L_back14_1:
    s_waitcnt lgkmcnt(0)
    v_mfma_f32_16x16x32_bf16 v[208:211], a[176:179], v[88:91], v[208:211]
    v_mfma_f32_16x16x32_bf16 v[208:211], a[180:183], v[92:95], v[208:211]
    s_waitcnt lgkmcnt(15)
    s_waitcnt vmcnt(63)
    v_mfma_f32_16x16x32_bf16 v[212:215], a[188:191], v[92:95], v[212:215]
    s_barrier
    v_mfma_f32_16x16x32_bf16 v[212:215], a[184:187], v[88:91], v[212:215]
    s_add_u32 m0, s29, 143360
    s_add_u32 s35, s41, 131072
    v_mfma_f32_16x16x32_bf16 v[216:219], a[192:195], v[88:91], v[216:219]
    buffer_load_dwordx4 v44, s[24:27], s35 offen offset:0 lds
    v_mfma_f32_16x16x32_bf16 v[216:219], a[196:199], v[92:95], v[216:219]
    ds_read_b64_tr_b16 a[144:145], v11 offset:0
    v_mfma_f32_16x16x32_bf16 v[220:223], a[204:207], v[92:95], v[220:223]
    ds_read_b64_tr_b16 a[146:147], v11 offset:4096
    v_mfma_f32_16x16x32_bf16 v[220:223], a[200:203], v[88:91], v[220:223]
    ds_read_b128 v[64:67], v8 offset:0
    v_mfma_f32_16x16x32_bf16 v[224:227], a[176:179], v[96:99], v[224:227]
    ds_read_b64_tr_b16 a[148:149], v11 offset:8192
    v_mfma_f32_16x16x32_bf16 v[224:227], a[180:183], v[100:103], v[224:227]
    buffer_load_dwordx4 v45, s[24:27], s35 offen offset:1024 lds
    v_mfma_f32_16x16x32_bf16 v[240:243], a[180:183], v[108:111], v[240:243]
    ds_read_b64_tr_b16 a[150:151], v11 offset:12288
    v_mfma_f32_16x16x32_bf16 v[240:243], a[176:179], v[104:107], v[240:243]
    ds_read_b128 v[68:71], v8 offset:18432
    v_mfma_f32_16x16x32_bf16 v[244:247], a[184:187], v[104:107], v[244:247]
    ds_read_b128 v[72:75], v8 offset:1024
    v_mfma_f32_16x16x32_bf16 v[244:247], a[188:191], v[108:111], v[244:247]
    ds_read_b128 v[76:79], v8 offset:19456
    v_mfma_f32_16x16x32_bf16 v[228:231], a[188:191], v[100:103], v[228:231]
    buffer_load_dwordx4 v46, s[24:27], s35 offen offset:2048 lds
    v_mfma_f32_16x16x32_bf16 v[228:231], a[184:187], v[96:99], v[228:231]
    ds_read_b64_tr_b16 a[152:153], v11 offset:8
    v_mfma_f32_16x16x32_bf16 v[232:235], a[192:195], v[96:99], v[232:235]
    ds_read_b64_tr_b16 a[154:155], v11 offset:4104
    v_mfma_f32_16x16x32_bf16 v[232:235], a[196:199], v[100:103], v[232:235]
    ds_read_b64_tr_b16 a[156:157], v11 offset:8200
    v_mfma_f32_16x16x32_bf16 v[248:251], a[196:199], v[108:111], v[248:251]
    ds_read_b64_tr_b16 a[158:159], v11 offset:12296
    v_mfma_f32_16x16x32_bf16 v[248:251], a[192:195], v[104:107], v[248:251]
    buffer_load_dwordx4 v47, s[24:27], s35 offen offset:3072 lds
    v_mfma_f32_16x16x32_bf16 v[252:255], a[200:203], v[104:107], v[252:255]
    s_add_u32 m0, s44, 106496
    s_add_u32 s35, s85, 1179648
    v_mfma_f32_16x16x32_bf16 v[252:255], a[204:207], v[108:111], v[252:255]
    ds_read_b64_tr_b16 a[160:161], v14 offset:0
    v_mfma_f32_16x16x32_bf16 v[236:239], a[204:207], v[100:103], v[236:239]
    ds_read_b64_tr_b16 a[162:163], v14 offset:4096
    v_mfma_f32_16x16x32_bf16 v[236:239], a[200:203], v[96:99], v[236:239]
    ds_read_b64_tr_b16 a[164:165], v14 offset:8192
    s_waitcnt lgkmcnt(9)
    v_mfma_f32_16x16x32_bf16 v[112:115], a[144:147], v[64:67], v[112:115]
    buffer_load_dwordx4 v38, s[20:23], s35 offen offset:0 sc1 lds
    v_mfma_f32_16x16x32_bf16 v[112:115], a[148:151], v[68:71], v[112:115]
    ds_read_b64_tr_b16 a[166:167], v14 offset:12288
    s_waitcnt lgkmcnt(8)
    v_mfma_f32_16x16x32_bf16 v[128:131], a[148:151], v[76:79], v[128:131]
    ds_read_b64_tr_b16 a[168:169], v14 offset:8
    v_mfma_f32_16x16x32_bf16 v[128:131], a[144:147], v[72:75], v[128:131]
    ds_read_b64_tr_b16 a[170:171], v14 offset:4104
    s_waitcnt lgkmcnt(6)
    v_mfma_f32_16x16x32_bf16 v[132:135], a[152:155], v[72:75], v[132:135]
    ds_read_b64_tr_b16 a[172:173], v14 offset:8200
    v_mfma_f32_16x16x32_bf16 v[132:135], a[156:159], v[76:79], v[132:135]
    buffer_load_dwordx4 v38, s[20:23], s35 offen offset:1024 sc1 lds
    v_mfma_f32_16x16x32_bf16 v[116:119], a[156:159], v[68:71], v[116:119]
    ds_read_b64_tr_b16 a[174:175], v14 offset:12296
    v_mfma_f32_16x16x32_bf16 v[116:119], a[152:155], v[64:67], v[116:119]
    ds_read_b128 v[80:83], v8 offset:2048
    s_waitcnt lgkmcnt(5)
    v_mfma_f32_16x16x32_bf16 v[120:123], a[160:163], v[64:67], v[120:123]
    ds_read_b128 v[84:87], v8 offset:20480
    v_mfma_f32_16x16x32_bf16 v[120:123], a[164:167], v[68:71], v[120:123]
    ds_read_b128 v[88:91], v8 offset:3072
    v_mfma_f32_16x16x32_bf16 v[136:139], a[164:167], v[76:79], v[136:139]
    buffer_load_dwordx4 v38, s[20:23], s35 offen offset:2048 sc1 lds
    v_mfma_f32_16x16x32_bf16 v[136:139], a[160:163], v[72:75], v[136:139]
    ds_read_b128 v[92:95], v8 offset:21504
    s_waitcnt lgkmcnt(4)
    v_mfma_f32_16x16x32_bf16 v[140:143], a[168:171], v[72:75], v[140:143]
    ds_read_b128 v[96:99], v8 offset:4096
    v_mfma_f32_16x16x32_bf16 v[140:143], a[172:175], v[76:79], v[140:143]
    ds_read_b128 v[100:103], v8 offset:22528
    v_mfma_f32_16x16x32_bf16 v[124:127], a[172:175], v[68:71], v[124:127]
    ds_read_b128 v[104:107], v8 offset:5120
    s_waitcnt lgkmcnt(3)
    v_mfma_f32_16x16x32_bf16 v[124:127], a[168:171], v[64:67], v[124:127]
    buffer_load_dwordx4 v38, s[20:23], s35 offen offset:3072 sc1 lds
    v_mfma_f32_16x16x32_bf16 v[144:147], a[144:147], v[80:83], v[144:147]
    s_add_u32 m0, s44, 110592
    s_add_u32 s35, s85, 1183744
    v_mfma_f32_16x16x32_bf16 v[144:147], a[148:151], v[84:87], v[144:147]
    ds_read_b128 v[108:111], v8 offset:23552
    v_mfma_f32_16x16x32_bf16 v[160:163], a[148:151], v[92:95], v[160:163]
    v_mfma_f32_16x16x32_bf16 v[160:163], a[144:147], v[88:91], v[160:163]
    v_mfma_f32_16x16x32_bf16 v[164:167], a[152:155], v[88:91], v[164:167]
    buffer_load_dwordx4 v38, s[20:23], s35 offen offset:0 sc1 lds
    v_mfma_f32_16x16x32_bf16 v[164:167], a[156:159], v[92:95], v[164:167]
    v_mfma_f32_16x16x32_bf16 v[148:151], a[156:159], v[84:87], v[148:151]
    v_mfma_f32_16x16x32_bf16 v[148:151], a[152:155], v[80:83], v[148:151]
    v_mfma_f32_16x16x32_bf16 v[152:155], a[160:163], v[80:83], v[152:155]
    v_mfma_f32_16x16x32_bf16 v[152:155], a[164:167], v[84:87], v[152:155]
    buffer_load_dwordx4 v38, s[20:23], s35 offen offset:1024 sc1 lds
    v_mfma_f32_16x16x32_bf16 v[168:171], a[164:167], v[92:95], v[168:171]
    v_mfma_f32_16x16x32_bf16 v[168:171], a[160:163], v[88:91], v[168:171]
    v_mfma_f32_16x16x32_bf16 v[172:175], a[168:171], v[88:91], v[172:175]
    ds_read_b128 v[64:67], v8 offset:6144
    v_mfma_f32_16x16x32_bf16 v[172:175], a[172:175], v[92:95], v[172:175]
    ds_read_b128 v[68:71], v8 offset:24576
    v_mfma_f32_16x16x32_bf16 v[156:159], a[172:175], v[84:87], v[156:159]
    buffer_load_dwordx4 v38, s[20:23], s35 offen offset:2048 sc1 lds
    v_mfma_f32_16x16x32_bf16 v[156:159], a[168:171], v[80:83], v[156:159]
    s_waitcnt lgkmcnt(2)
    v_mfma_f32_16x16x32_bf16 v[176:179], a[144:147], v[96:99], v[176:179]
    v_mfma_f32_16x16x32_bf16 v[176:179], a[148:151], v[100:103], v[176:179]
    v_mfma_f32_16x16x32_bf16 v[192:195], a[148:151], v[108:111], v[192:195]
    v_mfma_f32_16x16x32_bf16 v[192:195], a[144:147], v[104:107], v[192:195]
    buffer_load_dwordx4 v38, s[20:23], s35 offen offset:3072 sc1 lds
    v_mfma_f32_16x16x32_bf16 v[196:199], a[152:155], v[104:107], v[196:199]
    s_add_u32 m0, s44, 114688
    s_add_u32 s35, s85, 1187840
    v_mfma_f32_16x16x32_bf16 v[196:199], a[156:159], v[108:111], v[196:199]
    ds_read_b128 v[72:75], v8 offset:7168
    v_mfma_f32_16x16x32_bf16 v[180:183], a[156:159], v[100:103], v[180:183]
    ds_read_b128 v[76:79], v8 offset:25600
    v_mfma_f32_16x16x32_bf16 v[180:183], a[152:155], v[96:99], v[180:183]
    ds_read_b128 v[80:83], v8 offset:8192
    v_mfma_f32_16x16x32_bf16 v[184:187], a[160:163], v[96:99], v[184:187]
    buffer_load_dwordx4 v38, s[20:23], s35 offen offset:0 sc1 lds
    v_mfma_f32_16x16x32_bf16 v[184:187], a[164:167], v[100:103], v[184:187]
    ds_read_b128 v[84:87], v8 offset:26624
    v_mfma_f32_16x16x32_bf16 v[200:203], a[164:167], v[108:111], v[200:203]
    v_mfma_f32_16x16x32_bf16 v[200:203], a[160:163], v[104:107], v[200:203]
    v_mfma_f32_16x16x32_bf16 v[204:207], a[168:171], v[104:107], v[204:207]
    v_mfma_f32_16x16x32_bf16 v[204:207], a[172:175], v[108:111], v[204:207]
    v_mfma_f32_16x16x32_bf16 v[188:191], a[172:175], v[100:103], v[188:191]
    buffer_load_dword v30, v32, s[96:99], s91 offen sc1
    v_mfma_f32_16x16x32_bf16 v[188:191], a[168:171], v[96:99], v[188:191]
    s_waitcnt lgkmcnt(0)
    v_mfma_f32_16x16x32_bf16 v[208:211], a[144:147], v[64:67], v[208:211]
    v_mfma_f32_16x16x32_bf16 v[208:211], a[148:151], v[68:71], v[208:211]
    s_waitcnt lgkmcnt(15)
    s_waitcnt vmcnt(14)
    v_mfma_f32_16x16x32_bf16 v[212:215], a[156:159], v[68:71], v[212:215]
    s_barrier
    v_mfma_f32_16x16x32_bf16 v[212:215], a[152:155], v[64:67], v[212:215]
    s_add_u32 m0, s29, 36864
    s_add_u32 s35, s41, 196608
    v_mfma_f32_16x16x32_bf16 v[216:219], a[160:163], v[64:67], v[216:219]
    buffer_load_dwordx4 v44, s[24:27], s35 offen offset:0 lds
    v_mfma_f32_16x16x32_bf16 v[216:219], a[164:167], v[68:71], v[216:219]
    ds_read_b64_tr_b16 a[176:177], v12 offset:0
    v_mfma_f32_16x16x32_bf16 v[220:223], a[172:175], v[68:71], v[220:223]
    ds_read_b64_tr_b16 a[178:179], v12 offset:4096
    v_mfma_f32_16x16x32_bf16 v[220:223], a[168:171], v[64:67], v[220:223]
    ds_read_b128 v[88:91], v9 offset:0
    v_mfma_f32_16x16x32_bf16 v[224:227], a[144:147], v[72:75], v[224:227]
    ds_read_b64_tr_b16 a[180:181], v12 offset:8192
    v_mfma_f32_16x16x32_bf16 v[224:227], a[148:151], v[76:79], v[224:227]
    buffer_load_dwordx4 v45, s[24:27], s35 offen offset:1024 lds
    v_mfma_f32_16x16x32_bf16 v[240:243], a[148:151], v[84:87], v[240:243]
    ds_read_b64_tr_b16 a[182:183], v12 offset:12288
    v_mfma_f32_16x16x32_bf16 v[240:243], a[144:147], v[80:83], v[240:243]
    ds_read_b128 v[92:95], v9 offset:18432
    v_mfma_f32_16x16x32_bf16 v[244:247], a[152:155], v[80:83], v[244:247]
    ds_read_b128 v[96:99], v9 offset:1024
    v_mfma_f32_16x16x32_bf16 v[244:247], a[156:159], v[84:87], v[244:247]
    ds_read_b128 v[100:103], v9 offset:19456
    v_mfma_f32_16x16x32_bf16 v[228:231], a[156:159], v[76:79], v[228:231]
    buffer_load_dwordx4 v46, s[24:27], s35 offen offset:2048 lds
    v_mfma_f32_16x16x32_bf16 v[228:231], a[152:155], v[72:75], v[228:231]
    ds_read_b64_tr_b16 a[184:185], v12 offset:8
    v_mfma_f32_16x16x32_bf16 v[232:235], a[160:163], v[72:75], v[232:235]
    ds_read_b64_tr_b16 a[186:187], v12 offset:4104
    v_mfma_f32_16x16x32_bf16 v[232:235], a[164:167], v[76:79], v[232:235]
    ds_read_b64_tr_b16 a[188:189], v12 offset:8200
    v_mfma_f32_16x16x32_bf16 v[248:251], a[164:167], v[84:87], v[248:251]
    ds_read_b64_tr_b16 a[190:191], v12 offset:12296
    v_mfma_f32_16x16x32_bf16 v[248:251], a[160:163], v[80:83], v[248:251]
    buffer_load_dwordx4 v47, s[24:27], s35 offen offset:3072 lds
    v_mfma_f32_16x16x32_bf16 v[252:255], a[168:171], v[80:83], v[252:255]
    s_add_u32 m0, s44, 0
    s_add_u32 s35, s85, 1216512
    v_mfma_f32_16x16x32_bf16 v[252:255], a[172:175], v[84:87], v[252:255]
    ds_read_b64_tr_b16 a[192:193], v15 offset:0
    v_mfma_f32_16x16x32_bf16 v[236:239], a[172:175], v[76:79], v[236:239]
    ds_read_b64_tr_b16 a[194:195], v15 offset:4096
    v_mfma_f32_16x16x32_bf16 v[236:239], a[168:171], v[72:75], v[236:239]
    ds_read_b64_tr_b16 a[196:197], v15 offset:8192
    s_waitcnt lgkmcnt(9)
    v_mfma_f32_16x16x32_bf16 v[112:115], a[176:179], v[88:91], v[112:115]
    buffer_load_dwordx4 v38, s[20:23], s35 offen offset:0 sc1 lds
    v_mfma_f32_16x16x32_bf16 v[112:115], a[180:183], v[92:95], v[112:115]
    ds_read_b64_tr_b16 a[198:199], v15 offset:12288
    s_waitcnt lgkmcnt(8)
    v_mfma_f32_16x16x32_bf16 v[128:131], a[180:183], v[100:103], v[128:131]
    ds_read_b64_tr_b16 a[200:201], v15 offset:8
    v_mfma_f32_16x16x32_bf16 v[128:131], a[176:179], v[96:99], v[128:131]
    ds_read_b64_tr_b16 a[202:203], v15 offset:4104
    s_waitcnt lgkmcnt(6)
    v_mfma_f32_16x16x32_bf16 v[132:135], a[184:187], v[96:99], v[132:135]
    ds_read_b64_tr_b16 a[204:205], v15 offset:8200
    v_mfma_f32_16x16x32_bf16 v[132:135], a[188:191], v[100:103], v[132:135]
    buffer_load_dwordx4 v38, s[20:23], s35 offen offset:1024 sc1 lds
    v_mfma_f32_16x16x32_bf16 v[116:119], a[188:191], v[92:95], v[116:119]
    ds_read_b64_tr_b16 a[206:207], v15 offset:12296
    v_mfma_f32_16x16x32_bf16 v[116:119], a[184:187], v[88:91], v[116:119]
    ds_read_b128 v[104:107], v9 offset:2048
    s_waitcnt lgkmcnt(5)
    v_mfma_f32_16x16x32_bf16 v[120:123], a[192:195], v[88:91], v[120:123]
    ds_read_b128 v[108:111], v9 offset:20480
    v_mfma_f32_16x16x32_bf16 v[120:123], a[196:199], v[92:95], v[120:123]
    ds_read_b128 v[64:67], v9 offset:3072
    v_mfma_f32_16x16x32_bf16 v[136:139], a[196:199], v[100:103], v[136:139]
    buffer_load_dwordx4 v38, s[20:23], s35 offen offset:2048 sc1 lds
    v_mfma_f32_16x16x32_bf16 v[136:139], a[192:195], v[96:99], v[136:139]
    ds_read_b128 v[68:71], v9 offset:21504
    s_waitcnt lgkmcnt(4)
    v_mfma_f32_16x16x32_bf16 v[140:143], a[200:203], v[96:99], v[140:143]
    ds_read_b128 v[72:75], v9 offset:4096
    v_mfma_f32_16x16x32_bf16 v[140:143], a[204:207], v[100:103], v[140:143]
    ds_read_b128 v[76:79], v9 offset:22528
    v_mfma_f32_16x16x32_bf16 v[124:127], a[204:207], v[92:95], v[124:127]
    ds_read_b128 v[80:83], v9 offset:5120
    s_waitcnt lgkmcnt(3)
    v_mfma_f32_16x16x32_bf16 v[124:127], a[200:203], v[88:91], v[124:127]
    buffer_load_dwordx4 v38, s[20:23], s35 offen offset:3072 sc1 lds
    v_mfma_f32_16x16x32_bf16 v[144:147], a[176:179], v[104:107], v[144:147]
    s_add_u32 m0, s44, 4096
    s_add_u32 s35, s85, 1220608
    v_mfma_f32_16x16x32_bf16 v[144:147], a[180:183], v[108:111], v[144:147]
    ds_read_b128 v[84:87], v9 offset:23552
    v_mfma_f32_16x16x32_bf16 v[160:163], a[180:183], v[68:71], v[160:163]
    v_mfma_f32_16x16x32_bf16 v[160:163], a[176:179], v[64:67], v[160:163]
    v_mfma_f32_16x16x32_bf16 v[164:167], a[184:187], v[64:67], v[164:167]
    buffer_load_dwordx4 v38, s[20:23], s35 offen offset:0 sc1 lds
    v_mfma_f32_16x16x32_bf16 v[164:167], a[188:191], v[68:71], v[164:167]
    v_mfma_f32_16x16x32_bf16 v[148:151], a[188:191], v[108:111], v[148:151]
    v_mfma_f32_16x16x32_bf16 v[148:151], a[184:187], v[104:107], v[148:151]
    v_mfma_f32_16x16x32_bf16 v[152:155], a[192:195], v[104:107], v[152:155]
    v_mfma_f32_16x16x32_bf16 v[152:155], a[196:199], v[108:111], v[152:155]
    buffer_load_dwordx4 v38, s[20:23], s35 offen offset:1024 sc1 lds
    v_mfma_f32_16x16x32_bf16 v[168:171], a[196:199], v[68:71], v[168:171]
    v_mfma_f32_16x16x32_bf16 v[168:171], a[192:195], v[64:67], v[168:171]
    v_mfma_f32_16x16x32_bf16 v[172:175], a[200:203], v[64:67], v[172:175]
    ds_read_b128 v[88:91], v9 offset:6144
    v_mfma_f32_16x16x32_bf16 v[172:175], a[204:207], v[68:71], v[172:175]
    ds_read_b128 v[92:95], v9 offset:24576
    v_mfma_f32_16x16x32_bf16 v[156:159], a[204:207], v[108:111], v[156:159]
    buffer_load_dwordx4 v38, s[20:23], s35 offen offset:2048 sc1 lds
    v_mfma_f32_16x16x32_bf16 v[156:159], a[200:203], v[104:107], v[156:159]
    s_waitcnt lgkmcnt(2)
    v_mfma_f32_16x16x32_bf16 v[176:179], a[176:179], v[72:75], v[176:179]
    v_mfma_f32_16x16x32_bf16 v[176:179], a[180:183], v[76:79], v[176:179]
    v_mfma_f32_16x16x32_bf16 v[192:195], a[180:183], v[84:87], v[192:195]
    v_mfma_f32_16x16x32_bf16 v[192:195], a[176:179], v[80:83], v[192:195]
    buffer_load_dwordx4 v38, s[20:23], s35 offen offset:3072 sc1 lds
    v_mfma_f32_16x16x32_bf16 v[196:199], a[184:187], v[80:83], v[196:199]
    s_add_u32 m0, s44, 8192
    s_add_u32 s35, s85, 1224704
    v_mfma_f32_16x16x32_bf16 v[196:199], a[188:191], v[84:87], v[196:199]
    ds_read_b128 v[96:99], v9 offset:7168
    v_mfma_f32_16x16x32_bf16 v[180:183], a[188:191], v[76:79], v[180:183]
    ds_read_b128 v[100:103], v9 offset:25600
    v_mfma_f32_16x16x32_bf16 v[180:183], a[184:187], v[72:75], v[180:183]
    ds_read_b128 v[104:107], v9 offset:8192
    v_mfma_f32_16x16x32_bf16 v[184:187], a[192:195], v[72:75], v[184:187]
    buffer_load_dwordx4 v38, s[20:23], s35 offen offset:0 sc1 lds
    v_mfma_f32_16x16x32_bf16 v[184:187], a[196:199], v[76:79], v[184:187]
    ds_read_b128 v[108:111], v9 offset:26624
    v_mfma_f32_16x16x32_bf16 v[200:203], a[196:199], v[84:87], v[200:203]
    v_mfma_f32_16x16x32_bf16 v[200:203], a[192:195], v[80:83], v[200:203]
    v_mfma_f32_16x16x32_bf16 v[204:207], a[200:203], v[80:83], v[204:207]
    v_mfma_f32_16x16x32_bf16 v[204:207], a[204:207], v[84:87], v[204:207]
    v_mfma_f32_16x16x32_bf16 v[188:191], a[204:207], v[76:79], v[188:191]
    v_mfma_f32_16x16x32_bf16 v[188:191], a[200:203], v[72:75], v[188:191]
    s_waitcnt vmcnt(13)
    v_cmp_ne_u32 vcc, 1, v30
    s_nop 3
    s_bitcmp1_b32 vcc_lo, 2
    s_cbranch_scc1 L_spin14_2
L_back14_2:
    s_waitcnt lgkmcnt(0)
    v_mfma_f32_16x16x32_bf16 v[208:211], a[176:179], v[88:91], v[208:211]
    v_mfma_f32_16x16x32_bf16 v[208:211], a[180:183], v[92:95], v[208:211]
    s_waitcnt lgkmcnt(15)
    s_waitcnt vmcnt(63)
    v_mfma_f32_16x16x32_bf16 v[212:215], a[188:191], v[92:95], v[212:215]
    s_barrier
    v_mfma_f32_16x16x32_bf16 v[212:215], a[184:187], v[88:91], v[212:215]
    s_add_u32 m0, s29, 90112
    s_add_u32 s35, s42, 131072
    v_mfma_f32_16x16x32_bf16 v[216:219], a[192:195], v[88:91], v[216:219]
    buffer_load_dwordx4 v44, s[24:27], s35 offen offset:0 lds
    v_mfma_f32_16x16x32_bf16 v[216:219], a[196:199], v[92:95], v[216:219]
    ds_read_b64_tr_b16 a[144:145], v13 offset:0
    v_mfma_f32_16x16x32_bf16 v[220:223], a[204:207], v[92:95], v[220:223]
    ds_read_b64_tr_b16 a[146:147], v13 offset:4096
    v_mfma_f32_16x16x32_bf16 v[220:223], a[200:203], v[88:91], v[220:223]
    ds_read_b128 v[64:67], v10 offset:0
    v_mfma_f32_16x16x32_bf16 v[224:227], a[176:179], v[96:99], v[224:227]
    ds_read_b64_tr_b16 a[148:149], v13 offset:8192
    v_mfma_f32_16x16x32_bf16 v[224:227], a[180:183], v[100:103], v[224:227]
    buffer_load_dwordx4 v45, s[24:27], s35 offen offset:1024 lds
    v_mfma_f32_16x16x32_bf16 v[240:243], a[180:183], v[108:111], v[240:243]
    ds_read_b64_tr_b16 a[150:151], v13 offset:12288
    v_mfma_f32_16x16x32_bf16 v[240:243], a[176:179], v[104:107], v[240:243]
    ds_read_b128 v[68:71], v10 offset:18432
    v_mfma_f32_16x16x32_bf16 v[244:247], a[184:187], v[104:107], v[244:247]
    ds_read_b128 v[72:75], v10 offset:1024
    v_mfma_f32_16x16x32_bf16 v[244:247], a[188:191], v[108:111], v[244:247]
    ds_read_b128 v[76:79], v10 offset:19456
    v_mfma_f32_16x16x32_bf16 v[228:231], a[188:191], v[100:103], v[228:231]
    buffer_load_dwordx4 v46, s[24:27], s35 offen offset:2048 lds
    v_mfma_f32_16x16x32_bf16 v[228:231], a[184:187], v[96:99], v[228:231]
    ds_read_b64_tr_b16 a[152:153], v13 offset:8
    v_mfma_f32_16x16x32_bf16 v[232:235], a[192:195], v[96:99], v[232:235]
    ds_read_b64_tr_b16 a[154:155], v13 offset:4104
    v_mfma_f32_16x16x32_bf16 v[232:235], a[196:199], v[100:103], v[232:235]
    ds_read_b64_tr_b16 a[156:157], v13 offset:8200
    v_mfma_f32_16x16x32_bf16 v[248:251], a[196:199], v[108:111], v[248:251]
    ds_read_b64_tr_b16 a[158:159], v13 offset:12296
    v_mfma_f32_16x16x32_bf16 v[248:251], a[192:195], v[104:107], v[248:251]
    buffer_load_dwordx4 v47, s[24:27], s35 offen offset:3072 lds
    v_mfma_f32_16x16x32_bf16 v[252:255], a[200:203], v[104:107], v[252:255]
    s_add_u32 m0, s44, 53248
    s_add_u32 s35, s86, 1179648
    v_mfma_f32_16x16x32_bf16 v[252:255], a[204:207], v[108:111], v[252:255]
    ds_read_b64_tr_b16 a[160:161], v16 offset:0
    v_mfma_f32_16x16x32_bf16 v[236:239], a[204:207], v[100:103], v[236:239]
    ds_read_b64_tr_b16 a[162:163], v16 offset:4096
    v_mfma_f32_16x16x32_bf16 v[236:239], a[200:203], v[96:99], v[236:239]
    ds_read_b64_tr_b16 a[164:165], v16 offset:8192
    s_waitcnt lgkmcnt(9)
    v_mfma_f32_16x16x32_bf16 v[112:115], a[144:147], v[64:67], v[112:115]
    buffer_load_dwordx4 v38, s[20:23], s35 offen offset:0 sc1 lds
    v_mfma_f32_16x16x32_bf16 v[112:115], a[148:151], v[68:71], v[112:115]
    ds_read_b64_tr_b16 a[166:167], v16 offset:12288
    s_waitcnt lgkmcnt(8)
    v_mfma_f32_16x16x32_bf16 v[128:131], a[148:151], v[76:79], v[128:131]
    ds_read_b64_tr_b16 a[168:169], v16 offset:8
    v_mfma_f32_16x16x32_bf16 v[128:131], a[144:147], v[72:75], v[128:131]
    ds_read_b64_tr_b16 a[170:171], v16 offset:4104
    s_waitcnt lgkmcnt(6)
    v_mfma_f32_16x16x32_bf16 v[132:135], a[152:155], v[72:75], v[132:135]
    ds_read_b64_tr_b16 a[172:173], v16 offset:8200
    v_mfma_f32_16x16x32_bf16 v[132:135], a[156:159], v[76:79], v[132:135]
    buffer_load_dwordx4 v38, s[20:23], s35 offen offset:1024 sc1 lds
    v_mfma_f32_16x16x32_bf16 v[116:119], a[156:159], v[68:71], v[116:119]
    ds_read_b64_tr_b16 a[174:175], v16 offset:12296
    v_mfma_f32_16x16x32_bf16 v[116:119], a[152:155], v[64:67], v[116:119]
    ds_read_b128 v[80:83], v10 offset:2048
    s_waitcnt lgkmcnt(5)
    v_mfma_f32_16x16x32_bf16 v[120:123], a[160:163], v[64:67], v[120:123]
    ds_read_b128 v[84:87], v10 offset:20480
    v_mfma_f32_16x16x32_bf16 v[120:123], a[164:167], v[68:71], v[120:123]
    ds_read_b128 v[88:91], v10 offset:3072
    v_mfma_f32_16x16x32_bf16 v[136:139], a[164:167], v[76:79], v[136:139]
    buffer_load_dwordx4 v38, s[20:23], s35 offen offset:2048 sc1 lds
    v_mfma_f32_16x16x32_bf16 v[136:139], a[160:163], v[72:75], v[136:139]
    ds_read_b128 v[92:95], v10 offset:21504
    s_waitcnt lgkmcnt(4)
    v_mfma_f32_16x16x32_bf16 v[140:143], a[168:171], v[72:75], v[140:143]
    ds_read_b128 v[96:99], v10 offset:4096
    v_mfma_f32_16x16x32_bf16 v[140:143], a[172:175], v[76:79], v[140:143]
    ds_read_b128 v[100:103], v10 offset:22528
    v_mfma_f32_16x16x32_bf16 v[124:127], a[172:175], v[68:71], v[124:127]
    ds_read_b128 v[104:107], v10 offset:5120
    s_waitcnt lgkmcnt(3)
    v_mfma_f32_16x16x32_bf16 v[124:127], a[168:171], v[64:67], v[124:127]
    buffer_load_dwordx4 v38, s[20:23], s35 offen offset:3072 sc1 lds
    v_mfma_f32_16x16x32_bf16 v[144:147], a[144:147], v[80:83], v[144:147]
    s_add_u32 m0, s44, 57344
    s_add_u32 s35, s86, 1183744
    v_mfma_f32_16x16x32_bf16 v[144:147], a[148:151], v[84:87], v[144:147]
    ds_read_b128 v[108:111], v10 offset:23552
    v_mfma_f32_16x16x32_bf16 v[160:163], a[148:151], v[92:95], v[160:163]
    v_mfma_f32_16x16x32_bf16 v[160:163], a[144:147], v[88:91], v[160:163]
    v_mfma_f32_16x16x32_bf16 v[164:167], a[152:155], v[88:91], v[164:167]
    buffer_load_dwordx4 v38, s[20:23], s35 offen offset:0 sc1 lds
    v_mfma_f32_16x16x32_bf16 v[164:167], a[156:159], v[92:95], v[164:167]
    v_mfma_f32_16x16x32_bf16 v[148:151], a[156:159], v[84:87], v[148:151]
    v_mfma_f32_16x16x32_bf16 v[148:151], a[152:155], v[80:83], v[148:151]
    v_mfma_f32_16x16x32_bf16 v[152:155], a[160:163], v[80:83], v[152:155]
    v_mfma_f32_16x16x32_bf16 v[152:155], a[164:167], v[84:87], v[152:155]
    buffer_load_dwordx4 v38, s[20:23], s35 offen offset:1024 sc1 lds
    v_mfma_f32_16x16x32_bf16 v[168:171], a[164:167], v[92:95], v[168:171]
    v_mfma_f32_16x16x32_bf16 v[168:171], a[160:163], v[88:91], v[168:171]
    v_mfma_f32_16x16x32_bf16 v[172:175], a[168:171], v[88:91], v[172:175]
    ds_read_b128 v[64:67], v10 offset:6144
    v_mfma_f32_16x16x32_bf16 v[172:175], a[172:175], v[92:95], v[172:175]
    ds_read_b128 v[68:71], v10 offset:24576
    v_mfma_f32_16x16x32_bf16 v[156:159], a[172:175], v[84:87], v[156:159]
    buffer_load_dwordx4 v38, s[20:23], s35 offen offset:2048 sc1 lds
    v_mfma_f32_16x16x32_bf16 v[156:159], a[168:171], v[80:83], v[156:159]
    s_waitcnt lgkmcnt(2)
    v_mfma_f32_16x16x32_bf16 v[176:179], a[144:147], v[96:99], v[176:179]
    v_mfma_f32_16x16x32_bf16 v[176:179], a[148:151], v[100:103], v[176:179]
    v_mfma_f32_16x16x32_bf16 v[192:195], a[148:151], v[108:111], v[192:195]
    v_mfma_f32_16x16x32_bf16 v[192:195], a[144:147], v[104:107], v[192:195]
    buffer_load_dwordx4 v38, s[20:23], s35 offen offset:3072 sc1 lds
    v_mfma_f32_16x16x32_bf16 v[196:199], a[152:155], v[104:107], v[196:199]
    s_add_u32 m0, s44, 61440
    s_add_u32 s35, s86, 1187840
    v_mfma_f32_16x16x32_bf16 v[196:199], a[156:159], v[108:111], v[196:199]
    ds_read_b128 v[72:75], v10 offset:7168
    v_mfma_f32_16x16x32_bf16 v[180:183], a[156:159], v[100:103], v[180:183]
    ds_read_b128 v[76:79], v10 offset:25600
    v_mfma_f32_16x16x32_bf16 v[180:183], a[152:155], v[96:99], v[180:183]
    ds_read_b128 v[80:83], v10 offset:8192
    v_mfma_f32_16x16x32_bf16 v[184:187], a[160:163], v[96:99], v[184:187]
    buffer_load_dwordx4 v38, s[20:23], s35 offen offset:0 sc1 lds
    v_mfma_f32_16x16x32_bf16 v[184:187], a[164:167], v[100:103], v[184:187]
    ds_read_b128 v[84:87], v10 offset:26624
    v_mfma_f32_16x16x32_bf16 v[200:203], a[164:167], v[108:111], v[200:203]
    v_mfma_f32_16x16x32_bf16 v[200:203], a[160:163], v[104:107], v[200:203]
    v_mfma_f32_16x16x32_bf16 v[204:207], a[168:171], v[104:107], v[204:207]
    v_mfma_f32_16x16x32_bf16 v[204:207], a[172:175], v[108:111], v[204:207]
    v_mfma_f32_16x16x32_bf16 v[188:191], a[172:175], v[100:103], v[188:191]
    buffer_load_dword v30, v32, s[96:99], s91 offen sc1
    v_mfma_f32_16x16x32_bf16 v[188:191], a[168:171], v[96:99], v[188:191]
    s_waitcnt lgkmcnt(0)
    v_mfma_f32_16x16x32_bf16 v[208:211], a[144:147], v[64:67], v[208:211]
    v_mfma_f32_16x16x32_bf16 v[208:211], a[148:151], v[68:71], v[208:211]
    s_waitcnt lgkmcnt(15)
    s_waitcnt vmcnt(14)
    v_mfma_f32_16x16x32_bf16 v[212:215], a[156:159], v[68:71], v[212:215]
    s_barrier
    v_mfma_f32_16x16x32_bf16 v[212:215], a[152:155], v[64:67], v[212:215]
    s_add_u32 m0, s29, 143360
    s_add_u32 s35, s42, 196608
    v_mfma_f32_16x16x32_bf16 v[216:219], a[160:163], v[64:67], v[216:219]
    buffer_load_dwordx4 v44, s[24:27], s35 offen offset:0 lds
    v_mfma_f32_16x16x32_bf16 v[216:219], a[164:167], v[68:71], v[216:219]
    ds_read_b64_tr_b16 a[176:177], v11 offset:0
    v_mfma_f32_16x16x32_bf16 v[220:223], a[172:175], v[68:71], v[220:223]
    ds_read_b64_tr_b16 a[178:179], v11 offset:4096
    v_mfma_f32_16x16x32_bf16 v[220:223], a[168:171], v[64:67], v[220:223]
    ds_read_b128 v[88:91], v8 offset:0
    v_mfma_f32_16x16x32_bf16 v[224:227], a[144:147], v[72:75], v[224:227]
    ds_read_b64_tr_b16 a[180:181], v11 offset:8192
    v_mfma_f32_16x16x32_bf16 v[224:227], a[148:151], v[76:79], v[224:227]
    buffer_load_dwordx4 v45, s[24:27], s35 offen offset:1024 lds
    v_mfma_f32_16x16x32_bf16 v[240:243], a[148:151], v[84:87], v[240:243]
    ds_read_b64_tr_b16 a[182:183], v11 offset:12288
    v_mfma_f32_16x16x32_bf16 v[240:243], a[144:147], v[80:83], v[240:243]
    ds_read_b128 v[92:95], v8 offset:18432
    v_mfma_f32_16x16x32_bf16 v[244:247], a[152:155], v[80:83], v[244:247]
    ds_read_b128 v[96:99], v8 offset:1024
    v_mfma_f32_16x16x32_bf16 v[244:247], a[156:159], v[84:87], v[244:247]
    ds_read_b128 v[100:103], v8 offset:19456
    v_mfma_f32_16x16x32_bf16 v[228:231], a[156:159], v[76:79], v[228:231]
    buffer_load_dwordx4 v46, s[24:27], s35 offen offset:2048 lds
    v_mfma_f32_16x16x32_bf16 v[228:231], a[152:155], v[72:75], v[228:231]
    ds_read_b64_tr_b16 a[184:185], v11 offset:8
    v_mfma_f32_16x16x32_bf16 v[232:235], a[160:163], v[72:75], v[232:235]
    ds_read_b64_tr_b16 a[186:187], v11 offset:4104
    v_mfma_f32_16x16x32_bf16 v[232:235], a[164:167], v[76:79], v[232:235]
    ds_read_b64_tr_b16 a[188:189], v11 offset:8200
    v_mfma_f32_16x16x32_bf16 v[248:251], a[164:167], v[84:87], v[248:251]
    ds_read_b64_tr_b16 a[190:191], v11 offset:12296
    v_mfma_f32_16x16x32_bf16 v[248:251], a[160:163], v[80:83], v[248:251]
    buffer_load_dwordx4 v47, s[24:27], s35 offen offset:3072 lds
    v_mfma_f32_16x16x32_bf16 v[252:255], a[168:171], v[80:83], v[252:255]
    s_add_u32 m0, s44, 106496
    s_add_u32 s35, s86, 1216512
    v_mfma_f32_16x16x32_bf16 v[252:255], a[172:175], v[84:87], v[252:255]
    ds_read_b64_tr_b16 a[192:193], v14 offset:0
    v_mfma_f32_16x16x32_bf16 v[236:239], a[172:175], v[76:79], v[236:239]
    ds_read_b64_tr_b16 a[194:195], v14 offset:4096
    v_mfma_f32_16x16x32_bf16 v[236:239], a[168:171], v[72:75], v[236:239]
    ds_read_b64_tr_b16 a[196:197], v14 offset:8192
    s_waitcnt lgkmcnt(9)
    v_mfma_f32_16x16x32_bf16 v[112:115], a[176:179], v[88:91], v[112:115]
    buffer_load_dwordx4 v38, s[20:23], s35 offen offset:0 sc1 lds
    v_mfma_f32_16x16x32_bf16 v[112:115], a[180:183], v[92:95], v[112:115]
    ds_read_b64_tr_b16 a[198:199], v14 offset:12288
    s_waitcnt lgkmcnt(8)
    v_mfma_f32_16x16x32_bf16 v[128:131], a[180:183], v[100:103], v[128:131]
    ds_read_b64_tr_b16 a[200:201], v14 offset:8
    v_mfma_f32_16x16x32_bf16 v[128:131], a[176:179], v[96:99], v[128:131]
    ds_read_b64_tr_b16 a[202:203], v14 offset:4104
    s_waitcnt lgkmcnt(6)
    v_mfma_f32_16x16x32_bf16 v[132:135], a[184:187], v[96:99], v[132:135]
    ds_read_b64_tr_b16 a[204:205], v14 offset:8200
    v_mfma_f32_16x16x32_bf16 v[132:135], a[188:191], v[100:103], v[132:135]
    buffer_load_dwordx4 v38, s[20:23], s35 offen offset:1024 sc1 lds
    v_mfma_f32_16x16x32_bf16 v[116:119], a[188:191], v[92:95], v[116:119]
    ds_read_b64_tr_b16 a[206:207], v14 offset:12296
    v_mfma_f32_16x16x32_bf16 v[116:119], a[184:187], v[88:91], v[116:119]
    ds_read_b128 v[104:107], v8 offset:2048
    s_waitcnt lgkmcnt(5)
    v_mfma_f32_16x16x32_bf16 v[120:123], a[192:195], v[88:91], v[120:123]
    ds_read_b128 v[108:111], v8 offset:20480
    v_mfma_f32_16x16x32_bf16 v[120:123], a[196:199], v[92:95], v[120:123]
    ds_read_b128 v[64:67], v8 offset:3072
    v_mfma_f32_16x16x32_bf16 v[136:139], a[196:199], v[100:103], v[136:139]
    buffer_load_dwordx4 v38, s[20:23], s35 offen offset:2048 sc1 lds
    v_mfma_f32_16x16x32_bf16 v[136:139], a[192:195], v[96:99], v[136:139]
    ds_read_b128 v[68:71], v8 offset:21504
    s_waitcnt lgkmcnt(4)
    v_mfma_f32_16x16x32_bf16 v[140:143], a[200:203], v[96:99], v[140:143]
    ds_read_b128 v[72:75], v8 offset:4096
    v_mfma_f32_16x16x32_bf16 v[140:143], a[204:207], v[100:103], v[140:143]
    ds_read_b128 v[76:79], v8 offset:22528
    v_mfma_f32_16x16x32_bf16 v[124:127], a[204:207], v[92:95], v[124:127]
    ds_read_b128 v[80:83], v8 offset:5120
    s_waitcnt lgkmcnt(3)
    v_mfma_f32_16x16x32_bf16 v[124:127], a[200:203], v[88:91], v[124:127]
    buffer_load_dwordx4 v38, s[20:23], s35 offen offset:3072 sc1 lds
    v_mfma_f32_16x16x32_bf16 v[144:147], a[176:179], v[104:107], v[144:147]
    s_add_u32 m0, s44, 110592
    s_add_u32 s35, s86, 1220608
    v_mfma_f32_16x16x32_bf16 v[144:147], a[180:183], v[108:111], v[144:147]
    ds_read_b128 v[84:87], v8 offset:23552
    v_mfma_f32_16x16x32_bf16 v[160:163], a[180:183], v[68:71], v[160:163]
    v_mfma_f32_16x16x32_bf16 v[160:163], a[176:179], v[64:67], v[160:163]
    v_mfma_f32_16x16x32_bf16 v[164:167], a[184:187], v[64:67], v[164:167]
    buffer_load_dwordx4 v38, s[20:23], s35 offen offset:0 sc1 lds
    v_mfma_f32_16x16x32_bf16 v[164:167], a[188:191], v[68:71], v[164:167]
    v_mfma_f32_16x16x32_bf16 v[148:151], a[188:191], v[108:111], v[148:151]
    v_mfma_f32_16x16x32_bf16 v[148:151], a[184:187], v[104:107], v[148:151]
    v_mfma_f32_16x16x32_bf16 v[152:155], a[192:195], v[104:107], v[152:155]
    v_mfma_f32_16x16x32_bf16 v[152:155], a[196:199], v[108:111], v[152:155]
    buffer_load_dwordx4 v38, s[20:23], s35 offen offset:1024 sc1 lds
    v_mfma_f32_16x16x32_bf16 v[168:171], a[196:199], v[68:71], v[168:171]
    v_mfma_f32_16x16x32_bf16 v[168:171], a[192:195], v[64:67], v[168:171]
    v_mfma_f32_16x16x32_bf16 v[172:175], a[200:203], v[64:67], v[172:175]
    ds_read_b128 v[88:91], v8 offset:6144
    v_mfma_f32_16x16x32_bf16 v[172:175], a[204:207], v[68:71], v[172:175]
    ds_read_b128 v[92:95], v8 offset:24576
    v_mfma_f32_16x16x32_bf16 v[156:159], a[204:207], v[108:111], v[156:159]
    buffer_load_dwordx4 v38, s[20:23], s35 offen offset:2048 sc1 lds
    v_mfma_f32_16x16x32_bf16 v[156:159], a[200:203], v[104:107], v[156:159]
    s_waitcnt lgkmcnt(2)
    v_mfma_f32_16x16x32_bf16 v[176:179], a[176:179], v[72:75], v[176:179]
    v_mfma_f32_16x16x32_bf16 v[176:179], a[180:183], v[76:79], v[176:179]
    v_mfma_f32_16x16x32_bf16 v[192:195], a[180:183], v[84:87], v[192:195]
    v_mfma_f32_16x16x32_bf16 v[192:195], a[176:179], v[80:83], v[192:195]
    buffer_load_dwordx4 v38, s[20:23], s35 offen offset:3072 sc1 lds
    v_mfma_f32_16x16x32_bf16 v[196:199], a[184:187], v[80:83], v[196:199]
    s_add_u32 m0, s44, 114688
    s_add_u32 s35, s86, 1224704
    v_mfma_f32_16x16x32_bf16 v[196:199], a[188:191], v[84:87], v[196:199]
    ds_read_b128 v[96:99], v8 offset:7168
    v_mfma_f32_16x16x32_bf16 v[180:183], a[188:191], v[76:79], v[180:183]
    ds_read_b128 v[100:103], v8 offset:25600
    v_mfma_f32_16x16x32_bf16 v[180:183], a[184:187], v[72:75], v[180:183]
    ds_read_b128 v[104:107], v8 offset:8192
    v_mfma_f32_16x16x32_bf16 v[184:187], a[192:195], v[72:75], v[184:187]
    buffer_load_dwordx4 v38, s[20:23], s35 offen offset:0 sc1 lds
    v_mfma_f32_16x16x32_bf16 v[184:187], a[196:199], v[76:79], v[184:187]
    ds_read_b128 v[108:111], v8 offset:26624
    v_mfma_f32_16x16x32_bf16 v[200:203], a[196:199], v[84:87], v[200:203]
    v_mfma_f32_16x16x32_bf16 v[200:203], a[192:195], v[80:83], v[200:203]
    v_mfma_f32_16x16x32_bf16 v[204:207], a[200:203], v[80:83], v[204:207]
    v_mfma_f32_16x16x32_bf16 v[204:207], a[204:207], v[84:87], v[204:207]
    v_mfma_f32_16x16x32_bf16 v[188:191], a[204:207], v[76:79], v[188:191]
    v_mfma_f32_16x16x32_bf16 v[188:191], a[200:203], v[72:75], v[188:191]
    s_waitcnt vmcnt(13)
    v_cmp_ne_u32 vcc, 1, v30
    s_nop 3
    s_bitcmp1_b32 vcc_lo, 3
    s_cbranch_scc1 L_spin14_3
L_back14_3:
    s_waitcnt lgkmcnt(0)
    v_mfma_f32_16x16x32_bf16 v[208:211], a[176:179], v[88:91], v[208:211]
    v_mfma_f32_16x16x32_bf16 v[208:211], a[180:183], v[92:95], v[208:211]
    s_waitcnt lgkmcnt(15)
    s_waitcnt vmcnt(63)
    v_mfma_f32_16x16x32_bf16 v[212:215], a[188:191], v[92:95], v[212:215]
    s_barrier
    v_mfma_f32_16x16x32_bf16 v[212:215], a[184:187], v[88:91], v[212:215]
    s_add_u32 m0, s29, 36864
    s_add_u32 s35, s43, 131072
    v_mfma_f32_16x16x32_bf16 v[216:219], a[192:195], v[88:91], v[216:219]
    buffer_load_dwordx4 v44, s[24:27], s35 offen offset:0 lds
    v_mfma_f32_16x16x32_bf16 v[216:219], a[196:199], v[92:95], v[216:219]
    ds_read_b64_tr_b16 a[144:145], v12 offset:0
    v_mfma_f32_16x16x32_bf16 v[220:223], a[204:207], v[92:95], v[220:223]
    ds_read_b64_tr_b16 a[146:147], v12 offset:4096
    v_mfma_f32_16x16x32_bf16 v[220:223], a[200:203], v[88:91], v[220:223]
    ds_read_b128 v[64:67], v9 offset:0
    v_mfma_f32_16x16x32_bf16 v[224:227], a[176:179], v[96:99], v[224:227]
    ds_read_b64_tr_b16 a[148:149], v12 offset:8192
    v_mfma_f32_16x16x32_bf16 v[224:227], a[180:183], v[100:103], v[224:227]
    buffer_load_dwordx4 v45, s[24:27], s35 offen offset:1024 lds
    v_mfma_f32_16x16x32_bf16 v[240:243], a[180:183], v[108:111], v[240:243]
    ds_read_b64_tr_b16 a[150:151], v12 offset:12288
    v_mfma_f32_16x16x32_bf16 v[240:243], a[176:179], v[104:107], v[240:243]
    ds_read_b128 v[68:71], v9 offset:18432
    v_mfma_f32_16x16x32_bf16 v[244:247], a[184:187], v[104:107], v[244:247]
    ds_read_b128 v[72:75], v9 offset:1024
    v_mfma_f32_16x16x32_bf16 v[244:247], a[188:191], v[108:111], v[244:247]
    ds_read_b128 v[76:79], v9 offset:19456
    v_mfma_f32_16x16x32_bf16 v[228:231], a[188:191], v[100:103], v[228:231]
    buffer_load_dwordx4 v46, s[24:27], s35 offen offset:2048 lds
    v_mfma_f32_16x16x32_bf16 v[228:231], a[184:187], v[96:99], v[228:231]
    ds_read_b64_tr_b16 a[152:153], v12 offset:8
    v_mfma_f32_16x16x32_bf16 v[232:235], a[192:195], v[96:99], v[232:235]
    ds_read_b64_tr_b16 a[154:155], v12 offset:4104
    v_mfma_f32_16x16x32_bf16 v[232:235], a[196:199], v[100:103], v[232:235]
    ds_read_b64_tr_b16 a[156:157], v12 offset:8200
    v_mfma_f32_16x16x32_bf16 v[248:251], a[196:199], v[108:111], v[248:251]
    ds_read_b64_tr_b16 a[158:159], v12 offset:12296
    v_mfma_f32_16x16x32_bf16 v[248:251], a[192:195], v[104:107], v[248:251]
    buffer_load_dwordx4 v47, s[24:27], s35 offen offset:3072 lds
    v_mfma_f32_16x16x32_bf16 v[252:255], a[200:203], v[104:107], v[252:255]
    s_add_u32 m0, s44, 0
    s_add_u32 s35, s87, 1179648
    v_mfma_f32_16x16x32_bf16 v[252:255], a[204:207], v[108:111], v[252:255]
    ds_read_b64_tr_b16 a[160:161], v15 offset:0
    v_mfma_f32_16x16x32_bf16 v[236:239], a[204:207], v[100:103], v[236:239]
    ds_read_b64_tr_b16 a[162:163], v15 offset:4096
    v_mfma_f32_16x16x32_bf16 v[236:239], a[200:203], v[96:99], v[236:239]
    ds_read_b64_tr_b16 a[164:165], v15 offset:8192
    s_waitcnt lgkmcnt(9)
    v_mfma_f32_16x16x32_bf16 v[112:115], a[144:147], v[64:67], v[112:115]
    buffer_load_dwordx4 v38, s[20:23], s35 offen offset:0 sc1 lds
    v_mfma_f32_16x16x32_bf16 v[112:115], a[148:151], v[68:71], v[112:115]
    ds_read_b64_tr_b16 a[166:167], v15 offset:12288
    s_waitcnt lgkmcnt(8)
    v_mfma_f32_16x16x32_bf16 v[128:131], a[148:151], v[76:79], v[128:131]
    ds_read_b64_tr_b16 a[168:169], v15 offset:8
    v_mfma_f32_16x16x32_bf16 v[128:131], a[144:147], v[72:75], v[128:131]
    ds_read_b64_tr_b16 a[170:171], v15 offset:4104
    s_waitcnt lgkmcnt(6)
    v_mfma_f32_16x16x32_bf16 v[132:135], a[152:155], v[72:75], v[132:135]
    ds_read_b64_tr_b16 a[172:173], v15 offset:8200
    v_mfma_f32_16x16x32_bf16 v[132:135], a[156:159], v[76:79], v[132:135]
    buffer_load_dwordx4 v38, s[20:23], s35 offen offset:1024 sc1 lds
    v_mfma_f32_16x16x32_bf16 v[116:119], a[156:159], v[68:71], v[116:119]
    ds_read_b64_tr_b16 a[174:175], v15 offset:12296
    v_mfma_f32_16x16x32_bf16 v[116:119], a[152:155], v[64:67], v[116:119]
    ds_read_b128 v[80:83], v9 offset:2048
    s_waitcnt lgkmcnt(5)
    v_mfma_f32_16x16x32_bf16 v[120:123], a[160:163], v[64:67], v[120:123]
    ds_read_b128 v[84:87], v9 offset:20480
    v_mfma_f32_16x16x32_bf16 v[120:123], a[164:167], v[68:71], v[120:123]
    ds_read_b128 v[88:91], v9 offset:3072
    v_mfma_f32_16x16x32_bf16 v[136:139], a[164:167], v[76:79], v[136:139]
    buffer_load_dwordx4 v38, s[20:23], s35 offen offset:2048 sc1 lds
    v_mfma_f32_16x16x32_bf16 v[136:139], a[160:163], v[72:75], v[136:139]
    ds_read_b128 v[92:95], v9 offset:21504
    s_waitcnt lgkmcnt(4)
    v_mfma_f32_16x16x32_bf16 v[140:143], a[168:171], v[72:75], v[140:143]
    ds_read_b128 v[96:99], v9 offset:4096
    v_mfma_f32_16x16x32_bf16 v[140:143], a[172:175], v[76:79], v[140:143]
    ds_read_b128 v[100:103], v9 offset:22528
    v_mfma_f32_16x16x32_bf16 v[124:127], a[172:175], v[68:71], v[124:127]
    ds_read_b128 v[104:107], v9 offset:5120
    s_waitcnt lgkmcnt(3)
    v_mfma_f32_16x16x32_bf16 v[124:127], a[168:171], v[64:67], v[124:127]
    buffer_load_dwordx4 v38, s[20:23], s35 offen offset:3072 sc1 lds
    v_mfma_f32_16x16x32_bf16 v[144:147], a[144:147], v[80:83], v[144:147]
    s_add_u32 m0, s44, 4096
    s_add_u32 s35, s87, 1183744
    v_mfma_f32_16x16x32_bf16 v[144:147], a[148:151], v[84:87], v[144:147]
    ds_read_b128 v[108:111], v9 offset:23552
    v_mfma_f32_16x16x32_bf16 v[160:163], a[148:151], v[92:95], v[160:163]
    v_mfma_f32_16x16x32_bf16 v[160:163], a[144:147], v[88:91], v[160:163]
    v_mfma_f32_16x16x32_bf16 v[164:167], a[152:155], v[88:91], v[164:167]
    buffer_load_dwordx4 v38, s[20:23], s35 offen offset:0 sc1 lds
    v_mfma_f32_16x16x32_bf16 v[164:167], a[156:159], v[92:95], v[164:167]
    v_mfma_f32_16x16x32_bf16 v[148:151], a[156:159], v[84:87], v[148:151]
    v_mfma_f32_16x16x32_bf16 v[148:151], a[152:155], v[80:83], v[148:151]
    v_mfma_f32_16x16x32_bf16 v[152:155], a[160:163], v[80:83], v[152:155]
    v_mfma_f32_16x16x32_bf16 v[152:155], a[164:167], v[84:87], v[152:155]
    buffer_load_dwordx4 v38, s[20:23], s35 offen offset:1024 sc1 lds
    v_mfma_f32_16x16x32_bf16 v[168:171], a[164:167], v[92:95], v[168:171]
    v_mfma_f32_16x16x32_bf16 v[168:171], a[160:163], v[88:91], v[168:171]
    v_mfma_f32_16x16x32_bf16 v[172:175], a[168:171], v[88:91], v[172:175]
    ds_read_b128 v[64:67], v9 offset:6144
    v_mfma_f32_16x16x32_bf16 v[172:175], a[172:175], v[92:95], v[172:175]
    ds_read_b128 v[68:71], v9 offset:24576
    v_mfma_f32_16x16x32_bf16 v[156:159], a[172:175], v[84:87], v[156:159]
    buffer_load_dwordx4 v38, s[20:23], s35 offen offset:2048 sc1 lds
    v_mfma_f32_16x16x32_bf16 v[156:159], a[168:171], v[80:83], v[156:159]
    s_waitcnt lgkmcnt(2)
    v_mfma_f32_16x16x32_bf16 v[176:179], a[144:147], v[96:99], v[176:179]
    v_mfma_f32_16x16x32_bf16 v[176:179], a[148:151], v[100:103], v[176:179]
    v_mfma_f32_16x16x32_bf16 v[192:195], a[148:151], v[108:111], v[192:195]
    v_mfma_f32_16x16x32_bf16 v[192:195], a[144:147], v[104:107], v[192:195]
    buffer_load_dwordx4 v38, s[20:23], s35 offen offset:3072 sc1 lds
    v_mfma_f32_16x16x32_bf16 v[196:199], a[152:155], v[104:107], v[196:199]
    s_add_u32 m0, s44, 8192
    s_add_u32 s35, s87, 1187840
    v_mfma_f32_16x16x32_bf16 v[196:199], a[156:159], v[108:111], v[196:199]
    ds_read_b128 v[72:75], v9 offset:7168
    v_mfma_f32_16x16x32_bf16 v[180:183], a[156:159], v[100:103], v[180:183]
    ds_read_b128 v[76:79], v9 offset:25600
    v_mfma_f32_16x16x32_bf16 v[180:183], a[152:155], v[96:99], v[180:183]
    ds_read_b128 v[80:83], v9 offset:8192
    v_mfma_f32_16x16x32_bf16 v[184:187], a[160:163], v[96:99], v[184:187]
    buffer_load_dwordx4 v38, s[20:23], s35 offen offset:0 sc1 lds
    v_mfma_f32_16x16x32_bf16 v[184:187], a[164:167], v[100:103], v[184:187]
    ds_read_b128 v[84:87], v9 offset:26624
    v_mfma_f32_16x16x32_bf16 v[200:203], a[164:167], v[108:111], v[200:203]
    v_mfma_f32_16x16x32_bf16 v[200:203], a[160:163], v[104:107], v[200:203]
    v_mfma_f32_16x16x32_bf16 v[204:207], a[168:171], v[104:107], v[204:207]
    v_mfma_f32_16x16x32_bf16 v[204:207], a[172:175], v[108:111], v[204:207]
    v_mfma_f32_16x16x32_bf16 v[188:191], a[172:175], v[100:103], v[188:191]
    v_mfma_f32_16x16x32_bf16 v[188:191], a[168:171], v[96:99], v[188:191]
    s_waitcnt lgkmcnt(0)
    v_mfma_f32_16x16x32_bf16 v[208:211], a[144:147], v[64:67], v[208:211]
    v_mfma_f32_16x16x32_bf16 v[208:211], a[148:151], v[68:71], v[208:211]
    s_waitcnt lgkmcnt(15)
    s_waitcnt vmcnt(13)
    v_mfma_f32_16x16x32_bf16 v[212:215], a[156:159], v[68:71], v[212:215]
    s_barrier
    v_mfma_f32_16x16x32_bf16 v[212:215], a[152:155], v[64:67], v[212:215]
    s_add_u32 m0, s29, 90112
    s_add_u32 s35, s43, 196608
    v_mfma_f32_16x16x32_bf16 v[216:219], a[160:163], v[64:67], v[216:219]
    buffer_load_dwordx4 v44, s[24:27], s35 offen offset:0 lds
    v_mfma_f32_16x16x32_bf16 v[216:219], a[164:167], v[68:71], v[216:219]
    ds_read_b64_tr_b16 a[176:177], v13 offset:0
    v_mfma_f32_16x16x32_bf16 v[220:223], a[172:175], v[68:71], v[220:223]
    ds_read_b64_tr_b16 a[178:179], v13 offset:4096
    v_mfma_f32_16x16x32_bf16 v[220:223], a[168:171], v[64:67], v[220:223]
    ds_read_b128 v[88:91], v10 offset:0
    v_mfma_f32_16x16x32_bf16 v[224:227], a[144:147], v[72:75], v[224:227]
    ds_read_b64_tr_b16 a[180:181], v13 offset:8192
    v_mfma_f32_16x16x32_bf16 v[224:227], a[148:151], v[76:79], v[224:227]
    buffer_load_dwordx4 v45, s[24:27], s35 offen offset:1024 lds
    v_mfma_f32_16x16x32_bf16 v[240:243], a[148:151], v[84:87], v[240:243]
    ds_read_b64_tr_b16 a[182:183], v13 offset:12288
    v_mfma_f32_16x16x32_bf16 v[240:243], a[144:147], v[80:83], v[240:243]
    ds_read_b128 v[92:95], v10 offset:18432
    v_mfma_f32_16x16x32_bf16 v[244:247], a[152:155], v[80:83], v[244:247]
    ds_read_b128 v[96:99], v10 offset:1024
    v_mfma_f32_16x16x32_bf16 v[244:247], a[156:159], v[84:87], v[244:247]
    ds_read_b128 v[100:103], v10 offset:19456
    v_mfma_f32_16x16x32_bf16 v[228:231], a[156:159], v[76:79], v[228:231]
    buffer_load_dwordx4 v46, s[24:27], s35 offen offset:2048 lds
    v_mfma_f32_16x16x32_bf16 v[228:231], a[152:155], v[72:75], v[228:231]
    ds_read_b64_tr_b16 a[184:185], v13 offset:8
    v_mfma_f32_16x16x32_bf16 v[232:235], a[160:163], v[72:75], v[232:235]
    ds_read_b64_tr_b16 a[186:187], v13 offset:4104
    v_mfma_f32_16x16x32_bf16 v[232:235], a[164:167], v[76:79], v[232:235]
    ds_read_b64_tr_b16 a[188:189], v13 offset:8200
    v_mfma_f32_16x16x32_bf16 v[248:251], a[164:167], v[84:87], v[248:251]
    ds_read_b64_tr_b16 a[190:191], v13 offset:12296
    v_mfma_f32_16x16x32_bf16 v[248:251], a[160:163], v[80:83], v[248:251]
    buffer_load_dwordx4 v47, s[24:27], s35 offen offset:3072 lds
    v_mfma_f32_16x16x32_bf16 v[252:255], a[168:171], v[80:83], v[252:255]
    s_add_u32 m0, s44, 53248
    s_add_u32 s35, s87, 1216512
    v_mfma_f32_16x16x32_bf16 v[252:255], a[172:175], v[84:87], v[252:255]
    ds_read_b64_tr_b16 a[192:193], v16 offset:0
    v_mfma_f32_16x16x32_bf16 v[236:239], a[172:175], v[76:79], v[236:239]
    ds_read_b64_tr_b16 a[194:195], v16 offset:4096
    v_mfma_f32_16x16x32_bf16 v[236:239], a[168:171], v[72:75], v[236:239]
    ds_read_b64_tr_b16 a[196:197], v16 offset:8192
    s_waitcnt lgkmcnt(9)
    v_mfma_f32_16x16x32_bf16 v[112:115], a[176:179], v[88:91], v[112:115]
    buffer_load_dwordx4 v38, s[20:23], s35 offen offset:0 sc1 lds
    v_mfma_f32_16x16x32_bf16 v[112:115], a[180:183], v[92:95], v[112:115]
    ds_read_b64_tr_b16 a[198:199], v16 offset:12288
    s_waitcnt lgkmcnt(8)
    v_mfma_f32_16x16x32_bf16 v[128:131], a[180:183], v[100:103], v[128:131]
    ds_read_b64_tr_b16 a[200:201], v16 offset:8
    v_mfma_f32_16x16x32_bf16 v[128:131], a[176:179], v[96:99], v[128:131]
    ds_read_b64_tr_b16 a[202:203], v16 offset:4104
    s_waitcnt lgkmcnt(6)
    v_mfma_f32_16x16x32_bf16 v[132:135], a[184:187], v[96:99], v[132:135]
    ds_read_b64_tr_b16 a[204:205], v16 offset:8200
    v_mfma_f32_16x16x32_bf16 v[132:135], a[188:191], v[100:103], v[132:135]
    buffer_load_dwordx4 v38, s[20:23], s35 offen offset:1024 sc1 lds
    v_mfma_f32_16x16x32_bf16 v[116:119], a[188:191], v[92:95], v[116:119]
    ds_read_b64_tr_b16 a[206:207], v16 offset:12296
    v_mfma_f32_16x16x32_bf16 v[116:119], a[184:187], v[88:91], v[116:119]
    ds_read_b128 v[104:107], v10 offset:2048
    s_waitcnt lgkmcnt(5)
    v_mfma_f32_16x16x32_bf16 v[120:123], a[192:195], v[88:91], v[120:123]
    ds_read_b128 v[108:111], v10 offset:20480
    v_mfma_f32_16x16x32_bf16 v[120:123], a[196:199], v[92:95], v[120:123]
    ds_read_b128 v[64:67], v10 offset:3072
    v_mfma_f32_16x16x32_bf16 v[136:139], a[196:199], v[100:103], v[136:139]
    buffer_load_dwordx4 v38, s[20:23], s35 offen offset:2048 sc1 lds
    v_mfma_f32_16x16x32_bf16 v[136:139], a[192:195], v[96:99], v[136:139]
    ds_read_b128 v[68:71], v10 offset:21504
    s_waitcnt lgkmcnt(4)
    v_mfma_f32_16x16x32_bf16 v[140:143], a[200:203], v[96:99], v[140:143]
    ds_read_b128 v[72:75], v10 offset:4096
    v_mfma_f32_16x16x32_bf16 v[140:143], a[204:207], v[100:103], v[140:143]
    ds_read_b128 v[76:79], v10 offset:22528
    v_mfma_f32_16x16x32_bf16 v[124:127], a[204:207], v[92:95], v[124:127]
    ds_read_b128 v[80:83], v10 offset:5120
    s_waitcnt lgkmcnt(3)
    v_mfma_f32_16x16x32_bf16 v[124:127], a[200:203], v[88:91], v[124:127]
    buffer_load_dwordx4 v38, s[20:23], s35 offen offset:3072 sc1 lds
    v_mfma_f32_16x16x32_bf16 v[144:147], a[176:179], v[104:107], v[144:147]
    s_add_u32 m0, s44, 57344
    s_add_u32 s35, s87, 1220608
    v_mfma_f32_16x16x32_bf16 v[144:147], a[180:183], v[108:111], v[144:147]
    ds_read_b128 v[84:87], v10 offset:23552
    v_mfma_f32_16x16x32_bf16 v[160:163], a[180:183], v[68:71], v[160:163]
    v_mfma_f32_16x16x32_bf16 v[160:163], a[176:179], v[64:67], v[160:163]
    v_mfma_f32_16x16x32_bf16 v[164:167], a[184:187], v[64:67], v[164:167]
    buffer_load_dwordx4 v38, s[20:23], s35 offen offset:0 sc1 lds
    v_mfma_f32_16x16x32_bf16 v[164:167], a[188:191], v[68:71], v[164:167]
    v_mfma_f32_16x16x32_bf16 v[148:151], a[188:191], v[108:111], v[148:151]
    v_mfma_f32_16x16x32_bf16 v[148:151], a[184:187], v[104:107], v[148:151]
    v_mfma_f32_16x16x32_bf16 v[152:155], a[192:195], v[104:107], v[152:155]
    v_mfma_f32_16x16x32_bf16 v[152:155], a[196:199], v[108:111], v[152:155]
    buffer_load_dwordx4 v38, s[20:23], s35 offen offset:1024 sc1 lds
    v_mfma_f32_16x16x32_bf16 v[168:171], a[196:199], v[68:71], v[168:171]
    v_mfma_f32_16x16x32_bf16 v[168:171], a[192:195], v[64:67], v[168:171]
    v_mfma_f32_16x16x32_bf16 v[172:175], a[200:203], v[64:67], v[172:175]
    ds_read_b128 v[88:91], v10 offset:6144
    v_mfma_f32_16x16x32_bf16 v[172:175], a[204:207], v[68:71], v[172:175]
    ds_read_b128 v[92:95], v10 offset:24576
    v_mfma_f32_16x16x32_bf16 v[156:159], a[204:207], v[108:111], v[156:159]
    buffer_load_dwordx4 v38, s[20:23], s35 offen offset:2048 sc1 lds
    v_mfma_f32_16x16x32_bf16 v[156:159], a[200:203], v[104:107], v[156:159]
    s_waitcnt lgkmcnt(2)
    v_mfma_f32_16x16x32_bf16 v[176:179], a[176:179], v[72:75], v[176:179]
    v_mfma_f32_16x16x32_bf16 v[176:179], a[180:183], v[76:79], v[176:179]
    v_mfma_f32_16x16x32_bf16 v[192:195], a[180:183], v[84:87], v[192:195]
    v_mfma_f32_16x16x32_bf16 v[192:195], a[176:179], v[80:83], v[192:195]
    buffer_load_dwordx4 v38, s[20:23], s35 offen offset:3072 sc1 lds
    v_mfma_f32_16x16x32_bf16 v[196:199], a[184:187], v[80:83], v[196:199]
    s_add_u32 m0, s44, 61440
    s_add_u32 s35, s87, 1224704
    v_mfma_f32_16x16x32_bf16 v[196:199], a[188:191], v[84:87], v[196:199]
    ds_read_b128 v[96:99], v10 offset:7168
    v_mfma_f32_16x16x32_bf16 v[180:183], a[188:191], v[76:79], v[180:183]
    ds_read_b128 v[100:103], v10 offset:25600
    v_mfma_f32_16x16x32_bf16 v[180:183], a[184:187], v[72:75], v[180:183]
    ds_read_b128 v[104:107], v10 offset:8192
    v_mfma_f32_16x16x32_bf16 v[184:187], a[192:195], v[72:75], v[184:187]
    buffer_load_dwordx4 v38, s[20:23], s35 offen offset:0 sc1 lds
    v_mfma_f32_16x16x32_bf16 v[184:187], a[196:199], v[76:79], v[184:187]
    ds_read_b128 v[108:111], v10 offset:26624
    v_mfma_f32_16x16x32_bf16 v[200:203], a[196:199], v[84:87], v[200:203]
    v_mfma_f32_16x16x32_bf16 v[200:203], a[192:195], v[80:83], v[200:203]
    v_mfma_f32_16x16x32_bf16 v[204:207], a[200:203], v[80:83], v[204:207]
    v_mfma_f32_16x16x32_bf16 v[204:207], a[204:207], v[84:87], v[204:207]
    v_mfma_f32_16x16x32_bf16 v[188:191], a[204:207], v[76:79], v[188:191]
    v_mfma_f32_16x16x32_bf16 v[188:191], a[200:203], v[72:75], v[188:191]
    s_waitcnt lgkmcnt(0)
    v_mfma_f32_16x16x32_bf16 v[208:211], a[176:179], v[88:91], v[208:211]
    v_mfma_f32_16x16x32_bf16 v[208:211], a[180:183], v[92:95], v[208:211]
    s_waitcnt lgkmcnt(15)
    s_waitcnt vmcnt(13)
    v_mfma_f32_16x16x32_bf16 v[212:215], a[188:191], v[92:95], v[212:215]
    s_barrier
    v_mfma_f32_16x16x32_bf16 v[212:215], a[184:187], v[88:91], v[212:215]
    v_mfma_f32_16x16x32_bf16 v[216:219], a[192:195], v[88:91], v[216:219]
    v_mfma_f32_16x16x32_bf16 v[216:219], a[196:199], v[92:95], v[216:219]
    ds_read_b64_tr_b16 a[144:145], v11 offset:0
    v_mfma_f32_16x16x32_bf16 v[220:223], a[204:207], v[92:95], v[220:223]
    ds_read_b64_tr_b16 a[146:147], v11 offset:4096
    v_mfma_f32_16x16x32_bf16 v[220:223], a[200:203], v[88:91], v[220:223]
    ds_read_b128 v[64:67], v8 offset:0
    v_mfma_f32_16x16x32_bf16 v[224:227], a[176:179], v[96:99], v[224:227]
    ds_read_b64_tr_b16 a[148:149], v11 offset:8192
    v_mfma_f32_16x16x32_bf16 v[224:227], a[180:183], v[100:103], v[224:227]
    v_mfma_f32_16x16x32_bf16 v[240:243], a[180:183], v[108:111], v[240:243]
    ds_read_b64_tr_b16 a[150:151], v11 offset:12288
    v_mfma_f32_16x16x32_bf16 v[240:243], a[176:179], v[104:107], v[240:243]
    ds_read_b128 v[68:71], v8 offset:18432
    v_mfma_f32_16x16x32_bf16 v[244:247], a[184:187], v[104:107], v[244:247]
    ds_read_b128 v[72:75], v8 offset:1024
    v_mfma_f32_16x16x32_bf16 v[244:247], a[188:191], v[108:111], v[244:247]
    ds_read_b128 v[76:79], v8 offset:19456
    v_mfma_f32_16x16x32_bf16 v[228:231], a[188:191], v[100:103], v[228:231]
    v_mfma_f32_16x16x32_bf16 v[228:231], a[184:187], v[96:99], v[228:231]
    ds_read_b64_tr_b16 a[152:153], v11 offset:8
    v_mfma_f32_16x16x32_bf16 v[232:235], a[192:195], v[96:99], v[232:235]
    ds_read_b64_tr_b16 a[154:155], v11 offset:4104
    v_mfma_f32_16x16x32_bf16 v[232:235], a[196:199], v[100:103], v[232:235]
    ds_read_b64_tr_b16 a[156:157], v11 offset:8200
    v_mfma_f32_16x16x32_bf16 v[248:251], a[196:199], v[108:111], v[248:251]
    ds_read_b64_tr_b16 a[158:159], v11 offset:12296
    v_mfma_f32_16x16x32_bf16 v[248:251], a[192:195], v[104:107], v[248:251]
    v_mfma_f32_16x16x32_bf16 v[252:255], a[200:203], v[104:107], v[252:255]
    v_mfma_f32_16x16x32_bf16 v[252:255], a[204:207], v[108:111], v[252:255]
    ds_read_b64_tr_b16 a[160:161], v14 offset:0
    v_mfma_f32_16x16x32_bf16 v[236:239], a[204:207], v[100:103], v[236:239]
    ds_read_b64_tr_b16 a[162:163], v14 offset:4096
    v_mfma_f32_16x16x32_bf16 v[236:239], a[200:203], v[96:99], v[236:239]
    ds_read_b64_tr_b16 a[164:165], v14 offset:8192
    s_waitcnt lgkmcnt(9)
    v_mfma_f32_16x16x32_bf16 v[112:115], a[144:147], v[64:67], v[112:115]
    v_mfma_f32_16x16x32_bf16 v[112:115], a[148:151], v[68:71], v[112:115]
    ds_read_b64_tr_b16 a[166:167], v14 offset:12288
    s_waitcnt lgkmcnt(8)
    v_mfma_f32_16x16x32_bf16 v[128:131], a[148:151], v[76:79], v[128:131]
    ds_read_b64_tr_b16 a[168:169], v14 offset:8
    v_mfma_f32_16x16x32_bf16 v[128:131], a[144:147], v[72:75], v[128:131]
    ds_read_b64_tr_b16 a[170:171], v14 offset:4104
    s_waitcnt lgkmcnt(6)
    v_mfma_f32_16x16x32_bf16 v[132:135], a[152:155], v[72:75], v[132:135]
    ds_read_b64_tr_b16 a[172:173], v14 offset:8200
    v_mfma_f32_16x16x32_bf16 v[132:135], a[156:159], v[76:79], v[132:135]
    v_mfma_f32_16x16x32_bf16 v[116:119], a[156:159], v[68:71], v[116:119]
    ds_read_b64_tr_b16 a[174:175], v14 offset:12296
    v_mfma_f32_16x16x32_bf16 v[116:119], a[152:155], v[64:67], v[116:119]
    ds_read_b128 v[80:83], v8 offset:2048
    s_waitcnt lgkmcnt(5)
    v_mfma_f32_16x16x32_bf16 v[120:123], a[160:163], v[64:67], v[120:123]
    ds_read_b128 v[84:87], v8 offset:20480
    v_mfma_f32_16x16x32_bf16 v[120:123], a[164:167], v[68:71], v[120:123]
    ds_read_b128 v[88:91], v8 offset:3072
    v_mfma_f32_16x16x32_bf16 v[136:139], a[164:167], v[76:79], v[136:139]
    v_mfma_f32_16x16x32_bf16 v[136:139], a[160:163], v[72:75], v[136:139]
    ds_read_b128 v[92:95], v8 offset:21504
    s_waitcnt lgkmcnt(4)
    v_mfma_f32_16x16x32_bf16 v[140:143], a[168:171], v[72:75], v[140:143]
    ds_read_b128 v[96:99], v8 offset:4096
    v_mfma_f32_16x16x32_bf16 v[140:143], a[172:175], v[76:79], v[140:143]
    ds_read_b128 v[100:103], v8 offset:22528
    v_mfma_f32_16x16x32_bf16 v[124:127], a[172:175], v[68:71], v[124:127]
    ds_read_b128 v[104:107], v8 offset:5120
    s_waitcnt lgkmcnt(3)
    v_mfma_f32_16x16x32_bf16 v[124:127], a[168:171], v[64:67], v[124:127]
    v_mfma_f32_16x16x32_bf16 v[144:147], a[144:147], v[80:83], v[144:147]
    v_mfma_f32_16x16x32_bf16 v[144:147], a[148:151], v[84:87], v[144:147]
    ds_read_b128 v[108:111], v8 offset:23552
    v_mfma_f32_16x16x32_bf16 v[160:163], a[148:151], v[92:95], v[160:163]
    v_mfma_f32_16x16x32_bf16 v[160:163], a[144:147], v[88:91], v[160:163]
    v_mfma_f32_16x16x32_bf16 v[164:167], a[152:155], v[88:91], v[164:167]
    v_mfma_f32_16x16x32_bf16 v[164:167], a[156:159], v[92:95], v[164:167]
    v_mfma_f32_16x16x32_bf16 v[148:151], a[156:159], v[84:87], v[148:151]
    v_mfma_f32_16x16x32_bf16 v[148:151], a[152:155], v[80:83], v[148:151]
    v_mfma_f32_16x16x32_bf16 v[152:155], a[160:163], v[80:83], v[152:155]
    v_mfma_f32_16x16x32_bf16 v[152:155], a[164:167], v[84:87], v[152:155]
    v_mfma_f32_16x16x32_bf16 v[168:171], a[164:167], v[92:95], v[168:171]
    v_mfma_f32_16x16x32_bf16 v[168:171], a[160:163], v[88:91], v[168:171]
    v_mfma_f32_16x16x32_bf16 v[172:175], a[168:171], v[88:91], v[172:175]
    ds_read_b128 v[64:67], v8 offset:6144
    v_mfma_f32_16x16x32_bf16 v[172:175], a[172:175], v[92:95], v[172:175]
    ds_read_b128 v[68:71], v8 offset:24576
    v_mfma_f32_16x16x32_bf16 v[156:159], a[172:175], v[84:87], v[156:159]
    v_mfma_f32_16x16x32_bf16 v[156:159], a[168:171], v[80:83], v[156:159]
    s_waitcnt lgkmcnt(2)
    v_mfma_f32_16x16x32_bf16 v[176:179], a[144:147], v[96:99], v[176:179]
    v_mfma_f32_16x16x32_bf16 v[176:179], a[148:151], v[100:103], v[176:179]
    v_mfma_f32_16x16x32_bf16 v[192:195], a[148:151], v[108:111], v[192:195]
    v_mfma_f32_16x16x32_bf16 v[192:195], a[144:147], v[104:107], v[192:195]
    v_mfma_f32_16x16x32_bf16 v[196:199], a[152:155], v[104:107], v[196:199]
    v_mfma_f32_16x16x32_bf16 v[196:199], a[156:159], v[108:111], v[196:199]
    ds_read_b128 v[72:75], v8 offset:7168
    v_mfma_f32_16x16x32_bf16 v[180:183], a[156:159], v[100:103], v[180:183]
    ds_read_b128 v[76:79], v8 offset:25600
    v_mfma_f32_16x16x32_bf16 v[180:183], a[152:155], v[96:99], v[180:183]
    ds_read_b128 v[80:83], v8 offset:8192
    v_mfma_f32_16x16x32_bf16 v[184:187], a[160:163], v[96:99], v[184:187]
    v_mfma_f32_16x16x32_bf16 v[184:187], a[164:167], v[100:103], v[184:187]
    ds_read_b128 v[84:87], v8 offset:26624
    v_mfma_f32_16x16x32_bf16 v[200:203], a[164:167], v[108:111], v[200:203]
    v_mfma_f32_16x16x32_bf16 v[200:203], a[160:163], v[104:107], v[200:203]
    v_mfma_f32_16x16x32_bf16 v[204:207], a[168:171], v[104:107], v[204:207]
    v_mfma_f32_16x16x32_bf16 v[204:207], a[172:175], v[108:111], v[204:207]
    v_mfma_f32_16x16x32_bf16 v[188:191], a[172:175], v[100:103], v[188:191]
    v_mfma_f32_16x16x32_bf16 v[188:191], a[168:171], v[96:99], v[188:191]
    s_waitcnt lgkmcnt(0)
    v_mfma_f32_16x16x32_bf16 v[208:211], a[144:147], v[64:67], v[208:211]
    v_mfma_f32_16x16x32_bf16 v[208:211], a[148:151], v[68:71], v[208:211]
    s_waitcnt lgkmcnt(15)
    s_waitcnt vmcnt(0)
    v_mfma_f32_16x16x32_bf16 v[212:215], a[156:159], v[68:71], v[212:215]
    s_barrier
    v_mfma_f32_16x16x32_bf16 v[212:215], a[152:155], v[64:67], v[212:215]
    v_mfma_f32_16x16x32_bf16 v[216:219], a[160:163], v[64:67], v[216:219]
    v_mfma_f32_16x16x32_bf16 v[216:219], a[164:167], v[68:71], v[216:219]
    ds_read_b64_tr_b16 a[176:177], v12 offset:0
    v_mfma_f32_16x16x32_bf16 v[220:223], a[172:175], v[68:71], v[220:223]
    ds_read_b64_tr_b16 a[178:179], v12 offset:4096
    v_mfma_f32_16x16x32_bf16 v[220:223], a[168:171], v[64:67], v[220:223]
    ds_read_b128 v[88:91], v9 offset:0
    v_mfma_f32_16x16x32_bf16 v[224:227], a[144:147], v[72:75], v[224:227]
    ds_read_b64_tr_b16 a[180:181], v12 offset:8192
    v_mfma_f32_16x16x32_bf16 v[224:227], a[148:151], v[76:79], v[224:227]
    v_mfma_f32_16x16x32_bf16 v[240:243], a[148:151], v[84:87], v[240:243]
    ds_read_b64_tr_b16 a[182:183], v12 offset:12288
    v_mfma_f32_16x16x32_bf16 v[240:243], a[144:147], v[80:83], v[240:243]
    ds_read_b128 v[92:95], v9 offset:18432
    v_mfma_f32_16x16x32_bf16 v[244:247], a[152:155], v[80:83], v[244:247]
    ds_read_b128 v[96:99], v9 offset:1024
    v_mfma_f32_16x16x32_bf16 v[244:247], a[156:159], v[84:87], v[244:247]
    ds_read_b128 v[100:103], v9 offset:19456
    v_mfma_f32_16x16x32_bf16 v[228:231], a[156:159], v[76:79], v[228:231]
    v_mfma_f32_16x16x32_bf16 v[228:231], a[152:155], v[72:75], v[228:231]
    ds_read_b64_tr_b16 a[184:185], v12 offset:8
    v_mfma_f32_16x16x32_bf16 v[232:235], a[160:163], v[72:75], v[232:235]
    ds_read_b64_tr_b16 a[186:187], v12 offset:4104
    v_mfma_f32_16x16x32_bf16 v[232:235], a[164:167], v[76:79], v[232:235]
    ds_read_b64_tr_b16 a[188:189], v12 offset:8200
    v_mfma_f32_16x16x32_bf16 v[248:251], a[164:167], v[84:87], v[248:251]
    ds_read_b64_tr_b16 a[190:191], v12 offset:12296
    v_mfma_f32_16x16x32_bf16 v[248:251], a[160:163], v[80:83], v[248:251]
    v_mfma_f32_16x16x32_bf16 v[252:255], a[168:171], v[80:83], v[252:255]
    v_mfma_f32_16x16x32_bf16 v[252:255], a[172:175], v[84:87], v[252:255]
    ds_read_b64_tr_b16 a[192:193], v15 offset:0
    v_mfma_f32_16x16x32_bf16 v[236:239], a[172:175], v[76:79], v[236:239]
    ds_read_b64_tr_b16 a[194:195], v15 offset:4096
    v_mfma_f32_16x16x32_bf16 v[236:239], a[168:171], v[72:75], v[236:239]
    ds_read_b64_tr_b16 a[196:197], v15 offset:8192
    s_waitcnt lgkmcnt(9)
    v_mfma_f32_16x16x32_bf16 v[112:115], a[176:179], v[88:91], v[112:115]
    v_mfma_f32_16x16x32_bf16 v[112:115], a[180:183], v[92:95], v[112:115]
    ds_read_b64_tr_b16 a[198:199], v15 offset:12288
    s_waitcnt lgkmcnt(8)
    v_mfma_f32_16x16x32_bf16 v[128:131], a[180:183], v[100:103], v[128:131]
    ds_read_b64_tr_b16 a[200:201], v15 offset:8
    v_mfma_f32_16x16x32_bf16 v[128:131], a[176:179], v[96:99], v[128:131]
    ds_read_b64_tr_b16 a[202:203], v15 offset:4104
    s_waitcnt lgkmcnt(6)
    v_mfma_f32_16x16x32_bf16 v[132:135], a[184:187], v[96:99], v[132:135]
    ds_read_b64_tr_b16 a[204:205], v15 offset:8200
    v_mfma_f32_16x16x32_bf16 v[132:135], a[188:191], v[100:103], v[132:135]
    v_mfma_f32_16x16x32_bf16 v[116:119], a[188:191], v[92:95], v[116:119]
    ds_read_b64_tr_b16 a[206:207], v15 offset:12296
    v_mfma_f32_16x16x32_bf16 v[116:119], a[184:187], v[88:91], v[116:119]
    ds_read_b128 v[104:107], v9 offset:2048
    s_waitcnt lgkmcnt(5)
    v_mfma_f32_16x16x32_bf16 v[120:123], a[192:195], v[88:91], v[120:123]
    ds_read_b128 v[108:111], v9 offset:20480
    v_mfma_f32_16x16x32_bf16 v[120:123], a[196:199], v[92:95], v[120:123]
    ds_read_b128 v[64:67], v9 offset:3072
    v_mfma_f32_16x16x32_bf16 v[136:139], a[196:199], v[100:103], v[136:139]
    v_mfma_f32_16x16x32_bf16 v[136:139], a[192:195], v[96:99], v[136:139]
    ds_read_b128 v[68:71], v9 offset:21504
    s_waitcnt lgkmcnt(4)
    v_mfma_f32_16x16x32_bf16 v[140:143], a[200:203], v[96:99], v[140:143]
    ds_read_b128 v[72:75], v9 offset:4096
    v_cvt_pk_bf16_f32 v112, v112, v113
    v_mfma_f32_16x16x32_bf16 v[140:143], a[204:207], v[100:103], v[140:143]
    ds_read_b128 v[76:79], v9 offset:22528
    v_cvt_pk_bf16_f32 v113, v114, v115
    v_mfma_f32_16x16x32_bf16 v[124:127], a[204:207], v[92:95], v[124:127]
    ds_read_b128 v[80:83], v9 offset:5120
    s_waitcnt lgkmcnt(3)
    v_mfma_f32_16x16x32_bf16 v[124:127], a[200:203], v[88:91], v[124:127]
    v_cvt_pk_bf16_f32 v114, v116, v117
    v_cvt_pk_bf16_f32 v115, v118, v119
    v_mfma_f32_16x16x32_bf16 v[144:147], a[176:179], v[104:107], v[144:147]
    buffer_store_dwordx4 v[112:115], v38, s[12:15], s45 offen offset:0 sc1
    v_mfma_f32_16x16x32_bf16 v[144:147], a[180:183], v[108:111], v[144:147]
    ds_read_b128 v[84:87], v9 offset:23552
    v_cvt_pk_bf16_f32 v128, v128, v129
    v_mfma_f32_16x16x32_bf16 v[160:163], a[180:183], v[68:71], v[160:163]
    v_cvt_pk_bf16_f32 v129, v130, v131
    v_cvt_pk_bf16_f32 v130, v132, v133
    v_mfma_f32_16x16x32_bf16 v[160:163], a[176:179], v[64:67], v[160:163]
    v_cvt_pk_bf16_f32 v131, v134, v135
    v_mfma_f32_16x16x32_bf16 v[164:167], a[184:187], v[64:67], v[164:167]
    buffer_store_dwordx4 v[128:131], v38, s[12:15], s45 offen offset:2048 sc1
    v_mfma_f32_16x16x32_bf16 v[164:167], a[188:191], v[68:71], v[164:167]
    v_cvt_pk_bf16_f32 v120, v120, v121
    v_cvt_pk_bf16_f32 v121, v122, v123
    v_mfma_f32_16x16x32_bf16 v[148:151], a[188:191], v[108:111], v[148:151]
    v_cvt_pk_bf16_f32 v122, v124, v125
    v_cvt_pk_bf16_f32 v123, v126, v127
    v_mfma_f32_16x16x32_bf16 v[148:151], a[184:187], v[104:107], v[148:151]
    buffer_store_dwordx4 v[120:123], v38, s[12:15], s45 offen offset:1024 sc1
    v_mfma_f32_16x16x32_bf16 v[152:155], a[192:195], v[104:107], v[152:155]
    v_cvt_pk_bf16_f32 v136, v136, v137
    v_cvt_pk_bf16_f32 v137, v138, v139
    v_mfma_f32_16x16x32_bf16 v[152:155], a[196:199], v[108:111], v[152:155]
    v_cvt_pk_bf16_f32 v138, v140, v141
    v_cvt_pk_bf16_f32 v139, v142, v143
    v_mfma_f32_16x16x32_bf16 v[168:171], a[196:199], v[68:71], v[168:171]
    buffer_store_dwordx4 v[136:139], v38, s[12:15], s45 offen offset:3072 sc1
    v_mfma_f32_16x16x32_bf16 v[168:171], a[192:195], v[64:67], v[168:171]
    v_mfma_f32_16x16x32_bf16 v[172:175], a[200:203], v[64:67], v[172:175]
    ds_read_b128 v[88:91], v9 offset:6144
    v_cvt_pk_bf16_f32 v144, v144, v145
    v_mfma_f32_16x16x32_bf16 v[172:175], a[204:207], v[68:71], v[172:175]
    ds_read_b128 v[92:95], v9 offset:24576
    v_cvt_pk_bf16_f32 v145, v146, v147
    v_mfma_f32_16x16x32_bf16 v[156:159], a[204:207], v[108:111], v[156:159]
    v_cvt_pk_bf16_f32 v146, v148, v149
    v_cvt_pk_bf16_f32 v147, v150, v151
    v_mfma_f32_16x16x32_bf16 v[156:159], a[200:203], v[104:107], v[156:159]
    s_waitcnt lgkmcnt(2)
    v_mfma_f32_16x16x32_bf16 v[176:179], a[176:179], v[72:75], v[176:179]
    buffer_store_dwordx4 v[144:147], v38, s[12:15], s46 offen offset:0 sc1
    v_mfma_f32_16x16x32_bf16 v[176:179], a[180:183], v[76:79], v[176:179]
    v_cvt_pk_bf16_f32 v160, v160, v161
    v_cvt_pk_bf16_f32 v161, v162, v163
    v_mfma_f32_16x16x32_bf16 v[192:195], a[180:183], v[84:87], v[192:195]
    v_cvt_pk_bf16_f32 v162, v164, v165
    v_cvt_pk_bf16_f32 v163, v166, v167
    v_mfma_f32_16x16x32_bf16 v[192:195], a[176:179], v[80:83], v[192:195]
    buffer_store_dwordx4 v[160:163], v38, s[12:15], s46 offen offset:2048 sc1
    v_mfma_f32_16x16x32_bf16 v[196:199], a[184:187], v[80:83], v[196:199]
    v_cvt_pk_bf16_f32 v152, v152, v153
    v_cvt_pk_bf16_f32 v153, v154, v155
    v_mfma_f32_16x16x32_bf16 v[196:199], a[188:191], v[84:87], v[196:199]
    ds_read_b128 v[96:99], v9 offset:7168
    v_cvt_pk_bf16_f32 v154, v156, v157
    v_mfma_f32_16x16x32_bf16 v[180:183], a[188:191], v[76:79], v[180:183]
    ds_read_b128 v[100:103], v9 offset:25600
    v_cvt_pk_bf16_f32 v155, v158, v159
    v_mfma_f32_16x16x32_bf16 v[180:183], a[184:187], v[72:75], v[180:183]
    ds_read_b128 v[104:107], v9 offset:8192
    v_mfma_f32_16x16x32_bf16 v[184:187], a[192:195], v[72:75], v[184:187]
    buffer_store_dwordx4 v[152:155], v38, s[12:15], s46 offen offset:1024 sc1
    v_mfma_f32_16x16x32_bf16 v[184:187], a[196:199], v[76:79], v[184:187]
    ds_read_b128 v[108:111], v9 offset:26624
    v_cvt_pk_bf16_f32 v168, v168, v169
    v_mfma_f32_16x16x32_bf16 v[200:203], a[196:199], v[84:87], v[200:203]
    v_cvt_pk_bf16_f32 v169, v170, v171
    v_cvt_pk_bf16_f32 v170, v172, v173
    v_mfma_f32_16x16x32_bf16 v[200:203], a[192:195], v[80:83], v[200:203]
    v_cvt_pk_bf16_f32 v171, v174, v175
    v_mfma_f32_16x16x32_bf16 v[204:207], a[200:203], v[80:83], v[204:207]
    buffer_store_dwordx4 v[168:171], v38, s[12:15], s46 offen offset:3072 sc1
    v_mfma_f32_16x16x32_bf16 v[204:207], a[204:207], v[84:87], v[204:207]
    v_cvt_pk_bf16_f32 v176, v176, v177
    v_cvt_pk_bf16_f32 v177, v178, v179
    v_mfma_f32_16x16x32_bf16 v[188:191], a[204:207], v[76:79], v[188:191]
    v_cvt_pk_bf16_f32 v178, v180, v181
    v_cvt_pk_bf16_f32 v179, v182, v183
    v_mfma_f32_16x16x32_bf16 v[188:191], a[200:203], v[72:75], v[188:191]
    s_waitcnt lgkmcnt(0)
    v_mfma_f32_16x16x32_bf16 v[208:211], a[176:179], v[88:91], v[208:211]
    buffer_store_dwordx4 v[176:179], v38, s[12:15], s47 offen offset:0 sc1
    v_mfma_f32_16x16x32_bf16 v[208:211], a[180:183], v[92:95], v[208:211]
    v_cvt_pk_bf16_f32 v192, v192, v193
    v_cvt_pk_bf16_f32 v193, v194, v195
    v_mfma_f32_16x16x32_bf16 v[212:215], a[188:191], v[92:95], v[212:215]
    v_cvt_pk_bf16_f32 v194, v196, v197
    v_cvt_pk_bf16_f32 v195, v198, v199
    v_mfma_f32_16x16x32_bf16 v[212:215], a[184:187], v[88:91], v[212:215]
    buffer_store_dwordx4 v[192:195], v38, s[12:15], s47 offen offset:2048 sc1
    v_mfma_f32_16x16x32_bf16 v[216:219], a[192:195], v[88:91], v[216:219]
    v_cvt_pk_bf16_f32 v184, v184, v185
    v_cvt_pk_bf16_f32 v185, v186, v187
    v_mfma_f32_16x16x32_bf16 v[216:219], a[196:199], v[92:95], v[216:219]
    v_cvt_pk_bf16_f32 v186, v188, v189
    v_cvt_pk_bf16_f32 v187, v190, v191
    v_mfma_f32_16x16x32_bf16 v[220:223], a[204:207], v[92:95], v[220:223]
    buffer_store_dwordx4 v[184:187], v38, s[12:15], s47 offen offset:1024 sc1
    v_mfma_f32_16x16x32_bf16 v[220:223], a[200:203], v[88:91], v[220:223]
    v_cvt_pk_bf16_f32 v200, v200, v201
    v_cvt_pk_bf16_f32 v201, v202, v203
    v_mfma_f32_16x16x32_bf16 v[224:227], a[176:179], v[96:99], v[224:227]
    v_cvt_pk_bf16_f32 v202, v204, v205
    v_cvt_pk_bf16_f32 v203, v206, v207
    v_mfma_f32_16x16x32_bf16 v[224:227], a[180:183], v[100:103], v[224:227]
    buffer_store_dwordx4 v[200:203], v38, s[12:15], s47 offen offset:3072 sc1
    v_mfma_f32_16x16x32_bf16 v[240:243], a[180:183], v[108:111], v[240:243]
    v_cvt_pk_bf16_f32 v56, v208, v209
    v_cvt_pk_bf16_f32 v57, v210, v211
    v_mfma_f32_16x16x32_bf16 v[240:243], a[176:179], v[104:107], v[240:243]
    v_cvt_pk_bf16_f32 v58, v212, v213
    v_cvt_pk_bf16_f32 v59, v214, v215
    v_mfma_f32_16x16x32_bf16 v[244:247], a[184:187], v[104:107], v[244:247]
    buffer_store_dwordx4 v[56:59], v38, s[12:15], s59 offen offset:0 sc1
    v_mfma_f32_16x16x32_bf16 v[244:247], a[188:191], v[108:111], v[244:247]
    v_cvt_pk_bf16_f32 v60, v216, v217
    v_cvt_pk_bf16_f32 v61, v218, v219
    v_mfma_f32_16x16x32_bf16 v[228:231], a[188:191], v[100:103], v[228:231]
    v_cvt_pk_bf16_f32 v62, v220, v221
    v_cvt_pk_bf16_f32 v63, v222, v223
    v_mfma_f32_16x16x32_bf16 v[228:231], a[184:187], v[96:99], v[228:231]
    buffer_store_dwordx4 v[60:63], v38, s[12:15], s59 offen offset:1024 sc1
    v_mfma_f32_16x16x32_bf16 v[232:235], a[192:195], v[96:99], v[232:235]
    v_mfma_f32_16x16x32_bf16 v[232:235], a[196:199], v[100:103], v[232:235]
    v_mfma_f32_16x16x32_bf16 v[248:251], a[196:199], v[108:111], v[248:251]
    v_mfma_f32_16x16x32_bf16 v[248:251], a[192:195], v[104:107], v[248:251]
    v_mfma_f32_16x16x32_bf16 v[252:255], a[200:203], v[104:107], v[252:255]
    v_mfma_f32_16x16x32_bf16 v[252:255], a[204:207], v[108:111], v[252:255]
    v_mfma_f32_16x16x32_bf16 v[236:239], a[204:207], v[100:103], v[236:239]
    v_mfma_f32_16x16x32_bf16 v[236:239], a[200:203], v[96:99], v[236:239]
    s_branch L_p3done
L_spin0:
    v_mov_b32 v3, 0
L_spin0b:
    s_mov_b32 s89, 65536
L_spin0b_l:
    s_sleep 1
    buffer_load_dword v2, v3, s[92:95], 0 offen sc1
    s_waitcnt vmcnt(0)
    v_cmp_gt_u32 vcc, 16, v2
    s_nop 3
    s_cbranch_vccz L_back0
    s_sub_u32 s89, s89, 1
    s_cmp_lg_u32 s89, 0
    s_cbranch_scc1 L_spin0b_l
    s_branch L_back0
L_spin18_0:
    s_mov_b32 s89, 65536
L_spin18_0_l:
    s_sleep 1
    buffer_load_dword v30, v33, s[96:99], s91 offen sc1
    s_waitcnt vmcnt(0)
    v_cmp_ne_u32 vcc, 1, v30
    s_nop 3
    s_bitcmp1_b32 vcc_lo, 0
    s_cbranch_scc0 L_back18_0
    s_sub_u32 s89, s89, 1
    s_cmp_lg_u32 s89, 0
    s_cbranch_scc1 L_spin18_0_l
    s_branch L_back18_0
L_spin18_1:
    s_mov_b32 s89, 65536
L_spin18_1_l:
    s_sleep 1
    buffer_load_dword v30, v33, s[96:99], s91 offen sc1
    s_waitcnt vmcnt(0)
    v_cmp_ne_u32 vcc, 1, v30
    s_nop 3
    s_bitcmp1_b32 vcc_lo, 1
    s_cbranch_scc0 L_back18_1
    s_sub_u32 s89, s89, 1
    s_cmp_lg_u32 s89, 0
    s_cbranch_scc1 L_spin18_1_l
    s_branch L_back18_1
L_spin18_2:
    s_mov_b32 s89, 65536
L_spin18_2_l:
    s_sleep 1
    buffer_load_dword v30, v33, s[96:99], s91 offen sc1
    s_waitcnt vmcnt(0)
    v_cmp_ne_u32 vcc, 1, v30
    s_nop 3
    s_bitcmp1_b32 vcc_lo, 2
    s_cbranch_scc0 L_back18_2
    s_sub_u32 s89, s89, 1
    s_cmp_lg_u32 s89, 0
    s_cbranch_scc1 L_spin18_2_l
    s_branch L_back18_2
L_spin18_3:
    s_mov_b32 s89, 65536
L_spin18_3_l:
    s_sleep 1
    buffer_load_dword v30, v33, s[96:99], s91 offen sc1
    s_waitcnt vmcnt(0)
    v_cmp_ne_u32 vcc, 1, v30
    s_nop 3
    s_bitcmp1_b32 vcc_lo, 3
    s_cbranch_scc0 L_back18_3
    s_sub_u32 s89, s89, 1
    s_cmp_lg_u32 s89, 0
    s_cbranch_scc1 L_spin18_3_l
    s_branch L_back18_3
L_spin14_1:
    s_mov_b32 s89, 65536
L_spin14_1_l:
    s_sleep 1
    buffer_load_dword v30, v32, s[96:99], s91 offen sc1
    s_waitcnt vmcnt(0)
    v_cmp_ne_u32 vcc, 1, v30
    s_nop 3
    s_bitcmp1_b32 vcc_lo, 1
    s_cbranch_scc0 L_back14_1
    s_sub_u32 s89, s89, 1
    s_cmp_lg_u32 s89, 0
    s_cbranch_scc1 L_spin14_1_l
    s_branch L_back14_1
L_spin14_2:
    s_mov_b32 s89, 65536
L_spin14_2_l:
    s_sleep 1
    buffer_load_dword v30, v32, s[96:99], s91 offen sc1
    s_waitcnt vmcnt(0)
    v_cmp_ne_u32 vcc, 1, v30
    s_nop 3
    s_bitcmp1_b32 vcc_lo, 2
    s_cbranch_scc0 L_back14_2
    s_sub_u32 s89, s89, 1
    s_cmp_lg_u32 s89, 0
    s_cbranch_scc1 L_spin14_2_l
    s_branch L_back14_2
L_spin14_3:
    s_mov_b32 s89, 65536
L_spin14_3_l:
    s_sleep 1
    buffer_load_dword v30, v32, s[96:99], s91 offen sc1
    s_waitcnt vmcnt(0)
    v_cmp_ne_u32 vcc, 1, v30
    s_nop 3
    s_bitcmp1_b32 vcc_lo, 3
    s_cbranch_scc0 L_back14_3
    s_sub_u32 s89, s89, 1
    s_cmp_lg_u32 s89, 0
    s_cbranch_scc1 L_spin14_3_l
    s_branch L_back14_3
L_fallback:
    s_waitcnt vmcnt(0) lgkmcnt(0)
    s_barrier
    ds_write_b128 v39, v[200:203] offset:0
    ds_write_b128 v39, v[204:207] offset:1024
    ds_write_b128 v39, v[208:211] offset:2048
    ds_write_b128 v39, v[212:215] offset:3072
    ds_write_b128 v39, v[216:219] offset:4096
    ds_write_b128 v39, v[220:223] offset:5120
    ds_write_b128 v39, v[224:227] offset:6144
    ds_write_b128 v39, v[228:231] offset:7168
    s_waitcnt lgkmcnt(0)
    s_lshl_b32 s30, s33, 18
    s_add_u32 s30, s30, s29
    v_mov_b32 v200, 0xff800000
    v_mov_b32 v201, 0xff800000
    v_mov_b32 v202, 0xff800000
    v_mov_b32 v203, 0xff800000
    v_mov_b32 v204, 0xff800000
    s_mov_b32 s32, 16
L_fb_loop:
    s_add_u32 m0, s29, 0
    s_nop 0
    buffer_load_dwordx4 v32, s[4:7], s30 offen offset:0 nt lds
    buffer_load_dwordx4 v33, s[4:7], s30 offen offset:1024 nt lds
    buffer_load_dwordx4 v34, s[4:7], s30 offen offset:2048 nt lds
    buffer_load_dwordx4 v35, s[4:7], s30 offen offset:3072 nt lds
    s_add_u32 s30, s30, 16384
    s_waitcnt vmcnt(0)
    s_barrier
    ds_read_b128 a[184:187], v8 offset:0
    ds_read_b128 a[188:191], v10 offset:0
    ds_read_b128 a[192:195], v12 offset:0
    ds_read_b128 a[196:199], v14 offset:0
    s_waitcnt lgkmcnt(3)
    v_mfma_f32_16x16x32_bf16 v[160:163], a[184:187], v[64:67], 0
    s_waitcnt lgkmcnt(2)
    v_mfma_f32_16x16x32_bf16 v[160:163], a[188:191], v[80:83], v[160:163]
    s_waitcnt lgkmcnt(1)
    v_mfma_f32_16x16x32_bf16 v[160:163], a[192:195], v[96:99], v[160:163]
    s_waitcnt lgkmcnt(0)
    v_mfma_f32_16x16x32_bf16 v[160:163], a[196:199], v[112:115], v[160:163]
    v_mfma_f32_16x16x32_bf16 v[164:167], a[184:187], v[68:71], 0
    v_mfma_f32_16x16x32_bf16 v[164:167], a[188:191], v[84:87], v[164:167]
    v_mfma_f32_16x16x32_bf16 v[164:167], a[192:195], v[100:103], v[164:167]
    v_mfma_f32_16x16x32_bf16 v[164:167], a[196:199], v[116:119], v[164:167]
    v_mfma_f32_16x16x32_bf16 v[168:171], a[184:187], v[72:75], 0
    v_mfma_f32_16x16x32_bf16 v[168:171], a[188:191], v[88:91], v[168:171]
    v_mfma_f32_16x16x32_bf16 v[168:171], a[192:195], v[104:107], v[168:171]
    v_mfma_f32_16x16x32_bf16 v[168:171], a[196:199], v[120:123], v[168:171]
    v_mfma_f32_16x16x32_bf16 v[172:175], a[184:187], v[76:79], 0
    v_mfma_f32_16x16x32_bf16 v[172:175], a[188:191], v[92:95], v[172:175]
    v_mfma_f32_16x16x32_bf16 v[172:175], a[192:195], v[108:111], v[172:175]
    v_mfma_f32_16x16x32_bf16 v[172:175], a[196:199], v[124:127], v[172:175]
    v_mfma_f32_16x16x32_bf16 v[176:179], a[184:187], v[128:131], 0
    v_mfma_f32_16x16x32_bf16 v[176:179], a[188:191], v[132:135], v[176:179]
    v_mfma_f32_16x16x32_bf16 v[176:179], a[192:195], v[136:139], v[176:179]
    v_mfma_f32_16x16x32_bf16 v[176:179], a[196:199], v[140:143], v[176:179]
    v_max3_f32 v200, v200, v160, v161
    v_max3_f32 v200, v200, v162, v163
    v_max3_f32 v201, v201, v164, v165
    v_max3_f32 v201, v201, v166, v167
    v_max3_f32 v202, v202, v168, v169
    v_max3_f32 v202, v202, v170, v171
    v_max3_f32 v203, v203, v172, v173
    v_max3_f32 v203, v203, v174, v175
    v_max3_f32 v204, v204, v176, v177
    v_max3_f32 v204, v204, v178, v179
    ds_read_b128 a[184:187], v8 offset:4096
    ds_read_b128 a[188:191], v10 offset:4096
    ds_read_b128 a[192:195], v12 offset:4096
    ds_read_b128 a[196:199], v14 offset:4096
    s_waitcnt lgkmcnt(3)
    v_mfma_f32_16x16x32_bf16 v[160:163], a[184:187], v[64:67], 0
    s_waitcnt lgkmcnt(2)
    v_mfma_f32_16x16x32_bf16 v[160:163], a[188:191], v[80:83], v[160:163]
    s_waitcnt lgkmcnt(1)
    v_mfma_f32_16x16x32_bf16 v[160:163], a[192:195], v[96:99], v[160:163]
    s_waitcnt lgkmcnt(0)
    v_mfma_f32_16x16x32_bf16 v[160:163], a[196:199], v[112:115], v[160:163]
    v_mfma_f32_16x16x32_bf16 v[164:167], a[184:187], v[68:71], 0
    v_mfma_f32_16x16x32_bf16 v[164:167], a[188:191], v[84:87], v[164:167]
    v_mfma_f32_16x16x32_bf16 v[164:167], a[192:195], v[100:103], v[164:167]
    v_mfma_f32_16x16x32_bf16 v[164:167], a[196:199], v[116:119], v[164:167]
    v_mfma_f32_16x16x32_bf16 v[168:171], a[184:187], v[72:75], 0
    v_mfma_f32_16x16x32_bf16 v[168:171], a[188:191], v[88:91], v[168:171]
    v_mfma_f32_16x16x32_bf16 v[168:171], a[192:195], v[104:107], v[168:171]
    v_mfma_f32_16x16x32_bf16 v[168:171], a[196:199], v[120:123], v[168:171]
    v_mfma_f32_16x16x32_bf16 v[172:175], a[184:187], v[76:79], 0
    v_mfma_f32_16x16x32_bf16 v[172:175], a[188:191], v[92:95], v[172:175]
    v_mfma_f32_16x16x32_bf16 v[172:175], a[192:195], v[108:111], v[172:175]
    v_mfma_f32_16x16x32_bf16 v[172:175], a[196:199], v[124:127], v[172:175]
    v_mfma_f32_16x16x32_bf16 v[176:179], a[184:187], v[128:131], 0
    v_mfma_f32_16x16x32_bf16 v[176:179], a[188:191], v[132:135], v[176:179]
    v_mfma_f32_16x16x32_bf16 v[176:179], a[192:195], v[136:139], v[176:179]
    v_mfma_f32_16x16x32_bf16 v[176:179], a[196:199], v[140:143], v[176:179]
    v_max3_f32 v200, v200, v160, v161
    v_max3_f32 v200, v200, v162, v163
    v_max3_f32 v201, v201, v164, v165
    v_max3_f32 v201, v201, v166, v167
    v_max3_f32 v202, v202, v168, v169
    v_max3_f32 v202, v202, v170, v171
    v_max3_f32 v203, v203, v172, v173
    v_max3_f32 v203, v203, v174, v175
    v_max3_f32 v204, v204, v176, v177
    v_max3_f32 v204, v204, v178, v179
    ds_read_b128 a[184:187], v9 offset:0
    ds_read_b128 a[188:191], v11 offset:0
    ds_read_b128 a[192:195], v13 offset:0
    ds_read_b128 a[196:199], v15 offset:0
    s_waitcnt lgkmcnt(3)
    v_mfma_f32_16x16x32_bf16 v[160:163], a[184:187], v[64:67], 0
    s_waitcnt lgkmcnt(2)
    v_mfma_f32_16x16x32_bf16 v[160:163], a[188:191], v[80:83], v[160:163]
    s_waitcnt lgkmcnt(1)
    v_mfma_f32_16x16x32_bf16 v[160:163], a[192:195], v[96:99], v[160:163]
    s_waitcnt lgkmcnt(0)
    v_mfma_f32_16x16x32_bf16 v[160:163], a[196:199], v[112:115], v[160:163]
    v_mfma_f32_16x16x32_bf16 v[164:167], a[184:187], v[68:71], 0
    v_mfma_f32_16x16x32_bf16 v[164:167], a[188:191], v[84:87], v[164:167]
    v_mfma_f32_16x16x32_bf16 v[164:167], a[192:195], v[100:103], v[164:167]
    v_mfma_f32_16x16x32_bf16 v[164:167], a[196:199], v[116:119], v[164:167]
    v_mfma_f32_16x16x32_bf16 v[168:171], a[184:187], v[72:75], 0
    v_mfma_f32_16x16x32_bf16 v[168:171], a[188:191], v[88:91], v[168:171]
    v_mfma_f32_16x16x32_bf16 v[168:171], a[192:195], v[104:107], v[168:171]
    v_mfma_f32_16x16x32_bf16 v[168:171], a[196:199], v[120:123], v[168:171]
    v_mfma_f32_16x16x32_bf16 v[172:175], a[184:187], v[76:79], 0
    v_mfma_f32_16x16x32_bf16 v[172:175], a[188:191], v[92:95], v[172:175]
    v_mfma_f32_16x16x32_bf16 v[172:175], a[192:195], v[108:111], v[172:175]
    v_mfma_f32_16x16x32_bf16 v[172:175], a[196:199], v[124:127], v[172:175]
    v_mfma_f32_16x16x32_bf16 v[176:179], a[184:187], v[128:131], 0
    v_mfma_f32_16x16x32_bf16 v[176:179], a[188:191], v[132:135], v[176:179]
    v_mfma_f32_16x16x32_bf16 v[176:179], a[192:195], v[136:139], v[176:179]
    v_mfma_f32_16x16x32_bf16 v[176:179], a[196:199], v[140:143], v[176:179]
    v_max3_f32 v200, v200, v160, v161
    v_max3_f32 v200, v200, v162, v163
    v_max3_f32 v201, v201, v164, v165
    v_max3_f32 v201, v201, v166, v167
    v_max3_f32 v202, v202, v168, v169
    v_max3_f32 v202, v202, v170, v171
    v_max3_f32 v203, v203, v172, v173
    v_max3_f32 v203, v203, v174, v175
    v_max3_f32 v204, v204, v176, v177
    v_max3_f32 v204, v204, v178, v179
    ds_read_b128 a[184:187], v9 offset:4096
    ds_read_b128 a[188:191], v11 offset:4096
    ds_read_b128 a[192:195], v13 offset:4096
    ds_read_b128 a[196:199], v15 offset:4096
    s_waitcnt lgkmcnt(3)
    v_mfma_f32_16x16x32_bf16 v[160:163], a[184:187], v[64:67], 0
    s_waitcnt lgkmcnt(2)
    v_mfma_f32_16x16x32_bf16 v[160:163], a[188:191], v[80:83], v[160:163]
    s_waitcnt lgkmcnt(1)
    v_mfma_f32_16x16x32_bf16 v[160:163], a[192:195], v[96:99], v[160:163]
    s_waitcnt lgkmcnt(0)
    v_mfma_f32_16x16x32_bf16 v[160:163], a[196:199], v[112:115], v[160:163]
    v_mfma_f32_16x16x32_bf16 v[164:167], a[184:187], v[68:71], 0
    v_mfma_f32_16x16x32_bf16 v[164:167], a[188:191], v[84:87], v[164:167]
    v_mfma_f32_16x16x32_bf16 v[164:167], a[192:195], v[100:103], v[164:167]
    v_mfma_f32_16x16x32_bf16 v[164:167], a[196:199], v[116:119], v[164:167]
    v_mfma_f32_16x16x32_bf16 v[168:171], a[184:187], v[72:75], 0
    v_mfma_f32_16x16x32_bf16 v[168:171], a[188:191], v[88:91], v[168:171]
    v_mfma_f32_16x16x32_bf16 v[168:171], a[192:195], v[104:107], v[168:171]
    v_mfma_f32_16x16x32_bf16 v[168:171], a[196:199], v[120:123], v[168:171]
    v_mfma_f32_16x16x32_bf16 v[172:175], a[184:187], v[76:79], 0
    v_mfma_f32_16x16x32_bf16 v[172:175], a[188:191], v[92:95], v[172:175]
    v_mfma_f32_16x16x32_bf16 v[172:175], a[192:195], v[108:111], v[172:175]
    v_mfma_f32_16x16x32_bf16 v[172:175], a[196:199], v[124:127], v[172:175]
    v_mfma_f32_16x16x32_bf16 v[176:179], a[184:187], v[128:131], 0
    v_mfma_f32_16x16x32_bf16 v[176:179], a[188:191], v[132:135], v[176:179]
    v_mfma_f32_16x16x32_bf16 v[176:179], a[192:195], v[136:139], v[176:179]
    v_mfma_f32_16x16x32_bf16 v[176:179], a[196:199], v[140:143], v[176:179]
    v_max3_f32 v200, v200, v160, v161
    v_max3_f32 v200, v200, v162, v163
    v_max3_f32 v201, v201, v164, v165
    v_max3_f32 v201, v201, v166, v167
    v_max3_f32 v202, v202, v168, v169
    v_max3_f32 v202, v202, v170, v171
    v_max3_f32 v203, v203, v172, v173
    v_max3_f32 v203, v203, v174, v175
    v_max3_f32 v204, v204, v176, v177
    v_max3_f32 v204, v204, v178, v179
    s_waitcnt lgkmcnt(0)
    s_barrier
    s_sub_u32 s32, s32, 1
    s_cmp_lg_u32 s32, 0
    s_cbranch_scc1 L_fb_loop
    v_mov_b32 v7, v200
    s_nop 1
    v_permlane32_swap_b32 v200, v7
    v_max_f32 v200, v200, v7
    v_mov_b32 v7, v200
    s_nop 1
    v_permlane16_swap_b32 v200, v7
    v_max_f32 v200, v200, v7
    v_sub_f32 v44, 0, v200
    v_sub_f32 v45, 0, v200
    v_sub_f32 v46, 0, v200
    v_sub_f32 v47, 0, v200
    v_mov_b32 v7, v201
    s_nop 1
    v_permlane32_swap_b32 v201, v7
    v_max_f32 v201, v201, v7
    v_mov_b32 v7, v201
    s_nop 1
    v_permlane16_swap_b32 v201, v7
    v_max_f32 v201, v201, v7
    v_sub_f32 v48, 0, v201
    v_sub_f32 v49, 0, v201
    v_sub_f32 v50, 0, v201
    v_sub_f32 v51, 0, v201
    v_mov_b32 v7, v202
    s_nop 1
    v_permlane32_swap_b32 v202, v7
    v_max_f32 v202, v202, v7
    v_mov_b32 v7, v202
    s_nop 1
    v_permlane16_swap_b32 v202, v7
    v_max_f32 v202, v202, v7
    v_sub_f32 v52, 0, v202
    v_sub_f32 v53, 0, v202
    v_sub_f32 v54, 0, v202
    v_sub_f32 v55, 0, v202
    v_mov_b32 v7, v203
    s_nop 1
    v_permlane32_swap_b32 v203, v7
    v_max_f32 v203, v203, v7
    v_mov_b32 v7, v203
    s_nop 1
    v_permlane16_swap_b32 v203, v7
    v_max_f32 v203, v203, v7
    v_sub_f32 v56, 0, v203
    v_sub_f32 v57, 0, v203
    v_sub_f32 v58, 0, v203
    v_sub_f32 v59, 0, v203
    v_mov_b32 v7, v204
    s_nop 1
    v_permlane32_swap_b32 v204, v7
    v_max_f32 v204, v204, v7
    v_mov_b32 v7, v204
    s_nop 1
    v_permlane16_swap_b32 v204, v7
    v_max_f32 v204, v204, v7
    v_sub_f32 v60, 0, v204
    v_sub_f32 v61, 0, v204
    v_sub_f32 v62, 0, v204
    v_sub_f32 v63, 0, v204
    s_lshl_b32 s30, s33, 18
    s_add_u32 s30, s30, s29
    s_mov_b32 s31, s30
    s_add_u32 m0, s29, 0
    s_nop 0
    buffer_load_dwordx4 v32, s[4:7], s30 offen offset:0 nt lds
    buffer_load_dwordx4 v33, s[4:7], s30 offen offset:1024 nt lds
    buffer_load_dwordx4 v34, s[4:7], s30 offen offset:2048 nt lds
    buffer_load_dwordx4 v35, s[4:7], s30 offen offset:3072 nt lds
    s_add_u32 s30, s30, 16384
    s_add_u32 m0, s29, 16384
    s_nop 0
    buffer_load_dwordx4 v32, s[4:7], s30 offen offset:0 nt lds
    buffer_load_dwordx4 v33, s[4:7], s30 offen offset:1024 nt lds
    buffer_load_dwordx4 v34, s[4:7], s30 offen offset:2048 nt lds
    buffer_load_dwordx4 v35, s[4:7], s30 offen offset:3072 nt lds
    s_add_u32 s30, s30, 16384
    s_add_u32 m0, s29, 32768
    s_nop 0
    buffer_load_dwordx4 v32, s[4:7], s30 offen offset:0 nt lds
    buffer_load_dwordx4 v33, s[4:7], s30 offen offset:1024 nt lds
    buffer_load_dwordx4 v34, s[4:7], s30 offen offset:2048 nt lds
    buffer_load_dwordx4 v35, s[4:7], s30 offen offset:3072 nt lds
    s_add_u32 s30, s30, 16384
    s_add_u32 m0, s29, 49152
    s_nop 0
    buffer_load_dwordx4 v32, s[4:7], s30 offen offset:0 nt lds
    buffer_load_dwordx4 v33, s[4:7], s30 offen offset:1024 nt lds
    buffer_load_dwordx4 v34, s[4:7], s30 offen offset:2048 nt lds
    buffer_load_dwordx4 v35, s[4:7], s30 offen offset:3072 nt lds
    s_add_u32 s30, s30, 16384
    s_add_u32 m0, s29, 65536
    s_nop 0
    buffer_load_dwordx4 v36, s[8:11], s31 offen offset:0 nt lds
    buffer_load_dwordx4 v37, s[8:11], s31 offen offset:1024 nt lds
    buffer_load_dwordx4 v36, s[8:11], s31 offen offset:2048 nt lds
    buffer_load_dwordx4 v37, s[8:11], s31 offen offset:3072 nt lds
    s_add_u32 s31, s31, 16384
    s_add_u32 m0, s29, 81920
    s_nop 0
    buffer_load_dwordx4 v36, s[8:11], s31 offen offset:0 nt lds
    buffer_load_dwordx4 v37, s[8:11], s31 offen offset:1024 nt lds
    buffer_load_dwordx4 v36, s[8:11], s31 offen offset:2048 nt lds
    buffer_load_dwordx4 v37, s[8:11], s31 offen offset:3072 nt lds
    s_add_u32 s31, s31, 16384
    s_add_u32 m0, s29, 98304
    s_nop 0
    buffer_load_dwordx4 v36, s[8:11], s31 offen offset:0 nt lds
    buffer_load_dwordx4 v37, s[8:11], s31 offen offset:1024 nt lds
    buffer_load_dwordx4 v36, s[8:11], s31 offen offset:2048 nt lds
    buffer_load_dwordx4 v37, s[8:11], s31 offen offset:3072 nt lds
    s_add_u32 s31, s31, 16384
    v_mov_b32 v196, 0
    v_mov_b32 v197, 0
    v_mov_b32 v198, 0
    v_mov_b32 v199, 0
    s_nop 1
    v_mfma_f32_32x32x16_bf16 a[0:15], v[196:199], v[196:199], 0
    v_mfma_f32_32x32x16_bf16 a[16:31], v[196:199], v[196:199], 0
    v_mfma_f32_32x32x16_bf16 a[32:47], v[196:199], v[196:199], 0
    v_mfma_f32_32x32x16_bf16 a[48:63], v[196:199], v[196:199], 0
    v_mfma_f32_32x32x16_bf16 a[64:79], v[196:199], v[196:199], 0
    v_mfma_f32_32x32x16_bf16 a[80:95], v[196:199], v[196:199], 0
    v_mfma_f32_32x32x16_bf16 a[96:111], v[196:199], v[196:199], 0
    v_mfma_f32_32x32x16_bf16 a[112:127], v[196:199], v[196:199], 0
    v_mfma_f32_32x32x16_bf16 a[128:143], v[196:199], v[196:199], 0
    v_mfma_f32_32x32x16_bf16 a[144:159], v[196:199], v[196:199], 0
    v_mfma_f32_16x16x32_bf16 a[160:163], v[196:199], v[196:199], 0
    v_mfma_f32_16x16x32_bf16 a[164:167], v[196:199], v[196:199], 0
    v_mfma_f32_16x16x32_bf16 a[176:179], v[196:199], v[196:199], 0
    s_mov_b32 s34, 1
    s_waitcnt vmcnt(0)
    s_barrier
    ds_read_b128 a[184:187], v8 offset:0
    ds_read_b128 a[188:191], v10 offset:0
    ds_read_b128 a[192:195], v12 offset:0
    ds_read_b128 a[196:199], v14 offset:0
    s_waitcnt lgkmcnt(0)
    s_branch L_enter
L_last:
.section .rodata,"a"
.p2align 6
.amdhsa_kernel concat_heads__mha_block_cached__gqa_block_cached__near_ridge_kernel
  .amdhsa_next_free_vgpr 512
  .amdhsa_next_free_sgpr 102
  .amdhsa_accum_offset 256
  .amdhsa_group_segment_fixed_size 0
  .amdhsa_kernarg_size 104
  .amdhsa_user_sgpr_count 2
  .amdhsa_user_sgpr_kernarg_segment_ptr 1
  .amdhsa_system_sgpr_workgroup_id_x 1
.end_amdhsa_kernel
```
